```python
import torch

def _softmax(x, axis=-1):
    return torch.softmax(x, dim=axis)

def _gelu(x):
    return torch.nn.functional.gelu(x, approximate='tanh')

def _silu(x):
    return torch.nn.functional.silu(x)

def _sigmoid(x):
    return torch.sigmoid(x)

def _layernorm(x, axis=-1, eps=1e-05):
    m = x.mean(dim=axis, keepdim=True)
    v = x.var(dim=axis, keepdim=True, unbiased=False)
    return (x - m) / torch.sqrt(v + eps)

def _scatter_add(tgt, idx, src, axis=0):
    return tgt.clone().index_add_(axis, idx, src)

def _segment_sum(src, seg, n):
    out = torch.zeros((n,) + src.shape[1:], dtype=src.dtype)
    return out.index_add_(0, seg, src)

def _pad(x, pw):
    flat = tuple((v for pair in reversed(pw) for v in pair))
    return torch.nn.functional.pad(x, flat)
kernel_name = 'adaLN_cond__sliding_block_cached__glu_gated_bilinear__prompt'

def setup_inputs():

    _w = lambda a: (lambda t: t.to(torch.bfloat16) if t.is_floating_point() else t)(torch.as_tensor(a))

    def _A_setup():
        B, Sq, D = (1, 2048, 576)
        Hq, Hkv, Sk, Dh = (32, 16, 2048, 128)
        assert Hq % Hkv == 0, (Hq, Hkv)
        return {'x': _w((lambda *s: torch.randn(*s, dtype=torch.bfloat16) * 0.05)(B, Sq, D)), 'k_cache': _w((lambda *s: torch.randn(*s, dtype=torch.bfloat16) * 1.6)(B, Hkv, Sk, Dh)), 'v_cache': _w((lambda *s: torch.randn(*s, dtype=torch.bfloat16) * 0.8)(B, Hkv, Sk, Dh)), 'wq': _w((lambda *s: torch.randn(*s, dtype=torch.bfloat16) * 1.6)(D, Hq * Dh) * D ** (-0.5)), 'wo': _w((lambda *s: torch.randn(*s, dtype=torch.bfloat16) * 0.8)(Hq * Dh, D) * (Hq * Dh) ** (-0.5))}
    _A_in = _A_setup()

    def _B_setup():
        B, S, D, F = (1, 2048, 576, 4608)
        return {'x': _w((lambda *s: torch.randn(*s, dtype=torch.bfloat16) * 0.05)(B, S, D)), 'w_gate': _w((lambda *s: torch.randn(*s, dtype=torch.bfloat16) * 0.4)(D, F) * D ** (-0.5)), 'w_up': _w((lambda *s: torch.randn(*s, dtype=torch.bfloat16) * 0.4)(D, F) * D ** (-0.5)), 'w_down': _w((lambda *s: torch.randn(*s, dtype=torch.bfloat16) * 0.4)(F, D) * F ** (-0.5))}
    _B_in = _B_setup()
    return {'A_x': _A_in['x'], 'A_k_cache': _A_in['k_cache'], 'A_v_cache': _A_in['v_cache'], 'A_wq': _A_in['wq'], 'A_wo': _A_in['wo'], 'B_x': _B_in['x'], 'B_w_gate': _B_in['w_gate'], 'B_w_up': _B_in['w_up'], 'B_w_down': _B_in['w_down'], 'c': _w((lambda *s: torch.randn(*s, dtype=torch.bfloat16) * 0.2)(1, 576) * 8.0), 'w_mod': _w((lambda *s: torch.randn(*s, dtype=torch.bfloat16) * 0.2)(576, 6 * 576) * 576 ** (-0.5) * 8.0)}

def reference(A_x, A_k_cache, A_v_cache, A_wq, A_wo, B_x, B_w_gate, B_w_up, B_w_down, c, w_mod):

    def _A_ref(x, k_cache, v_cache, wq, wo):
        B, Sq, D = x.shape
        Hq, Dh = (32, 128)
        Hkv, Sk = (k_cache.shape[1], k_cache.shape[2])
        W = min(4096, max(256, Sk // 4))
        rep = Hq // Hkv
        q = (lambda x, *d: x.permute(*d))((x @ wq).reshape(B, Sq, Hq, Dh), 0, 2, 1, 3)
        k = (lambda x, n, axis: torch.repeat_interleave(x, n, dim=axis))(k_cache[:, :, Sk - W:, :], rep, axis=1)
        v = (lambda x, n, axis: torch.repeat_interleave(x, n, dim=axis))(v_cache[:, :, Sk - W:, :], rep, axis=1)
        scores = torch.einsum('bhqd,bhkd->bhqk', q, k) * Dh ** (-0.5)
        p = _softmax(scores, axis=-1)
        o = torch.einsum('bhqk,bhkd->bhqd', p, v)
        return (lambda x, *d: x.permute(*d))(o, 0, 2, 1, 3).reshape(B, Sq, Hq * Dh) @ wo

    def _B_ref(x, w_gate, w_up, w_down):
        g = torch.einsum('bsd,df->bsf', x, w_gate)
        u = torch.einsum('bsd,df->bsf', x, w_up)
        h = g * u
        return torch.einsum('bsf,fd->bsd', h, w_down)
    x = A_x
    mod = (_silu(c) @ w_mod).reshape(c.shape[0], 6, 1, -1)
    sa, ca, ga, sb, cb, gb = (mod[:, 0].clone(), mod[:, 1].clone(), mod[:, 2].clone(), mod[:, 3].clone(), mod[:, 4].clone(), mod[:, 5].clone())
    h = _layernorm(x, axis=-1) * (1 + ca) + sa
    x = x + ga * _A_ref(h, A_k_cache, A_v_cache, A_wq, A_wo)
    h = _layernorm(x, axis=-1) * (1 + cb) + sb
    x = x + gb * _B_ref(h, B_w_gate, B_w_up, B_w_down)
    return x
```

```asm
; @launch kernel=k0_mod_kernel grid=(216,1,1) block=(384,1,1) lds=1536
; @launch kernel=kf_main_kernel grid=(256,1,1) block=(512,1,1) lds=163840
.amdgcn_target "amdgcn-amd-amdhsa--gfx950"
.text
.globl k0_mod_kernel
.p2align 8
.type k0_mod_kernel,@function
k0_mod_kernel:
  s_cmp_ge_u32 s2, 216
  s_cbranch_scc1 k0_mod_kernel_end
  s_getpc_b64 s[64:65]
k0_mod_kernel_pc:
  s_add_u32 s64, s64, kf_main_kernel-k0_mod_kernel_pc
  s_addc_u32 s65, s65, 0
  s_load_dwordx2 s[68:69], s[0:1], 0
  s_load_dwordx2 s[72:73], s[0:1], 24
  s_load_dwordx2 s[76:77], s[0:1], 8
  s_load_dwordx2 s[80:81], s[0:1], 16
  s_load_dwordx2 s[4:5], s[0:1], 72
  s_load_dwordx2 s[6:7], s[0:1], 80
  s_load_dwordx2 s[8:9], s[0:1], 104
  s_and_b32 s3, s2, 7
  s_mul_i32 s3, s3, 27
  s_lshr_b32 s10, s2, 3
  s_add_u32 s3, s3, s10
  v_and_b32 v1, 1, v0
  v_lshrrev_b32 v2, 1, v0
  s_movk_i32 s10, 6912
  v_mul_lo_u32 v3, v2, s10
  v_lshl_add_u32 v3, v1, 4, v3
  s_lshl_b32 s11, s3, 5
  v_add_u32 v3, s11, v3
  v_lshlrev_b32 v4, 1, v2
  s_waitcnt lgkmcnt(0)
  s_mov_b32 s12, s4
  s_mov_b32 s13, s5
  s_mov_b32 s14, 0x480
  s_mov_b32 s15, 0x00020000
  s_mov_b32 s16, s6
  s_mov_b32 s17, s7
  s_mov_b32 s18, 0x3cc000
  s_mov_b32 s19, 0x00020000
  s_mov_b32 s20, s8
  s_mov_b32 s21, s9
  s_mov_b32 s22, 0x3600
  s_mov_b32 s23, 0x00020000
  buffer_load_ushort v8, v4, s[12:15], 0 offen offset:0
  buffer_load_ushort v9, v4, s[12:15], 0 offen offset:384
  buffer_load_ushort v10, v4, s[12:15], 0 offen offset:768
  s_mov_b32 s24, 0
  buffer_load_dwordx4 v[12:15], v3, s[16:19], s24 offen
  s_mov_b32 s24, 1327104
  buffer_load_dwordx4 v[16:19], v3, s[16:19], s24 offen
  s_mov_b32 s24, 2654208
  buffer_load_dwordx4 v[20:23], v3, s[16:19], s24 offen
  s_mov_b32 s28, s8
  s_mov_b32 s29, s9
  s_mov_b32 s30, 0x320000
  s_mov_b32 s31, 0x00020000
  s_lshl_b32 s24, s2, 10
  s_add_u32 s24, s24, 3145728
  v_lshlrev_b32 v6, 2, v0
  v_add_u32 v6, s24, v6
  v_mov_b32 v7, 0
  v_cmp_gt_u32 vcc, 0x100, v0
  s_nop 1
  v_cndmask_b32 v6, -1, v6, vcc
  buffer_store_dword v7, v6, s[28:31], 0 offen
  s_lshr_b32 s60, s2, 3
  s_mul_i32 s60, s60, 384
  s_and_b32 s61, s2, 7
  s_sub_u32 s62, s60, 0
  v_add_u32 v40, s62, v0
  v_lshlrev_b32 v41, 7, v40
  s_mul_i32 s63, s61, 0
  s_add_u32 s63, s63, 0
  v_add_u32 v41, s63, v41
  v_cmp_gt_u32 vcc, 768, v40
  s_nop 1
  v_cndmask_b32 v41, -1, v41, vcc
  s_mov_b32 s66, kf_main_kernel_end-kf_main_kernel
  s_mov_b32 s67, 0x00020000
  buffer_load_dword v42, v41, s[64:67], 0 offen
  s_sub_u32 s62, s60, 768
  v_add_u32 v40, s62, v0
  s_mov_b32 s63, 7282
  v_mul_lo_u32 v41, v40, s63
  v_lshrrev_b32 v41, 20, v41
  s_mov_b32 s63, 129024
  v_mul_lo_u32 v41, v41, s63
  v_lshl_add_u32 v41, v40, 7, v41
  s_mul_i32 s63, s61, 18432
  s_add_u32 s63, s63, 0
  v_add_u32 v41, s63, v41
  v_cmp_gt_u32 vcc, 2304, v40
  s_nop 1
  v_cndmask_b32 v41, -1, v41, vcc
  s_mov_b32 s70, 2359296
  s_mov_b32 s71, 0x00020000
  buffer_load_dword v43, v41, s[68:71], 0 offen
  s_sub_u32 s62, s60, 3072
  v_add_u32 v40, s62, v0
  s_mov_b32 s63, 131072
  v_mul_lo_u32 v41, v40, s63
  v_lshrrev_b32 v41, 20, v41
  s_mov_b32 s63, 7168
  v_mul_lo_u32 v41, v41, s63
  v_lshl_add_u32 v41, v40, 7, v41
  s_mul_i32 s63, s61, 1024
  s_add_u32 s63, s63, 0
  v_add_u32 v41, s63, v41
  v_cmp_gt_u32 vcc, 4608, v40
  s_nop 1
  v_cndmask_b32 v41, -1, v41, vcc
  s_mov_b32 s74, 4718592
  s_mov_b32 s75, 0x00020000
  buffer_load_dword v44, v41, s[72:75], 0 offen
  s_sub_u32 s62, s60, 7680
  v_add_u32 v40, s62, v0
  s_mov_b32 s63, 2048
  v_mul_lo_u32 v41, v40, s63
  v_lshrrev_b32 v41, 20, v41
  s_mov_b32 s63, 458752
  v_mul_lo_u32 v41, v41, s63
  v_lshl_add_u32 v41, v40, 7, v41
  s_mul_i32 s63, s61, 1048576
  s_add_u32 s63, s63, 393216
  v_add_u32 v41, s63, v41
  v_cmp_gt_u32 vcc, 1024, v40
  s_nop 1
  v_cndmask_b32 v41, -1, v41, vcc
  s_mov_b32 s78, 8388608
  s_mov_b32 s79, 0x00020000
  buffer_load_dword v45, v41, s[76:79], 0 offen
  s_sub_u32 s62, s60, 8704
  v_add_u32 v40, s62, v0
  s_mov_b32 s63, 2048
  v_mul_lo_u32 v41, v40, s63
  v_lshrrev_b32 v41, 20, v41
  s_mov_b32 s63, 458752
  v_mul_lo_u32 v41, v41, s63
  v_lshl_add_u32 v41, v40, 7, v41
  s_mul_i32 s63, s61, 1048576
  s_add_u32 s63, s63, 393216
  v_add_u32 v41, s63, v41
  v_cmp_gt_u32 vcc, 1024, v40
  s_nop 1
  v_cndmask_b32 v41, -1, v41, vcc
  s_mov_b32 s82, 8388608
  s_mov_b32 s83, 0x00020000
  buffer_load_dword v46, v41, s[80:83], 0 offen
  s_waitcnt vmcnt(11)
  v_lshlrev_b32 v8, 16, v8
  v_mul_f32 v5, 0xbfb8aa3b, v8
  v_exp_f32 v5, v5
  s_nop 0
  v_add_f32 v5, 1.0, v5
  v_rcp_f32 v5, v5
  s_nop 0
  v_mul_f32 v5, v8, v5
  v_cvt_pk_bf16_f32 v5, v5, v5
  v_and_b32 v24, 0xffff, v5
  v_and_b32 v28, 0xffff0000, v5
  s_waitcnt vmcnt(10)
  v_lshlrev_b32 v9, 16, v9
  v_mul_f32 v5, 0xbfb8aa3b, v9
  v_exp_f32 v5, v5
  s_nop 0
  v_add_f32 v5, 1.0, v5
  v_rcp_f32 v5, v5
  s_nop 0
  v_mul_f32 v5, v9, v5
  v_cvt_pk_bf16_f32 v5, v5, v5
  v_and_b32 v25, 0xffff, v5
  v_and_b32 v29, 0xffff0000, v5
  s_waitcnt vmcnt(9)
  v_lshlrev_b32 v10, 16, v10
  v_mul_f32 v5, 0xbfb8aa3b, v10
  v_exp_f32 v5, v5
  s_nop 0
  v_add_f32 v5, 1.0, v5
  v_rcp_f32 v5, v5
  s_nop 0
  v_mul_f32 v5, v10, v5
  v_cvt_pk_bf16_f32 v5, v5, v5
  v_and_b32 v26, 0xffff, v5
  v_and_b32 v30, 0xffff0000, v5
  s_waitcnt vmcnt(8)
  v_dot2_f32_bf16 v32, v12, v24, 0
  v_dot2_f32_bf16 v33, v12, v28, 0
  v_dot2_f32_bf16 v34, v13, v24, 0
  v_dot2_f32_bf16 v35, v13, v28, 0
  v_dot2_f32_bf16 v36, v14, v24, 0
  v_dot2_f32_bf16 v37, v14, v28, 0
  v_dot2_f32_bf16 v38, v15, v24, 0
  v_dot2_f32_bf16 v39, v15, v28, 0
  s_waitcnt vmcnt(7)
  v_dot2_f32_bf16 v32, v16, v25, v32
  v_dot2_f32_bf16 v33, v16, v29, v33
  v_dot2_f32_bf16 v34, v17, v25, v34
  v_dot2_f32_bf16 v35, v17, v29, v35
  v_dot2_f32_bf16 v36, v18, v25, v36
  v_dot2_f32_bf16 v37, v18, v29, v37
  v_dot2_f32_bf16 v38, v19, v25, v38
  v_dot2_f32_bf16 v39, v19, v29, v39
  s_waitcnt vmcnt(6)
  v_dot2_f32_bf16 v32, v20, v26, v32
  v_dot2_f32_bf16 v33, v20, v30, v33
  v_dot2_f32_bf16 v34, v21, v26, v34
  v_dot2_f32_bf16 v35, v21, v30, v35
  v_dot2_f32_bf16 v36, v22, v26, v36
  v_dot2_f32_bf16 v37, v22, v30, v37
  v_dot2_f32_bf16 v38, v23, v26, v38
  v_dot2_f32_bf16 v39, v23, v30, v39
  s_nop 2
  v_add_f32_dpp v32, v32, v32 quad_perm:[2,3,0,1] row_mask:0xf bank_mask:0xf
  v_add_f32_dpp v33, v33, v33 quad_perm:[2,3,0,1] row_mask:0xf bank_mask:0xf
  v_add_f32_dpp v34, v34, v34 quad_perm:[2,3,0,1] row_mask:0xf bank_mask:0xf
  v_add_f32_dpp v35, v35, v35 quad_perm:[2,3,0,1] row_mask:0xf bank_mask:0xf
  v_add_f32_dpp v36, v36, v36 quad_perm:[2,3,0,1] row_mask:0xf bank_mask:0xf
  v_add_f32_dpp v37, v37, v37 quad_perm:[2,3,0,1] row_mask:0xf bank_mask:0xf
  v_add_f32_dpp v38, v38, v38 quad_perm:[2,3,0,1] row_mask:0xf bank_mask:0xf
  v_add_f32_dpp v39, v39, v39 quad_perm:[2,3,0,1] row_mask:0xf bank_mask:0xf
  v_add_f32_dpp v32, v32, v32 row_ror:4 row_mask:0xf bank_mask:0xf
  v_add_f32_dpp v33, v33, v33 row_ror:4 row_mask:0xf bank_mask:0xf
  v_add_f32_dpp v34, v34, v34 row_ror:4 row_mask:0xf bank_mask:0xf
  v_add_f32_dpp v35, v35, v35 row_ror:4 row_mask:0xf bank_mask:0xf
  v_add_f32_dpp v36, v36, v36 row_ror:4 row_mask:0xf bank_mask:0xf
  v_add_f32_dpp v37, v37, v37 row_ror:4 row_mask:0xf bank_mask:0xf
  v_add_f32_dpp v38, v38, v38 row_ror:4 row_mask:0xf bank_mask:0xf
  v_add_f32_dpp v39, v39, v39 row_ror:4 row_mask:0xf bank_mask:0xf
  v_add_f32_dpp v32, v32, v32 row_ror:8 row_mask:0xf bank_mask:0xf
  v_add_f32_dpp v33, v33, v33 row_ror:8 row_mask:0xf bank_mask:0xf
  v_add_f32_dpp v34, v34, v34 row_ror:8 row_mask:0xf bank_mask:0xf
  v_add_f32_dpp v35, v35, v35 row_ror:8 row_mask:0xf bank_mask:0xf
  v_add_f32_dpp v36, v36, v36 row_ror:8 row_mask:0xf bank_mask:0xf
  v_add_f32_dpp v37, v37, v37 row_ror:8 row_mask:0xf bank_mask:0xf
  v_add_f32_dpp v38, v38, v38 row_ror:8 row_mask:0xf bank_mask:0xf
  v_add_f32_dpp v39, v39, v39 row_ror:8 row_mask:0xf bank_mask:0xf
  v_lshrrev_b32 v5, 4, v0
  v_lshlrev_b32 v5, 6, v5
  v_lshl_add_u32 v5, v1, 5, v5
  s_mov_b32 exec_lo, 0x00030003
  s_mov_b32 exec_hi, 0x00030003
  ds_write_b128 v5, v[32:35]
  ds_write_b128 v5, v[36:39] offset:16
  s_mov_b64 exec, -1
  s_waitcnt lgkmcnt(0)
  s_barrier
  v_readfirstlane_b32 s25, v0
  s_nop 0
  s_cmp_ge_u32 s25, 64
  s_cbranch_scc1 k0_mod_kernel_end
  v_lshlrev_b32 v5, 2, v0
  ds_read_b32 v8, v5 offset:0
  ds_read_b32 v9, v5 offset:256
  ds_read_b32 v10, v5 offset:512
  ds_read_b32 v11, v5 offset:768
  ds_read_b32 v12, v5 offset:1024
  ds_read_b32 v13, v5 offset:1280
  s_waitcnt lgkmcnt(4)
  v_add_f32 v8, v8, v9
  s_waitcnt lgkmcnt(3)
  v_add_f32 v8, v8, v10
  s_waitcnt lgkmcnt(2)
  v_add_f32 v8, v8, v11
  s_waitcnt lgkmcnt(1)
  v_add_f32 v8, v8, v12
  s_waitcnt lgkmcnt(0)
  v_add_f32 v8, v8, v13
  v_mov_b32 v9, v8
  s_nop 1
  v_permlane16_swap_b32 v9, v8
  v_add_f32 v8, v8, v9
  v_mov_b32 v9, v8
  s_nop 1
  v_permlane32_swap_b32 v9, v8
  v_add_f32 v8, v8, v9
  v_cvt_pk_bf16_f32 v8, v8, v8
  v_lshlrev_b32 v8, 16, v8
  s_mul_i32 s26, s3, 1821
  s_lshr_b32 s26, s26, 16
  s_mov_b32 s27, 0
  s_cmp_eq_u32 s26, 1
  s_cselect_b32 s27, 1.0, s27
  s_cmp_eq_u32 s26, 4
  s_cselect_b32 s27, 1.0, s27
  v_add_f32 v8, s27, v8
  v_cvt_pk_bf16_f32 v8, v8, v8
  v_lshlrev_b32 v8, 16, v8
  s_lshl_b32 s11, s3, 6
  v_add_u32 v5, s11, v5
  s_mov_b64 exec, 0xffff
  buffer_store_dword v8, v5, s[20:23], 0 offen
  s_waitcnt vmcnt(0)
k0_mod_kernel_end:
  s_waitcnt vmcnt(0)
  s_endpgm
.globl kf_main_kernel
.p2align 8
.type kf_main_kernel,@function
kf_main_kernel:
  s_cmp_ge_u32 s2, 256
  s_cbranch_scc1 kf_main_kernel_end
  s_load_dwordx2 s[60:61], s[0:1], 0
  s_load_dwordx2 s[76:77], s[0:1], 48
  s_load_dwordx2 s[80:81], s[0:1], 56
  s_load_dwordx2 s[84:85], s[0:1], 64
  s_load_dwordx2 s[4:5], s[0:1], 8
  s_load_dwordx2 s[6:7], s[0:1], 16
  s_load_dwordx2 s[8:9], s[0:1], 24
  s_load_dwordx2 s[10:11], s[0:1], 32
  s_load_dwordx2 s[48:49], s[0:1], 104
  v_and_b32 v1, 63, v0
  v_lshrrev_b32 v6, 6, v0
  v_bfe_u32 v2, v0, 2, 2
  v_and_b32 v3, 3, v0
  v_bfe_u32 v4, v0, 4, 1
  v_bfe_u32 v5, v0, 5, 1
  v_readfirstlane_b32 s3, v6
  s_and_b32 s30, s2, 7
  s_lshl_b32 s30, s30, 1
  s_bfe_u32 s31, s2, 0x10003
  s_add_u32 s30, s30, s31
  s_lshr_b32 s31, s2, 4
  s_and_b32 s32, s3, 3
  s_lshr_b32 s33, s3, 2
  s_lshl_b32 s34, s3, 10
  v_lshrrev_b32 v6, 5, v0
  v_bfe_u32 v7, v0, 2, 3
  v_and_b32 v44, 3, v6
  v_xor_b32 v7, v7, v44
  v_lshlrev_b32 v6, 13, v6
  v_lshl_add_u32 v6, v7, 6, v6
  v_lshl_add_u32 v6, v3, 4, v6
  s_lshl_b32 s40, s30, 9
  v_add_u32 v8, s40, v6
  s_lshl_b32 s40, s31, 2
  s_add_u32 s40, s40, s33
  s_mul_i32 s40, s40, 36
  s_add_u32 s40, s40, s32
  s_lshl_b32 s40, s40, 10
  s_add_u32 s40, s40, 65536
  v_lshlrev_b32 v45, 4, v1
  v_add_u32 v9, s40, v45
  s_waitcnt lgkmcnt(0)
  s_mov_b32 s12, s8
  s_mov_b32 s13, s9
  s_mov_b32 s14, 0x480000
  s_mov_b32 s15, 0x00020000
  s_mov_b32 s24, s48
  s_mov_b32 s25, s49
  s_mov_b32 s26, 0x10000000
  s_mov_b32 s27, 0x00020000
  s_mov_b32 s62, 2359296
  s_mov_b32 s63, 0x00020000
  v_and_b32 v48, 7, v0
  v_lshrrev_b32 v49, 3, v0
  s_lshl_b32 s64, s31, 4
  s_add_u32 s64, s64, s30
  s_lshr_b32 s65, s64, 2
  s_lshl_b32 s64, s64, 3
  v_add_u32 v50, s64, v48
  s_movk_i32 s66, 1152
  v_mul_lo_u32 v57, v50, s66
  v_lshl_add_u32 v51, v49, 4, v57
  v_lshlrev_b32 v52, 5, v49
  v_and_b32 v50, 31, v50
  v_lshlrev_b32 v56, 5, v48
  v_add_u32 v56, 147456, v56
  s_lshl_b32 s66, s3, 2
  v_add_u32 v55, s66, v56
  v_lshlrev_b32 v54, 9, v49
  v_lshl_add_u32 v54, v50, 4, v54
  s_mul_i32 s66, s65, 36864
  s_add_u32 s66, s66, 65536
  v_add_u32 v54, s66, v54
  buffer_load_dwordx4 v[72:75], v51, s[60:63], 0 offen
  v_lshl_add_u32 v58, v49, 1, v57
  buffer_load_ushort v68, v58, s[60:63], 0 offen offset:1024
  v_lshlrev_b32 v59, 2, v49
  s_movk_i32 s66, 2304
  buffer_load_dwordx4 v[84:87], v52, s[24:27], s66 offen
  buffer_load_dwordx4 v[88:91], v52, s[24:27], s66 offen offset:16
  buffer_load_dword v92, v59, s[24:27], s66 offen offset:2048
  s_movk_i32 s66, 0
  buffer_load_dwordx4 v[94:97], v52, s[24:27], s66 offen
  buffer_load_dwordx4 v[98:101], v52, s[24:27], s66 offen offset:16
  buffer_load_dword v102, v59, s[24:27], s66 offen offset:2048
  s_waitcnt vmcnt(7)
  v_lshlrev_b32 v60, 16, v72
  v_and_b32 v61, 0xffff0000, v72
  v_lshlrev_b32 v62, 16, v73
  v_and_b32 v63, 0xffff0000, v73
  v_lshlrev_b32 v64, 16, v74
  v_and_b32 v65, 0xffff0000, v74
  v_lshlrev_b32 v66, 16, v75
  v_and_b32 v67, 0xffff0000, v75
  s_waitcnt vmcnt(6)
  v_lshlrev_b32 v68, 16, v68
  v_add_f32 v58, v60, v61
  v_add_f32 v59, v62, v63
  v_add_f32 v72, v64, v65
  v_add_f32 v73, v66, v67
  v_add_f32 v58, v58, v59
  v_add_f32 v72, v72, v73
  v_add_f32 v58, v58, v68
  v_add_f32 v58, v58, v72
  s_nop 1
  v_add_f32_dpp v58, v58, v58 row_ror:8 row_mask:0xf bank_mask:0xf
  v_mov_b32 v72, v58
  s_nop 1
  v_permlane16_swap_b32 v72, v58
  v_add_f32 v58, v58, v72
  v_mov_b32 v72, v58
  s_nop 1
  v_permlane32_swap_b32 v72, v58
  v_add_f32 v58, v58, v72
  s_mov_b64 exec, 0xff
  ds_write_b32 v55, v58 offset:0
  s_mov_b64 exec, -1
  s_waitcnt lgkmcnt(0)
  s_barrier
  ds_read_b128 v[72:75], v56 offset:0
  ds_read_b128 v[76:79], v56 offset:16
  s_waitcnt lgkmcnt(1)
  v_add_f32 v72, v72, v73
  v_add_f32 v74, v74, v75
  s_waitcnt lgkmcnt(0)
  v_add_f32 v76, v76, v77
  v_add_f32 v78, v78, v79
  v_add_f32 v72, v72, v74
  v_add_f32 v76, v76, v78
  v_add_f32 v58, v72, v76
  v_mul_f32 v58, 0x3ae38e39, v58
  v_sub_f32 v72, v60, v58
  v_sub_f32 v73, v61, v58
  v_sub_f32 v74, v62, v58
  v_sub_f32 v75, v63, v58
  v_sub_f32 v76, v64, v58
  v_sub_f32 v77, v65, v58
  v_sub_f32 v78, v66, v58
  v_sub_f32 v79, v67, v58
  v_sub_f32 v80, v68, v58
  v_mul_f32 v59, v72, v72
  v_fmac_f32 v59, v73, v73
  v_fmac_f32 v59, v74, v74
  v_fmac_f32 v59, v75, v75
  v_fmac_f32 v59, v76, v76
  v_fmac_f32 v59, v77, v77
  v_fmac_f32 v59, v78, v78
  v_fmac_f32 v59, v79, v79
  v_fmac_f32 v59, v80, v80
  s_nop 1
  v_add_f32_dpp v59, v59, v59 row_ror:8 row_mask:0xf bank_mask:0xf
  v_mov_b32 v72, v59
  s_nop 1
  v_permlane16_swap_b32 v72, v59
  v_add_f32 v59, v59, v72
  v_mov_b32 v72, v59
  s_nop 1
  v_permlane32_swap_b32 v72, v59
  v_add_f32 v59, v59, v72
  s_mov_b64 exec, 0xff
  ds_write_b32 v55, v59 offset:512
  s_mov_b64 exec, -1
  s_waitcnt lgkmcnt(0)
  s_barrier
  ds_read_b128 v[72:75], v56 offset:512
  ds_read_b128 v[76:79], v56 offset:528
  s_waitcnt lgkmcnt(1)
  v_add_f32 v72, v72, v73
  v_add_f32 v74, v74, v75
  s_waitcnt lgkmcnt(0)
  v_add_f32 v76, v76, v77
  v_add_f32 v78, v78, v79
  v_add_f32 v72, v72, v74
  v_add_f32 v76, v76, v78
  v_add_f32 v59, v72, v76
  v_mul_f32 v59, 0x3ae38e39, v59
  v_cvt_pk_bf16_f32 v72, v58, v59
  v_lshlrev_b32 v58, 16, v72
  v_and_b32 v59, 0xffff0000, v72
  v_add_f32 v59, 0x3727c5ac, v59
  v_cvt_pk_bf16_f32 v59, v59, v59
  v_lshlrev_b32 v59, 16, v59
  v_sqrt_f32 v59, v59
  s_nop 0
  v_cvt_pk_bf16_f32 v59, v59, v59
  v_lshlrev_b32 v59, 16, v59
  v_rcp_f32 v59, v59
  v_sub_f32 v60, v60, v58
  v_sub_f32 v61, v61, v58
  v_sub_f32 v62, v62, v58
  v_sub_f32 v63, v63, v58
  v_sub_f32 v64, v64, v58
  v_sub_f32 v65, v65, v58
  v_sub_f32 v66, v66, v58
  v_sub_f32 v67, v67, v58
  v_sub_f32 v68, v68, v58
  v_cvt_pk_bf16_f32 v72, v60, v61
  v_cvt_pk_bf16_f32 v73, v62, v63
  v_cvt_pk_bf16_f32 v74, v64, v65
  v_cvt_pk_bf16_f32 v75, v66, v67
  v_cvt_pk_bf16_f32 v68, v68, v68
  v_lshlrev_b32 v60, 16, v72
  v_and_b32 v61, 0xffff0000, v72
  v_lshlrev_b32 v62, 16, v73
  v_and_b32 v63, 0xffff0000, v73
  v_lshlrev_b32 v64, 16, v74
  v_and_b32 v65, 0xffff0000, v74
  v_lshlrev_b32 v66, 16, v75
  v_and_b32 v67, 0xffff0000, v75
  v_lshlrev_b32 v68, 16, v68
  v_mul_f32 v60, v60, v59
  v_mul_f32 v61, v61, v59
  v_mul_f32 v62, v62, v59
  v_mul_f32 v63, v63, v59
  v_mul_f32 v64, v64, v59
  v_mul_f32 v65, v65, v59
  v_mul_f32 v66, v66, v59
  v_mul_f32 v67, v67, v59
  v_mul_f32 v68, v68, v59
  v_cvt_pk_bf16_f32 v72, v60, v61
  v_cvt_pk_bf16_f32 v73, v62, v63
  v_cvt_pk_bf16_f32 v74, v64, v65
  v_cvt_pk_bf16_f32 v75, v66, v67
  v_cvt_pk_bf16_f32 v68, v68, v68
  v_lshlrev_b32 v60, 16, v72
  v_and_b32 v61, 0xffff0000, v72
  v_lshlrev_b32 v62, 16, v73
  v_and_b32 v63, 0xffff0000, v73
  v_lshlrev_b32 v64, 16, v74
  v_and_b32 v65, 0xffff0000, v74
  v_lshlrev_b32 v66, 16, v75
  v_and_b32 v67, 0xffff0000, v75
  v_lshlrev_b32 v68, 16, v68
  s_waitcnt vmcnt(5)
  v_mul_f32 v60, v60, v84
  v_mul_f32 v61, v61, v85
  v_mul_f32 v62, v62, v86
  v_mul_f32 v63, v63, v87
  s_waitcnt vmcnt(4)
  v_mul_f32 v64, v64, v88
  v_mul_f32 v65, v65, v89
  v_mul_f32 v66, v66, v90
  v_mul_f32 v67, v67, v91
  s_waitcnt vmcnt(3)
  v_mul_f32 v68, v68, v92
  v_cvt_pk_bf16_f32 v72, v60, v61
  v_cvt_pk_bf16_f32 v73, v62, v63
  v_cvt_pk_bf16_f32 v74, v64, v65
  v_cvt_pk_bf16_f32 v75, v66, v67
  v_cvt_pk_bf16_f32 v68, v68, v68
  v_lshlrev_b32 v60, 16, v72
  v_and_b32 v61, 0xffff0000, v72
  v_lshlrev_b32 v62, 16, v73
  v_and_b32 v63, 0xffff0000, v73
  v_lshlrev_b32 v64, 16, v74
  v_and_b32 v65, 0xffff0000, v74
  v_lshlrev_b32 v66, 16, v75
  v_and_b32 v67, 0xffff0000, v75
  v_lshlrev_b32 v68, 16, v68
  s_waitcnt vmcnt(2)
  v_add_f32 v60, v60, v94
  v_add_f32 v61, v61, v95
  v_add_f32 v62, v62, v96
  v_add_f32 v63, v63, v97
  s_waitcnt vmcnt(1)
  v_add_f32 v64, v64, v98
  v_add_f32 v65, v65, v99
  v_add_f32 v66, v66, v100
  v_add_f32 v67, v67, v101
  s_waitcnt vmcnt(0)
  v_add_f32 v68, v68, v102
  v_cvt_pk_bf16_f32 v72, v60, v61
  v_cvt_pk_bf16_f32 v73, v62, v63
  v_cvt_pk_bf16_f32 v74, v64, v65
  v_cvt_pk_bf16_f32 v75, v66, v67
  v_cvt_pk_bf16_f32 v76, v68, v68
  buffer_store_dwordx4 v[72:75], v54, s[24:27], 0 offen sc1
  v_bfe_u32 v58, v0, 3, 3
  v_lshlrev_b32 v59, 4, v48
  s_lshl_b32 s66, s3, 7
  s_add_u32 s66, s66, 148480
  v_add_u32 v59, s66, v59
  v_lshl_add_u32 v58, v58, 1, v59
  ds_write_b16 v58, v76
  s_waitcnt lgkmcnt(0)
  ds_read_b128 v[124:127], v59
  s_mul_i32 s66, s3, 3584
  s_sub_u32 s66, 32768, s66
  s_mov_b64 exec, 0xff
  s_waitcnt lgkmcnt(0)
  buffer_store_dwordx4 v[124:127], v54, s[24:27], s66 offen sc1
  s_mov_b64 exec, -1
  s_lshl_b32 s68, s31, 11
  s_add_u32 s68, s68, 3145728
  s_lshl_b32 s69, s30, 7
  s_add_u32 s69, s69, s68
  s_waitcnt vmcnt(0)
  s_barrier
  s_cmp_lg_u32 s3, 7
  s_cbranch_scc1 kf_main_kernel_gb0_p
  v_mov_b32 v47, 9
  s_mov_b64 exec, 1
  buffer_store_dword v47, off, s[24:27], s69 sc1
  s_mov_b64 exec, -1
kf_main_kernel_gb0_p:
  s_add_u32 m0, s34, 0
  s_mov_b32 s40, 0
  buffer_load_dwordx4 v8, s[12:15], s40 offen lds
  s_add_u32 m0, s34, 8192
  s_mov_b32 s40, 131072
  buffer_load_dwordx4 v8, s[12:15], s40 offen lds
  s_add_u32 m0, s34, 16384
  s_mov_b32 s40, 262144
  buffer_load_dwordx4 v8, s[12:15], s40 offen lds
  s_add_u32 m0, s34, 24576
  s_mov_b32 s40, 393216
  buffer_load_dwordx4 v8, s[12:15], s40 offen lds
  s_add_u32 m0, s34, 49152
  s_mov_b32 s40, 524288
  buffer_load_dwordx4 v8, s[12:15], s40 offen lds
  s_add_u32 m0, s34, 57344
  s_mov_b32 s40, 655360
  buffer_load_dwordx4 v8, s[12:15], s40 offen lds
  s_add_u32 m0, s34, 65536
  s_mov_b32 s40, 786432
  buffer_load_dwordx4 v8, s[12:15], s40 offen lds
  s_add_u32 m0, s34, 73728
  s_mov_b32 s40, 917504
  buffer_load_dwordx4 v8, s[12:15], s40 offen lds
  s_add_u32 m0, s34, 98304
  s_mov_b32 s40, 1048576
  buffer_load_dwordx4 v8, s[12:15], s40 offen lds
  s_add_u32 m0, s34, 106496
  s_mov_b32 s40, 1179648
  buffer_load_dwordx4 v8, s[12:15], s40 offen lds
  s_add_u32 m0, s34, 114688
  s_mov_b32 s40, 1310720
  buffer_load_dwordx4 v8, s[12:15], s40 offen lds
  s_add_u32 m0, s34, 122880
  s_mov_b32 s40, 1441792
  buffer_load_dwordx4 v8, s[12:15], s40 offen lds
  s_lshr_b32 s72, s2, 3
  s_and_b32 s73, s2, 7
  s_sub_u32 s74, s72, 0
  v_lshl_add_u32 v144, v0, 5, s74
  v_lshlrev_b32 v145, 7, v144
  s_mul_i32 s75, s73, 589824
  s_add_u32 s75, s75, 0
  v_add_u32 v145, s75, v145
  s_mov_b32 s75, 4608
  v_cmp_gt_u32 s[70:71], s75, v144
  s_nop 1
  v_cndmask_b32 v47, -1, v145, s[70:71]
  s_mov_b32 s78, 4718592
  s_mov_b32 s79, 0x00020000
  s_mov_b32 s16, s4
  s_mov_b32 s17, s5
  s_mov_b32 s18, 0x800000
  s_mov_b32 s19, 0x00020000
  s_mov_b32 s20, s6
  s_mov_b32 s21, s7
  s_mov_b32 s22, 0x800000
  s_mov_b32 s23, 0x00020000
  s_mov_b32 s44, s10
  s_mov_b32 s45, s11
  s_mov_b32 s46, 0x480000
  s_mov_b32 s47, 0x00020000
  v_lshrrev_b32 v6, 4, v0
  v_and_b32 v7, 15, v0
  v_and_b32 v44, 15, v6
  v_xor_b32 v7, v7, v44
  v_lshlrev_b32 v46, 8, v6
  s_lshl_b32 s40, s30, 19
  s_add_u32 s40, s40, 393216
  v_add_u32 v46, s40, v46
  v_lshl_add_u32 v10, v7, 4, v46
  v_and_b32 v44, 3, v6
  v_xor_b32 v7, v2, v44
  v_lshl_add_u32 v46, v7, 6, v46
  v_lshl_add_u32 v11, v3, 4, v46
  s_lshl_b32 s43, s30, 8
  v_lshrrev_b32 v7, 3, v0
  v_add_u32 v7, s43, v7
  s_movk_i32 s40, 1152
  v_mul_lo_u32 v12, v7, s40
  v_bfe_u32 v7, v0, 2, 1
  v_xor_b32 v7, v7, v4
  v_lshl_add_u32 v12, v7, 6, v12
  v_lshl_add_u32 v12, v3, 4, v12
  s_lshl_b32 s40, s30, 6
  s_lshl_b32 s41, s31, 2
  s_add_u32 s40, s40, s41
  s_add_u32 s40, s40, s32
  s_mul_i32 s40, s40, 18
  s_add_u32 s40, s40, s33
  s_lshl_b32 s40, s40, 11
  s_add_u32 s40, s40, 16777216
  v_add_u32 v13, s40, v45
  s_lshl_b32 s40, s3, 13
  s_add_u32 s41, s40, 32768
  v_add_u32 v32, s41, v45
  s_xor_b32 s40, s40, 32768
  s_add_u32 s41, s40, 32768
  v_add_u32 v33, s41, v45
  s_lshl_b32 s40, s32, 12
  s_add_u32 s40, s40, 32768
  v_add_u32 v188, s40, v45
  v_add_u32 v189, 49152, v188
  v_add_u32 v190, 98304, v188
  v_lshl_add_u32 v6, v5, 3, v2
  v_lshlrev_b32 v6, 9, v6
  v_lshl_add_u32 v6, v4, 5, v6
  v_and_b32 v7, 1, v3
  v_lshl_add_u32 v6, v7, 4, v6
  v_lshrrev_b32 v7, 1, v3
  v_lshl_add_u32 v6, v7, 3, v6
  s_lshl_b32 s40, s33, 8
  v_add_u32 v6, s40, v6
  v_xor_b32 v7, 0, v2
  v_lshl_add_u32 v176, v7, 6, v6
  v_add_u32 v180, 49152, v176
  v_add_u32 v184, 98304, v176
  v_xor_b32 v7, 1, v2
  v_lshl_add_u32 v177, v7, 6, v6
  v_add_u32 v181, 49152, v177
  v_add_u32 v185, 98304, v177
  v_xor_b32 v7, 2, v2
  v_lshl_add_u32 v178, v7, 6, v6
  v_add_u32 v182, 49152, v178
  v_add_u32 v186, 98304, v178
  v_xor_b32 v7, 3, v2
  v_lshl_add_u32 v179, v7, 6, v6
  v_add_u32 v183, 49152, v179
  v_add_u32 v187, 98304, v179
  v_and_b32 v6, 31, v0
  v_and_b32 v7, 15, v0
  v_xor_b32 v7, v7, v5
  v_lshlrev_b32 v6, 8, v6
  v_lshl_add_u32 v14, v7, 4, v6
  v_xor_b32 v15, 32, v14
  v_xor_b32 v16, 64, v14
  v_xor_b32 v17, 96, v14
  v_xor_b32 v18, 128, v14
  v_xor_b32 v19, 160, v14
  v_xor_b32 v20, 192, v14
  v_xor_b32 v21, 224, v14
  v_lshl_add_u32 v6, v5, 2, v2
  v_lshlrev_b32 v6, 8, v6
  v_lshl_add_u32 v6, v4, 5, v6
  v_lshl_add_u32 v6, v3, 3, v6
  v_add_u32 v6, 0x10000, v6
  v_xor_b32 v7, 0, v2
  v_lshl_add_u32 v22, v7, 6, v6
  v_xor_b32 v7, 1, v2
  v_lshl_add_u32 v23, v7, 6, v6
  v_xor_b32 v7, 2, v2
  v_lshl_add_u32 v24, v7, 6, v6
  v_xor_b32 v7, 3, v2
  v_lshl_add_u32 v25, v7, 6, v6
  v_lshl_add_u32 v6, v5, 2, v2
  v_lshlrev_b32 v6, 7, v6
  v_lshrrev_b32 v7, 1, v2
  v_xor_b32 v7, s33, v7
  v_lshl_add_u32 v6, v7, 6, v6
  v_and_b32 v7, 1, v3
  v_lshl_add_u32 v6, v7, 5, v6
  v_lshrrev_b32 v7, 1, v3
  v_lshl_add_u32 v6, v7, 3, v6
  v_lshl_add_u32 v6, v4, 4, v6
  s_lshl_b32 s40, s33, 14
  v_add_u32 v26, s40, v6
  s_xor_b32 s40, s40, 16384
  v_add_u32 v29, s40, v6
  s_mov_b32 s36, 0x3e0293ee
  s_mov_b32 s37, 0x5d800000
  v_mov_b32 v34, 0
  v_add_u32 v27, 65536, v26
  v_add_u32 v30, 65536, v29
  v_add_u32 v28, 131072, v26
  v_add_u32 v31, 131072, v29
  s_lshr_b32 s72, s2, 3
  s_and_b32 s73, s2, 7
  s_sub_u32 s74, s72, 0
  v_lshl_add_u32 v144, v0, 5, s74
  s_mov_b32 s75, 116509
  v_mul_lo_u32 v145, v144, s75
  v_lshrrev_b32 v145, 20, v145
  s_mov_b32 s75, 8064
  v_mul_lo_u32 v145, v145, s75
  v_lshl_add_u32 v145, v144, 7, v145
  s_mul_i32 s75, s73, 1152
  s_add_u32 s75, s75, 0
  v_add_u32 v145, s75, v145
  s_mov_b32 s75, 5184
  v_cmp_gt_u32 s[70:71], s75, v144
  s_nop 1
  v_cndmask_b32 v44, -1, v145, s[70:71]
  s_mov_b32 s78, 5308416
  s_mov_b32 s79, 0x00020000
  s_sub_u32 s74, s72, 5184
  v_lshl_add_u32 v144, v0, 5, s74
  s_mov_b32 s75, 116509
  v_mul_lo_u32 v145, v144, s75
  v_lshrrev_b32 v145, 20, v145
  s_mov_b32 s75, 8064
  v_mul_lo_u32 v145, v145, s75
  v_lshl_add_u32 v145, v144, 7, v145
  s_mul_i32 s75, s73, 1152
  s_add_u32 s75, s75, 0
  v_add_u32 v145, s75, v145
  s_mov_b32 s75, 5184
  v_cmp_gt_u32 s[70:71], s75, v144
  s_nop 1
  v_cndmask_b32 v45, -1, v145, s[70:71]
  s_mov_b32 s82, 5308416
  s_mov_b32 s83, 0x00020000
  s_sub_u32 s74, s72, 10368
  v_lshl_add_u32 v144, v0, 5, s74
  v_lshlrev_b32 v145, 7, v144
  s_mul_i32 s75, s73, 663552
  s_add_u32 s75, s75, 0
  v_add_u32 v145, s75, v145
  s_mov_b32 s75, 5184
  v_cmp_gt_u32 s[70:71], s75, v144
  s_nop 1
  v_cndmask_b32 v46, -1, v145, s[70:71]
  s_mov_b32 s86, 5308416
  s_mov_b32 s87, 0x00020000
  v_lshrrev_b32 v6, 2, v49
  v_lshlrev_b32 v6, 11, v6
  v_and_b32 v7, 1, v49
  v_lshl_add_u32 v6, v7, 10, v6
  v_bfe_u32 v7, v49, 1, 1
  v_lshl_add_u32 v6, v7, 9, v6
  v_lshl_add_u32 v6, v50, 4, v6
  s_mul_i32 s66, s65, 36864
  s_add_u32 s66, s66, 16777216
  v_add_u32 v6, s66, v6
  v_and_b32 v7, 15, v0
  v_lshlrev_b32 v7, 7, v7
  s_mov_b32 s70, 9
  s_cmp_lg_u32 s3, 7
  s_cbranch_scc1 kf_main_kernel_gb0_out
  v_and_b32 v48, 15, v0
  v_lshlrev_b32 v48, 7, v48
  s_mov_b32 s71, 0x100000
kf_main_kernel_gb0_poll:
  buffer_load_dword v49, v48, s[24:27], s68 offen sc1
  s_waitcnt vmcnt(0)
  v_cmp_gt_u32 vcc, s70, v49
  s_sub_u32 s71, s71, 1
  s_cbranch_scc1 kf_main_kernel_gb0_out
  s_cbranch_vccnz kf_main_kernel_gb0_poll
kf_main_kernel_gb0_out:
  s_barrier
  s_add_u32 m0, s34, 32768
  s_mov_b32 s40, 0
  buffer_load_dwordx4 v9, s[24:27], s40 offen sc1 lds
  s_add_u32 m0, s34, 40960
  s_mov_b32 s40, 73728
  buffer_load_dwordx4 v9, s[24:27], s40 offen sc1 lds
  s_add_u32 m0, s34, 81920
  s_mov_b32 s40, 4096
  buffer_load_dwordx4 v9, s[24:27], s40 offen sc1 lds
  s_add_u32 m0, s34, 90112
  s_mov_b32 s40, 77824
  buffer_load_dwordx4 v9, s[24:27], s40 offen sc1 lds
  s_add_u32 m0, s34, 131072
  s_mov_b32 s40, 8192
  buffer_load_dwordx4 v9, s[24:27], s40 offen sc1 lds
  s_add_u32 m0, s34, 139264
  s_mov_b32 s40, 81920
  buffer_load_dwordx4 v9, s[24:27], s40 offen sc1 lds
  s_lshl_b32 s68, s31, 11
  s_add_u32 s68, s68, 3178496
  s_lshl_b32 s69, s30, 7
  s_add_u32 s69, s69, s68
  s_waitcnt vmcnt(4)
  s_barrier
  ds_read_b128 v[224:227], v188 offset:0
  ds_read_b64_tr_b16 v[48:49], v176 offset:0
  ds_read_b64_tr_b16 v[50:51], v176 offset:2048
  ds_read_b64_tr_b16 v[52:53], v177 offset:0
  ds_read_b64_tr_b16 v[54:55], v177 offset:2048
  ds_read_b64_tr_b16 v[56:57], v178 offset:0
  ds_read_b64_tr_b16 v[58:59], v178 offset:2048
  s_waitcnt lgkmcnt(4)
  v_mfma_f32_32x32x16_bf16 v[80:95], v[48:51], v[224:227], 0
  ds_read_b64_tr_b16 v[60:61], v179 offset:0
  ds_read_b64_tr_b16 v[62:63], v179 offset:2048
  ds_read_b128 v[228:231], v188 offset:1024
  ds_read_b64_tr_b16 v[64:65], v176 offset:8192
  ds_read_b64_tr_b16 v[66:67], v176 offset:10240
  s_waitcnt lgkmcnt(7)
  v_mfma_f32_32x32x16_bf16 v[96:111], v[52:55], v[224:227], 0
  ds_read_b64_tr_b16 v[68:69], v177 offset:8192
  ds_read_b64_tr_b16 v[70:71], v177 offset:10240
  ds_read_b64_tr_b16 v[72:73], v178 offset:8192
  ds_read_b64_tr_b16 v[74:75], v178 offset:10240
  s_waitcnt lgkmcnt(9)
  v_mfma_f32_32x32x16_bf16 v[112:127], v[56:59], v[224:227], 0
  ds_read_b64_tr_b16 v[76:77], v179 offset:8192
  ds_read_b64_tr_b16 v[78:79], v179 offset:10240
  ds_read_b128 v[232:235], v188 offset:2048
  ds_read_b64_tr_b16 v[48:49], v176 offset:16384
  ds_read_b64_tr_b16 v[50:51], v176 offset:18432
  s_waitcnt lgkmcnt(12)
  v_mfma_f32_32x32x16_bf16 v[128:143], v[60:63], v[224:227], 0
  ds_read_b64_tr_b16 v[52:53], v177 offset:16384
  ds_read_b64_tr_b16 v[54:55], v177 offset:18432
  ds_read_b64_tr_b16 v[56:57], v178 offset:16384
  ds_read_b64_tr_b16 v[58:59], v178 offset:18432
  s_waitcnt lgkmcnt(13)
  v_mfma_f32_32x32x16_bf16 v[80:95], v[64:67], v[228:231], v[80:95]
  ds_read_b64_tr_b16 v[60:61], v179 offset:16384
  ds_read_b64_tr_b16 v[62:63], v179 offset:18432
  s_waitcnt lgkmcnt(13)
  v_mfma_f32_32x32x16_bf16 v[96:111], v[68:71], v[228:231], v[96:111]
  ds_read_b128 v[236:239], v188 offset:3072
  ds_read_b64_tr_b16 v[64:65], v176 offset:24576
  ds_read_b64_tr_b16 v[66:67], v176 offset:26624
  s_waitcnt lgkmcnt(14)
  v_mfma_f32_32x32x16_bf16 v[112:127], v[72:75], v[228:231], v[112:127]
  ds_read_b64_tr_b16 v[68:69], v177 offset:24576
  ds_read_b64_tr_b16 v[70:71], v177 offset:26624
  s_waitcnt lgkmcnt(14)
  v_mfma_f32_32x32x16_bf16 v[128:143], v[76:79], v[228:231], v[128:143]
  ds_read_b64_tr_b16 v[72:73], v178 offset:24576
  ds_read_b64_tr_b16 v[74:75], v178 offset:26624
  s_waitcnt lgkmcnt(13)
  v_mfma_f32_32x32x16_bf16 v[80:95], v[48:51], v[232:235], v[80:95]
  ds_read_b64_tr_b16 v[76:77], v179 offset:24576
  ds_read_b64_tr_b16 v[78:79], v179 offset:26624
  s_waitcnt lgkmcnt(13)
  v_mfma_f32_32x32x16_bf16 v[96:111], v[52:55], v[232:235], v[96:111]
  s_waitcnt lgkmcnt(11)
  v_mfma_f32_32x32x16_bf16 v[112:127], v[56:59], v[232:235], v[112:127]
  s_waitcnt vmcnt(2) lgkmcnt(0)
  s_barrier
  ds_read_b128 v[240:243], v189 offset:0
  ds_read_b64_tr_b16 v[48:49], v180 offset:0
  ds_read_b64_tr_b16 v[50:51], v180 offset:2048
  ds_read_b64_tr_b16 v[52:53], v181 offset:0
  ds_read_b64_tr_b16 v[54:55], v181 offset:2048
  v_mfma_f32_32x32x16_bf16 v[128:143], v[60:63], v[232:235], v[128:143]
  s_add_u32 m0, s34, 32768
  s_mov_b32 s40, 12288
  buffer_load_dwordx4 v9, s[24:27], s40 offen sc1 lds
  ds_read_b64_tr_b16 v[56:57], v182 offset:0
  ds_read_b64_tr_b16 v[58:59], v182 offset:2048
  v_mfma_f32_32x32x16_bf16 v[80:95], v[64:67], v[236:239], v[80:95]
  s_add_u32 m0, s34, 40960
  s_mov_b32 s40, 86016
  buffer_load_dwordx4 v9, s[24:27], s40 offen sc1 lds
  ds_read_b64_tr_b16 v[60:61], v183 offset:0
  ds_read_b64_tr_b16 v[62:63], v183 offset:2048
  v_mfma_f32_32x32x16_bf16 v[96:111], v[68:71], v[236:239], v[96:111]
  s_add_u32 m0, s34, 0
  s_mov_b32 s40, 1572864
  buffer_load_dwordx4 v8, s[12:15], s40 offen lds
  ds_read_b128 v[244:247], v189 offset:1024
  ds_read_b64_tr_b16 v[64:65], v180 offset:8192
  ds_read_b64_tr_b16 v[66:67], v180 offset:10240
  v_mfma_f32_32x32x16_bf16 v[112:127], v[72:75], v[236:239], v[112:127]
  s_add_u32 m0, s34, 8192
  s_mov_b32 s40, 1703936
  buffer_load_dwordx4 v8, s[12:15], s40 offen lds
  ds_read_b64_tr_b16 v[68:69], v181 offset:8192
  ds_read_b64_tr_b16 v[70:71], v181 offset:10240
  v_mfma_f32_32x32x16_bf16 v[128:143], v[76:79], v[236:239], v[128:143]
  s_add_u32 m0, s34, 16384
  s_mov_b32 s40, 1835008
  buffer_load_dwordx4 v8, s[12:15], s40 offen lds
  ds_read_b64_tr_b16 v[72:73], v182 offset:8192
  ds_read_b64_tr_b16 v[74:75], v182 offset:10240
  s_waitcnt lgkmcnt(13)
  v_mfma_f32_32x32x16_bf16 v[80:95], v[48:51], v[240:243], v[80:95]
  s_add_u32 m0, s34, 24576
  s_mov_b32 s40, 1966080
  buffer_load_dwordx4 v8, s[12:15], s40 offen lds
  ds_read_b64_tr_b16 v[76:77], v183 offset:8192
  ds_read_b64_tr_b16 v[78:79], v183 offset:10240
  s_waitcnt lgkmcnt(13)
  v_mfma_f32_32x32x16_bf16 v[96:111], v[52:55], v[240:243], v[96:111]
  ds_read_b128 v[248:251], v189 offset:2048
  ds_read_b64_tr_b16 v[48:49], v180 offset:16384
  ds_read_b64_tr_b16 v[50:51], v180 offset:18432
  s_waitcnt lgkmcnt(14)
  v_mfma_f32_32x32x16_bf16 v[112:127], v[56:59], v[240:243], v[112:127]
  ds_read_b64_tr_b16 v[52:53], v181 offset:16384
  ds_read_b64_tr_b16 v[54:55], v181 offset:18432
  s_waitcnt lgkmcnt(14)
  v_mfma_f32_32x32x16_bf16 v[128:143], v[60:63], v[240:243], v[128:143]
  ds_read_b64_tr_b16 v[56:57], v182 offset:16384
  ds_read_b64_tr_b16 v[58:59], v182 offset:18432
  s_waitcnt lgkmcnt(13)
  v_mfma_f32_32x32x16_bf16 v[80:95], v[64:67], v[244:247], v[80:95]
  ds_read_b64_tr_b16 v[60:61], v183 offset:16384
  ds_read_b64_tr_b16 v[62:63], v183 offset:18432
  s_waitcnt lgkmcnt(13)
  v_mfma_f32_32x32x16_bf16 v[96:111], v[68:71], v[244:247], v[96:111]
  ds_read_b128 v[252:255], v189 offset:3072
  ds_read_b64_tr_b16 v[64:65], v180 offset:24576
  ds_read_b64_tr_b16 v[66:67], v180 offset:26624
  s_waitcnt lgkmcnt(14)
  v_mfma_f32_32x32x16_bf16 v[112:127], v[72:75], v[244:247], v[112:127]
  ds_read_b64_tr_b16 v[68:69], v181 offset:24576
  ds_read_b64_tr_b16 v[70:71], v181 offset:26624
  s_waitcnt lgkmcnt(14)
  v_mfma_f32_32x32x16_bf16 v[128:143], v[76:79], v[244:247], v[128:143]
  ds_read_b64_tr_b16 v[72:73], v182 offset:24576
  ds_read_b64_tr_b16 v[74:75], v182 offset:26624
  s_waitcnt lgkmcnt(13)
  v_mfma_f32_32x32x16_bf16 v[80:95], v[48:51], v[248:251], v[80:95]
  ds_read_b64_tr_b16 v[76:77], v183 offset:24576
  ds_read_b64_tr_b16 v[78:79], v183 offset:26624
  s_waitcnt lgkmcnt(13)
  v_mfma_f32_32x32x16_bf16 v[96:111], v[52:55], v[248:251], v[96:111]
  s_waitcnt lgkmcnt(11)
  v_mfma_f32_32x32x16_bf16 v[112:127], v[56:59], v[248:251], v[112:127]
  s_waitcnt vmcnt(6) lgkmcnt(0)
  s_barrier
  ds_read_b128 v[224:227], v190 offset:0
  ds_read_b64_tr_b16 v[48:49], v184 offset:0
  ds_read_b64_tr_b16 v[50:51], v184 offset:2048
  ds_read_b64_tr_b16 v[52:53], v185 offset:0
  ds_read_b64_tr_b16 v[54:55], v185 offset:2048
  v_mfma_f32_32x32x16_bf16 v[128:143], v[60:63], v[248:251], v[128:143]
  s_add_u32 m0, s34, 81920
  s_mov_b32 s40, 16384
  buffer_load_dwordx4 v9, s[24:27], s40 offen sc1 lds
  ds_read_b64_tr_b16 v[56:57], v186 offset:0
  ds_read_b64_tr_b16 v[58:59], v186 offset:2048
  v_mfma_f32_32x32x16_bf16 v[80:95], v[64:67], v[252:255], v[80:95]
  s_add_u32 m0, s34, 90112
  s_mov_b32 s40, 90112
  buffer_load_dwordx4 v9, s[24:27], s40 offen sc1 lds
  ds_read_b64_tr_b16 v[60:61], v187 offset:0
  ds_read_b64_tr_b16 v[62:63], v187 offset:2048
  v_mfma_f32_32x32x16_bf16 v[96:111], v[68:71], v[252:255], v[96:111]
  s_add_u32 m0, s34, 49152
  s_mov_b32 s40, 2097152
  buffer_load_dwordx4 v8, s[12:15], s40 offen lds
  ds_read_b128 v[228:231], v190 offset:1024
  ds_read_b64_tr_b16 v[64:65], v184 offset:8192
  ds_read_b64_tr_b16 v[66:67], v184 offset:10240
  v_mfma_f32_32x32x16_bf16 v[112:127], v[72:75], v[252:255], v[112:127]
  s_add_u32 m0, s34, 57344
  s_mov_b32 s40, 2228224
  buffer_load_dwordx4 v8, s[12:15], s40 offen lds
  ds_read_b64_tr_b16 v[68:69], v185 offset:8192
  ds_read_b64_tr_b16 v[70:71], v185 offset:10240
  v_mfma_f32_32x32x16_bf16 v[128:143], v[76:79], v[252:255], v[128:143]
  s_add_u32 m0, s34, 65536
  s_mov_b32 s40, 2359296
  buffer_load_dwordx4 v8, s[12:15], s40 offen lds
  ds_read_b64_tr_b16 v[72:73], v186 offset:8192
  ds_read_b64_tr_b16 v[74:75], v186 offset:10240
  s_waitcnt lgkmcnt(13)
  v_mfma_f32_32x32x16_bf16 v[80:95], v[48:51], v[224:227], v[80:95]
  s_add_u32 m0, s34, 73728
  s_mov_b32 s40, 2490368
  buffer_load_dwordx4 v8, s[12:15], s40 offen lds
  ds_read_b64_tr_b16 v[76:77], v187 offset:8192
  ds_read_b64_tr_b16 v[78:79], v187 offset:10240
  s_waitcnt lgkmcnt(13)
  v_mfma_f32_32x32x16_bf16 v[96:111], v[52:55], v[224:227], v[96:111]
  ds_read_b128 v[232:235], v190 offset:2048
  ds_read_b64_tr_b16 v[48:49], v184 offset:16384
  ds_read_b64_tr_b16 v[50:51], v184 offset:18432
  s_waitcnt lgkmcnt(14)
  v_mfma_f32_32x32x16_bf16 v[112:127], v[56:59], v[224:227], v[112:127]
  ds_read_b64_tr_b16 v[52:53], v185 offset:16384
  ds_read_b64_tr_b16 v[54:55], v185 offset:18432
  s_waitcnt lgkmcnt(14)
  v_mfma_f32_32x32x16_bf16 v[128:143], v[60:63], v[224:227], v[128:143]
  ds_read_b64_tr_b16 v[56:57], v186 offset:16384
  ds_read_b64_tr_b16 v[58:59], v186 offset:18432
  s_waitcnt lgkmcnt(13)
  v_mfma_f32_32x32x16_bf16 v[80:95], v[64:67], v[228:231], v[80:95]
  ds_read_b64_tr_b16 v[60:61], v187 offset:16384
  ds_read_b64_tr_b16 v[62:63], v187 offset:18432
  s_waitcnt lgkmcnt(13)
  v_mfma_f32_32x32x16_bf16 v[96:111], v[68:71], v[228:231], v[96:111]
  ds_read_b128 v[236:239], v190 offset:3072
  ds_read_b64_tr_b16 v[64:65], v184 offset:24576
  ds_read_b64_tr_b16 v[66:67], v184 offset:26624
  s_waitcnt lgkmcnt(14)
  v_mfma_f32_32x32x16_bf16 v[112:127], v[72:75], v[228:231], v[112:127]
  ds_read_b64_tr_b16 v[68:69], v185 offset:24576
  ds_read_b64_tr_b16 v[70:71], v185 offset:26624
  s_waitcnt lgkmcnt(14)
  v_mfma_f32_32x32x16_bf16 v[128:143], v[76:79], v[228:231], v[128:143]
  ds_read_b64_tr_b16 v[72:73], v186 offset:24576
  ds_read_b64_tr_b16 v[74:75], v186 offset:26624
  s_waitcnt lgkmcnt(13)
  v_mfma_f32_32x32x16_bf16 v[80:95], v[48:51], v[232:235], v[80:95]
  ds_read_b64_tr_b16 v[76:77], v187 offset:24576
  ds_read_b64_tr_b16 v[78:79], v187 offset:26624
  s_waitcnt lgkmcnt(13)
  v_mfma_f32_32x32x16_bf16 v[96:111], v[52:55], v[232:235], v[96:111]
  s_waitcnt lgkmcnt(11)
  v_mfma_f32_32x32x16_bf16 v[112:127], v[56:59], v[232:235], v[112:127]
  s_waitcnt vmcnt(6) lgkmcnt(0)
  s_barrier
  ds_read_b128 v[240:243], v188 offset:0
  ds_read_b64_tr_b16 v[48:49], v176 offset:0
  ds_read_b64_tr_b16 v[50:51], v176 offset:2048
  ds_read_b64_tr_b16 v[52:53], v177 offset:0
  ds_read_b64_tr_b16 v[54:55], v177 offset:2048
  v_mfma_f32_32x32x16_bf16 v[128:143], v[60:63], v[232:235], v[128:143]
  s_add_u32 m0, s34, 131072
  s_mov_b32 s40, 20480
  buffer_load_dwordx4 v9, s[24:27], s40 offen sc1 lds
  ds_read_b64_tr_b16 v[56:57], v178 offset:0
  ds_read_b64_tr_b16 v[58:59], v178 offset:2048
  v_mfma_f32_32x32x16_bf16 v[80:95], v[64:67], v[236:239], v[80:95]
  s_add_u32 m0, s34, 139264
  s_mov_b32 s40, 94208
  buffer_load_dwordx4 v9, s[24:27], s40 offen sc1 lds
  ds_read_b64_tr_b16 v[60:61], v179 offset:0
  ds_read_b64_tr_b16 v[62:63], v179 offset:2048
  v_mfma_f32_32x32x16_bf16 v[96:111], v[68:71], v[236:239], v[96:111]
  s_add_u32 m0, s34, 98304
  s_mov_b32 s40, 2621440
  buffer_load_dwordx4 v8, s[12:15], s40 offen lds
  ds_read_b128 v[244:247], v188 offset:1024
  ds_read_b64_tr_b16 v[64:65], v176 offset:8192
  ds_read_b64_tr_b16 v[66:67], v176 offset:10240
  v_mfma_f32_32x32x16_bf16 v[112:127], v[72:75], v[236:239], v[112:127]
  s_add_u32 m0, s34, 106496
  s_mov_b32 s40, 2752512
  buffer_load_dwordx4 v8, s[12:15], s40 offen lds
  ds_read_b64_tr_b16 v[68:69], v177 offset:8192
  ds_read_b64_tr_b16 v[70:71], v177 offset:10240
  v_mfma_f32_32x32x16_bf16 v[128:143], v[76:79], v[236:239], v[128:143]
  s_add_u32 m0, s34, 114688
  s_mov_b32 s40, 2883584
  buffer_load_dwordx4 v8, s[12:15], s40 offen lds
  ds_read_b64_tr_b16 v[72:73], v178 offset:8192
  ds_read_b64_tr_b16 v[74:75], v178 offset:10240
  s_waitcnt lgkmcnt(13)
  v_mfma_f32_32x32x16_bf16 v[80:95], v[48:51], v[240:243], v[80:95]
  s_add_u32 m0, s34, 122880
  s_mov_b32 s40, 3014656
  buffer_load_dwordx4 v8, s[12:15], s40 offen lds
  ds_read_b64_tr_b16 v[76:77], v179 offset:8192
  ds_read_b64_tr_b16 v[78:79], v179 offset:10240
  s_waitcnt lgkmcnt(13)
  v_mfma_f32_32x32x16_bf16 v[96:111], v[52:55], v[240:243], v[96:111]
  ds_read_b128 v[248:251], v188 offset:2048
  ds_read_b64_tr_b16 v[48:49], v176 offset:16384
  ds_read_b64_tr_b16 v[50:51], v176 offset:18432
  s_waitcnt lgkmcnt(14)
  v_mfma_f32_32x32x16_bf16 v[112:127], v[56:59], v[240:243], v[112:127]
  ds_read_b64_tr_b16 v[52:53], v177 offset:16384
  ds_read_b64_tr_b16 v[54:55], v177 offset:18432
  s_waitcnt lgkmcnt(14)
  v_mfma_f32_32x32x16_bf16 v[128:143], v[60:63], v[240:243], v[128:143]
  ds_read_b64_tr_b16 v[56:57], v178 offset:16384
  ds_read_b64_tr_b16 v[58:59], v178 offset:18432
  s_waitcnt lgkmcnt(13)
  v_mfma_f32_32x32x16_bf16 v[80:95], v[64:67], v[244:247], v[80:95]
  ds_read_b64_tr_b16 v[60:61], v179 offset:16384
  ds_read_b64_tr_b16 v[62:63], v179 offset:18432
  s_waitcnt lgkmcnt(13)
  v_mfma_f32_32x32x16_bf16 v[96:111], v[68:71], v[244:247], v[96:111]
  ds_read_b128 v[252:255], v188 offset:3072
  ds_read_b64_tr_b16 v[64:65], v176 offset:24576
  ds_read_b64_tr_b16 v[66:67], v176 offset:26624
  s_waitcnt lgkmcnt(14)
  v_mfma_f32_32x32x16_bf16 v[112:127], v[72:75], v[244:247], v[112:127]
  ds_read_b64_tr_b16 v[68:69], v177 offset:24576
  ds_read_b64_tr_b16 v[70:71], v177 offset:26624
  s_waitcnt lgkmcnt(14)
  v_mfma_f32_32x32x16_bf16 v[128:143], v[76:79], v[244:247], v[128:143]
  ds_read_b64_tr_b16 v[72:73], v178 offset:24576
  ds_read_b64_tr_b16 v[74:75], v178 offset:26624
  s_waitcnt lgkmcnt(13)
  v_mfma_f32_32x32x16_bf16 v[80:95], v[48:51], v[248:251], v[80:95]
  ds_read_b64_tr_b16 v[76:77], v179 offset:24576
  ds_read_b64_tr_b16 v[78:79], v179 offset:26624
  s_waitcnt lgkmcnt(13)
  v_mfma_f32_32x32x16_bf16 v[96:111], v[52:55], v[248:251], v[96:111]
  s_waitcnt lgkmcnt(11)
  v_mfma_f32_32x32x16_bf16 v[112:127], v[56:59], v[248:251], v[112:127]
  s_waitcnt vmcnt(6) lgkmcnt(0)
  s_barrier
  ds_read_b128 v[224:227], v189 offset:0
  ds_read_b64_tr_b16 v[48:49], v180 offset:0
  ds_read_b64_tr_b16 v[50:51], v180 offset:2048
  ds_read_b64_tr_b16 v[52:53], v181 offset:0
  ds_read_b64_tr_b16 v[54:55], v181 offset:2048
  v_mfma_f32_32x32x16_bf16 v[128:143], v[60:63], v[248:251], v[128:143]
  s_add_u32 m0, s34, 32768
  s_mov_b32 s40, 24576
  buffer_load_dwordx4 v9, s[24:27], s40 offen sc1 lds
  ds_read_b64_tr_b16 v[56:57], v182 offset:0
  ds_read_b64_tr_b16 v[58:59], v182 offset:2048
  v_mfma_f32_32x32x16_bf16 v[80:95], v[64:67], v[252:255], v[80:95]
  s_add_u32 m0, s34, 40960
  s_mov_b32 s40, 98304
  buffer_load_dwordx4 v9, s[24:27], s40 offen sc1 lds
  ds_read_b64_tr_b16 v[60:61], v183 offset:0
  ds_read_b64_tr_b16 v[62:63], v183 offset:2048
  v_mfma_f32_32x32x16_bf16 v[96:111], v[68:71], v[252:255], v[96:111]
  s_add_u32 m0, s34, 0
  s_mov_b32 s40, 3145728
  buffer_load_dwordx4 v8, s[12:15], s40 offen lds
  ds_read_b128 v[228:231], v189 offset:1024
  ds_read_b64_tr_b16 v[64:65], v180 offset:8192
  ds_read_b64_tr_b16 v[66:67], v180 offset:10240
  v_mfma_f32_32x32x16_bf16 v[112:127], v[72:75], v[252:255], v[112:127]
  s_add_u32 m0, s34, 8192
  s_mov_b32 s40, 3276800
  buffer_load_dwordx4 v8, s[12:15], s40 offen lds
  ds_read_b64_tr_b16 v[68:69], v181 offset:8192
  ds_read_b64_tr_b16 v[70:71], v181 offset:10240
  v_mfma_f32_32x32x16_bf16 v[128:143], v[76:79], v[252:255], v[128:143]
  s_add_u32 m0, s34, 16384
  s_mov_b32 s40, 3407872
  buffer_load_dwordx4 v8, s[12:15], s40 offen lds
  ds_read_b64_tr_b16 v[72:73], v182 offset:8192
  ds_read_b64_tr_b16 v[74:75], v182 offset:10240
  s_waitcnt lgkmcnt(13)
  v_mfma_f32_32x32x16_bf16 v[80:95], v[48:51], v[224:227], v[80:95]
  s_add_u32 m0, s34, 24576
  s_mov_b32 s40, 3538944
  buffer_load_dwordx4 v8, s[12:15], s40 offen lds
  ds_read_b64_tr_b16 v[76:77], v183 offset:8192
  ds_read_b64_tr_b16 v[78:79], v183 offset:10240
  s_waitcnt lgkmcnt(13)
  v_mfma_f32_32x32x16_bf16 v[96:111], v[52:55], v[224:227], v[96:111]
  ds_read_b128 v[232:235], v189 offset:2048
  ds_read_b64_tr_b16 v[48:49], v180 offset:16384
  ds_read_b64_tr_b16 v[50:51], v180 offset:18432
  s_waitcnt lgkmcnt(14)
  v_mfma_f32_32x32x16_bf16 v[112:127], v[56:59], v[224:227], v[112:127]
  ds_read_b64_tr_b16 v[52:53], v181 offset:16384
  ds_read_b64_tr_b16 v[54:55], v181 offset:18432
  s_waitcnt lgkmcnt(14)
  v_mfma_f32_32x32x16_bf16 v[128:143], v[60:63], v[224:227], v[128:143]
  ds_read_b64_tr_b16 v[56:57], v182 offset:16384
  ds_read_b64_tr_b16 v[58:59], v182 offset:18432
  s_waitcnt lgkmcnt(13)
  v_mfma_f32_32x32x16_bf16 v[80:95], v[64:67], v[228:231], v[80:95]
  ds_read_b64_tr_b16 v[60:61], v183 offset:16384
  ds_read_b64_tr_b16 v[62:63], v183 offset:18432
  s_waitcnt lgkmcnt(13)
  v_mfma_f32_32x32x16_bf16 v[96:111], v[68:71], v[228:231], v[96:111]
  ds_read_b128 v[236:239], v189 offset:3072
  ds_read_b64_tr_b16 v[64:65], v180 offset:24576
  ds_read_b64_tr_b16 v[66:67], v180 offset:26624
  s_waitcnt lgkmcnt(14)
  v_mfma_f32_32x32x16_bf16 v[112:127], v[72:75], v[228:231], v[112:127]
  ds_read_b64_tr_b16 v[68:69], v181 offset:24576
  ds_read_b64_tr_b16 v[70:71], v181 offset:26624
  s_waitcnt lgkmcnt(14)
  v_mfma_f32_32x32x16_bf16 v[128:143], v[76:79], v[228:231], v[128:143]
  ds_read_b64_tr_b16 v[72:73], v182 offset:24576
  ds_read_b64_tr_b16 v[74:75], v182 offset:26624
  s_waitcnt lgkmcnt(13)
  v_mfma_f32_32x32x16_bf16 v[80:95], v[48:51], v[232:235], v[80:95]
  ds_read_b64_tr_b16 v[76:77], v183 offset:24576
  ds_read_b64_tr_b16 v[78:79], v183 offset:26624
  s_waitcnt lgkmcnt(13)
  v_mfma_f32_32x32x16_bf16 v[96:111], v[52:55], v[232:235], v[96:111]
  s_waitcnt lgkmcnt(11)
  v_mfma_f32_32x32x16_bf16 v[112:127], v[56:59], v[232:235], v[112:127]
  s_waitcnt vmcnt(6) lgkmcnt(0)
  s_barrier
  ds_read_b128 v[240:243], v190 offset:0
  ds_read_b64_tr_b16 v[48:49], v184 offset:0
  ds_read_b64_tr_b16 v[50:51], v184 offset:2048
  ds_read_b64_tr_b16 v[52:53], v185 offset:0
  ds_read_b64_tr_b16 v[54:55], v185 offset:2048
  v_mfma_f32_32x32x16_bf16 v[128:143], v[60:63], v[232:235], v[128:143]
  s_add_u32 m0, s34, 81920
  s_mov_b32 s40, 28672
  buffer_load_dwordx4 v9, s[24:27], s40 offen sc1 lds
  ds_read_b64_tr_b16 v[56:57], v186 offset:0
  ds_read_b64_tr_b16 v[58:59], v186 offset:2048
  v_mfma_f32_32x32x16_bf16 v[80:95], v[64:67], v[236:239], v[80:95]
  s_add_u32 m0, s34, 90112
  s_mov_b32 s40, 102400
  buffer_load_dwordx4 v9, s[24:27], s40 offen sc1 lds
  ds_read_b64_tr_b16 v[60:61], v187 offset:0
  ds_read_b64_tr_b16 v[62:63], v187 offset:2048
  v_mfma_f32_32x32x16_bf16 v[96:111], v[68:71], v[236:239], v[96:111]
  s_add_u32 m0, s34, 49152
  s_mov_b32 s40, 3670016
  buffer_load_dwordx4 v8, s[12:15], s40 offen lds
  ds_read_b128 v[244:247], v190 offset:1024
  ds_read_b64_tr_b16 v[64:65], v184 offset:8192
  ds_read_b64_tr_b16 v[66:67], v184 offset:10240
  v_mfma_f32_32x32x16_bf16 v[112:127], v[72:75], v[236:239], v[112:127]
  s_add_u32 m0, s34, 57344
  s_mov_b32 s40, 3801088
  buffer_load_dwordx4 v8, s[12:15], s40 offen lds
  ds_read_b64_tr_b16 v[68:69], v185 offset:8192
  ds_read_b64_tr_b16 v[70:71], v185 offset:10240
  v_mfma_f32_32x32x16_bf16 v[128:143], v[76:79], v[236:239], v[128:143]
  s_add_u32 m0, s34, 65536
  s_mov_b32 s40, 3932160
  buffer_load_dwordx4 v8, s[12:15], s40 offen lds
  ds_read_b64_tr_b16 v[72:73], v186 offset:8192
  ds_read_b64_tr_b16 v[74:75], v186 offset:10240
  s_waitcnt lgkmcnt(13)
  v_mfma_f32_32x32x16_bf16 v[80:95], v[48:51], v[240:243], v[80:95]
  s_add_u32 m0, s34, 73728
  s_mov_b32 s40, 4063232
  buffer_load_dwordx4 v8, s[12:15], s40 offen lds
  ds_read_b64_tr_b16 v[76:77], v187 offset:8192
  ds_read_b64_tr_b16 v[78:79], v187 offset:10240
  s_waitcnt lgkmcnt(13)
  v_mfma_f32_32x32x16_bf16 v[96:111], v[52:55], v[240:243], v[96:111]
  ds_read_b128 v[248:251], v190 offset:2048
  ds_read_b64_tr_b16 v[48:49], v184 offset:16384
  ds_read_b64_tr_b16 v[50:51], v184 offset:18432
  s_waitcnt lgkmcnt(14)
  v_mfma_f32_32x32x16_bf16 v[112:127], v[56:59], v[240:243], v[112:127]
  ds_read_b64_tr_b16 v[52:53], v185 offset:16384
  ds_read_b64_tr_b16 v[54:55], v185 offset:18432
  s_waitcnt lgkmcnt(14)
  v_mfma_f32_32x32x16_bf16 v[128:143], v[60:63], v[240:243], v[128:143]
  ds_read_b64_tr_b16 v[56:57], v186 offset:16384
  ds_read_b64_tr_b16 v[58:59], v186 offset:18432
  s_waitcnt lgkmcnt(13)
  v_mfma_f32_32x32x16_bf16 v[80:95], v[64:67], v[244:247], v[80:95]
  ds_read_b64_tr_b16 v[60:61], v187 offset:16384
  ds_read_b64_tr_b16 v[62:63], v187 offset:18432
  s_waitcnt lgkmcnt(13)
  v_mfma_f32_32x32x16_bf16 v[96:111], v[68:71], v[244:247], v[96:111]
  ds_read_b128 v[252:255], v190 offset:3072
  ds_read_b64_tr_b16 v[64:65], v184 offset:24576
  ds_read_b64_tr_b16 v[66:67], v184 offset:26624
  s_waitcnt lgkmcnt(14)
  v_mfma_f32_32x32x16_bf16 v[112:127], v[72:75], v[244:247], v[112:127]
  ds_read_b64_tr_b16 v[68:69], v185 offset:24576
  ds_read_b64_tr_b16 v[70:71], v185 offset:26624
  s_waitcnt lgkmcnt(14)
  v_mfma_f32_32x32x16_bf16 v[128:143], v[76:79], v[244:247], v[128:143]
  ds_read_b64_tr_b16 v[72:73], v186 offset:24576
  ds_read_b64_tr_b16 v[74:75], v186 offset:26624
  s_waitcnt lgkmcnt(13)
  v_mfma_f32_32x32x16_bf16 v[80:95], v[48:51], v[248:251], v[80:95]
  ds_read_b64_tr_b16 v[76:77], v187 offset:24576
  ds_read_b64_tr_b16 v[78:79], v187 offset:26624
  s_waitcnt lgkmcnt(13)
  v_mfma_f32_32x32x16_bf16 v[96:111], v[52:55], v[248:251], v[96:111]
  s_waitcnt lgkmcnt(11)
  v_mfma_f32_32x32x16_bf16 v[112:127], v[56:59], v[248:251], v[112:127]
  s_waitcnt vmcnt(6) lgkmcnt(0)
  s_barrier
  ds_read_b128 v[224:227], v188 offset:0
  ds_read_b64_tr_b16 v[48:49], v176 offset:0
  ds_read_b64_tr_b16 v[50:51], v176 offset:2048
  ds_read_b64_tr_b16 v[52:53], v177 offset:0
  ds_read_b64_tr_b16 v[54:55], v177 offset:2048
  v_mfma_f32_32x32x16_bf16 v[128:143], v[60:63], v[248:251], v[128:143]
  s_add_u32 m0, s34, 131072
  s_mov_b32 s40, 32768
  buffer_load_dwordx4 v9, s[24:27], s40 offen sc1 lds
  ds_read_b64_tr_b16 v[56:57], v178 offset:0
  ds_read_b64_tr_b16 v[58:59], v178 offset:2048
  v_mfma_f32_32x32x16_bf16 v[80:95], v[64:67], v[252:255], v[80:95]
  s_add_u32 m0, s34, 139264
  s_mov_b32 s40, 106496
  buffer_load_dwordx4 v9, s[24:27], s40 offen sc1 lds
  ds_read_b64_tr_b16 v[60:61], v179 offset:0
  ds_read_b64_tr_b16 v[62:63], v179 offset:2048
  v_mfma_f32_32x32x16_bf16 v[96:111], v[68:71], v[252:255], v[96:111]
  s_add_u32 m0, s34, 98304
  s_mov_b32 s40, 4194304
  buffer_load_dwordx4 v8, s[12:15], s40 offen lds
  ds_read_b128 v[228:231], v188 offset:1024
  ds_read_b64_tr_b16 v[64:65], v176 offset:8192
  ds_read_b64_tr_b16 v[66:67], v176 offset:10240
  v_mfma_f32_32x32x16_bf16 v[112:127], v[72:75], v[252:255], v[112:127]
  s_add_u32 m0, s34, 106496
  s_mov_b32 s40, 4325376
  buffer_load_dwordx4 v8, s[12:15], s40 offen lds
  ds_read_b64_tr_b16 v[68:69], v177 offset:8192
  ds_read_b64_tr_b16 v[70:71], v177 offset:10240
  v_mfma_f32_32x32x16_bf16 v[128:143], v[76:79], v[252:255], v[128:143]
  s_add_u32 m0, s34, 114688
  s_mov_b32 s40, 4456448
  buffer_load_dwordx4 v8, s[12:15], s40 offen lds
  ds_read_b64_tr_b16 v[72:73], v178 offset:8192
  ds_read_b64_tr_b16 v[74:75], v178 offset:10240
  s_waitcnt lgkmcnt(13)
  v_mfma_f32_32x32x16_bf16 v[80:95], v[48:51], v[224:227], v[80:95]
  s_add_u32 m0, s34, 122880
  s_mov_b32 s40, 4587520
  buffer_load_dwordx4 v8, s[12:15], s40 offen lds
  ds_read_b64_tr_b16 v[76:77], v179 offset:8192
  ds_read_b64_tr_b16 v[78:79], v179 offset:10240
  s_waitcnt lgkmcnt(13)
  v_mfma_f32_32x32x16_bf16 v[96:111], v[52:55], v[224:227], v[96:111]
  ds_read_b128 v[232:235], v188 offset:2048
  ds_read_b64_tr_b16 v[48:49], v176 offset:16384
  ds_read_b64_tr_b16 v[50:51], v176 offset:18432
  s_waitcnt lgkmcnt(14)
  v_mfma_f32_32x32x16_bf16 v[112:127], v[56:59], v[224:227], v[112:127]
  ds_read_b64_tr_b16 v[52:53], v177 offset:16384
  ds_read_b64_tr_b16 v[54:55], v177 offset:18432
  s_waitcnt lgkmcnt(14)
  v_mfma_f32_32x32x16_bf16 v[128:143], v[60:63], v[224:227], v[128:143]
  ds_read_b64_tr_b16 v[56:57], v178 offset:16384
  ds_read_b64_tr_b16 v[58:59], v178 offset:18432
  s_waitcnt lgkmcnt(13)
  v_mfma_f32_32x32x16_bf16 v[80:95], v[64:67], v[228:231], v[80:95]
  ds_read_b64_tr_b16 v[60:61], v179 offset:16384
  ds_read_b64_tr_b16 v[62:63], v179 offset:18432
  s_waitcnt lgkmcnt(13)
  v_mfma_f32_32x32x16_bf16 v[96:111], v[68:71], v[228:231], v[96:111]
  ds_read_b128 v[236:239], v188 offset:3072
  ds_read_b64_tr_b16 v[64:65], v176 offset:24576
  ds_read_b64_tr_b16 v[66:67], v176 offset:26624
  s_waitcnt lgkmcnt(14)
  v_mfma_f32_32x32x16_bf16 v[112:127], v[72:75], v[228:231], v[112:127]
  ds_read_b64_tr_b16 v[68:69], v177 offset:24576
  ds_read_b64_tr_b16 v[70:71], v177 offset:26624
  s_waitcnt lgkmcnt(14)
  v_mfma_f32_32x32x16_bf16 v[128:143], v[76:79], v[228:231], v[128:143]
  ds_read_b64_tr_b16 v[72:73], v178 offset:24576
  ds_read_b64_tr_b16 v[74:75], v178 offset:26624
  s_waitcnt lgkmcnt(13)
  v_mfma_f32_32x32x16_bf16 v[80:95], v[48:51], v[232:235], v[80:95]
  ds_read_b64_tr_b16 v[76:77], v179 offset:24576
  ds_read_b64_tr_b16 v[78:79], v179 offset:26624
  s_waitcnt lgkmcnt(13)
  v_mfma_f32_32x32x16_bf16 v[96:111], v[52:55], v[232:235], v[96:111]
  s_waitcnt lgkmcnt(11)
  v_mfma_f32_32x32x16_bf16 v[112:127], v[56:59], v[232:235], v[112:127]
  s_waitcnt vmcnt(6) lgkmcnt(0)
  s_barrier
  ds_read_b128 v[240:243], v189 offset:0
  ds_read_b64_tr_b16 v[48:49], v180 offset:0
  ds_read_b64_tr_b16 v[50:51], v180 offset:2048
  ds_read_b64_tr_b16 v[52:53], v181 offset:0
  ds_read_b64_tr_b16 v[54:55], v181 offset:2048
  v_mfma_f32_32x32x16_bf16 v[128:143], v[60:63], v[232:235], v[128:143]
  s_add_u32 m0, s34, 0
  s_mov_b32 s40, 0
  buffer_load_dwordx4 v10, s[16:19], s40 offen lds
  ds_read_b64_tr_b16 v[56:57], v182 offset:0
  ds_read_b64_tr_b16 v[58:59], v182 offset:2048
  v_mfma_f32_32x32x16_bf16 v[80:95], v[64:67], v[236:239], v[80:95]
  s_add_u32 m0, s34, 8192
  s_mov_b32 s40, 8192
  buffer_load_dwordx4 v10, s[16:19], s40 offen lds
  ds_read_b64_tr_b16 v[60:61], v183 offset:0
  ds_read_b64_tr_b16 v[62:63], v183 offset:2048
  v_mfma_f32_32x32x16_bf16 v[96:111], v[68:71], v[236:239], v[96:111]
  s_add_u32 m0, s34, 16384
  s_mov_b32 s40, 16384
  buffer_load_dwordx4 v10, s[16:19], s40 offen lds
  ds_read_b128 v[244:247], v189 offset:1024
  ds_read_b64_tr_b16 v[64:65], v180 offset:8192
  ds_read_b64_tr_b16 v[66:67], v180 offset:10240
  v_mfma_f32_32x32x16_bf16 v[112:127], v[72:75], v[236:239], v[112:127]
  s_add_u32 m0, s34, 24576
  s_mov_b32 s40, 24576
  buffer_load_dwordx4 v10, s[16:19], s40 offen lds
  ds_read_b64_tr_b16 v[68:69], v181 offset:8192
  ds_read_b64_tr_b16 v[70:71], v181 offset:10240
  v_mfma_f32_32x32x16_bf16 v[128:143], v[76:79], v[236:239], v[128:143]
  s_add_u32 m0, s34, 32768
  s_mov_b32 s40, 32768
  buffer_load_dwordx4 v10, s[16:19], s40 offen lds
  ds_read_b64_tr_b16 v[72:73], v182 offset:8192
  ds_read_b64_tr_b16 v[74:75], v182 offset:10240
  s_waitcnt lgkmcnt(13)
  v_mfma_f32_32x32x16_bf16 v[80:95], v[48:51], v[240:243], v[80:95]
  s_add_u32 m0, s34, 40960
  s_mov_b32 s40, 40960
  buffer_load_dwordx4 v10, s[16:19], s40 offen lds
  ds_read_b64_tr_b16 v[76:77], v183 offset:8192
  ds_read_b64_tr_b16 v[78:79], v183 offset:10240
  s_waitcnt lgkmcnt(13)
  v_mfma_f32_32x32x16_bf16 v[96:111], v[52:55], v[240:243], v[96:111]
  ds_read_b128 v[248:251], v189 offset:2048
  ds_read_b64_tr_b16 v[48:49], v180 offset:16384
  ds_read_b64_tr_b16 v[50:51], v180 offset:18432
  s_waitcnt lgkmcnt(14)
  v_mfma_f32_32x32x16_bf16 v[112:127], v[56:59], v[240:243], v[112:127]
  ds_read_b64_tr_b16 v[52:53], v181 offset:16384
  ds_read_b64_tr_b16 v[54:55], v181 offset:18432
  s_waitcnt lgkmcnt(14)
  v_mfma_f32_32x32x16_bf16 v[128:143], v[60:63], v[240:243], v[128:143]
  ds_read_b64_tr_b16 v[56:57], v182 offset:16384
  ds_read_b64_tr_b16 v[58:59], v182 offset:18432
  s_waitcnt lgkmcnt(13)
  v_mfma_f32_32x32x16_bf16 v[80:95], v[64:67], v[244:247], v[80:95]
  ds_read_b64_tr_b16 v[60:61], v183 offset:16384
  ds_read_b64_tr_b16 v[62:63], v183 offset:18432
  s_waitcnt lgkmcnt(13)
  v_mfma_f32_32x32x16_bf16 v[96:111], v[68:71], v[244:247], v[96:111]
  ds_read_b128 v[252:255], v189 offset:3072
  ds_read_b64_tr_b16 v[64:65], v180 offset:24576
  ds_read_b64_tr_b16 v[66:67], v180 offset:26624
  s_waitcnt lgkmcnt(14)
  v_mfma_f32_32x32x16_bf16 v[112:127], v[72:75], v[244:247], v[112:127]
  ds_read_b64_tr_b16 v[68:69], v181 offset:24576
  ds_read_b64_tr_b16 v[70:71], v181 offset:26624
  s_waitcnt lgkmcnt(14)
  v_mfma_f32_32x32x16_bf16 v[128:143], v[76:79], v[244:247], v[128:143]
  ds_read_b64_tr_b16 v[72:73], v182 offset:24576
  ds_read_b64_tr_b16 v[74:75], v182 offset:26624
  s_waitcnt lgkmcnt(13)
  v_mfma_f32_32x32x16_bf16 v[80:95], v[48:51], v[248:251], v[80:95]
  ds_read_b64_tr_b16 v[76:77], v183 offset:24576
  ds_read_b64_tr_b16 v[78:79], v183 offset:26624
  s_waitcnt lgkmcnt(13)
  v_mfma_f32_32x32x16_bf16 v[96:111], v[52:55], v[248:251], v[96:111]
  s_waitcnt lgkmcnt(11)
  v_mfma_f32_32x32x16_bf16 v[112:127], v[56:59], v[248:251], v[112:127]
  s_waitcnt vmcnt(6) lgkmcnt(0)
  s_barrier
  ds_read_b128 v[224:227], v190 offset:0
  ds_read_b64_tr_b16 v[48:49], v184 offset:0
  ds_read_b64_tr_b16 v[50:51], v184 offset:2048
  ds_read_b128 v[228:231], v190 offset:1024
  ds_read_b64_tr_b16 v[52:53], v184 offset:8192
  ds_read_b64_tr_b16 v[54:55], v184 offset:10240
  v_mfma_f32_32x32x16_bf16 v[128:143], v[60:63], v[248:251], v[128:143]
  s_add_u32 m0, s34, 65536
  s_mov_b32 s40, 0
  buffer_load_dwordx4 v11, s[20:23], s40 offen lds
  ds_read_b128 v[232:235], v190 offset:2048
  ds_read_b64_tr_b16 v[56:57], v184 offset:16384
  ds_read_b64_tr_b16 v[58:59], v184 offset:18432
  v_mfma_f32_32x32x16_bf16 v[80:95], v[64:67], v[252:255], v[80:95]
  s_add_u32 m0, s34, 73728
  s_mov_b32 s40, 8192
  buffer_load_dwordx4 v11, s[20:23], s40 offen lds
  ds_read_b128 v[236:239], v190 offset:3072
  ds_read_b64_tr_b16 v[60:61], v184 offset:24576
  ds_read_b64_tr_b16 v[62:63], v184 offset:26624
  v_mfma_f32_32x32x16_bf16 v[96:111], v[68:71], v[252:255], v[96:111]
  s_add_u32 m0, s34, 49152
  s_mov_b32 s40, 49152
  buffer_load_dwordx4 v10, s[16:19], s40 offen lds
  ds_read_b64_tr_b16 v[64:65], v185 offset:0
  ds_read_b64_tr_b16 v[66:67], v185 offset:2048
  v_mfma_f32_32x32x16_bf16 v[112:127], v[72:75], v[252:255], v[112:127]
  s_add_u32 m0, s34, 57344
  s_mov_b32 s40, 57344
  buffer_load_dwordx4 v10, s[16:19], s40 offen lds
  ds_read_b64_tr_b16 v[68:69], v185 offset:8192
  ds_read_b64_tr_b16 v[70:71], v185 offset:10240
  v_mfma_f32_32x32x16_bf16 v[128:143], v[76:79], v[252:255], v[128:143]
  s_add_u32 m0, s34, 81920
  s_mov_b32 s40, 16384
  buffer_load_dwordx4 v11, s[20:23], s40 offen lds
  ds_read_b64_tr_b16 v[72:73], v185 offset:16384
  ds_read_b64_tr_b16 v[74:75], v185 offset:18432
  s_waitcnt lgkmcnt(15)
  v_mfma_f32_32x32x16_bf16 v[80:95], v[48:51], v[224:227], v[80:95]
  s_add_u32 m0, s34, 90112
  s_mov_b32 s40, 24576
  buffer_load_dwordx4 v11, s[20:23], s40 offen lds
  ds_read_b64_tr_b16 v[76:77], v185 offset:24576
  ds_read_b64_tr_b16 v[78:79], v185 offset:26624
  s_waitcnt lgkmcnt(14)
  v_mfma_f32_32x32x16_bf16 v[80:95], v[52:55], v[228:231], v[80:95]
  ds_read_b64_tr_b16 v[48:49], v186 offset:0
  ds_read_b64_tr_b16 v[50:51], v186 offset:2048
  s_waitcnt lgkmcnt(13)
  v_mfma_f32_32x32x16_bf16 v[80:95], v[56:59], v[232:235], v[80:95]
  ds_read_b64_tr_b16 v[52:53], v186 offset:8192
  ds_read_b64_tr_b16 v[54:55], v186 offset:10240
  s_waitcnt lgkmcnt(12)
  v_mfma_f32_32x32x16_bf16 v[80:95], v[60:63], v[236:239], v[80:95]
  ds_read_b64_tr_b16 v[56:57], v186 offset:16384
  ds_read_b64_tr_b16 v[58:59], v186 offset:18432
  s_waitcnt lgkmcnt(12)
  v_mfma_f32_32x32x16_bf16 v[96:111], v[64:67], v[224:227], v[96:111]
  ds_read_b64_tr_b16 v[60:61], v186 offset:24576
  ds_read_b64_tr_b16 v[62:63], v186 offset:26624
  s_waitcnt lgkmcnt(12)
  v_mfma_f32_32x32x16_bf16 v[96:111], v[68:71], v[228:231], v[96:111]
  s_nop 3
  v_mul_f32 v80, s36, v80
  v_mul_f32 v81, s36, v81
  v_mul_f32 v82, s36, v82
  v_mul_f32 v83, s36, v83
  v_mul_f32 v84, s36, v84
  v_mul_f32 v85, s36, v85
  ds_read_b64_tr_b16 v[64:65], v187 offset:0
  ds_read_b64_tr_b16 v[66:67], v187 offset:2048
  s_waitcnt lgkmcnt(12)
  v_mfma_f32_32x32x16_bf16 v[96:111], v[72:75], v[232:235], v[96:111]
  v_mul_f32 v86, s36, v86
  v_mul_f32 v87, s36, v87
  v_mul_f32 v88, s36, v88
  v_mul_f32 v89, s36, v89
  v_mul_f32 v90, s36, v90
  v_mul_f32 v91, s36, v91
  ds_read_b64_tr_b16 v[68:69], v187 offset:8192
  ds_read_b64_tr_b16 v[70:71], v187 offset:10240
  s_waitcnt lgkmcnt(12)
  v_mfma_f32_32x32x16_bf16 v[96:111], v[76:79], v[236:239], v[96:111]
  v_mul_f32 v92, s36, v92
  v_mul_f32 v93, s36, v93
  v_mul_f32 v94, s36, v94
  v_mul_f32 v95, s36, v95
  v_cvt_pk_bf16_f32 v144, v80, v81
  v_cvt_pk_bf16_f32 v145, v82, v83
  ds_read_b64_tr_b16 v[72:73], v187 offset:16384
  ds_read_b64_tr_b16 v[74:75], v187 offset:18432
  s_waitcnt lgkmcnt(12)
  v_mfma_f32_32x32x16_bf16 v[112:127], v[48:51], v[224:227], v[112:127]
  v_cvt_pk_bf16_f32 v146, v84, v85
  v_cvt_pk_bf16_f32 v147, v86, v87
  v_cvt_pk_bf16_f32 v148, v88, v89
  v_cvt_pk_bf16_f32 v149, v90, v91
  v_cvt_pk_bf16_f32 v150, v92, v93
  v_cvt_pk_bf16_f32 v151, v94, v95
  ds_read_b64_tr_b16 v[76:77], v187 offset:24576
  ds_read_b64_tr_b16 v[78:79], v187 offset:26624
  s_waitcnt lgkmcnt(12)
  v_mfma_f32_32x32x16_bf16 v[112:127], v[52:55], v[228:231], v[112:127]
  v_mul_f32 v96, s36, v96
  v_mul_f32 v97, s36, v97
  v_mul_f32 v98, s36, v98
  v_mul_f32 v99, s36, v99
  v_mul_f32 v100, s36, v100
  v_mul_f32 v101, s36, v101
  s_waitcnt lgkmcnt(10)
  v_mfma_f32_32x32x16_bf16 v[112:127], v[56:59], v[232:235], v[112:127]
  v_mul_f32 v102, s36, v102
  v_mul_f32 v103, s36, v103
  v_mul_f32 v104, s36, v104
  v_mul_f32 v105, s36, v105
  v_mul_f32 v106, s36, v106
  v_mul_f32 v107, s36, v107
  s_waitcnt vmcnt(10) lgkmcnt(0)
  s_barrier
  s_cmp_eq_u32 s3, 0
  s_cselect_b32 s41, 0, -1
  v_or_b32 v252, s41, v47
  buffer_load_dword v252, v252, s[44:47], 0 offen
  s_cmp_eq_u32 s3, 0
  s_cselect_b32 s78, 5308416, 0
  buffer_load_dword v240, v44, s[76:79], 0 offen
  s_cselect_b32 s82, 5308416, 0
  buffer_load_dword v241, v45, s[80:83], 0 offen
  s_cselect_b32 s86, 5308416, 0
  buffer_load_dword v242, v46, s[84:87], 0 offen
  ds_read_b128 v[48:51], v14 offset:0
  ds_read_b128 v[52:55], v15 offset:0
  v_mfma_f32_32x32x16_bf16 v[112:127], v[60:63], v[236:239], v[112:127]
  s_add_u32 m0, s34, 98304
  s_mov_b32 s40, 32768
  buffer_load_dwordx4 v11, s[20:23], s40 offen lds
  v_mul_f32 v108, s36, v108
  v_mul_f32 v109, s36, v109
  v_mul_f32 v110, s36, v110
  v_mul_f32 v111, s36, v111
  ds_read_b128 v[56:59], v16 offset:0
  v_mfma_f32_32x32x16_bf16 v[128:143], v[64:67], v[224:227], v[128:143]
  s_add_u32 m0, s34, 106496
  s_mov_b32 s40, 40960
  buffer_load_dwordx4 v11, s[20:23], s40 offen lds
  v_cvt_pk_bf16_f32 v152, v96, v97
  v_cvt_pk_bf16_f32 v153, v98, v99
  v_cvt_pk_bf16_f32 v154, v100, v101
  v_cvt_pk_bf16_f32 v155, v102, v103
  ds_read_b128 v[60:63], v17 offset:0
  v_mfma_f32_32x32x16_bf16 v[128:143], v[68:71], v[228:231], v[128:143]
  s_add_u32 m0, s34, 114688
  s_mov_b32 s40, 49152
  buffer_load_dwordx4 v11, s[20:23], s40 offen lds
  v_cvt_pk_bf16_f32 v156, v104, v105
  v_cvt_pk_bf16_f32 v157, v106, v107
  v_cvt_pk_bf16_f32 v158, v108, v109
  v_cvt_pk_bf16_f32 v159, v110, v111
  ds_read_b128 v[64:67], v18 offset:0
  v_mfma_f32_32x32x16_bf16 v[128:143], v[72:75], v[232:235], v[128:143]
  s_add_u32 m0, s34, 122880
  s_mov_b32 s40, 57344
  buffer_load_dwordx4 v11, s[20:23], s40 offen lds
  v_mul_f32 v112, s36, v112
  v_mul_f32 v113, s36, v113
  v_mul_f32 v114, s36, v114
  v_mul_f32 v115, s36, v115
  ds_read_b128 v[68:71], v19 offset:0
  v_mfma_f32_32x32x16_bf16 v[128:143], v[76:79], v[236:239], v[128:143]
  v_mul_f32 v116, s36, v116
  v_mul_f32 v117, s36, v117
  v_mul_f32 v118, s36, v118
  v_mul_f32 v119, s36, v119
  v_mul_f32 v120, s36, v120
  v_mul_f32 v121, s36, v121
  ds_read_b128 v[72:75], v20 offset:0
  s_waitcnt lgkmcnt(6)
  v_mfma_f32_32x32x16_bf16 v[176:191], v[48:51], v[144:147], 0
  v_mul_f32 v122, s36, v122
  v_mul_f32 v123, s36, v123
  v_mul_f32 v124, s36, v124
  v_mul_f32 v125, s36, v125
  v_mul_f32 v126, s36, v126
  v_mul_f32 v127, s36, v127
  ds_read_b128 v[76:79], v21 offset:0
  s_waitcnt lgkmcnt(6)
  v_mfma_f32_32x32x16_bf16 v[176:191], v[52:55], v[148:151], v[176:191]
  v_cvt_pk_bf16_f32 v160, v112, v113
  v_cvt_pk_bf16_f32 v161, v114, v115
  v_cvt_pk_bf16_f32 v162, v116, v117
  v_cvt_pk_bf16_f32 v163, v118, v119
  v_cvt_pk_bf16_f32 v164, v120, v121
  v_cvt_pk_bf16_f32 v165, v122, v123
  ds_read_b128 v[48:51], v14 offset:8192
  s_waitcnt lgkmcnt(6)
  v_mfma_f32_32x32x16_bf16 v[176:191], v[56:59], v[152:155], v[176:191]
  v_cvt_pk_bf16_f32 v166, v124, v125
  v_cvt_pk_bf16_f32 v167, v126, v127
  v_mul_f32 v128, s36, v128
  v_mul_f32 v129, s36, v129
  v_mul_f32 v130, s36, v130
  v_mul_f32 v131, s36, v131
  ds_read_b128 v[52:55], v15 offset:8192
  s_waitcnt lgkmcnt(6)
  v_mfma_f32_32x32x16_bf16 v[176:191], v[60:63], v[156:159], v[176:191]
  v_mul_f32 v132, s36, v132
  v_mul_f32 v133, s36, v133
  v_mul_f32 v134, s36, v134
  v_mul_f32 v135, s36, v135
  v_mul_f32 v136, s36, v136
  v_mul_f32 v137, s36, v137
  ds_read_b128 v[56:59], v16 offset:8192
  s_waitcnt lgkmcnt(6)
  v_mfma_f32_32x32x16_bf16 v[176:191], v[64:67], v[160:163], v[176:191]
  v_mul_f32 v138, s36, v138
  v_mul_f32 v139, s36, v139
  v_mul_f32 v140, s36, v140
  v_mul_f32 v141, s36, v141
  v_mul_f32 v142, s36, v142
  v_mul_f32 v143, s36, v143
  ds_read_b128 v[60:63], v17 offset:8192
  s_waitcnt lgkmcnt(6)
  v_mfma_f32_32x32x16_bf16 v[176:191], v[68:71], v[164:167], v[176:191]
  v_cvt_pk_bf16_f32 v168, v128, v129
  v_cvt_pk_bf16_f32 v169, v130, v131
  v_cvt_pk_bf16_f32 v170, v132, v133
  v_cvt_pk_bf16_f32 v171, v134, v135
  v_cvt_pk_bf16_f32 v172, v136, v137
  v_cvt_pk_bf16_f32 v173, v138, v139
  ds_read_b128 v[64:67], v18 offset:8192
  v_cvt_pk_bf16_f32 v174, v140, v141
  v_cvt_pk_bf16_f32 v175, v142, v143
  s_waitcnt lgkmcnt(6)
  v_mfma_f32_32x32x16_bf16 v[176:191], v[72:75], v[168:171], v[176:191]
  ds_read_b128 v[68:71], v19 offset:8192
  s_waitcnt lgkmcnt(6)
  v_mfma_f32_32x32x16_bf16 v[176:191], v[76:79], v[172:175], v[176:191]
  ds_read_b128 v[72:75], v20 offset:8192
  s_waitcnt lgkmcnt(6)
  v_mfma_f32_32x32x16_bf16 v[192:207], v[48:51], v[144:147], 0
  ds_read_b128 v[76:79], v21 offset:8192
  s_waitcnt lgkmcnt(6)
  v_mfma_f32_32x32x16_bf16 v[192:207], v[52:55], v[148:151], v[192:207]
  s_nop 5
  v_max3_f32 v42, v176, v177, v178
  v_max3_f32 v43, v179, v180, v181
  v_max3_f32 v42, v42, v182, v183
  v_max3_f32 v43, v43, v184, v185
  v_max3_f32 v42, v42, v186, v187
  v_max3_f32 v43, v43, v188, v189
  v_max3_f32 v42, v42, v190, v191
  v_max_f32 v42, v42, v43
  s_waitcnt lgkmcnt(5)
  v_mfma_f32_32x32x16_bf16 v[192:207], v[56:59], v[152:155], v[192:207]
  v_mov_b32 v43, v42
  s_nop 1
  v_permlane32_swap_b32 v43, v42
  v_max_f32 v42, v42, v43
  v_sub_f32 v224, 0, v42
  v_sub_f32 v225, 0, v42
  v_sub_f32 v226, 0, v42
  v_sub_f32 v227, 0, v42
  v_sub_f32 v228, 0, v42
  s_waitcnt vmcnt(12) lgkmcnt(0)
  s_barrier
  s_cmp_eq_u32 s3, 1
  s_cselect_b32 s41, 0, -1
  v_or_b32 v253, s41, v47
  buffer_load_dword v253, v253, s[44:47], 0 offen
  s_cmp_eq_u32 s3, 1
  s_cselect_b32 s78, 5308416, 0
  buffer_load_dword v243, v44, s[76:79], 0 offen
  s_cselect_b32 s82, 5308416, 0
  buffer_load_dword v244, v45, s[80:83], 0 offen
  s_cselect_b32 s86, 5308416, 0
  buffer_load_dword v245, v46, s[84:87], 0 offen
  ds_read_b128 v[48:51], v14 offset:16384
  ds_read_b128 v[52:55], v15 offset:16384
  v_mfma_f32_32x32x16_bf16 v[192:207], v[60:63], v[156:159], v[192:207]
  s_add_u32 m0, s34, 0
  s_mov_b32 s40, 65536
  buffer_load_dwordx4 v10, s[16:19], s40 offen lds
  v_sub_f32 v229, 0, v42
  v_sub_f32 v230, 0, v42
  v_sub_f32 v231, 0, v42
  v_sub_f32 v232, 0, v42
  v_sub_f32 v233, 0, v42
  v_sub_f32 v234, 0, v42
  ds_read_b128 v[56:59], v16 offset:16384
  v_mfma_f32_32x32x16_bf16 v[192:207], v[64:67], v[160:163], v[192:207]
  s_add_u32 m0, s34, 8192
  s_mov_b32 s40, 73728
  buffer_load_dwordx4 v10, s[16:19], s40 offen lds
  v_sub_f32 v235, 0, v42
  v_sub_f32 v236, 0, v42
  v_sub_f32 v237, 0, v42
  v_sub_f32 v238, 0, v42
  v_sub_f32 v239, 0, v42
  v_add_f32 v176, v176, v224
  ds_read_b128 v[60:63], v17 offset:16384
  v_mfma_f32_32x32x16_bf16 v[192:207], v[68:71], v[164:167], v[192:207]
  v_add_f32 v177, v177, v224
  v_add_f32 v178, v178, v224
  v_add_f32 v179, v179, v224
  v_add_f32 v180, v180, v224
  v_add_f32 v181, v181, v224
  v_add_f32 v182, v182, v224
  v_add_f32 v183, v183, v224
  v_add_f32 v184, v184, v224
  ds_read_b128 v[64:67], v18 offset:16384
  v_mfma_f32_32x32x16_bf16 v[192:207], v[72:75], v[168:171], v[192:207]
  v_add_f32 v185, v185, v224
  v_add_f32 v186, v186, v224
  v_add_f32 v187, v187, v224
  v_add_f32 v188, v188, v224
  v_add_f32 v189, v189, v224
  v_add_f32 v190, v190, v224
  v_add_f32 v191, v191, v224
  v_exp_f32 v38, v176
  ds_read_b128 v[68:71], v19 offset:16384
  v_mfma_f32_32x32x16_bf16 v[192:207], v[76:79], v[172:175], v[192:207]
  v_exp_f32 v39, v177
  v_exp_f32 v40, v178
  v_exp_f32 v41, v179
  v_add_f32 v35, v38, v39
  v_cvt_pk_bf16_f32 v208, v38, v39
  v_exp_f32 v38, v180
  v_exp_f32 v39, v181
  v_add_f32 v36, v40, v41
  v_cvt_pk_bf16_f32 v209, v40, v41
  v_exp_f32 v40, v182
  v_exp_f32 v41, v183
  v_add_f32 v35, v35, v38
  v_add_f32 v36, v36, v39
  v_cvt_pk_bf16_f32 v210, v38, v39
  v_exp_f32 v38, v184
  v_exp_f32 v39, v185
  v_add_f32 v35, v35, v40
  v_add_f32 v36, v36, v41
  v_cvt_pk_bf16_f32 v211, v40, v41
  v_exp_f32 v40, v186
  v_exp_f32 v41, v187
  v_add_f32 v35, v35, v38
  v_add_f32 v36, v36, v39
  v_cvt_pk_bf16_f32 v212, v38, v39
  v_exp_f32 v38, v188
  v_exp_f32 v39, v189
  v_add_f32 v35, v35, v40
  v_add_f32 v36, v36, v41
  v_cvt_pk_bf16_f32 v213, v40, v41
  v_exp_f32 v40, v190
  v_exp_f32 v41, v191
  v_add_f32 v35, v35, v38
  v_add_f32 v36, v36, v39
  v_cvt_pk_bf16_f32 v214, v38, v39
  v_add_f32 v35, v35, v40
  v_add_f32 v36, v36, v41
  v_cvt_pk_bf16_f32 v215, v40, v41
  v_add_f32 v35, v35, v36
  v_add_f32 v34, v34, v35
  ds_read_b128 v[72:75], v20 offset:16384
  s_waitcnt lgkmcnt(6)
  v_mfma_f32_32x32x16_bf16 v[176:191], v[48:51], v[144:147], v[224:239]
  ds_read_b128 v[76:79], v21 offset:16384
  s_waitcnt lgkmcnt(6)
  v_mfma_f32_32x32x16_bf16 v[176:191], v[52:55], v[148:151], v[176:191]
  v_add_f32 v192, v192, v224
  v_add_f32 v193, v193, v224
  v_add_f32 v194, v194, v224
  v_add_f32 v195, v195, v224
  v_add_f32 v196, v196, v224
  v_add_f32 v197, v197, v224
  v_add_f32 v198, v198, v224
  v_add_f32 v199, v199, v224
  ds_read_b64_tr_b16 v[48:49], v22 offset:0
  ds_read_b64_tr_b16 v[50:51], v22 offset:2048
  s_waitcnt lgkmcnt(7)
  v_mfma_f32_32x32x16_bf16 v[176:191], v[56:59], v[152:155], v[176:191]
  v_add_f32 v200, v200, v224
  v_add_f32 v201, v201, v224
  v_add_f32 v202, v202, v224
  v_add_f32 v203, v203, v224
  v_add_f32 v204, v204, v224
  v_add_f32 v205, v205, v224
  v_add_f32 v206, v206, v224
  v_add_f32 v207, v207, v224
  ds_read_b64_tr_b16 v[52:53], v22 offset:4096
  ds_read_b64_tr_b16 v[54:55], v22 offset:6144
  s_waitcnt lgkmcnt(8)
  v_mfma_f32_32x32x16_bf16 v[176:191], v[60:63], v[156:159], v[176:191]
  v_exp_f32 v38, v192
  v_exp_f32 v39, v193
  v_exp_f32 v40, v194
  v_exp_f32 v41, v195
  ds_read_b64_tr_b16 v[56:57], v23 offset:0
  ds_read_b64_tr_b16 v[58:59], v23 offset:2048
  s_waitcnt lgkmcnt(9)
  v_mfma_f32_32x32x16_bf16 v[176:191], v[64:67], v[160:163], v[176:191]
  v_add_f32 v35, v38, v39
  v_cvt_pk_bf16_f32 v216, v38, v39
  v_exp_f32 v38, v196
  v_exp_f32 v39, v197
  v_add_f32 v36, v40, v41
  v_cvt_pk_bf16_f32 v217, v40, v41
  ds_read_b64_tr_b16 v[60:61], v23 offset:4096
  ds_read_b64_tr_b16 v[62:63], v23 offset:6144
  s_waitcnt lgkmcnt(10)
  v_mfma_f32_32x32x16_bf16 v[176:191], v[68:71], v[164:167], v[176:191]
  v_exp_f32 v40, v198
  v_exp_f32 v41, v199
  v_add_f32 v35, v35, v38
  v_add_f32 v36, v36, v39
  v_cvt_pk_bf16_f32 v218, v38, v39
  v_exp_f32 v38, v200
  ds_read_b64_tr_b16 v[64:65], v24 offset:0
  ds_read_b64_tr_b16 v[66:67], v24 offset:2048
  s_waitcnt lgkmcnt(11)
  v_mfma_f32_32x32x16_bf16 v[176:191], v[72:75], v[168:171], v[176:191]
  v_exp_f32 v39, v201
  v_add_f32 v35, v35, v40
  v_add_f32 v36, v36, v41
  v_cvt_pk_bf16_f32 v219, v40, v41
  v_exp_f32 v40, v202
  v_exp_f32 v41, v203
  ds_read_b64_tr_b16 v[68:69], v24 offset:4096
  ds_read_b64_tr_b16 v[70:71], v24 offset:6144
  s_waitcnt lgkmcnt(12)
  v_mfma_f32_32x32x16_bf16 v[176:191], v[76:79], v[172:175], v[176:191]
  v_add_f32 v35, v35, v38
  v_add_f32 v36, v36, v39
  v_cvt_pk_bf16_f32 v220, v38, v39
  v_exp_f32 v38, v204
  v_exp_f32 v39, v205
  v_add_f32 v35, v35, v40
  ds_read_b64_tr_b16 v[72:73], v25 offset:0
  ds_read_b64_tr_b16 v[74:75], v25 offset:2048
  s_waitcnt lgkmcnt(12)
  v_mfma_f32_32x32x16_bf16 v[80:95], v[48:51], v[208:211], 0
  v_add_f32 v36, v36, v41
  v_cvt_pk_bf16_f32 v221, v40, v41
  v_exp_f32 v40, v206
  v_exp_f32 v41, v207
  v_add_f32 v35, v35, v38
  v_add_f32 v36, v36, v39
  ds_read_b64_tr_b16 v[76:77], v25 offset:4096
  ds_read_b64_tr_b16 v[78:79], v25 offset:6144
  s_waitcnt lgkmcnt(12)
  v_mfma_f32_32x32x16_bf16 v[80:95], v[52:55], v[212:215], v[80:95]
  v_cvt_pk_bf16_f32 v222, v38, v39
  v_add_f32 v35, v35, v40
  v_add_f32 v36, v36, v41
  v_cvt_pk_bf16_f32 v223, v40, v41
  v_add_f32 v35, v35, v36
  v_cmp_nge_f32 vcc, s37, v35
  ds_read_b128 v[48:51], v14 offset:24576
  s_waitcnt lgkmcnt(11)
  v_mfma_f32_32x32x16_bf16 v[96:111], v[56:59], v[208:211], 0
  ds_read_b128 v[52:55], v15 offset:24576
  s_waitcnt lgkmcnt(10)
  v_mfma_f32_32x32x16_bf16 v[96:111], v[60:63], v[212:215], v[96:111]
  ds_read_b128 v[56:59], v16 offset:24576
  s_waitcnt lgkmcnt(9)
  v_mfma_f32_32x32x16_bf16 v[112:127], v[64:67], v[208:211], 0
  ds_read_b128 v[60:63], v17 offset:24576
  s_waitcnt lgkmcnt(8)
  v_mfma_f32_32x32x16_bf16 v[112:127], v[68:71], v[212:215], v[112:127]
  ds_read_b128 v[64:67], v18 offset:24576
  s_waitcnt lgkmcnt(7)
  v_mfma_f32_32x32x16_bf16 v[128:143], v[72:75], v[208:211], 0
  ds_read_b128 v[68:71], v19 offset:24576
  s_waitcnt lgkmcnt(6)
  v_mfma_f32_32x32x16_bf16 v[128:143], v[76:79], v[212:215], v[128:143]
  s_cbranch_vccnz k1_rare1
k1_back1:
  v_add_f32 v34, v34, v35
  ds_read_b128 v[72:75], v20 offset:24576
  s_waitcnt lgkmcnt(6)
  v_mfma_f32_32x32x16_bf16 v[192:207], v[48:51], v[144:147], v[224:239]
  v_exp_f32 v38, v176
  v_exp_f32 v39, v177
  ds_read_b128 v[76:79], v21 offset:24576
  s_waitcnt lgkmcnt(6)
  v_mfma_f32_32x32x16_bf16 v[192:207], v[52:55], v[148:151], v[192:207]
  v_exp_f32 v40, v178
  v_exp_f32 v41, v179
  ds_read_b64_tr_b16 v[48:49], v22 offset:8192
  ds_read_b64_tr_b16 v[50:51], v22 offset:10240
  s_waitcnt lgkmcnt(7)
  v_mfma_f32_32x32x16_bf16 v[192:207], v[56:59], v[152:155], v[192:207]
  v_add_f32 v35, v38, v39
  v_cvt_pk_bf16_f32 v208, v38, v39
  v_exp_f32 v38, v180
  ds_read_b64_tr_b16 v[52:53], v22 offset:12288
  ds_read_b64_tr_b16 v[54:55], v22 offset:14336
  s_waitcnt lgkmcnt(8)
  v_mfma_f32_32x32x16_bf16 v[192:207], v[60:63], v[156:159], v[192:207]
  v_exp_f32 v39, v181
  v_add_f32 v36, v40, v41
  v_cvt_pk_bf16_f32 v209, v40, v41
  ds_read_b64_tr_b16 v[56:57], v23 offset:8192
  ds_read_b64_tr_b16 v[58:59], v23 offset:10240
  s_waitcnt lgkmcnt(9)
  v_mfma_f32_32x32x16_bf16 v[192:207], v[64:67], v[160:163], v[192:207]
  v_exp_f32 v40, v182
  v_exp_f32 v41, v183
  ds_read_b64_tr_b16 v[60:61], v23 offset:12288
  ds_read_b64_tr_b16 v[62:63], v23 offset:14336
  s_waitcnt lgkmcnt(10)
  v_mfma_f32_32x32x16_bf16 v[192:207], v[68:71], v[164:167], v[192:207]
  v_add_f32 v35, v35, v38
  v_add_f32 v36, v36, v39
  v_cvt_pk_bf16_f32 v210, v38, v39
  v_exp_f32 v38, v184
  ds_read_b64_tr_b16 v[64:65], v24 offset:8192
  ds_read_b64_tr_b16 v[66:67], v24 offset:10240
  s_waitcnt lgkmcnt(11)
  v_mfma_f32_32x32x16_bf16 v[192:207], v[72:75], v[168:171], v[192:207]
  v_exp_f32 v39, v185
  v_add_f32 v35, v35, v40
  v_add_f32 v36, v36, v41
  ds_read_b64_tr_b16 v[68:69], v24 offset:12288
  ds_read_b64_tr_b16 v[70:71], v24 offset:14336
  s_waitcnt lgkmcnt(12)
  v_mfma_f32_32x32x16_bf16 v[192:207], v[76:79], v[172:175], v[192:207]
  v_cvt_pk_bf16_f32 v211, v40, v41
  v_exp_f32 v40, v186
  v_exp_f32 v41, v187
  ds_read_b64_tr_b16 v[72:73], v25 offset:8192
  ds_read_b64_tr_b16 v[74:75], v25 offset:10240
  s_waitcnt lgkmcnt(12)
  v_mfma_f32_32x32x16_bf16 v[80:95], v[48:51], v[216:219], v[80:95]
  v_add_f32 v35, v35, v38
  v_add_f32 v36, v36, v39
  v_cvt_pk_bf16_f32 v212, v38, v39
  v_exp_f32 v38, v188
  ds_read_b64_tr_b16 v[76:77], v25 offset:12288
  ds_read_b64_tr_b16 v[78:79], v25 offset:14336
  s_waitcnt lgkmcnt(12)
  v_mfma_f32_32x32x16_bf16 v[80:95], v[52:55], v[220:223], v[80:95]
  v_exp_f32 v39, v189
  v_add_f32 v35, v35, v40
  v_add_f32 v36, v36, v41
  s_waitcnt lgkmcnt(10)
  v_mfma_f32_32x32x16_bf16 v[96:111], v[56:59], v[216:219], v[96:111]
  v_cvt_pk_bf16_f32 v213, v40, v41
  v_exp_f32 v40, v190
  v_exp_f32 v41, v191
  s_waitcnt vmcnt(14) lgkmcnt(0)
  s_barrier
  s_cmp_eq_u32 s3, 2
  s_cselect_b32 s41, 0, -1
  v_or_b32 v254, s41, v47
  buffer_load_dword v254, v254, s[44:47], 0 offen
  s_cmp_eq_u32 s3, 2
  s_cselect_b32 s78, 5308416, 0
  buffer_load_dword v246, v44, s[76:79], 0 offen
  s_cselect_b32 s82, 5308416, 0
  buffer_load_dword v247, v45, s[80:83], 0 offen
  s_cselect_b32 s86, 5308416, 0
  buffer_load_dword v248, v46, s[84:87], 0 offen
  ds_read_b128 v[48:51], v14 offset:32768
  ds_read_b128 v[52:55], v15 offset:32768
  v_mfma_f32_32x32x16_bf16 v[96:111], v[60:63], v[220:223], v[96:111]
  s_add_u32 m0, s34, 16384
  s_mov_b32 s40, 81920
  buffer_load_dwordx4 v10, s[16:19], s40 offen lds
  v_add_f32 v35, v35, v38
  v_add_f32 v36, v36, v39
  ds_read_b128 v[56:59], v16 offset:32768
  v_mfma_f32_32x32x16_bf16 v[112:127], v[64:67], v[216:219], v[112:127]
  s_add_u32 m0, s34, 24576
  s_mov_b32 s40, 90112
  buffer_load_dwordx4 v10, s[16:19], s40 offen lds
  v_cvt_pk_bf16_f32 v214, v38, v39
  v_add_f32 v35, v35, v40
  ds_read_b128 v[60:63], v17 offset:32768
  v_mfma_f32_32x32x16_bf16 v[112:127], v[68:71], v[220:223], v[112:127]
  s_add_u32 m0, s34, 65536
  s_mov_b32 s40, 65536
  buffer_load_dwordx4 v11, s[20:23], s40 offen lds
  v_add_f32 v36, v36, v41
  v_cvt_pk_bf16_f32 v215, v40, v41
  ds_read_b128 v[64:67], v18 offset:32768
  v_mfma_f32_32x32x16_bf16 v[128:143], v[72:75], v[216:219], v[128:143]
  s_add_u32 m0, s34, 73728
  s_mov_b32 s40, 73728
  buffer_load_dwordx4 v11, s[20:23], s40 offen lds
  v_add_f32 v35, v35, v36
  v_cmp_nge_f32 vcc, s37, v35
  ds_read_b128 v[68:71], v19 offset:32768
  v_mfma_f32_32x32x16_bf16 v[128:143], v[76:79], v[220:223], v[128:143]
  s_cbranch_vccnz k1_rare2
k1_back2:
  v_add_f32 v34, v34, v35
  ds_read_b128 v[72:75], v20 offset:32768
  s_waitcnt lgkmcnt(6)
  v_mfma_f32_32x32x16_bf16 v[176:191], v[48:51], v[144:147], v[224:239]
  v_exp_f32 v38, v192
  v_exp_f32 v39, v193
  ds_read_b128 v[76:79], v21 offset:32768
  s_waitcnt lgkmcnt(6)
  v_mfma_f32_32x32x16_bf16 v[176:191], v[52:55], v[148:151], v[176:191]
  v_exp_f32 v40, v194
  v_exp_f32 v41, v195
  ds_read_b64_tr_b16 v[48:49], v22 offset:16384
  ds_read_b64_tr_b16 v[50:51], v22 offset:18432
  s_waitcnt lgkmcnt(7)
  v_mfma_f32_32x32x16_bf16 v[176:191], v[56:59], v[152:155], v[176:191]
  v_add_f32 v35, v38, v39
  v_cvt_pk_bf16_f32 v216, v38, v39
  v_exp_f32 v38, v196
  ds_read_b64_tr_b16 v[52:53], v22 offset:20480
  ds_read_b64_tr_b16 v[54:55], v22 offset:22528
  s_waitcnt lgkmcnt(8)
  v_mfma_f32_32x32x16_bf16 v[176:191], v[60:63], v[156:159], v[176:191]
  v_exp_f32 v39, v197
  v_add_f32 v36, v40, v41
  v_cvt_pk_bf16_f32 v217, v40, v41
  ds_read_b64_tr_b16 v[56:57], v23 offset:16384
  ds_read_b64_tr_b16 v[58:59], v23 offset:18432
  s_waitcnt lgkmcnt(9)
  v_mfma_f32_32x32x16_bf16 v[176:191], v[64:67], v[160:163], v[176:191]
  v_exp_f32 v40, v198
  v_exp_f32 v41, v199
  ds_read_b64_tr_b16 v[60:61], v23 offset:20480
  ds_read_b64_tr_b16 v[62:63], v23 offset:22528
  s_waitcnt lgkmcnt(10)
  v_mfma_f32_32x32x16_bf16 v[176:191], v[68:71], v[164:167], v[176:191]
  v_add_f32 v35, v35, v38
  v_add_f32 v36, v36, v39
  v_cvt_pk_bf16_f32 v218, v38, v39
  v_exp_f32 v38, v200
  ds_read_b64_tr_b16 v[64:65], v24 offset:16384
  ds_read_b64_tr_b16 v[66:67], v24 offset:18432
  s_waitcnt lgkmcnt(11)
  v_mfma_f32_32x32x16_bf16 v[176:191], v[72:75], v[168:171], v[176:191]
  v_exp_f32 v39, v201
  v_add_f32 v35, v35, v40
  v_add_f32 v36, v36, v41
  ds_read_b64_tr_b16 v[68:69], v24 offset:20480
  ds_read_b64_tr_b16 v[70:71], v24 offset:22528
  s_waitcnt lgkmcnt(12)
  v_mfma_f32_32x32x16_bf16 v[176:191], v[76:79], v[172:175], v[176:191]
  v_cvt_pk_bf16_f32 v219, v40, v41
  v_exp_f32 v40, v202
  v_exp_f32 v41, v203
  ds_read_b64_tr_b16 v[72:73], v25 offset:16384
  ds_read_b64_tr_b16 v[74:75], v25 offset:18432
  s_waitcnt lgkmcnt(12)
  v_mfma_f32_32x32x16_bf16 v[80:95], v[48:51], v[208:211], v[80:95]
  v_add_f32 v35, v35, v38
  v_add_f32 v36, v36, v39
  v_cvt_pk_bf16_f32 v220, v38, v39
  v_exp_f32 v38, v204
  ds_read_b64_tr_b16 v[76:77], v25 offset:20480
  ds_read_b64_tr_b16 v[78:79], v25 offset:22528
  s_waitcnt lgkmcnt(12)
  v_mfma_f32_32x32x16_bf16 v[80:95], v[52:55], v[212:215], v[80:95]
  v_exp_f32 v39, v205
  v_add_f32 v35, v35, v40
  v_add_f32 v36, v36, v41
  ds_read_b128 v[48:51], v14 offset:40960
  s_waitcnt lgkmcnt(11)
  v_mfma_f32_32x32x16_bf16 v[96:111], v[56:59], v[208:211], v[96:111]
  v_cvt_pk_bf16_f32 v221, v40, v41
  v_exp_f32 v40, v206
  v_exp_f32 v41, v207
  ds_read_b128 v[52:55], v15 offset:40960
  s_waitcnt lgkmcnt(10)
  v_mfma_f32_32x32x16_bf16 v[96:111], v[60:63], v[212:215], v[96:111]
  v_add_f32 v35, v35, v38
  v_add_f32 v36, v36, v39
  v_cvt_pk_bf16_f32 v222, v38, v39
  v_add_f32 v35, v35, v40
  ds_read_b128 v[56:59], v16 offset:40960
  s_waitcnt lgkmcnt(9)
  v_mfma_f32_32x32x16_bf16 v[112:127], v[64:67], v[208:211], v[112:127]
  v_add_f32 v36, v36, v41
  v_cvt_pk_bf16_f32 v223, v40, v41
  v_add_f32 v35, v35, v36
  v_cmp_nge_f32 vcc, s37, v35
  ds_read_b128 v[60:63], v17 offset:40960
  s_waitcnt lgkmcnt(8)
  v_mfma_f32_32x32x16_bf16 v[112:127], v[68:71], v[212:215], v[112:127]
  ds_read_b128 v[64:67], v18 offset:40960
  s_waitcnt lgkmcnt(7)
  v_mfma_f32_32x32x16_bf16 v[128:143], v[72:75], v[208:211], v[128:143]
  ds_read_b128 v[68:71], v19 offset:40960
  s_waitcnt lgkmcnt(6)
  v_mfma_f32_32x32x16_bf16 v[128:143], v[76:79], v[212:215], v[128:143]
  s_cbranch_vccnz k1_rare3
k1_back3:
  v_add_f32 v34, v34, v35
  ds_read_b128 v[72:75], v20 offset:40960
  s_waitcnt lgkmcnt(6)
  v_mfma_f32_32x32x16_bf16 v[192:207], v[48:51], v[144:147], v[224:239]
  v_exp_f32 v38, v176
  v_exp_f32 v39, v177
  ds_read_b128 v[76:79], v21 offset:40960
  s_waitcnt lgkmcnt(6)
  v_mfma_f32_32x32x16_bf16 v[192:207], v[52:55], v[148:151], v[192:207]
  v_exp_f32 v40, v178
  v_exp_f32 v41, v179
  ds_read_b64_tr_b16 v[48:49], v22 offset:24576
  ds_read_b64_tr_b16 v[50:51], v22 offset:26624
  s_waitcnt lgkmcnt(7)
  v_mfma_f32_32x32x16_bf16 v[192:207], v[56:59], v[152:155], v[192:207]
  v_add_f32 v35, v38, v39
  v_cvt_pk_bf16_f32 v208, v38, v39
  v_exp_f32 v38, v180
  ds_read_b64_tr_b16 v[52:53], v22 offset:28672
  ds_read_b64_tr_b16 v[54:55], v22 offset:30720
  s_waitcnt lgkmcnt(8)
  v_mfma_f32_32x32x16_bf16 v[192:207], v[60:63], v[156:159], v[192:207]
  v_exp_f32 v39, v181
  v_add_f32 v36, v40, v41
  v_cvt_pk_bf16_f32 v209, v40, v41
  ds_read_b64_tr_b16 v[56:57], v23 offset:24576
  ds_read_b64_tr_b16 v[58:59], v23 offset:26624
  s_waitcnt lgkmcnt(9)
  v_mfma_f32_32x32x16_bf16 v[192:207], v[64:67], v[160:163], v[192:207]
  v_exp_f32 v40, v182
  v_exp_f32 v41, v183
  ds_read_b64_tr_b16 v[60:61], v23 offset:28672
  ds_read_b64_tr_b16 v[62:63], v23 offset:30720
  s_waitcnt lgkmcnt(10)
  v_mfma_f32_32x32x16_bf16 v[192:207], v[68:71], v[164:167], v[192:207]
  v_add_f32 v35, v35, v38
  v_add_f32 v36, v36, v39
  v_cvt_pk_bf16_f32 v210, v38, v39
  v_exp_f32 v38, v184
  ds_read_b64_tr_b16 v[64:65], v24 offset:24576
  ds_read_b64_tr_b16 v[66:67], v24 offset:26624
  s_waitcnt lgkmcnt(11)
  v_mfma_f32_32x32x16_bf16 v[192:207], v[72:75], v[168:171], v[192:207]
  v_exp_f32 v39, v185
  v_add_f32 v35, v35, v40
  v_add_f32 v36, v36, v41
  ds_read_b64_tr_b16 v[68:69], v24 offset:28672
  ds_read_b64_tr_b16 v[70:71], v24 offset:30720
  s_waitcnt lgkmcnt(12)
  v_mfma_f32_32x32x16_bf16 v[192:207], v[76:79], v[172:175], v[192:207]
  v_cvt_pk_bf16_f32 v211, v40, v41
  v_exp_f32 v40, v186
  v_exp_f32 v41, v187
  ds_read_b64_tr_b16 v[72:73], v25 offset:24576
  ds_read_b64_tr_b16 v[74:75], v25 offset:26624
  s_waitcnt lgkmcnt(12)
  v_mfma_f32_32x32x16_bf16 v[80:95], v[48:51], v[216:219], v[80:95]
  v_add_f32 v35, v35, v38
  v_add_f32 v36, v36, v39
  v_cvt_pk_bf16_f32 v212, v38, v39
  v_exp_f32 v38, v188
  ds_read_b64_tr_b16 v[76:77], v25 offset:28672
  ds_read_b64_tr_b16 v[78:79], v25 offset:30720
  s_waitcnt lgkmcnt(12)
  v_mfma_f32_32x32x16_bf16 v[80:95], v[52:55], v[220:223], v[80:95]
  v_exp_f32 v39, v189
  v_add_f32 v35, v35, v40
  v_add_f32 v36, v36, v41
  s_waitcnt lgkmcnt(10)
  v_mfma_f32_32x32x16_bf16 v[96:111], v[56:59], v[216:219], v[96:111]
  v_cvt_pk_bf16_f32 v213, v40, v41
  v_exp_f32 v40, v190
  v_exp_f32 v41, v191
  s_waitcnt vmcnt(16) lgkmcnt(0)
  s_barrier
  s_cmp_eq_u32 s3, 3
  s_cselect_b32 s78, 5308416, 0
  buffer_load_dword v249, v44, s[76:79], 0 offen
  s_cselect_b32 s82, 5308416, 0
  buffer_load_dword v250, v45, s[80:83], 0 offen
  s_cselect_b32 s86, 5308416, 0
  buffer_load_dword v251, v46, s[84:87], 0 offen
  ds_read_b128 v[48:51], v14 offset:49152
  ds_read_b128 v[52:55], v15 offset:49152
  v_mfma_f32_32x32x16_bf16 v[96:111], v[60:63], v[220:223], v[96:111]
  s_add_u32 m0, s34, 32768
  s_mov_b32 s40, 98304
  buffer_load_dwordx4 v10, s[16:19], s40 offen lds
  v_add_f32 v35, v35, v38
  v_add_f32 v36, v36, v39
  ds_read_b128 v[56:59], v16 offset:49152
  v_mfma_f32_32x32x16_bf16 v[112:127], v[64:67], v[216:219], v[112:127]
  s_add_u32 m0, s34, 40960
  s_mov_b32 s40, 106496
  buffer_load_dwordx4 v10, s[16:19], s40 offen lds
  v_cvt_pk_bf16_f32 v214, v38, v39
  v_add_f32 v35, v35, v40
  ds_read_b128 v[60:63], v17 offset:49152
  v_mfma_f32_32x32x16_bf16 v[112:127], v[68:71], v[220:223], v[112:127]
  s_add_u32 m0, s34, 81920
  s_mov_b32 s40, 81920
  buffer_load_dwordx4 v11, s[20:23], s40 offen lds
  v_add_f32 v36, v36, v41
  v_cvt_pk_bf16_f32 v215, v40, v41
  ds_read_b128 v[64:67], v18 offset:49152
  v_mfma_f32_32x32x16_bf16 v[128:143], v[72:75], v[216:219], v[128:143]
  s_add_u32 m0, s34, 90112
  s_mov_b32 s40, 90112
  buffer_load_dwordx4 v11, s[20:23], s40 offen lds
  v_add_f32 v35, v35, v36
  v_cmp_nge_f32 vcc, s37, v35
  ds_read_b128 v[68:71], v19 offset:49152
  v_mfma_f32_32x32x16_bf16 v[128:143], v[76:79], v[220:223], v[128:143]
  s_cbranch_vccnz k1_rare4
k1_back4:
  v_add_f32 v34, v34, v35
  ds_read_b128 v[72:75], v20 offset:49152
  s_waitcnt lgkmcnt(6)
  v_mfma_f32_32x32x16_bf16 v[176:191], v[48:51], v[144:147], v[224:239]
  v_exp_f32 v38, v192
  v_exp_f32 v39, v193
  ds_read_b128 v[76:79], v21 offset:49152
  s_waitcnt lgkmcnt(6)
  v_mfma_f32_32x32x16_bf16 v[176:191], v[52:55], v[148:151], v[176:191]
  v_exp_f32 v40, v194
  v_exp_f32 v41, v195
  ds_read_b64_tr_b16 v[48:49], v22 offset:32768
  ds_read_b64_tr_b16 v[50:51], v22 offset:34816
  s_waitcnt lgkmcnt(7)
  v_mfma_f32_32x32x16_bf16 v[176:191], v[56:59], v[152:155], v[176:191]
  v_add_f32 v35, v38, v39
  v_cvt_pk_bf16_f32 v216, v38, v39
  v_exp_f32 v38, v196
  ds_read_b64_tr_b16 v[52:53], v22 offset:36864
  ds_read_b64_tr_b16 v[54:55], v22 offset:38912
  s_waitcnt lgkmcnt(8)
  v_mfma_f32_32x32x16_bf16 v[176:191], v[60:63], v[156:159], v[176:191]
  v_exp_f32 v39, v197
  v_add_f32 v36, v40, v41
  v_cvt_pk_bf16_f32 v217, v40, v41
  ds_read_b64_tr_b16 v[56:57], v23 offset:32768
  ds_read_b64_tr_b16 v[58:59], v23 offset:34816
  s_waitcnt lgkmcnt(9)
  v_mfma_f32_32x32x16_bf16 v[176:191], v[64:67], v[160:163], v[176:191]
  v_exp_f32 v40, v198
  v_exp_f32 v41, v199
  ds_read_b64_tr_b16 v[60:61], v23 offset:36864
  ds_read_b64_tr_b16 v[62:63], v23 offset:38912
  s_waitcnt lgkmcnt(10)
  v_mfma_f32_32x32x16_bf16 v[176:191], v[68:71], v[164:167], v[176:191]
  v_add_f32 v35, v35, v38
  v_add_f32 v36, v36, v39
  v_cvt_pk_bf16_f32 v218, v38, v39
  v_exp_f32 v38, v200
  ds_read_b64_tr_b16 v[64:65], v24 offset:32768
  ds_read_b64_tr_b16 v[66:67], v24 offset:34816
  s_waitcnt lgkmcnt(11)
  v_mfma_f32_32x32x16_bf16 v[176:191], v[72:75], v[168:171], v[176:191]
  v_exp_f32 v39, v201
  v_add_f32 v35, v35, v40
  v_add_f32 v36, v36, v41
  ds_read_b64_tr_b16 v[68:69], v24 offset:36864
  ds_read_b64_tr_b16 v[70:71], v24 offset:38912
  s_waitcnt lgkmcnt(12)
  v_mfma_f32_32x32x16_bf16 v[176:191], v[76:79], v[172:175], v[176:191]
  v_cvt_pk_bf16_f32 v219, v40, v41
  v_exp_f32 v40, v202
  v_exp_f32 v41, v203
  ds_read_b64_tr_b16 v[72:73], v25 offset:32768
  ds_read_b64_tr_b16 v[74:75], v25 offset:34816
  s_waitcnt lgkmcnt(12)
  v_mfma_f32_32x32x16_bf16 v[80:95], v[48:51], v[208:211], v[80:95]
  v_add_f32 v35, v35, v38
  v_add_f32 v36, v36, v39
  v_cvt_pk_bf16_f32 v220, v38, v39
  v_exp_f32 v38, v204
  ds_read_b64_tr_b16 v[76:77], v25 offset:36864
  ds_read_b64_tr_b16 v[78:79], v25 offset:38912
  s_waitcnt lgkmcnt(12)
  v_mfma_f32_32x32x16_bf16 v[80:95], v[52:55], v[212:215], v[80:95]
  v_exp_f32 v39, v205
  v_add_f32 v35, v35, v40
  v_add_f32 v36, v36, v41
  ds_read_b128 v[48:51], v14 offset:57344
  s_waitcnt lgkmcnt(11)
  v_mfma_f32_32x32x16_bf16 v[96:111], v[56:59], v[208:211], v[96:111]
  v_cvt_pk_bf16_f32 v221, v40, v41
  v_exp_f32 v40, v206
  v_exp_f32 v41, v207
  ds_read_b128 v[52:55], v15 offset:57344
  s_waitcnt lgkmcnt(10)
  v_mfma_f32_32x32x16_bf16 v[96:111], v[60:63], v[212:215], v[96:111]
  v_add_f32 v35, v35, v38
  v_add_f32 v36, v36, v39
  v_cvt_pk_bf16_f32 v222, v38, v39
  v_add_f32 v35, v35, v40
  ds_read_b128 v[56:59], v16 offset:57344
  s_waitcnt lgkmcnt(9)
  v_mfma_f32_32x32x16_bf16 v[112:127], v[64:67], v[208:211], v[112:127]
  v_add_f32 v36, v36, v41
  v_cvt_pk_bf16_f32 v223, v40, v41
  v_add_f32 v35, v35, v36
  v_cmp_nge_f32 vcc, s37, v35
  ds_read_b128 v[60:63], v17 offset:57344
  s_waitcnt lgkmcnt(8)
  v_mfma_f32_32x32x16_bf16 v[112:127], v[68:71], v[212:215], v[112:127]
  ds_read_b128 v[64:67], v18 offset:57344
  s_waitcnt lgkmcnt(7)
  v_mfma_f32_32x32x16_bf16 v[128:143], v[72:75], v[208:211], v[128:143]
  ds_read_b128 v[68:71], v19 offset:57344
  s_waitcnt lgkmcnt(6)
  v_mfma_f32_32x32x16_bf16 v[128:143], v[76:79], v[212:215], v[128:143]
  s_cbranch_vccnz k1_rare5
k1_back5:
  v_add_f32 v34, v34, v35
  ds_read_b128 v[72:75], v20 offset:57344
  s_waitcnt lgkmcnt(6)
  v_mfma_f32_32x32x16_bf16 v[192:207], v[48:51], v[144:147], v[224:239]
  v_exp_f32 v38, v176
  v_exp_f32 v39, v177
  ds_read_b128 v[76:79], v21 offset:57344
  s_waitcnt lgkmcnt(6)
  v_mfma_f32_32x32x16_bf16 v[192:207], v[52:55], v[148:151], v[192:207]
  v_exp_f32 v40, v178
  v_exp_f32 v41, v179
  ds_read_b64_tr_b16 v[48:49], v22 offset:40960
  ds_read_b64_tr_b16 v[50:51], v22 offset:43008
  s_waitcnt lgkmcnt(7)
  v_mfma_f32_32x32x16_bf16 v[192:207], v[56:59], v[152:155], v[192:207]
  v_add_f32 v35, v38, v39
  v_cvt_pk_bf16_f32 v208, v38, v39
  v_exp_f32 v38, v180
  ds_read_b64_tr_b16 v[52:53], v22 offset:45056
  ds_read_b64_tr_b16 v[54:55], v22 offset:47104
  s_waitcnt lgkmcnt(8)
  v_mfma_f32_32x32x16_bf16 v[192:207], v[60:63], v[156:159], v[192:207]
  v_exp_f32 v39, v181
  v_add_f32 v36, v40, v41
  v_cvt_pk_bf16_f32 v209, v40, v41
  ds_read_b64_tr_b16 v[56:57], v23 offset:40960
  ds_read_b64_tr_b16 v[58:59], v23 offset:43008
  s_waitcnt lgkmcnt(9)
  v_mfma_f32_32x32x16_bf16 v[192:207], v[64:67], v[160:163], v[192:207]
  v_exp_f32 v40, v182
  v_exp_f32 v41, v183
  ds_read_b64_tr_b16 v[60:61], v23 offset:45056
  ds_read_b64_tr_b16 v[62:63], v23 offset:47104
  s_waitcnt lgkmcnt(10)
  v_mfma_f32_32x32x16_bf16 v[192:207], v[68:71], v[164:167], v[192:207]
  v_add_f32 v35, v35, v38
  v_add_f32 v36, v36, v39
  v_cvt_pk_bf16_f32 v210, v38, v39
  v_exp_f32 v38, v184
  ds_read_b64_tr_b16 v[64:65], v24 offset:40960
  ds_read_b64_tr_b16 v[66:67], v24 offset:43008
  s_waitcnt lgkmcnt(11)
  v_mfma_f32_32x32x16_bf16 v[192:207], v[72:75], v[168:171], v[192:207]
  v_exp_f32 v39, v185
  v_add_f32 v35, v35, v40
  v_add_f32 v36, v36, v41
  ds_read_b64_tr_b16 v[68:69], v24 offset:45056
  ds_read_b64_tr_b16 v[70:71], v24 offset:47104
  s_waitcnt lgkmcnt(12)
  v_mfma_f32_32x32x16_bf16 v[192:207], v[76:79], v[172:175], v[192:207]
  v_cvt_pk_bf16_f32 v211, v40, v41
  v_exp_f32 v40, v186
  v_exp_f32 v41, v187
  ds_read_b64_tr_b16 v[72:73], v25 offset:40960
  ds_read_b64_tr_b16 v[74:75], v25 offset:43008
  s_waitcnt lgkmcnt(12)
  v_mfma_f32_32x32x16_bf16 v[80:95], v[48:51], v[216:219], v[80:95]
  v_add_f32 v35, v35, v38
  v_add_f32 v36, v36, v39
  v_cvt_pk_bf16_f32 v212, v38, v39
  v_exp_f32 v38, v188
  ds_read_b64_tr_b16 v[76:77], v25 offset:45056
  ds_read_b64_tr_b16 v[78:79], v25 offset:47104
  s_waitcnt lgkmcnt(12)
  v_mfma_f32_32x32x16_bf16 v[80:95], v[52:55], v[220:223], v[80:95]
  v_exp_f32 v39, v189
  v_add_f32 v35, v35, v40
  v_add_f32 v36, v36, v41
  s_waitcnt lgkmcnt(10)
  v_mfma_f32_32x32x16_bf16 v[96:111], v[56:59], v[216:219], v[96:111]
  v_cvt_pk_bf16_f32 v213, v40, v41
  v_exp_f32 v40, v190
  v_exp_f32 v41, v191
  s_waitcnt vmcnt(15) lgkmcnt(0)
  s_barrier
  s_cmp_eq_u32 s3, 4
  s_cselect_b32 s78, 5308416, 0
  buffer_load_dword v240, v44, s[76:79], 0 offen
  s_cselect_b32 s82, 5308416, 0
  buffer_load_dword v241, v45, s[80:83], 0 offen
  s_cselect_b32 s86, 5308416, 0
  buffer_load_dword v242, v46, s[84:87], 0 offen
  ds_read_b128 v[48:51], v14 offset:0
  ds_read_b128 v[52:55], v15 offset:0
  v_mfma_f32_32x32x16_bf16 v[96:111], v[60:63], v[220:223], v[96:111]
  s_add_u32 m0, s34, 49152
  s_mov_b32 s40, 114688
  buffer_load_dwordx4 v10, s[16:19], s40 offen lds
  v_add_f32 v35, v35, v38
  v_add_f32 v36, v36, v39
  ds_read_b128 v[56:59], v16 offset:0
  v_mfma_f32_32x32x16_bf16 v[112:127], v[64:67], v[216:219], v[112:127]
  s_add_u32 m0, s34, 57344
  s_mov_b32 s40, 122880
  buffer_load_dwordx4 v10, s[16:19], s40 offen lds
  v_cvt_pk_bf16_f32 v214, v38, v39
  v_add_f32 v35, v35, v40
  ds_read_b128 v[60:63], v17 offset:0
  v_mfma_f32_32x32x16_bf16 v[112:127], v[68:71], v[220:223], v[112:127]
  s_add_u32 m0, s34, 98304
  s_mov_b32 s40, 98304
  buffer_load_dwordx4 v11, s[20:23], s40 offen lds
  v_add_f32 v36, v36, v41
  v_cvt_pk_bf16_f32 v215, v40, v41
  ds_read_b128 v[64:67], v18 offset:0
  v_mfma_f32_32x32x16_bf16 v[128:143], v[72:75], v[216:219], v[128:143]
  s_add_u32 m0, s34, 106496
  s_mov_b32 s40, 106496
  buffer_load_dwordx4 v11, s[20:23], s40 offen lds
  v_add_f32 v35, v35, v36
  v_cmp_nge_f32 vcc, s37, v35
  ds_read_b128 v[68:71], v19 offset:0
  v_mfma_f32_32x32x16_bf16 v[128:143], v[76:79], v[220:223], v[128:143]
  s_cbranch_vccnz k1_rare6
k1_back6:
  v_add_f32 v34, v34, v35
  ds_read_b128 v[72:75], v20 offset:0
  s_waitcnt lgkmcnt(6)
  v_mfma_f32_32x32x16_bf16 v[176:191], v[48:51], v[144:147], v[224:239]
  v_exp_f32 v38, v192
  v_exp_f32 v39, v193
  ds_read_b128 v[76:79], v21 offset:0
  s_waitcnt lgkmcnt(6)
  v_mfma_f32_32x32x16_bf16 v[176:191], v[52:55], v[148:151], v[176:191]
  v_exp_f32 v40, v194
  v_exp_f32 v41, v195
  ds_read_b64_tr_b16 v[48:49], v22 offset:49152
  ds_read_b64_tr_b16 v[50:51], v22 offset:51200
  s_waitcnt lgkmcnt(7)
  v_mfma_f32_32x32x16_bf16 v[176:191], v[56:59], v[152:155], v[176:191]
  v_add_f32 v35, v38, v39
  v_cvt_pk_bf16_f32 v216, v38, v39
  v_exp_f32 v38, v196
  ds_read_b64_tr_b16 v[52:53], v22 offset:53248
  ds_read_b64_tr_b16 v[54:55], v22 offset:55296
  s_waitcnt lgkmcnt(8)
  v_mfma_f32_32x32x16_bf16 v[176:191], v[60:63], v[156:159], v[176:191]
  v_exp_f32 v39, v197
  v_add_f32 v36, v40, v41
  v_cvt_pk_bf16_f32 v217, v40, v41
  ds_read_b64_tr_b16 v[56:57], v23 offset:49152
  ds_read_b64_tr_b16 v[58:59], v23 offset:51200
  s_waitcnt lgkmcnt(9)
  v_mfma_f32_32x32x16_bf16 v[176:191], v[64:67], v[160:163], v[176:191]
  v_exp_f32 v40, v198
  v_exp_f32 v41, v199
  ds_read_b64_tr_b16 v[60:61], v23 offset:53248
  ds_read_b64_tr_b16 v[62:63], v23 offset:55296
  s_waitcnt lgkmcnt(10)
  v_mfma_f32_32x32x16_bf16 v[176:191], v[68:71], v[164:167], v[176:191]
  v_add_f32 v35, v35, v38
  v_add_f32 v36, v36, v39
  v_cvt_pk_bf16_f32 v218, v38, v39
  v_exp_f32 v38, v200
  ds_read_b64_tr_b16 v[64:65], v24 offset:49152
  ds_read_b64_tr_b16 v[66:67], v24 offset:51200
  s_waitcnt lgkmcnt(11)
  v_mfma_f32_32x32x16_bf16 v[176:191], v[72:75], v[168:171], v[176:191]
  v_exp_f32 v39, v201
  v_add_f32 v35, v35, v40
  v_add_f32 v36, v36, v41
  ds_read_b64_tr_b16 v[68:69], v24 offset:53248
  ds_read_b64_tr_b16 v[70:71], v24 offset:55296
  s_waitcnt lgkmcnt(12)
  v_mfma_f32_32x32x16_bf16 v[176:191], v[76:79], v[172:175], v[176:191]
  v_cvt_pk_bf16_f32 v219, v40, v41
  v_exp_f32 v40, v202
  v_exp_f32 v41, v203
  ds_read_b64_tr_b16 v[72:73], v25 offset:49152
  ds_read_b64_tr_b16 v[74:75], v25 offset:51200
  s_waitcnt lgkmcnt(12)
  v_mfma_f32_32x32x16_bf16 v[80:95], v[48:51], v[208:211], v[80:95]
  v_add_f32 v35, v35, v38
  v_add_f32 v36, v36, v39
  v_cvt_pk_bf16_f32 v220, v38, v39
  v_exp_f32 v38, v204
  ds_read_b64_tr_b16 v[76:77], v25 offset:53248
  ds_read_b64_tr_b16 v[78:79], v25 offset:55296
  s_waitcnt lgkmcnt(12)
  v_mfma_f32_32x32x16_bf16 v[80:95], v[52:55], v[212:215], v[80:95]
  v_exp_f32 v39, v205
  v_add_f32 v35, v35, v40
  v_add_f32 v36, v36, v41
  ds_read_b128 v[48:51], v14 offset:8192
  s_waitcnt lgkmcnt(11)
  v_mfma_f32_32x32x16_bf16 v[96:111], v[56:59], v[208:211], v[96:111]
  v_cvt_pk_bf16_f32 v221, v40, v41
  v_exp_f32 v40, v206
  v_exp_f32 v41, v207
  ds_read_b128 v[52:55], v15 offset:8192
  s_waitcnt lgkmcnt(10)
  v_mfma_f32_32x32x16_bf16 v[96:111], v[60:63], v[212:215], v[96:111]
  v_add_f32 v35, v35, v38
  v_add_f32 v36, v36, v39
  v_cvt_pk_bf16_f32 v222, v38, v39
  v_add_f32 v35, v35, v40
  ds_read_b128 v[56:59], v16 offset:8192
  s_waitcnt lgkmcnt(9)
  v_mfma_f32_32x32x16_bf16 v[112:127], v[64:67], v[208:211], v[112:127]
  v_add_f32 v36, v36, v41
  v_cvt_pk_bf16_f32 v223, v40, v41
  v_add_f32 v35, v35, v36
  v_cmp_nge_f32 vcc, s37, v35
  ds_read_b128 v[60:63], v17 offset:8192
  s_waitcnt lgkmcnt(8)
  v_mfma_f32_32x32x16_bf16 v[112:127], v[68:71], v[212:215], v[112:127]
  ds_read_b128 v[64:67], v18 offset:8192
  s_waitcnt lgkmcnt(7)
  v_mfma_f32_32x32x16_bf16 v[128:143], v[72:75], v[208:211], v[128:143]
  ds_read_b128 v[68:71], v19 offset:8192
  s_waitcnt lgkmcnt(6)
  v_mfma_f32_32x32x16_bf16 v[128:143], v[76:79], v[212:215], v[128:143]
  s_cbranch_vccnz k1_rare7
k1_back7:
  v_add_f32 v34, v34, v35
  ds_read_b128 v[72:75], v20 offset:8192
  s_waitcnt lgkmcnt(6)
  v_mfma_f32_32x32x16_bf16 v[192:207], v[48:51], v[144:147], v[224:239]
  v_exp_f32 v38, v176
  v_exp_f32 v39, v177
  ds_read_b128 v[76:79], v21 offset:8192
  s_waitcnt lgkmcnt(6)
  v_mfma_f32_32x32x16_bf16 v[192:207], v[52:55], v[148:151], v[192:207]
  v_exp_f32 v40, v178
  v_exp_f32 v41, v179
  ds_read_b64_tr_b16 v[48:49], v22 offset:57344
  ds_read_b64_tr_b16 v[50:51], v22 offset:59392
  s_waitcnt lgkmcnt(7)
  v_mfma_f32_32x32x16_bf16 v[192:207], v[56:59], v[152:155], v[192:207]
  v_add_f32 v35, v38, v39
  v_cvt_pk_bf16_f32 v208, v38, v39
  v_exp_f32 v38, v180
  ds_read_b64_tr_b16 v[52:53], v22 offset:61440
  ds_read_b64_tr_b16 v[54:55], v22 offset:63488
  s_waitcnt lgkmcnt(8)
  v_mfma_f32_32x32x16_bf16 v[192:207], v[60:63], v[156:159], v[192:207]
  v_exp_f32 v39, v181
  v_add_f32 v36, v40, v41
  v_cvt_pk_bf16_f32 v209, v40, v41
  ds_read_b64_tr_b16 v[56:57], v23 offset:57344
  ds_read_b64_tr_b16 v[58:59], v23 offset:59392
  s_waitcnt lgkmcnt(9)
  v_mfma_f32_32x32x16_bf16 v[192:207], v[64:67], v[160:163], v[192:207]
  v_exp_f32 v40, v182
  v_exp_f32 v41, v183
  ds_read_b64_tr_b16 v[60:61], v23 offset:61440
  ds_read_b64_tr_b16 v[62:63], v23 offset:63488
  s_waitcnt lgkmcnt(10)
  v_mfma_f32_32x32x16_bf16 v[192:207], v[68:71], v[164:167], v[192:207]
  v_add_f32 v35, v35, v38
  v_add_f32 v36, v36, v39
  v_cvt_pk_bf16_f32 v210, v38, v39
  v_exp_f32 v38, v184
  ds_read_b64_tr_b16 v[64:65], v24 offset:57344
  ds_read_b64_tr_b16 v[66:67], v24 offset:59392
  s_waitcnt lgkmcnt(11)
  v_mfma_f32_32x32x16_bf16 v[192:207], v[72:75], v[168:171], v[192:207]
  v_exp_f32 v39, v185
  v_add_f32 v35, v35, v40
  v_add_f32 v36, v36, v41
  ds_read_b64_tr_b16 v[68:69], v24 offset:61440
  ds_read_b64_tr_b16 v[70:71], v24 offset:63488
  s_waitcnt lgkmcnt(12)
  v_mfma_f32_32x32x16_bf16 v[192:207], v[76:79], v[172:175], v[192:207]
  v_cvt_pk_bf16_f32 v211, v40, v41
  v_exp_f32 v40, v186
  v_exp_f32 v41, v187
  ds_read_b64_tr_b16 v[72:73], v25 offset:57344
  ds_read_b64_tr_b16 v[74:75], v25 offset:59392
  s_waitcnt lgkmcnt(12)
  v_mfma_f32_32x32x16_bf16 v[80:95], v[48:51], v[216:219], v[80:95]
  v_add_f32 v35, v35, v38
  v_add_f32 v36, v36, v39
  v_cvt_pk_bf16_f32 v212, v38, v39
  v_exp_f32 v38, v188
  ds_read_b64_tr_b16 v[76:77], v25 offset:61440
  ds_read_b64_tr_b16 v[78:79], v25 offset:63488
  s_waitcnt lgkmcnt(12)
  v_mfma_f32_32x32x16_bf16 v[80:95], v[52:55], v[220:223], v[80:95]
  v_exp_f32 v39, v189
  v_add_f32 v35, v35, v40
  v_add_f32 v36, v36, v41
  s_waitcnt lgkmcnt(10)
  v_mfma_f32_32x32x16_bf16 v[96:111], v[56:59], v[216:219], v[96:111]
  v_cvt_pk_bf16_f32 v213, v40, v41
  v_exp_f32 v40, v190
  v_exp_f32 v41, v191
  s_waitcnt vmcnt(14) lgkmcnt(0)
  s_barrier
  s_cmp_eq_u32 s3, 5
  s_cselect_b32 s78, 5308416, 0
  buffer_load_dword v243, v44, s[76:79], 0 offen
  s_cselect_b32 s82, 5308416, 0
  buffer_load_dword v244, v45, s[80:83], 0 offen
  s_cselect_b32 s86, 5308416, 0
  buffer_load_dword v245, v46, s[84:87], 0 offen
  ds_read_b128 v[48:51], v14 offset:16384
  ds_read_b128 v[52:55], v15 offset:16384
  v_mfma_f32_32x32x16_bf16 v[96:111], v[60:63], v[220:223], v[96:111]
  s_add_u32 m0, s34, 114688
  s_mov_b32 s40, 114688
  buffer_load_dwordx4 v11, s[20:23], s40 offen lds
  v_add_f32 v35, v35, v38
  v_add_f32 v36, v36, v39
  ds_read_b128 v[56:59], v16 offset:16384
  v_mfma_f32_32x32x16_bf16 v[112:127], v[64:67], v[216:219], v[112:127]
  s_add_u32 m0, s34, 122880
  s_mov_b32 s40, 122880
  buffer_load_dwordx4 v11, s[20:23], s40 offen lds
  v_cvt_pk_bf16_f32 v214, v38, v39
  v_add_f32 v35, v35, v40
  ds_read_b128 v[60:63], v17 offset:16384
  v_mfma_f32_32x32x16_bf16 v[112:127], v[68:71], v[220:223], v[112:127]
  s_add_u32 m0, s34, 131072
  s_mov_b32 s40, 0
  buffer_load_dwordx4 v12, s[44:47], s40 offen lds
  v_add_f32 v36, v36, v41
  v_cvt_pk_bf16_f32 v215, v40, v41
  ds_read_b128 v[64:67], v18 offset:16384
  v_mfma_f32_32x32x16_bf16 v[128:143], v[72:75], v[216:219], v[128:143]
  s_add_u32 m0, s34, 139264
  s_mov_b32 s40, 73728
  buffer_load_dwordx4 v12, s[44:47], s40 offen lds
  v_add_f32 v35, v35, v36
  v_cmp_nge_f32 vcc, s37, v35
  ds_read_b128 v[68:71], v19 offset:16384
  v_mfma_f32_32x32x16_bf16 v[128:143], v[76:79], v[220:223], v[128:143]
  s_add_u32 m0, s34, 147456
  s_mov_b32 s40, 147456
  buffer_load_dwordx4 v12, s[44:47], s40 offen lds
  s_cbranch_vccnz k1_rare8
k1_back8:
  v_add_f32 v34, v34, v35
  ds_read_b128 v[72:75], v20 offset:16384
  s_waitcnt lgkmcnt(6)
  v_mfma_f32_32x32x16_bf16 v[176:191], v[48:51], v[144:147], v[224:239]
  s_add_u32 m0, s34, 155648
  s_mov_b32 s40, 221184
  buffer_load_dwordx4 v12, s[44:47], s40 offen lds
  v_exp_f32 v38, v192
  ds_read_b128 v[76:79], v21 offset:16384
  s_waitcnt lgkmcnt(6)
  v_mfma_f32_32x32x16_bf16 v[176:191], v[52:55], v[148:151], v[176:191]
  v_exp_f32 v39, v193
  v_exp_f32 v40, v194
  ds_read_b64_tr_b16 v[48:49], v22 offset:0
  ds_read_b64_tr_b16 v[50:51], v22 offset:2048
  s_waitcnt lgkmcnt(7)
  v_mfma_f32_32x32x16_bf16 v[176:191], v[56:59], v[152:155], v[176:191]
  v_exp_f32 v41, v195
  v_add_f32 v35, v38, v39
  v_cvt_pk_bf16_f32 v216, v38, v39
  ds_read_b64_tr_b16 v[52:53], v22 offset:4096
  ds_read_b64_tr_b16 v[54:55], v22 offset:6144
  s_waitcnt lgkmcnt(8)
  v_mfma_f32_32x32x16_bf16 v[176:191], v[60:63], v[156:159], v[176:191]
  v_exp_f32 v38, v196
  v_exp_f32 v39, v197
  ds_read_b64_tr_b16 v[56:57], v23 offset:0
  ds_read_b64_tr_b16 v[58:59], v23 offset:2048
  s_waitcnt lgkmcnt(9)
  v_mfma_f32_32x32x16_bf16 v[176:191], v[64:67], v[160:163], v[176:191]
  v_add_f32 v36, v40, v41
  v_cvt_pk_bf16_f32 v217, v40, v41
  v_exp_f32 v40, v198
  ds_read_b64_tr_b16 v[60:61], v23 offset:4096
  ds_read_b64_tr_b16 v[62:63], v23 offset:6144
  s_waitcnt lgkmcnt(10)
  v_mfma_f32_32x32x16_bf16 v[176:191], v[68:71], v[164:167], v[176:191]
  v_exp_f32 v41, v199
  v_add_f32 v35, v35, v38
  v_add_f32 v36, v36, v39
  ds_read_b64_tr_b16 v[64:65], v24 offset:0
  ds_read_b64_tr_b16 v[66:67], v24 offset:2048
  s_waitcnt lgkmcnt(11)
  v_mfma_f32_32x32x16_bf16 v[176:191], v[72:75], v[168:171], v[176:191]
  v_cvt_pk_bf16_f32 v218, v38, v39
  v_exp_f32 v38, v200
  v_exp_f32 v39, v201
  ds_read_b64_tr_b16 v[68:69], v24 offset:4096
  ds_read_b64_tr_b16 v[70:71], v24 offset:6144
  s_waitcnt lgkmcnt(12)
  v_mfma_f32_32x32x16_bf16 v[176:191], v[76:79], v[172:175], v[176:191]
  v_add_f32 v35, v35, v40
  v_add_f32 v36, v36, v41
  v_cvt_pk_bf16_f32 v219, v40, v41
  v_exp_f32 v40, v202
  ds_read_b64_tr_b16 v[72:73], v25 offset:0
  ds_read_b64_tr_b16 v[74:75], v25 offset:2048
  s_waitcnt lgkmcnt(12)
  v_mfma_f32_32x32x16_bf16 v[80:95], v[48:51], v[208:211], v[80:95]
  v_exp_f32 v41, v203
  v_add_f32 v35, v35, v38
  v_add_f32 v36, v36, v39
  ds_read_b64_tr_b16 v[76:77], v25 offset:4096
  ds_read_b64_tr_b16 v[78:79], v25 offset:6144
  s_waitcnt lgkmcnt(12)
  v_mfma_f32_32x32x16_bf16 v[80:95], v[52:55], v[212:215], v[80:95]
  v_cvt_pk_bf16_f32 v220, v38, v39
  v_exp_f32 v38, v204
  v_exp_f32 v39, v205
  ds_read_b128 v[48:51], v14 offset:24576
  s_waitcnt lgkmcnt(11)
  v_mfma_f32_32x32x16_bf16 v[96:111], v[56:59], v[208:211], v[96:111]
  v_add_f32 v35, v35, v40
  v_add_f32 v36, v36, v41
  v_cvt_pk_bf16_f32 v221, v40, v41
  v_exp_f32 v40, v206
  ds_read_b128 v[52:55], v15 offset:24576
  s_waitcnt lgkmcnt(10)
  v_mfma_f32_32x32x16_bf16 v[96:111], v[60:63], v[212:215], v[96:111]
  v_exp_f32 v41, v207
  v_add_f32 v35, v35, v38
  v_add_f32 v36, v36, v39
  ds_read_b128 v[56:59], v16 offset:24576
  s_waitcnt lgkmcnt(9)
  v_mfma_f32_32x32x16_bf16 v[112:127], v[64:67], v[208:211], v[112:127]
  v_cvt_pk_bf16_f32 v222, v38, v39
  v_add_f32 v35, v35, v40
  v_add_f32 v36, v36, v41
  v_cvt_pk_bf16_f32 v223, v40, v41
  ds_read_b128 v[60:63], v17 offset:24576
  s_waitcnt lgkmcnt(8)
  v_mfma_f32_32x32x16_bf16 v[112:127], v[68:71], v[212:215], v[112:127]
  v_add_f32 v35, v35, v36
  v_cmp_nge_f32 vcc, s37, v35
  ds_read_b128 v[64:67], v18 offset:24576
  s_waitcnt lgkmcnt(7)
  v_mfma_f32_32x32x16_bf16 v[128:143], v[72:75], v[208:211], v[128:143]
  ds_read_b128 v[68:71], v19 offset:24576
  s_waitcnt lgkmcnt(6)
  v_mfma_f32_32x32x16_bf16 v[128:143], v[76:79], v[212:215], v[128:143]
  s_cbranch_vccnz k1_rare9
k1_back9:
  v_add_f32 v34, v34, v35
  ds_read_b128 v[72:75], v20 offset:24576
  s_waitcnt lgkmcnt(6)
  v_mfma_f32_32x32x16_bf16 v[192:207], v[48:51], v[144:147], v[224:239]
  v_exp_f32 v38, v176
  v_exp_f32 v39, v177
  ds_read_b128 v[76:79], v21 offset:24576
  s_waitcnt lgkmcnt(6)
  v_mfma_f32_32x32x16_bf16 v[192:207], v[52:55], v[148:151], v[192:207]
  v_exp_f32 v40, v178
  v_exp_f32 v41, v179
  ds_read_b64_tr_b16 v[48:49], v22 offset:8192
  ds_read_b64_tr_b16 v[50:51], v22 offset:10240
  s_waitcnt lgkmcnt(7)
  v_mfma_f32_32x32x16_bf16 v[192:207], v[56:59], v[152:155], v[192:207]
  v_add_f32 v35, v38, v39
  v_cvt_pk_bf16_f32 v208, v38, v39
  v_exp_f32 v38, v180
  ds_read_b64_tr_b16 v[52:53], v22 offset:12288
  ds_read_b64_tr_b16 v[54:55], v22 offset:14336
  s_waitcnt lgkmcnt(8)
  v_mfma_f32_32x32x16_bf16 v[192:207], v[60:63], v[156:159], v[192:207]
  v_exp_f32 v39, v181
  v_add_f32 v36, v40, v41
  v_cvt_pk_bf16_f32 v209, v40, v41
  ds_read_b64_tr_b16 v[56:57], v23 offset:8192
  ds_read_b64_tr_b16 v[58:59], v23 offset:10240
  s_waitcnt lgkmcnt(9)
  v_mfma_f32_32x32x16_bf16 v[192:207], v[64:67], v[160:163], v[192:207]
  v_exp_f32 v40, v182
  v_exp_f32 v41, v183
  ds_read_b64_tr_b16 v[60:61], v23 offset:12288
  ds_read_b64_tr_b16 v[62:63], v23 offset:14336
  s_waitcnt lgkmcnt(10)
  v_mfma_f32_32x32x16_bf16 v[192:207], v[68:71], v[164:167], v[192:207]
  v_add_f32 v35, v35, v38
  v_add_f32 v36, v36, v39
  v_cvt_pk_bf16_f32 v210, v38, v39
  v_exp_f32 v38, v184
  ds_read_b64_tr_b16 v[64:65], v24 offset:8192
  ds_read_b64_tr_b16 v[66:67], v24 offset:10240
  s_waitcnt lgkmcnt(11)
  v_mfma_f32_32x32x16_bf16 v[192:207], v[72:75], v[168:171], v[192:207]
  v_exp_f32 v39, v185
  v_add_f32 v35, v35, v40
  v_add_f32 v36, v36, v41
  ds_read_b64_tr_b16 v[68:69], v24 offset:12288
  ds_read_b64_tr_b16 v[70:71], v24 offset:14336
  s_waitcnt lgkmcnt(12)
  v_mfma_f32_32x32x16_bf16 v[192:207], v[76:79], v[172:175], v[192:207]
  v_cvt_pk_bf16_f32 v211, v40, v41
  v_exp_f32 v40, v186
  v_exp_f32 v41, v187
  ds_read_b64_tr_b16 v[72:73], v25 offset:8192
  ds_read_b64_tr_b16 v[74:75], v25 offset:10240
  s_waitcnt lgkmcnt(12)
  v_mfma_f32_32x32x16_bf16 v[80:95], v[48:51], v[216:219], v[80:95]
  v_add_f32 v35, v35, v38
  v_add_f32 v36, v36, v39
  v_cvt_pk_bf16_f32 v212, v38, v39
  v_exp_f32 v38, v188
  ds_read_b64_tr_b16 v[76:77], v25 offset:12288
  ds_read_b64_tr_b16 v[78:79], v25 offset:14336
  s_waitcnt lgkmcnt(12)
  v_mfma_f32_32x32x16_bf16 v[80:95], v[52:55], v[220:223], v[80:95]
  v_exp_f32 v39, v189
  v_add_f32 v35, v35, v40
  v_add_f32 v36, v36, v41
  s_waitcnt lgkmcnt(10)
  v_mfma_f32_32x32x16_bf16 v[96:111], v[56:59], v[216:219], v[96:111]
  v_cvt_pk_bf16_f32 v213, v40, v41
  v_exp_f32 v40, v190
  v_exp_f32 v41, v191
  s_waitcnt vmcnt(16) lgkmcnt(0)
  s_barrier
  s_cmp_eq_u32 s3, 6
  s_cselect_b32 s78, 5308416, 0
  buffer_load_dword v246, v44, s[76:79], 0 offen
  s_cselect_b32 s82, 5308416, 0
  buffer_load_dword v247, v45, s[80:83], 0 offen
  s_cselect_b32 s86, 5308416, 0
  buffer_load_dword v248, v46, s[84:87], 0 offen
  ds_read_b128 v[48:51], v14 offset:32768
  ds_read_b128 v[52:55], v15 offset:32768
  v_mfma_f32_32x32x16_bf16 v[96:111], v[60:63], v[220:223], v[96:111]
  s_add_u32 m0, s34, 0
  s_mov_b32 s40, 128
  buffer_load_dwordx4 v12, s[44:47], s40 offen lds
  v_add_f32 v35, v35, v38
  v_add_f32 v36, v36, v39
  ds_read_b128 v[56:59], v16 offset:32768
  v_mfma_f32_32x32x16_bf16 v[112:127], v[64:67], v[216:219], v[112:127]
  s_add_u32 m0, s34, 8192
  s_mov_b32 s40, 73856
  buffer_load_dwordx4 v12, s[44:47], s40 offen lds
  v_cvt_pk_bf16_f32 v214, v38, v39
  v_add_f32 v35, v35, v40
  ds_read_b128 v[60:63], v17 offset:32768
  v_mfma_f32_32x32x16_bf16 v[112:127], v[68:71], v[220:223], v[112:127]
  s_add_u32 m0, s34, 16384
  s_mov_b32 s40, 147584
  buffer_load_dwordx4 v12, s[44:47], s40 offen lds
  v_add_f32 v36, v36, v41
  v_cvt_pk_bf16_f32 v215, v40, v41
  ds_read_b128 v[64:67], v18 offset:32768
  v_mfma_f32_32x32x16_bf16 v[128:143], v[72:75], v[216:219], v[128:143]
  s_add_u32 m0, s34, 24576
  s_mov_b32 s40, 221312
  buffer_load_dwordx4 v12, s[44:47], s40 offen lds
  v_add_f32 v35, v35, v36
  v_cmp_nge_f32 vcc, s37, v35
  ds_read_b128 v[68:71], v19 offset:32768
  v_mfma_f32_32x32x16_bf16 v[128:143], v[76:79], v[220:223], v[128:143]
  s_cbranch_vccnz k1_rare10
k1_back10:
  v_add_f32 v34, v34, v35
  ds_read_b128 v[72:75], v20 offset:32768
  s_waitcnt lgkmcnt(6)
  v_mfma_f32_32x32x16_bf16 v[176:191], v[48:51], v[144:147], v[224:239]
  v_exp_f32 v38, v192
  v_exp_f32 v39, v193
  ds_read_b128 v[76:79], v21 offset:32768
  s_waitcnt lgkmcnt(6)
  v_mfma_f32_32x32x16_bf16 v[176:191], v[52:55], v[148:151], v[176:191]
  v_exp_f32 v40, v194
  v_exp_f32 v41, v195
  ds_read_b64_tr_b16 v[48:49], v22 offset:16384
  ds_read_b64_tr_b16 v[50:51], v22 offset:18432
  s_waitcnt lgkmcnt(7)
  v_mfma_f32_32x32x16_bf16 v[176:191], v[56:59], v[152:155], v[176:191]
  v_add_f32 v35, v38, v39
  v_cvt_pk_bf16_f32 v216, v38, v39
  v_exp_f32 v38, v196
  ds_read_b64_tr_b16 v[52:53], v22 offset:20480
  ds_read_b64_tr_b16 v[54:55], v22 offset:22528
  s_waitcnt lgkmcnt(8)
  v_mfma_f32_32x32x16_bf16 v[176:191], v[60:63], v[156:159], v[176:191]
  v_exp_f32 v39, v197
  v_add_f32 v36, v40, v41
  v_cvt_pk_bf16_f32 v217, v40, v41
  ds_read_b64_tr_b16 v[56:57], v23 offset:16384
  ds_read_b64_tr_b16 v[58:59], v23 offset:18432
  s_waitcnt lgkmcnt(9)
  v_mfma_f32_32x32x16_bf16 v[176:191], v[64:67], v[160:163], v[176:191]
  v_exp_f32 v40, v198
  v_exp_f32 v41, v199
  ds_read_b64_tr_b16 v[60:61], v23 offset:20480
  ds_read_b64_tr_b16 v[62:63], v23 offset:22528
  s_waitcnt lgkmcnt(10)
  v_mfma_f32_32x32x16_bf16 v[176:191], v[68:71], v[164:167], v[176:191]
  v_add_f32 v35, v35, v38
  v_add_f32 v36, v36, v39
  v_cvt_pk_bf16_f32 v218, v38, v39
  v_exp_f32 v38, v200
  ds_read_b64_tr_b16 v[64:65], v24 offset:16384
  ds_read_b64_tr_b16 v[66:67], v24 offset:18432
  s_waitcnt lgkmcnt(11)
  v_mfma_f32_32x32x16_bf16 v[176:191], v[72:75], v[168:171], v[176:191]
  v_exp_f32 v39, v201
  v_add_f32 v35, v35, v40
  v_add_f32 v36, v36, v41
  ds_read_b64_tr_b16 v[68:69], v24 offset:20480
  ds_read_b64_tr_b16 v[70:71], v24 offset:22528
  s_waitcnt lgkmcnt(12)
  v_mfma_f32_32x32x16_bf16 v[176:191], v[76:79], v[172:175], v[176:191]
  v_cvt_pk_bf16_f32 v219, v40, v41
  v_exp_f32 v40, v202
  v_exp_f32 v41, v203
  ds_read_b64_tr_b16 v[72:73], v25 offset:16384
  ds_read_b64_tr_b16 v[74:75], v25 offset:18432
  s_waitcnt lgkmcnt(12)
  v_mfma_f32_32x32x16_bf16 v[80:95], v[48:51], v[208:211], v[80:95]
  v_add_f32 v35, v35, v38
  v_add_f32 v36, v36, v39
  v_cvt_pk_bf16_f32 v220, v38, v39
  v_exp_f32 v38, v204
  ds_read_b64_tr_b16 v[76:77], v25 offset:20480
  ds_read_b64_tr_b16 v[78:79], v25 offset:22528
  s_waitcnt lgkmcnt(12)
  v_mfma_f32_32x32x16_bf16 v[80:95], v[52:55], v[212:215], v[80:95]
  v_exp_f32 v39, v205
  v_add_f32 v35, v35, v40
  v_add_f32 v36, v36, v41
  ds_read_b128 v[48:51], v14 offset:40960
  s_waitcnt lgkmcnt(11)
  v_mfma_f32_32x32x16_bf16 v[96:111], v[56:59], v[208:211], v[96:111]
  v_cvt_pk_bf16_f32 v221, v40, v41
  v_exp_f32 v40, v206
  v_exp_f32 v41, v207
  ds_read_b128 v[52:55], v15 offset:40960
  s_waitcnt lgkmcnt(10)
  v_mfma_f32_32x32x16_bf16 v[96:111], v[60:63], v[212:215], v[96:111]
  v_add_f32 v35, v35, v38
  v_add_f32 v36, v36, v39
  v_cvt_pk_bf16_f32 v222, v38, v39
  v_add_f32 v35, v35, v40
  ds_read_b128 v[56:59], v16 offset:40960
  s_waitcnt lgkmcnt(9)
  v_mfma_f32_32x32x16_bf16 v[112:127], v[64:67], v[208:211], v[112:127]
  v_add_f32 v36, v36, v41
  v_cvt_pk_bf16_f32 v223, v40, v41
  v_add_f32 v35, v35, v36
  v_cmp_nge_f32 vcc, s37, v35
  ds_read_b128 v[60:63], v17 offset:40960
  s_waitcnt lgkmcnt(8)
  v_mfma_f32_32x32x16_bf16 v[112:127], v[68:71], v[212:215], v[112:127]
  ds_read_b128 v[64:67], v18 offset:40960
  s_waitcnt lgkmcnt(7)
  v_mfma_f32_32x32x16_bf16 v[128:143], v[72:75], v[208:211], v[128:143]
  ds_read_b128 v[68:71], v19 offset:40960
  s_waitcnt lgkmcnt(6)
  v_mfma_f32_32x32x16_bf16 v[128:143], v[76:79], v[212:215], v[128:143]
  s_cbranch_vccnz k1_rare11
k1_back11:
  v_add_f32 v34, v34, v35
  ds_read_b128 v[72:75], v20 offset:40960
  s_waitcnt lgkmcnt(6)
  v_mfma_f32_32x32x16_bf16 v[192:207], v[48:51], v[144:147], v[224:239]
  v_exp_f32 v38, v176
  v_exp_f32 v39, v177
  ds_read_b128 v[76:79], v21 offset:40960
  s_waitcnt lgkmcnt(6)
  v_mfma_f32_32x32x16_bf16 v[192:207], v[52:55], v[148:151], v[192:207]
  v_exp_f32 v40, v178
  v_exp_f32 v41, v179
  ds_read_b64_tr_b16 v[48:49], v22 offset:24576
  ds_read_b64_tr_b16 v[50:51], v22 offset:26624
  s_waitcnt lgkmcnt(7)
  v_mfma_f32_32x32x16_bf16 v[192:207], v[56:59], v[152:155], v[192:207]
  v_add_f32 v35, v38, v39
  v_cvt_pk_bf16_f32 v208, v38, v39
  v_exp_f32 v38, v180
  ds_read_b64_tr_b16 v[52:53], v22 offset:28672
  ds_read_b64_tr_b16 v[54:55], v22 offset:30720
  s_waitcnt lgkmcnt(8)
  v_mfma_f32_32x32x16_bf16 v[192:207], v[60:63], v[156:159], v[192:207]
  v_exp_f32 v39, v181
  v_add_f32 v36, v40, v41
  v_cvt_pk_bf16_f32 v209, v40, v41
  ds_read_b64_tr_b16 v[56:57], v23 offset:24576
  ds_read_b64_tr_b16 v[58:59], v23 offset:26624
  s_waitcnt lgkmcnt(9)
  v_mfma_f32_32x32x16_bf16 v[192:207], v[64:67], v[160:163], v[192:207]
  v_exp_f32 v40, v182
  v_exp_f32 v41, v183
  ds_read_b64_tr_b16 v[60:61], v23 offset:28672
  ds_read_b64_tr_b16 v[62:63], v23 offset:30720
  s_waitcnt lgkmcnt(10)
  v_mfma_f32_32x32x16_bf16 v[192:207], v[68:71], v[164:167], v[192:207]
  v_add_f32 v35, v35, v38
  v_add_f32 v36, v36, v39
  v_cvt_pk_bf16_f32 v210, v38, v39
  v_exp_f32 v38, v184
  ds_read_b64_tr_b16 v[64:65], v24 offset:24576
  ds_read_b64_tr_b16 v[66:67], v24 offset:26624
  s_waitcnt lgkmcnt(11)
  v_mfma_f32_32x32x16_bf16 v[192:207], v[72:75], v[168:171], v[192:207]
  v_exp_f32 v39, v185
  v_add_f32 v35, v35, v40
  v_add_f32 v36, v36, v41
  ds_read_b64_tr_b16 v[68:69], v24 offset:28672
  ds_read_b64_tr_b16 v[70:71], v24 offset:30720
  s_waitcnt lgkmcnt(12)
  v_mfma_f32_32x32x16_bf16 v[192:207], v[76:79], v[172:175], v[192:207]
  v_cvt_pk_bf16_f32 v211, v40, v41
  v_exp_f32 v40, v186
  v_exp_f32 v41, v187
  ds_read_b64_tr_b16 v[72:73], v25 offset:24576
  ds_read_b64_tr_b16 v[74:75], v25 offset:26624
  s_waitcnt lgkmcnt(12)
  v_mfma_f32_32x32x16_bf16 v[80:95], v[48:51], v[216:219], v[80:95]
  v_add_f32 v35, v35, v38
  v_add_f32 v36, v36, v39
  v_cvt_pk_bf16_f32 v212, v38, v39
  v_exp_f32 v38, v188
  ds_read_b64_tr_b16 v[76:77], v25 offset:28672
  ds_read_b64_tr_b16 v[78:79], v25 offset:30720
  s_waitcnt lgkmcnt(12)
  v_mfma_f32_32x32x16_bf16 v[80:95], v[52:55], v[220:223], v[80:95]
  v_exp_f32 v39, v189
  v_add_f32 v35, v35, v40
  v_add_f32 v36, v36, v41
  s_waitcnt lgkmcnt(10)
  v_mfma_f32_32x32x16_bf16 v[96:111], v[56:59], v[216:219], v[96:111]
  v_cvt_pk_bf16_f32 v213, v40, v41
  v_exp_f32 v40, v190
  v_exp_f32 v41, v191
  s_waitcnt vmcnt(16) lgkmcnt(0)
  s_barrier
  s_cmp_eq_u32 s3, 7
  s_cselect_b32 s78, 5308416, 0
  buffer_load_dword v249, v44, s[76:79], 0 offen
  s_cselect_b32 s82, 5308416, 0
  buffer_load_dword v250, v45, s[80:83], 0 offen
  s_cselect_b32 s86, 5308416, 0
  buffer_load_dword v251, v46, s[84:87], 0 offen
  ds_read_b128 v[48:51], v14 offset:49152
  ds_read_b128 v[52:55], v15 offset:49152
  v_mfma_f32_32x32x16_bf16 v[96:111], v[60:63], v[220:223], v[96:111]
  v_add_f32 v35, v35, v38
  v_add_f32 v36, v36, v39
  v_cvt_pk_bf16_f32 v214, v38, v39
  v_add_f32 v35, v35, v40
  ds_read_b128 v[56:59], v16 offset:49152
  v_mfma_f32_32x32x16_bf16 v[112:127], v[64:67], v[216:219], v[112:127]
  v_add_f32 v36, v36, v41
  v_cvt_pk_bf16_f32 v215, v40, v41
  v_add_f32 v35, v35, v36
  v_cmp_nge_f32 vcc, s37, v35
  ds_read_b128 v[60:63], v17 offset:49152
  v_mfma_f32_32x32x16_bf16 v[112:127], v[68:71], v[220:223], v[112:127]
  ds_read_b128 v[64:67], v18 offset:49152
  v_mfma_f32_32x32x16_bf16 v[128:143], v[72:75], v[216:219], v[128:143]
  ds_read_b128 v[68:71], v19 offset:49152
  v_mfma_f32_32x32x16_bf16 v[128:143], v[76:79], v[220:223], v[128:143]
  s_cbranch_vccnz k1_rare12
k1_back12:
  v_add_f32 v34, v34, v35
  ds_read_b128 v[72:75], v20 offset:49152
  s_waitcnt lgkmcnt(6)
  v_mfma_f32_32x32x16_bf16 v[176:191], v[48:51], v[144:147], v[224:239]
  v_exp_f32 v38, v192
  v_exp_f32 v39, v193
  ds_read_b128 v[76:79], v21 offset:49152
  s_waitcnt lgkmcnt(6)
  v_mfma_f32_32x32x16_bf16 v[176:191], v[52:55], v[148:151], v[176:191]
  v_exp_f32 v40, v194
  v_exp_f32 v41, v195
  ds_read_b64_tr_b16 v[48:49], v22 offset:32768
  ds_read_b64_tr_b16 v[50:51], v22 offset:34816
  s_waitcnt lgkmcnt(7)
  v_mfma_f32_32x32x16_bf16 v[176:191], v[56:59], v[152:155], v[176:191]
  v_add_f32 v35, v38, v39
  v_cvt_pk_bf16_f32 v216, v38, v39
  v_exp_f32 v38, v196
  ds_read_b64_tr_b16 v[52:53], v22 offset:36864
  ds_read_b64_tr_b16 v[54:55], v22 offset:38912
  s_waitcnt lgkmcnt(8)
  v_mfma_f32_32x32x16_bf16 v[176:191], v[60:63], v[156:159], v[176:191]
  v_exp_f32 v39, v197
  v_add_f32 v36, v40, v41
  v_cvt_pk_bf16_f32 v217, v40, v41
  ds_read_b64_tr_b16 v[56:57], v23 offset:32768
  ds_read_b64_tr_b16 v[58:59], v23 offset:34816
  s_waitcnt lgkmcnt(9)
  v_mfma_f32_32x32x16_bf16 v[176:191], v[64:67], v[160:163], v[176:191]
  v_exp_f32 v40, v198
  v_exp_f32 v41, v199
  ds_read_b64_tr_b16 v[60:61], v23 offset:36864
  ds_read_b64_tr_b16 v[62:63], v23 offset:38912
  s_waitcnt lgkmcnt(10)
  v_mfma_f32_32x32x16_bf16 v[176:191], v[68:71], v[164:167], v[176:191]
  v_add_f32 v35, v35, v38
  v_add_f32 v36, v36, v39
  v_cvt_pk_bf16_f32 v218, v38, v39
  v_exp_f32 v38, v200
  ds_read_b64_tr_b16 v[64:65], v24 offset:32768
  ds_read_b64_tr_b16 v[66:67], v24 offset:34816
  s_waitcnt lgkmcnt(11)
  v_mfma_f32_32x32x16_bf16 v[176:191], v[72:75], v[168:171], v[176:191]
  v_exp_f32 v39, v201
  v_add_f32 v35, v35, v40
  v_add_f32 v36, v36, v41
  ds_read_b64_tr_b16 v[68:69], v24 offset:36864
  ds_read_b64_tr_b16 v[70:71], v24 offset:38912
  s_waitcnt lgkmcnt(12)
  v_mfma_f32_32x32x16_bf16 v[176:191], v[76:79], v[172:175], v[176:191]
  v_cvt_pk_bf16_f32 v219, v40, v41
  v_exp_f32 v40, v202
  v_exp_f32 v41, v203
  ds_read_b64_tr_b16 v[72:73], v25 offset:32768
  ds_read_b64_tr_b16 v[74:75], v25 offset:34816
  s_waitcnt lgkmcnt(12)
  v_mfma_f32_32x32x16_bf16 v[80:95], v[48:51], v[208:211], v[80:95]
  v_add_f32 v35, v35, v38
  v_add_f32 v36, v36, v39
  v_cvt_pk_bf16_f32 v220, v38, v39
  v_exp_f32 v38, v204
  ds_read_b64_tr_b16 v[76:77], v25 offset:36864
  ds_read_b64_tr_b16 v[78:79], v25 offset:38912
  s_waitcnt lgkmcnt(12)
  v_mfma_f32_32x32x16_bf16 v[80:95], v[52:55], v[212:215], v[80:95]
  v_exp_f32 v39, v205
  v_add_f32 v35, v35, v40
  v_add_f32 v36, v36, v41
  ds_read_b128 v[48:51], v14 offset:57344
  s_waitcnt lgkmcnt(11)
  v_mfma_f32_32x32x16_bf16 v[96:111], v[56:59], v[208:211], v[96:111]
  v_cvt_pk_bf16_f32 v221, v40, v41
  v_exp_f32 v40, v206
  v_exp_f32 v41, v207
  ds_read_b128 v[52:55], v15 offset:57344
  s_waitcnt lgkmcnt(10)
  v_mfma_f32_32x32x16_bf16 v[96:111], v[60:63], v[212:215], v[96:111]
  v_add_f32 v35, v35, v38
  v_add_f32 v36, v36, v39
  v_cvt_pk_bf16_f32 v222, v38, v39
  v_add_f32 v35, v35, v40
  ds_read_b128 v[56:59], v16 offset:57344
  s_waitcnt lgkmcnt(9)
  v_mfma_f32_32x32x16_bf16 v[112:127], v[64:67], v[208:211], v[112:127]
  v_add_f32 v36, v36, v41
  v_cvt_pk_bf16_f32 v223, v40, v41
  v_add_f32 v35, v35, v36
  v_cmp_nge_f32 vcc, s37, v35
  ds_read_b128 v[60:63], v17 offset:57344
  s_waitcnt lgkmcnt(8)
  v_mfma_f32_32x32x16_bf16 v[112:127], v[68:71], v[212:215], v[112:127]
  ds_read_b128 v[64:67], v18 offset:57344
  s_waitcnt lgkmcnt(7)
  v_mfma_f32_32x32x16_bf16 v[128:143], v[72:75], v[208:211], v[128:143]
  ds_read_b128 v[68:71], v19 offset:57344
  s_waitcnt lgkmcnt(6)
  v_mfma_f32_32x32x16_bf16 v[128:143], v[76:79], v[212:215], v[128:143]
  s_cbranch_vccnz k1_rare13
k1_back13:
  v_add_f32 v34, v34, v35
  ds_read_b128 v[72:75], v20 offset:57344
  s_waitcnt lgkmcnt(6)
  v_mfma_f32_32x32x16_bf16 v[192:207], v[48:51], v[144:147], v[224:239]
  v_exp_f32 v38, v176
  v_exp_f32 v39, v177
  ds_read_b128 v[76:79], v21 offset:57344
  s_waitcnt lgkmcnt(6)
  v_mfma_f32_32x32x16_bf16 v[192:207], v[52:55], v[148:151], v[192:207]
  v_exp_f32 v40, v178
  v_exp_f32 v41, v179
  ds_read_b64_tr_b16 v[48:49], v22 offset:40960
  ds_read_b64_tr_b16 v[50:51], v22 offset:43008
  s_waitcnt lgkmcnt(7)
  v_mfma_f32_32x32x16_bf16 v[192:207], v[56:59], v[152:155], v[192:207]
  v_add_f32 v35, v38, v39
  v_cvt_pk_bf16_f32 v208, v38, v39
  v_exp_f32 v38, v180
  ds_read_b64_tr_b16 v[52:53], v22 offset:45056
  ds_read_b64_tr_b16 v[54:55], v22 offset:47104
  s_waitcnt lgkmcnt(8)
  v_mfma_f32_32x32x16_bf16 v[192:207], v[60:63], v[156:159], v[192:207]
  v_exp_f32 v39, v181
  v_add_f32 v36, v40, v41
  v_cvt_pk_bf16_f32 v209, v40, v41
  ds_read_b64_tr_b16 v[56:57], v23 offset:40960
  ds_read_b64_tr_b16 v[58:59], v23 offset:43008
  s_waitcnt lgkmcnt(9)
  v_mfma_f32_32x32x16_bf16 v[192:207], v[64:67], v[160:163], v[192:207]
  v_exp_f32 v40, v182
  v_exp_f32 v41, v183
  ds_read_b64_tr_b16 v[60:61], v23 offset:45056
  ds_read_b64_tr_b16 v[62:63], v23 offset:47104
  s_waitcnt lgkmcnt(10)
  v_mfma_f32_32x32x16_bf16 v[192:207], v[68:71], v[164:167], v[192:207]
  v_add_f32 v35, v35, v38
  v_add_f32 v36, v36, v39
  v_cvt_pk_bf16_f32 v210, v38, v39
  v_exp_f32 v38, v184
  ds_read_b64_tr_b16 v[64:65], v24 offset:40960
  ds_read_b64_tr_b16 v[66:67], v24 offset:43008
  s_waitcnt lgkmcnt(11)
  v_mfma_f32_32x32x16_bf16 v[192:207], v[72:75], v[168:171], v[192:207]
  v_exp_f32 v39, v185
  v_add_f32 v35, v35, v40
  v_add_f32 v36, v36, v41
  ds_read_b64_tr_b16 v[68:69], v24 offset:45056
  ds_read_b64_tr_b16 v[70:71], v24 offset:47104
  s_waitcnt lgkmcnt(12)
  v_mfma_f32_32x32x16_bf16 v[192:207], v[76:79], v[172:175], v[192:207]
  v_cvt_pk_bf16_f32 v211, v40, v41
  v_exp_f32 v40, v186
  v_exp_f32 v41, v187
  ds_read_b64_tr_b16 v[72:73], v25 offset:40960
  ds_read_b64_tr_b16 v[74:75], v25 offset:43008
  s_waitcnt lgkmcnt(12)
  v_mfma_f32_32x32x16_bf16 v[80:95], v[48:51], v[216:219], v[80:95]
  v_add_f32 v35, v35, v38
  v_add_f32 v36, v36, v39
  v_cvt_pk_bf16_f32 v212, v38, v39
  v_exp_f32 v38, v188
  ds_read_b64_tr_b16 v[76:77], v25 offset:45056
  ds_read_b64_tr_b16 v[78:79], v25 offset:47104
  s_waitcnt lgkmcnt(12)
  v_mfma_f32_32x32x16_bf16 v[80:95], v[52:55], v[220:223], v[80:95]
  v_exp_f32 v39, v189
  v_add_f32 v35, v35, v40
  v_add_f32 v36, v36, v41
  s_waitcnt lgkmcnt(10)
  v_mfma_f32_32x32x16_bf16 v[96:111], v[56:59], v[216:219], v[96:111]
  v_cvt_pk_bf16_f32 v213, v40, v41
  v_exp_f32 v40, v190
  v_exp_f32 v41, v191
  s_waitcnt vmcnt(14) lgkmcnt(0)
  s_barrier
  ds_read_b64_tr_b16 v[48:49], v22 offset:49152
  ds_read_b64_tr_b16 v[50:51], v22 offset:51200
  ds_read_b64_tr_b16 v[52:53], v22 offset:53248
  ds_read_b64_tr_b16 v[54:55], v22 offset:55296
  v_mfma_f32_32x32x16_bf16 v[96:111], v[60:63], v[220:223], v[96:111]
  v_add_f32 v35, v35, v38
  v_add_f32 v36, v36, v39
  v_cvt_pk_bf16_f32 v214, v38, v39
  v_add_f32 v35, v35, v40
  ds_read_b64_tr_b16 v[56:57], v23 offset:49152
  ds_read_b64_tr_b16 v[58:59], v23 offset:51200
  v_mfma_f32_32x32x16_bf16 v[112:127], v[64:67], v[216:219], v[112:127]
  v_add_f32 v36, v36, v41
  v_cvt_pk_bf16_f32 v215, v40, v41
  v_add_f32 v35, v35, v36
  v_cmp_nge_f32 vcc, s37, v35
  ds_read_b64_tr_b16 v[60:61], v23 offset:53248
  ds_read_b64_tr_b16 v[62:63], v23 offset:55296
  v_mfma_f32_32x32x16_bf16 v[112:127], v[68:71], v[220:223], v[112:127]
  ds_read_b64_tr_b16 v[64:65], v24 offset:49152
  ds_read_b64_tr_b16 v[66:67], v24 offset:51200
  v_mfma_f32_32x32x16_bf16 v[128:143], v[72:75], v[216:219], v[128:143]
  ds_read_b64_tr_b16 v[68:69], v24 offset:53248
  ds_read_b64_tr_b16 v[70:71], v24 offset:55296
  v_mfma_f32_32x32x16_bf16 v[128:143], v[76:79], v[220:223], v[128:143]
  s_cbranch_vccnz k1_rare14
k1_back14:
  v_add_f32 v34, v34, v35
  ds_read_b64_tr_b16 v[72:73], v25 offset:49152
  ds_read_b64_tr_b16 v[74:75], v25 offset:51200
  s_waitcnt lgkmcnt(12)
  v_mfma_f32_32x32x16_bf16 v[80:95], v[48:51], v[208:211], v[80:95]
  v_exp_f32 v38, v192
  v_exp_f32 v39, v193
  v_exp_f32 v40, v194
  v_exp_f32 v41, v195
  ds_read_b64_tr_b16 v[76:77], v25 offset:53248
  ds_read_b64_tr_b16 v[78:79], v25 offset:55296
  s_waitcnt lgkmcnt(12)
  v_mfma_f32_32x32x16_bf16 v[80:95], v[52:55], v[212:215], v[80:95]
  v_add_f32 v35, v38, v39
  v_cvt_pk_bf16_f32 v216, v38, v39
  v_exp_f32 v38, v196
  v_exp_f32 v39, v197
  v_add_f32 v36, v40, v41
  v_cvt_pk_bf16_f32 v217, v40, v41
  ds_read_b64_tr_b16 v[48:49], v22 offset:57344
  ds_read_b64_tr_b16 v[50:51], v22 offset:59392
  s_waitcnt lgkmcnt(12)
  v_mfma_f32_32x32x16_bf16 v[96:111], v[56:59], v[208:211], v[96:111]
  v_exp_f32 v40, v198
  v_exp_f32 v41, v199
  v_add_f32 v35, v35, v38
  v_add_f32 v36, v36, v39
  v_cvt_pk_bf16_f32 v218, v38, v39
  v_exp_f32 v38, v200
  ds_read_b64_tr_b16 v[52:53], v22 offset:61440
  ds_read_b64_tr_b16 v[54:55], v22 offset:63488
  s_waitcnt lgkmcnt(12)
  v_mfma_f32_32x32x16_bf16 v[96:111], v[60:63], v[212:215], v[96:111]
  v_exp_f32 v39, v201
  v_add_f32 v35, v35, v40
  v_add_f32 v36, v36, v41
  v_cvt_pk_bf16_f32 v219, v40, v41
  v_exp_f32 v40, v202
  v_exp_f32 v41, v203
  ds_read_b64_tr_b16 v[56:57], v23 offset:57344
  ds_read_b64_tr_b16 v[58:59], v23 offset:59392
  s_waitcnt lgkmcnt(12)
  v_mfma_f32_32x32x16_bf16 v[112:127], v[64:67], v[208:211], v[112:127]
  v_add_f32 v35, v35, v38
  v_add_f32 v36, v36, v39
  v_cvt_pk_bf16_f32 v220, v38, v39
  v_exp_f32 v38, v204
  v_exp_f32 v39, v205
  v_add_f32 v35, v35, v40
  ds_read_b64_tr_b16 v[60:61], v23 offset:61440
  ds_read_b64_tr_b16 v[62:63], v23 offset:63488
  s_waitcnt lgkmcnt(12)
  v_mfma_f32_32x32x16_bf16 v[112:127], v[68:71], v[212:215], v[112:127]
  v_add_f32 v36, v36, v41
  v_cvt_pk_bf16_f32 v221, v40, v41
  v_exp_f32 v40, v206
  v_exp_f32 v41, v207
  v_add_f32 v35, v35, v38
  v_add_f32 v36, v36, v39
  ds_read_b64_tr_b16 v[64:65], v24 offset:57344
  ds_read_b64_tr_b16 v[66:67], v24 offset:59392
  s_waitcnt lgkmcnt(12)
  v_mfma_f32_32x32x16_bf16 v[128:143], v[72:75], v[208:211], v[128:143]
  v_cvt_pk_bf16_f32 v222, v38, v39
  v_add_f32 v35, v35, v40
  v_add_f32 v36, v36, v41
  v_cvt_pk_bf16_f32 v223, v40, v41
  v_add_f32 v35, v35, v36
  v_cmp_nge_f32 vcc, s37, v35
  ds_read_b64_tr_b16 v[68:69], v24 offset:61440
  ds_read_b64_tr_b16 v[70:71], v24 offset:63488
  s_waitcnt lgkmcnt(12)
  v_mfma_f32_32x32x16_bf16 v[128:143], v[76:79], v[212:215], v[128:143]
  s_cbranch_vccnz k1_rare15
k1_back15:
  v_add_f32 v34, v34, v35
  ds_read_b64_tr_b16 v[72:73], v25 offset:57344
  ds_read_b64_tr_b16 v[74:75], v25 offset:59392
  s_waitcnt lgkmcnt(12)
  v_mfma_f32_32x32x16_bf16 v[80:95], v[48:51], v[216:219], v[80:95]
  v_mov_b32 v42, v34
  s_nop 1
  v_permlane32_swap_b32 v42, v34
  v_add_f32 v34, v34, v42
  v_rcp_f32 v34, v34
  ds_read_b64_tr_b16 v[76:77], v25 offset:61440
  ds_read_b64_tr_b16 v[78:79], v25 offset:63488
  s_waitcnt lgkmcnt(12)
  v_mfma_f32_32x32x16_bf16 v[80:95], v[52:55], v[220:223], v[80:95]
  s_waitcnt lgkmcnt(10)
  v_mfma_f32_32x32x16_bf16 v[96:111], v[56:59], v[216:219], v[96:111]
  s_waitcnt vmcnt(10) lgkmcnt(0)
  s_barrier
  ds_read_b64_tr_b16 v[48:49], v28 offset:0
  ds_read_b64_tr_b16 v[50:51], v28 offset:1024
  ds_read_b64_tr_b16 v[52:53], v28 offset:2048
  ds_read_b64_tr_b16 v[54:55], v28 offset:3072
  v_mfma_f32_32x32x16_bf16 v[96:111], v[60:63], v[220:223], v[96:111]
  s_add_u32 m0, s34, 98304
  s_mov_b32 s40, 256
  buffer_load_dwordx4 v12, s[44:47], s40 offen lds
  v_mul_f32 v80, v34, v80
  v_mul_f32 v81, v34, v81
  v_mul_f32 v82, v34, v82
  v_mul_f32 v83, v34, v83
  v_mul_f32 v84, v34, v84
  v_mul_f32 v85, v34, v85
  v_mul_f32 v86, v34, v86
  v_mul_f32 v87, v34, v87
  ds_read_b64_tr_b16 v[56:57], v28 offset:4096
  ds_read_b64_tr_b16 v[58:59], v28 offset:5120
  v_mfma_f32_32x32x16_bf16 v[112:127], v[64:67], v[216:219], v[112:127]
  s_add_u32 m0, s34, 106496
  s_mov_b32 s40, 73984
  buffer_load_dwordx4 v12, s[44:47], s40 offen lds
  v_mul_f32 v88, v34, v88
  v_mul_f32 v89, v34, v89
  v_mul_f32 v90, v34, v90
  v_mul_f32 v91, v34, v91
  v_mul_f32 v92, v34, v92
  v_mul_f32 v93, v34, v93
  v_mul_f32 v94, v34, v94
  v_mul_f32 v95, v34, v95
  ds_read_b64_tr_b16 v[60:61], v28 offset:6144
  ds_read_b64_tr_b16 v[62:63], v28 offset:7168
  v_mfma_f32_32x32x16_bf16 v[112:127], v[68:71], v[220:223], v[112:127]
  s_add_u32 m0, s34, 114688
  s_mov_b32 s40, 147712
  buffer_load_dwordx4 v12, s[44:47], s40 offen lds
  v_cvt_pk_bf16_f32 v144, v80, v81
  v_cvt_pk_bf16_f32 v145, v82, v83
  v_cvt_pk_bf16_f32 v146, v84, v85
  v_cvt_pk_bf16_f32 v147, v86, v87
  v_cvt_pk_bf16_f32 v148, v88, v89
  v_cvt_pk_bf16_f32 v149, v90, v91
  v_cvt_pk_bf16_f32 v150, v92, v93
  v_cvt_pk_bf16_f32 v151, v94, v95
  ds_read_b64_tr_b16 v[64:65], v28 offset:8192
  ds_read_b64_tr_b16 v[66:67], v28 offset:9216
  v_mfma_f32_32x32x16_bf16 v[128:143], v[72:75], v[216:219], v[128:143]
  s_add_u32 m0, s34, 122880
  s_mov_b32 s40, 221440
  buffer_load_dwordx4 v12, s[44:47], s40 offen lds
  v_mul_f32 v96, v34, v96
  v_mul_f32 v97, v34, v97
  v_mul_f32 v98, v34, v98
  v_mul_f32 v99, v34, v99
  v_mul_f32 v100, v34, v100
  v_mul_f32 v101, v34, v101
  v_mul_f32 v102, v34, v102
  v_mul_f32 v103, v34, v103
  ds_read_b64_tr_b16 v[68:69], v28 offset:10240
  ds_read_b64_tr_b16 v[70:71], v28 offset:11264
  v_mfma_f32_32x32x16_bf16 v[128:143], v[76:79], v[220:223], v[128:143]
  ds_write_b128 v32, v[144:147] offset:0
  ds_write_b128 v32, v[148:151] offset:1024
  v_mul_f32 v104, v34, v104
  v_mul_f32 v105, v34, v105
  v_mul_f32 v106, v34, v106
  v_mul_f32 v107, v34, v107
  v_mul_f32 v108, v34, v108
  v_mul_f32 v109, v34, v109
  v_mul_f32 v110, v34, v110
  ds_read_b64_tr_b16 v[72:73], v28 offset:12288
  ds_read_b64_tr_b16 v[74:75], v28 offset:13312
  s_waitcnt lgkmcnt(14)
  v_mfma_f32_32x32x16_bf16 v[224:239], v[48:51], v[144:147], 0
  v_mul_f32 v111, v34, v111
  v_cvt_pk_bf16_f32 v152, v96, v97
  v_cvt_pk_bf16_f32 v153, v98, v99
  v_cvt_pk_bf16_f32 v154, v100, v101
  v_cvt_pk_bf16_f32 v155, v102, v103
  v_cvt_pk_bf16_f32 v156, v104, v105
  v_cvt_pk_bf16_f32 v157, v106, v107
  v_cvt_pk_bf16_f32 v158, v108, v109
  v_cvt_pk_bf16_f32 v159, v110, v111
  v_mul_f32 v112, v34, v112
  ds_read_b64_tr_b16 v[76:77], v28 offset:14336
  ds_read_b64_tr_b16 v[78:79], v28 offset:15360
  s_waitcnt lgkmcnt(14)
  v_mfma_f32_32x32x16_bf16 v[224:239], v[52:55], v[148:151], v[224:239]
  ds_write_b128 v32, v[152:155] offset:2048
  ds_write_b128 v32, v[156:159] offset:3072
  v_mul_f32 v113, v34, v113
  v_mul_f32 v114, v34, v114
  v_mul_f32 v115, v34, v115
  v_mul_f32 v116, v34, v116
  v_mul_f32 v117, v34, v117
  v_mul_f32 v118, v34, v118
  v_mul_f32 v119, v34, v119
  s_waitcnt lgkmcnt(14)
  v_mfma_f32_32x32x16_bf16 v[224:239], v[56:59], v[152:155], v[224:239]
  v_mul_f32 v120, v34, v120
  v_mul_f32 v121, v34, v121
  v_mul_f32 v122, v34, v122
  v_mul_f32 v123, v34, v123
  v_mul_f32 v124, v34, v124
  v_mul_f32 v125, v34, v125
  v_mul_f32 v126, v34, v126
  v_mul_f32 v127, v34, v127
  v_cvt_pk_bf16_f32 v160, v112, v113
  v_cvt_pk_bf16_f32 v161, v114, v115
  s_waitcnt lgkmcnt(12)
  v_mfma_f32_32x32x16_bf16 v[224:239], v[60:63], v[156:159], v[224:239]
  v_cvt_pk_bf16_f32 v162, v116, v117
  v_cvt_pk_bf16_f32 v163, v118, v119
  v_cvt_pk_bf16_f32 v164, v120, v121
  v_cvt_pk_bf16_f32 v165, v122, v123
  v_cvt_pk_bf16_f32 v166, v124, v125
  v_cvt_pk_bf16_f32 v167, v126, v127
  v_mul_f32 v128, v34, v128
  v_mul_f32 v129, v34, v129
  v_mul_f32 v130, v34, v130
  v_mul_f32 v131, v34, v131
  s_waitcnt lgkmcnt(10)
  v_mfma_f32_32x32x16_bf16 v[224:239], v[64:67], v[160:163], v[224:239]
  ds_write_b128 v32, v[160:163] offset:4096
  ds_write_b128 v32, v[164:167] offset:5120
  v_mul_f32 v132, v34, v132
  v_mul_f32 v133, v34, v133
  v_mul_f32 v134, v34, v134
  v_mul_f32 v135, v34, v135
  v_mul_f32 v136, v34, v136
  v_mul_f32 v137, v34, v137
  v_mul_f32 v138, v34, v138
  s_waitcnt lgkmcnt(10)
  v_mfma_f32_32x32x16_bf16 v[224:239], v[68:71], v[164:167], v[224:239]
  v_mul_f32 v139, v34, v139
  v_mul_f32 v140, v34, v140
  v_mul_f32 v141, v34, v141
  v_mul_f32 v142, v34, v142
  v_mul_f32 v143, v34, v143
  v_cvt_pk_bf16_f32 v168, v128, v129
  v_cvt_pk_bf16_f32 v169, v130, v131
  v_cvt_pk_bf16_f32 v170, v132, v133
  v_cvt_pk_bf16_f32 v171, v134, v135
  v_cvt_pk_bf16_f32 v172, v136, v137
  v_cvt_pk_bf16_f32 v173, v138, v139
  v_cvt_pk_bf16_f32 v174, v140, v141
  v_cvt_pk_bf16_f32 v175, v142, v143
  s_waitcnt lgkmcnt(6)
  v_mfma_f32_32x32x16_bf16 v[224:239], v[72:75], v[168:171], v[224:239]
  ds_write_b128 v32, v[168:171] offset:6144
  ds_write_b128 v32, v[172:175] offset:7168
  s_waitcnt lgkmcnt(0)
  s_barrier
  ds_read_b128 v[176:179], v33 offset:0
  ds_read_b64_tr_b16 v[48:49], v31 offset:0
  ds_read_b64_tr_b16 v[50:51], v31 offset:1024
  ds_read_b128 v[180:183], v33 offset:1024
  ds_read_b64_tr_b16 v[52:53], v31 offset:2048
  ds_read_b64_tr_b16 v[54:55], v31 offset:3072
  v_mfma_f32_32x32x16_bf16 v[224:239], v[76:79], v[172:175], v[224:239]
  ds_read_b128 v[184:187], v33 offset:2048
  ds_read_b64_tr_b16 v[56:57], v31 offset:4096
  ds_read_b64_tr_b16 v[58:59], v31 offset:5120
  ds_read_b128 v[188:191], v33 offset:3072
  ds_read_b64_tr_b16 v[60:61], v31 offset:6144
  ds_read_b64_tr_b16 v[62:63], v31 offset:7168
  s_waitcnt lgkmcnt(9)
  v_mfma_f32_32x32x16_bf16 v[224:239], v[48:51], v[176:179], v[224:239]
  ds_read_b128 v[192:195], v33 offset:4096
  ds_read_b64_tr_b16 v[64:65], v31 offset:8192
  ds_read_b64_tr_b16 v[66:67], v31 offset:9216
  ds_read_b128 v[196:199], v33 offset:5120
  ds_read_b64_tr_b16 v[68:69], v31 offset:10240
  ds_read_b64_tr_b16 v[70:71], v31 offset:11264
  s_waitcnt lgkmcnt(12)
  v_mfma_f32_32x32x16_bf16 v[224:239], v[52:55], v[180:183], v[224:239]
  ds_read_b128 v[200:203], v33 offset:6144
  ds_read_b64_tr_b16 v[72:73], v31 offset:12288
  ds_read_b64_tr_b16 v[74:75], v31 offset:13312
  ds_read_b128 v[204:207], v33 offset:7168
  ds_read_b64_tr_b16 v[76:77], v31 offset:14336
  ds_read_b64_tr_b16 v[78:79], v31 offset:15360
  s_waitcnt lgkmcnt(15)
  v_mfma_f32_32x32x16_bf16 v[224:239], v[56:59], v[184:187], v[224:239]
  s_waitcnt lgkmcnt(12)
  v_mfma_f32_32x32x16_bf16 v[224:239], v[60:63], v[188:191], v[224:239]
  s_waitcnt vmcnt(7) lgkmcnt(0)
  s_barrier
  ds_read_b64_tr_b16 v[48:49], v26 offset:0
  ds_read_b64_tr_b16 v[50:51], v26 offset:1024
  ds_read_b64_tr_b16 v[52:53], v26 offset:2048
  ds_read_b64_tr_b16 v[54:55], v26 offset:3072
  v_mfma_f32_32x32x16_bf16 v[224:239], v[64:67], v[192:195], v[224:239]
  s_add_u32 m0, s34, 32768
  s_mov_b32 s40, 384
  buffer_load_dwordx4 v12, s[44:47], s40 offen lds
  ds_read_b64_tr_b16 v[56:57], v26 offset:4096
  ds_read_b64_tr_b16 v[58:59], v26 offset:5120
  ds_read_b64_tr_b16 v[60:61], v26 offset:6144
  ds_read_b64_tr_b16 v[62:63], v26 offset:7168
  v_mfma_f32_32x32x16_bf16 v[224:239], v[68:71], v[196:199], v[224:239]
  s_add_u32 m0, s34, 40960
  s_mov_b32 s40, 74112
  buffer_load_dwordx4 v12, s[44:47], s40 offen lds
  ds_read_b64_tr_b16 v[64:65], v26 offset:8192
  ds_read_b64_tr_b16 v[66:67], v26 offset:9216
  v_mfma_f32_32x32x16_bf16 v[224:239], v[72:75], v[200:203], v[224:239]
  s_add_u32 m0, s34, 49152
  s_mov_b32 s40, 147840
  buffer_load_dwordx4 v12, s[44:47], s40 offen lds
  ds_read_b64_tr_b16 v[68:69], v26 offset:10240
  ds_read_b64_tr_b16 v[70:71], v26 offset:11264
  v_mfma_f32_32x32x16_bf16 v[224:239], v[76:79], v[204:207], v[224:239]
  s_add_u32 m0, s34, 57344
  s_mov_b32 s40, 221568
  buffer_load_dwordx4 v12, s[44:47], s40 offen lds
  ds_read_b64_tr_b16 v[72:73], v26 offset:12288
  ds_read_b64_tr_b16 v[74:75], v26 offset:13312
  s_waitcnt vmcnt(8) lgkmcnt(12)
  v_mfma_f32_32x32x16_bf16 v[240:255], v[48:51], v[144:147], 0
  s_add_u32 m0, s34, 65536
  s_mov_b32 s40, 512
  buffer_load_dwordx4 v12, s[44:47], s40 offen lds
  ds_read_b64_tr_b16 v[76:77], v26 offset:14336
  ds_read_b64_tr_b16 v[78:79], v26 offset:15360
  s_waitcnt lgkmcnt(12)
  v_mfma_f32_32x32x16_bf16 v[240:255], v[52:55], v[148:151], v[240:255]
  s_add_u32 m0, s34, 73728
  s_mov_b32 s40, 74240
  buffer_load_dwordx4 v12, s[44:47], s40 offen lds
  ds_read_b64_tr_b16 v[48:49], v29 offset:0
  ds_read_b64_tr_b16 v[50:51], v29 offset:1024
  s_waitcnt lgkmcnt(12)
  v_mfma_f32_32x32x16_bf16 v[240:255], v[56:59], v[152:155], v[240:255]
  s_add_u32 m0, s34, 81920
  s_mov_b32 s40, 147968
  buffer_load_dwordx4 v12, s[44:47], s40 offen lds
  v_cvt_pk_bf16_f32 v208, v224, v225
  v_cvt_pk_bf16_f32 v209, v226, v227
  v_cvt_pk_bf16_f32 v210, v228, v229
  v_cvt_pk_bf16_f32 v211, v230, v231
  ds_read_b64_tr_b16 v[52:53], v29 offset:2048
  ds_read_b64_tr_b16 v[54:55], v29 offset:3072
  s_waitcnt lgkmcnt(12)
  v_mfma_f32_32x32x16_bf16 v[240:255], v[60:63], v[156:159], v[240:255]
  s_add_u32 m0, s34, 90112
  s_mov_b32 s40, 221696
  buffer_load_dwordx4 v12, s[44:47], s40 offen lds
  v_cvt_pk_bf16_f32 v212, v232, v233
  v_cvt_pk_bf16_f32 v213, v234, v235
  v_cvt_pk_bf16_f32 v214, v236, v237
  v_cvt_pk_bf16_f32 v215, v238, v239
  ds_read_b64_tr_b16 v[56:57], v29 offset:4096
  ds_read_b64_tr_b16 v[58:59], v29 offset:5120
  s_waitcnt lgkmcnt(12)
  v_mfma_f32_32x32x16_bf16 v[240:255], v[64:67], v[160:163], v[240:255]
  s_add_u32 m0, s34, 131072
  s_mov_b32 s40, 640
  buffer_load_dwordx4 v12, s[44:47], s40 offen lds
  s_mov_b32 s41, 0
  buffer_store_dwordx4 v[208:211], v13, s[24:27], s41 offen offset:0 sc1
  buffer_store_dwordx4 v[212:215], v13, s[24:27], s41 offen offset:1024 sc1
  ds_read_b64_tr_b16 v[60:61], v29 offset:6144
  ds_read_b64_tr_b16 v[62:63], v29 offset:7168
  s_waitcnt lgkmcnt(12)
  v_mfma_f32_32x32x16_bf16 v[240:255], v[68:71], v[164:167], v[240:255]
  s_add_u32 m0, s34, 139264
  s_mov_b32 s40, 74368
  buffer_load_dwordx4 v12, s[44:47], s40 offen lds
  ds_read_b64_tr_b16 v[64:65], v29 offset:8192
  ds_read_b64_tr_b16 v[66:67], v29 offset:9216
  s_waitcnt lgkmcnt(12)
  v_mfma_f32_32x32x16_bf16 v[240:255], v[72:75], v[168:171], v[240:255]
  s_add_u32 m0, s34, 147456
  s_mov_b32 s40, 148096
  buffer_load_dwordx4 v12, s[44:47], s40 offen lds
  ds_read_b64_tr_b16 v[68:69], v29 offset:10240
  ds_read_b64_tr_b16 v[70:71], v29 offset:11264
  s_waitcnt lgkmcnt(12)
  v_mfma_f32_32x32x16_bf16 v[240:255], v[76:79], v[172:175], v[240:255]
  s_add_u32 m0, s34, 155648
  s_mov_b32 s40, 221824
  buffer_load_dwordx4 v12, s[44:47], s40 offen lds
  ds_read_b64_tr_b16 v[72:73], v29 offset:12288
  ds_read_b64_tr_b16 v[74:75], v29 offset:13312
  s_waitcnt lgkmcnt(12)
  v_mfma_f32_32x32x16_bf16 v[240:255], v[48:51], v[176:179], v[240:255]
  ds_read_b64_tr_b16 v[76:77], v29 offset:14336
  ds_read_b64_tr_b16 v[78:79], v29 offset:15360
  s_waitcnt lgkmcnt(12)
  v_mfma_f32_32x32x16_bf16 v[240:255], v[52:55], v[180:183], v[240:255]
  s_waitcnt lgkmcnt(10)
  v_mfma_f32_32x32x16_bf16 v[240:255], v[56:59], v[184:187], v[240:255]
  s_waitcnt vmcnt(14) lgkmcnt(0)
  s_barrier
  ds_read_b64_tr_b16 v[48:49], v27 offset:32768
  ds_read_b64_tr_b16 v[50:51], v27 offset:33792
  ds_read_b64_tr_b16 v[52:53], v27 offset:34816
  ds_read_b64_tr_b16 v[54:55], v27 offset:35840
  v_mfma_f32_32x32x16_bf16 v[240:255], v[60:63], v[188:191], v[240:255]
  s_add_u32 m0, s34, 0
  s_mov_b32 s40, 768
  buffer_load_dwordx4 v12, s[44:47], s40 offen lds
  ds_read_b64_tr_b16 v[56:57], v27 offset:36864
  ds_read_b64_tr_b16 v[58:59], v27 offset:37888
  v_mfma_f32_32x32x16_bf16 v[240:255], v[64:67], v[192:195], v[240:255]
  s_add_u32 m0, s34, 8192
  s_mov_b32 s40, 74496
  buffer_load_dwordx4 v12, s[44:47], s40 offen lds
  ds_read_b64_tr_b16 v[60:61], v27 offset:38912
  ds_read_b64_tr_b16 v[62:63], v27 offset:39936
  v_mfma_f32_32x32x16_bf16 v[240:255], v[68:71], v[196:199], v[240:255]
  s_add_u32 m0, s34, 16384
  s_mov_b32 s40, 148224
  buffer_load_dwordx4 v12, s[44:47], s40 offen lds
  ds_read_b64_tr_b16 v[64:65], v27 offset:40960
  ds_read_b64_tr_b16 v[66:67], v27 offset:41984
  v_mfma_f32_32x32x16_bf16 v[240:255], v[72:75], v[200:203], v[240:255]
  s_add_u32 m0, s34, 24576
  s_mov_b32 s40, 221952
  buffer_load_dwordx4 v12, s[44:47], s40 offen lds
  ds_read_b64_tr_b16 v[68:69], v27 offset:43008
  ds_read_b64_tr_b16 v[70:71], v27 offset:44032
  v_mfma_f32_32x32x16_bf16 v[240:255], v[76:79], v[204:207], v[240:255]
  ds_read_b64_tr_b16 v[72:73], v27 offset:45056
  ds_read_b64_tr_b16 v[74:75], v27 offset:46080
  s_waitcnt lgkmcnt(12)
  v_mfma_f32_32x32x16_bf16 v[224:239], v[48:51], v[144:147], 0
  ds_read_b64_tr_b16 v[76:77], v27 offset:47104
  ds_read_b64_tr_b16 v[78:79], v27 offset:48128
  s_waitcnt lgkmcnt(12)
  v_mfma_f32_32x32x16_bf16 v[224:239], v[52:55], v[148:151], v[224:239]
  ds_read_b64_tr_b16 v[48:49], v30 offset:32768
  ds_read_b64_tr_b16 v[50:51], v30 offset:33792
  s_waitcnt lgkmcnt(12)
  v_mfma_f32_32x32x16_bf16 v[224:239], v[56:59], v[152:155], v[224:239]
  v_cvt_pk_bf16_f32 v216, v240, v241
  v_cvt_pk_bf16_f32 v217, v242, v243
  v_cvt_pk_bf16_f32 v218, v244, v245
  v_cvt_pk_bf16_f32 v219, v246, v247
  v_cvt_pk_bf16_f32 v220, v248, v249
  v_cvt_pk_bf16_f32 v221, v250, v251
  ds_read_b64_tr_b16 v[52:53], v30 offset:34816
  ds_read_b64_tr_b16 v[54:55], v30 offset:35840
  s_waitcnt lgkmcnt(12)
  v_mfma_f32_32x32x16_bf16 v[224:239], v[60:63], v[156:159], v[224:239]
  v_cvt_pk_bf16_f32 v222, v252, v253
  v_cvt_pk_bf16_f32 v223, v254, v255
  s_mov_b32 s41, 4096
  buffer_store_dwordx4 v[216:219], v13, s[24:27], s41 offen offset:0 sc1
  buffer_store_dwordx4 v[220:223], v13, s[24:27], s41 offen offset:1024 sc1
  ds_read_b64_tr_b16 v[56:57], v30 offset:36864
  ds_read_b64_tr_b16 v[58:59], v30 offset:37888
  s_waitcnt lgkmcnt(12)
  v_mfma_f32_32x32x16_bf16 v[224:239], v[64:67], v[160:163], v[224:239]
  ds_read_b64_tr_b16 v[60:61], v30 offset:38912
  ds_read_b64_tr_b16 v[62:63], v30 offset:39936
  s_waitcnt lgkmcnt(12)
  v_mfma_f32_32x32x16_bf16 v[224:239], v[68:71], v[164:167], v[224:239]
  ds_read_b64_tr_b16 v[64:65], v30 offset:40960
  ds_read_b64_tr_b16 v[66:67], v30 offset:41984
  s_waitcnt lgkmcnt(12)
  v_mfma_f32_32x32x16_bf16 v[224:239], v[72:75], v[168:171], v[224:239]
  ds_read_b64_tr_b16 v[68:69], v30 offset:43008
  ds_read_b64_tr_b16 v[70:71], v30 offset:44032
  s_waitcnt lgkmcnt(12)
  v_mfma_f32_32x32x16_bf16 v[224:239], v[76:79], v[172:175], v[224:239]
  ds_read_b64_tr_b16 v[72:73], v30 offset:45056
  ds_read_b64_tr_b16 v[74:75], v30 offset:46080
  s_waitcnt lgkmcnt(12)
  v_mfma_f32_32x32x16_bf16 v[224:239], v[48:51], v[176:179], v[224:239]
  ds_read_b64_tr_b16 v[76:77], v30 offset:47104
  ds_read_b64_tr_b16 v[78:79], v30 offset:48128
  s_waitcnt lgkmcnt(12)
  v_mfma_f32_32x32x16_bf16 v[224:239], v[52:55], v[180:183], v[224:239]
  s_waitcnt lgkmcnt(10)
  v_mfma_f32_32x32x16_bf16 v[224:239], v[56:59], v[184:187], v[224:239]
  s_waitcnt vmcnt(9) lgkmcnt(0)
  s_barrier
  s_cmp_lg_u32 s3, 7
  s_cbranch_scc1 k1_pub3
  v_mov_b32 v47, 1
  s_mov_b64 exec, 1
  buffer_store_dword v47, off, s[24:27], s69 sc1
  s_mov_b64 exec, -1
k1_pub3:
  ds_read_b64_tr_b16 v[48:49], v26 offset:32768
  ds_read_b64_tr_b16 v[50:51], v26 offset:33792
  ds_read_b64_tr_b16 v[52:53], v26 offset:34816
  ds_read_b64_tr_b16 v[54:55], v26 offset:35840
  v_mfma_f32_32x32x16_bf16 v[224:239], v[60:63], v[188:191], v[224:239]
  s_add_u32 m0, s34, 98304
  s_mov_b32 s40, 896
  buffer_load_dwordx4 v12, s[44:47], s40 offen lds
  ds_read_b64_tr_b16 v[56:57], v26 offset:36864
  ds_read_b64_tr_b16 v[58:59], v26 offset:37888
  v_mfma_f32_32x32x16_bf16 v[224:239], v[64:67], v[192:195], v[224:239]
  s_add_u32 m0, s34, 106496
  s_mov_b32 s40, 74624
  buffer_load_dwordx4 v12, s[44:47], s40 offen lds
  ds_read_b64_tr_b16 v[60:61], v26 offset:38912
  ds_read_b64_tr_b16 v[62:63], v26 offset:39936
  v_mfma_f32_32x32x16_bf16 v[224:239], v[68:71], v[196:199], v[224:239]
  s_add_u32 m0, s34, 114688
  s_mov_b32 s40, 148352
  buffer_load_dwordx4 v12, s[44:47], s40 offen lds
  ds_read_b64_tr_b16 v[64:65], v26 offset:40960
  ds_read_b64_tr_b16 v[66:67], v26 offset:41984
  v_mfma_f32_32x32x16_bf16 v[224:239], v[72:75], v[200:203], v[224:239]
  s_add_u32 m0, s34, 122880
  s_mov_b32 s40, 222080
  buffer_load_dwordx4 v12, s[44:47], s40 offen lds
  ds_read_b64_tr_b16 v[68:69], v26 offset:43008
  ds_read_b64_tr_b16 v[70:71], v26 offset:44032
  v_mfma_f32_32x32x16_bf16 v[224:239], v[76:79], v[204:207], v[224:239]
  ds_read_b64_tr_b16 v[72:73], v26 offset:45056
  ds_read_b64_tr_b16 v[74:75], v26 offset:46080
  s_waitcnt lgkmcnt(12)
  v_mfma_f32_32x32x16_bf16 v[240:255], v[48:51], v[144:147], 0
  ds_read_b64_tr_b16 v[76:77], v26 offset:47104
  ds_read_b64_tr_b16 v[78:79], v26 offset:48128
  s_waitcnt lgkmcnt(12)
  v_mfma_f32_32x32x16_bf16 v[240:255], v[52:55], v[148:151], v[240:255]
  ds_read_b64_tr_b16 v[48:49], v29 offset:32768
  ds_read_b64_tr_b16 v[50:51], v29 offset:33792
  s_waitcnt lgkmcnt(12)
  v_mfma_f32_32x32x16_bf16 v[240:255], v[56:59], v[152:155], v[240:255]
  v_cvt_pk_bf16_f32 v208, v224, v225
  v_cvt_pk_bf16_f32 v209, v226, v227
  v_cvt_pk_bf16_f32 v210, v228, v229
  v_cvt_pk_bf16_f32 v211, v230, v231
  v_cvt_pk_bf16_f32 v212, v232, v233
  v_cvt_pk_bf16_f32 v213, v234, v235
  ds_read_b64_tr_b16 v[52:53], v29 offset:34816
  ds_read_b64_tr_b16 v[54:55], v29 offset:35840
  s_waitcnt lgkmcnt(12)
  v_mfma_f32_32x32x16_bf16 v[240:255], v[60:63], v[156:159], v[240:255]
  v_cvt_pk_bf16_f32 v214, v236, v237
  v_cvt_pk_bf16_f32 v215, v238, v239
  s_mov_b32 s41, 8192
  buffer_store_dwordx4 v[208:211], v13, s[24:27], s41 offen offset:0 sc1
  buffer_store_dwordx4 v[212:215], v13, s[24:27], s41 offen offset:1024 sc1
  ds_read_b64_tr_b16 v[56:57], v29 offset:36864
  ds_read_b64_tr_b16 v[58:59], v29 offset:37888
  s_waitcnt lgkmcnt(12)
  v_mfma_f32_32x32x16_bf16 v[240:255], v[64:67], v[160:163], v[240:255]
  ds_read_b64_tr_b16 v[60:61], v29 offset:38912
  ds_read_b64_tr_b16 v[62:63], v29 offset:39936
  s_waitcnt lgkmcnt(12)
  v_mfma_f32_32x32x16_bf16 v[240:255], v[68:71], v[164:167], v[240:255]
  ds_read_b64_tr_b16 v[64:65], v29 offset:40960
  ds_read_b64_tr_b16 v[66:67], v29 offset:41984
  s_waitcnt lgkmcnt(12)
  v_mfma_f32_32x32x16_bf16 v[240:255], v[72:75], v[168:171], v[240:255]
  ds_read_b64_tr_b16 v[68:69], v29 offset:43008
  ds_read_b64_tr_b16 v[70:71], v29 offset:44032
  s_waitcnt lgkmcnt(12)
  v_mfma_f32_32x32x16_bf16 v[240:255], v[76:79], v[172:175], v[240:255]
  ds_read_b64_tr_b16 v[72:73], v29 offset:45056
  ds_read_b64_tr_b16 v[74:75], v29 offset:46080
  s_waitcnt lgkmcnt(12)
  v_mfma_f32_32x32x16_bf16 v[240:255], v[48:51], v[176:179], v[240:255]
  ds_read_b64_tr_b16 v[76:77], v29 offset:47104
  ds_read_b64_tr_b16 v[78:79], v29 offset:48128
  s_waitcnt lgkmcnt(12)
  v_mfma_f32_32x32x16_bf16 v[240:255], v[52:55], v[180:183], v[240:255]
  s_waitcnt lgkmcnt(10)
  v_mfma_f32_32x32x16_bf16 v[240:255], v[56:59], v[184:187], v[240:255]
  s_waitcnt vmcnt(6) lgkmcnt(0)
  s_barrier
  s_cmp_lg_u32 s3, 7
  s_cbranch_scc1 k1_pub4
  v_mov_b32 v47, 2
  s_mov_b64 exec, 1
  buffer_store_dword v47, off, s[24:27], s69 sc1
  s_mov_b64 exec, -1
k1_pub4:
  ds_read_b64_tr_b16 v[48:49], v27 offset:0
  ds_read_b64_tr_b16 v[50:51], v27 offset:1024
  ds_read_b64_tr_b16 v[52:53], v27 offset:2048
  ds_read_b64_tr_b16 v[54:55], v27 offset:3072
  v_mfma_f32_32x32x16_bf16 v[240:255], v[60:63], v[188:191], v[240:255]
  s_add_u32 m0, s34, 32768
  s_mov_b32 s40, 1024
  buffer_load_dwordx4 v12, s[44:47], s40 offen lds
  ds_read_b64_tr_b16 v[56:57], v27 offset:4096
  ds_read_b64_tr_b16 v[58:59], v27 offset:5120
  v_mfma_f32_32x32x16_bf16 v[240:255], v[64:67], v[192:195], v[240:255]
  s_add_u32 m0, s34, 40960
  s_mov_b32 s40, 74752
  buffer_load_dwordx4 v12, s[44:47], s40 offen lds
  ds_read_b64_tr_b16 v[60:61], v27 offset:6144
  ds_read_b64_tr_b16 v[62:63], v27 offset:7168
  v_mfma_f32_32x32x16_bf16 v[240:255], v[68:71], v[196:199], v[240:255]
  s_add_u32 m0, s34, 49152
  s_mov_b32 s40, 148480
  buffer_load_dwordx4 v12, s[44:47], s40 offen lds
  ds_read_b64_tr_b16 v[64:65], v27 offset:8192
  ds_read_b64_tr_b16 v[66:67], v27 offset:9216
  v_mfma_f32_32x32x16_bf16 v[240:255], v[72:75], v[200:203], v[240:255]
  s_add_u32 m0, s34, 57344
  s_mov_b32 s40, 222208
  buffer_load_dwordx4 v12, s[44:47], s40 offen lds
  ds_read_b64_tr_b16 v[68:69], v27 offset:10240
  ds_read_b64_tr_b16 v[70:71], v27 offset:11264
  v_mfma_f32_32x32x16_bf16 v[240:255], v[76:79], v[204:207], v[240:255]
  ds_read_b64_tr_b16 v[72:73], v27 offset:12288
  ds_read_b64_tr_b16 v[74:75], v27 offset:13312
  s_waitcnt lgkmcnt(12)
  v_mfma_f32_32x32x16_bf16 v[224:239], v[48:51], v[144:147], 0
  ds_read_b64_tr_b16 v[76:77], v27 offset:14336
  ds_read_b64_tr_b16 v[78:79], v27 offset:15360
  s_waitcnt lgkmcnt(12)
  v_mfma_f32_32x32x16_bf16 v[224:239], v[52:55], v[148:151], v[224:239]
  ds_read_b64_tr_b16 v[48:49], v30 offset:0
  ds_read_b64_tr_b16 v[50:51], v30 offset:1024
  s_waitcnt lgkmcnt(12)
  v_mfma_f32_32x32x16_bf16 v[224:239], v[56:59], v[152:155], v[224:239]
  v_cvt_pk_bf16_f32 v216, v240, v241
  v_cvt_pk_bf16_f32 v217, v242, v243
  v_cvt_pk_bf16_f32 v218, v244, v245
  v_cvt_pk_bf16_f32 v219, v246, v247
  v_cvt_pk_bf16_f32 v220, v248, v249
  v_cvt_pk_bf16_f32 v221, v250, v251
  ds_read_b64_tr_b16 v[52:53], v30 offset:2048
  ds_read_b64_tr_b16 v[54:55], v30 offset:3072
  s_waitcnt lgkmcnt(12)
  v_mfma_f32_32x32x16_bf16 v[224:239], v[60:63], v[156:159], v[224:239]
  v_cvt_pk_bf16_f32 v222, v252, v253
  v_cvt_pk_bf16_f32 v223, v254, v255
  s_mov_b32 s41, 12288
  buffer_store_dwordx4 v[216:219], v13, s[24:27], s41 offen offset:0 sc1
  buffer_store_dwordx4 v[220:223], v13, s[24:27], s41 offen offset:1024 sc1
  ds_read_b64_tr_b16 v[56:57], v30 offset:4096
  ds_read_b64_tr_b16 v[58:59], v30 offset:5120
  s_waitcnt lgkmcnt(12)
  v_mfma_f32_32x32x16_bf16 v[224:239], v[64:67], v[160:163], v[224:239]
  ds_read_b64_tr_b16 v[60:61], v30 offset:6144
  ds_read_b64_tr_b16 v[62:63], v30 offset:7168
  s_waitcnt lgkmcnt(12)
  v_mfma_f32_32x32x16_bf16 v[224:239], v[68:71], v[164:167], v[224:239]
  ds_read_b64_tr_b16 v[64:65], v30 offset:8192
  ds_read_b64_tr_b16 v[66:67], v30 offset:9216
  s_waitcnt lgkmcnt(12)
  v_mfma_f32_32x32x16_bf16 v[224:239], v[72:75], v[168:171], v[224:239]
  ds_read_b64_tr_b16 v[68:69], v30 offset:10240
  ds_read_b64_tr_b16 v[70:71], v30 offset:11264
  s_waitcnt lgkmcnt(12)
  v_mfma_f32_32x32x16_bf16 v[224:239], v[76:79], v[172:175], v[224:239]
  ds_read_b64_tr_b16 v[72:73], v30 offset:12288
  ds_read_b64_tr_b16 v[74:75], v30 offset:13312
  s_waitcnt lgkmcnt(12)
  v_mfma_f32_32x32x16_bf16 v[224:239], v[48:51], v[176:179], v[224:239]
  ds_read_b64_tr_b16 v[76:77], v30 offset:14336
  ds_read_b64_tr_b16 v[78:79], v30 offset:15360
  s_waitcnt lgkmcnt(12)
  v_mfma_f32_32x32x16_bf16 v[224:239], v[52:55], v[180:183], v[224:239]
  s_waitcnt lgkmcnt(10)
  v_mfma_f32_32x32x16_bf16 v[224:239], v[56:59], v[184:187], v[224:239]
  s_waitcnt vmcnt(6) lgkmcnt(0)
  s_barrier
  s_cmp_lg_u32 s3, 7
  s_cbranch_scc1 k1_pub5
  v_mov_b32 v47, 3
  s_mov_b64 exec, 1
  buffer_store_dword v47, off, s[24:27], s69 sc1
  s_mov_b64 exec, -1
k1_pub5:
  ds_read_b64_tr_b16 v[48:49], v28 offset:0
  ds_read_b64_tr_b16 v[50:51], v28 offset:1024
  ds_read_b64_tr_b16 v[52:53], v28 offset:2048
  ds_read_b64_tr_b16 v[54:55], v28 offset:3072
  v_mfma_f32_32x32x16_bf16 v[224:239], v[60:63], v[188:191], v[224:239]
  ds_read_b64_tr_b16 v[56:57], v28 offset:4096
  ds_read_b64_tr_b16 v[58:59], v28 offset:5120
  v_mfma_f32_32x32x16_bf16 v[224:239], v[64:67], v[192:195], v[224:239]
  ds_read_b64_tr_b16 v[60:61], v28 offset:6144
  ds_read_b64_tr_b16 v[62:63], v28 offset:7168
  v_mfma_f32_32x32x16_bf16 v[224:239], v[68:71], v[196:199], v[224:239]
  ds_read_b64_tr_b16 v[64:65], v28 offset:8192
  ds_read_b64_tr_b16 v[66:67], v28 offset:9216
  v_mfma_f32_32x32x16_bf16 v[224:239], v[72:75], v[200:203], v[224:239]
  ds_read_b64_tr_b16 v[68:69], v28 offset:10240
  ds_read_b64_tr_b16 v[70:71], v28 offset:11264
  v_mfma_f32_32x32x16_bf16 v[224:239], v[76:79], v[204:207], v[224:239]
  ds_read_b64_tr_b16 v[72:73], v28 offset:12288
  ds_read_b64_tr_b16 v[74:75], v28 offset:13312
  s_waitcnt lgkmcnt(12)
  v_mfma_f32_32x32x16_bf16 v[240:255], v[48:51], v[144:147], 0
  ds_read_b64_tr_b16 v[76:77], v28 offset:14336
  ds_read_b64_tr_b16 v[78:79], v28 offset:15360
  s_waitcnt lgkmcnt(12)
  v_mfma_f32_32x32x16_bf16 v[240:255], v[52:55], v[148:151], v[240:255]
  ds_read_b64_tr_b16 v[48:49], v31 offset:0
  ds_read_b64_tr_b16 v[50:51], v31 offset:1024
  s_waitcnt lgkmcnt(12)
  v_mfma_f32_32x32x16_bf16 v[240:255], v[56:59], v[152:155], v[240:255]
  v_cvt_pk_bf16_f32 v208, v224, v225
  v_cvt_pk_bf16_f32 v209, v226, v227
  v_cvt_pk_bf16_f32 v210, v228, v229
  v_cvt_pk_bf16_f32 v211, v230, v231
  v_cvt_pk_bf16_f32 v212, v232, v233
  v_cvt_pk_bf16_f32 v213, v234, v235
  ds_read_b64_tr_b16 v[52:53], v31 offset:2048
  ds_read_b64_tr_b16 v[54:55], v31 offset:3072
  s_waitcnt lgkmcnt(12)
  v_mfma_f32_32x32x16_bf16 v[240:255], v[60:63], v[156:159], v[240:255]
  v_cvt_pk_bf16_f32 v214, v236, v237
  v_cvt_pk_bf16_f32 v215, v238, v239
  s_mov_b32 s41, 16384
  buffer_store_dwordx4 v[208:211], v13, s[24:27], s41 offen offset:0 sc1
  buffer_store_dwordx4 v[212:215], v13, s[24:27], s41 offen offset:1024 sc1
  ds_read_b64_tr_b16 v[56:57], v31 offset:4096
  ds_read_b64_tr_b16 v[58:59], v31 offset:5120
  s_waitcnt lgkmcnt(12)
  v_mfma_f32_32x32x16_bf16 v[240:255], v[64:67], v[160:163], v[240:255]
  ds_read_b64_tr_b16 v[60:61], v31 offset:6144
  ds_read_b64_tr_b16 v[62:63], v31 offset:7168
  s_waitcnt lgkmcnt(12)
  v_mfma_f32_32x32x16_bf16 v[240:255], v[68:71], v[164:167], v[240:255]
  ds_read_b64_tr_b16 v[64:65], v31 offset:8192
  ds_read_b64_tr_b16 v[66:67], v31 offset:9216
  s_waitcnt lgkmcnt(12)
  v_mfma_f32_32x32x16_bf16 v[240:255], v[72:75], v[168:171], v[240:255]
  ds_read_b64_tr_b16 v[68:69], v31 offset:10240
  ds_read_b64_tr_b16 v[70:71], v31 offset:11264
  s_waitcnt lgkmcnt(12)
  v_mfma_f32_32x32x16_bf16 v[240:255], v[76:79], v[172:175], v[240:255]
  ds_read_b64_tr_b16 v[72:73], v31 offset:12288
  ds_read_b64_tr_b16 v[74:75], v31 offset:13312
  s_waitcnt lgkmcnt(12)
  v_mfma_f32_32x32x16_bf16 v[240:255], v[48:51], v[176:179], v[240:255]
  ds_read_b64_tr_b16 v[76:77], v31 offset:14336
  ds_read_b64_tr_b16 v[78:79], v31 offset:15360
  s_waitcnt lgkmcnt(12)
  v_mfma_f32_32x32x16_bf16 v[240:255], v[52:55], v[180:183], v[240:255]
  s_waitcnt lgkmcnt(10)
  v_mfma_f32_32x32x16_bf16 v[240:255], v[56:59], v[184:187], v[240:255]
  s_waitcnt vmcnt(2) lgkmcnt(0)
  s_barrier
  s_cmp_lg_u32 s3, 7
  s_cbranch_scc1 k1_pub6
  v_mov_b32 v47, 4
  s_mov_b64 exec, 1
  buffer_store_dword v47, off, s[24:27], s69 sc1
  s_mov_b64 exec, -1
k1_pub6:
  ds_read_b64_tr_b16 v[48:49], v26 offset:0
  ds_read_b64_tr_b16 v[50:51], v26 offset:1024
  ds_read_b64_tr_b16 v[52:53], v26 offset:2048
  ds_read_b64_tr_b16 v[54:55], v26 offset:3072
  v_mfma_f32_32x32x16_bf16 v[240:255], v[60:63], v[188:191], v[240:255]
  ds_read_b64_tr_b16 v[56:57], v26 offset:4096
  ds_read_b64_tr_b16 v[58:59], v26 offset:5120
  v_mfma_f32_32x32x16_bf16 v[240:255], v[64:67], v[192:195], v[240:255]
  ds_read_b64_tr_b16 v[60:61], v26 offset:6144
  ds_read_b64_tr_b16 v[62:63], v26 offset:7168
  v_mfma_f32_32x32x16_bf16 v[240:255], v[68:71], v[196:199], v[240:255]
  ds_read_b64_tr_b16 v[64:65], v26 offset:8192
  ds_read_b64_tr_b16 v[66:67], v26 offset:9216
  v_mfma_f32_32x32x16_bf16 v[240:255], v[72:75], v[200:203], v[240:255]
  ds_read_b64_tr_b16 v[68:69], v26 offset:10240
  ds_read_b64_tr_b16 v[70:71], v26 offset:11264
  v_mfma_f32_32x32x16_bf16 v[240:255], v[76:79], v[204:207], v[240:255]
  ds_read_b64_tr_b16 v[72:73], v26 offset:12288
  ds_read_b64_tr_b16 v[74:75], v26 offset:13312
  s_waitcnt lgkmcnt(12)
  v_mfma_f32_32x32x16_bf16 v[224:239], v[48:51], v[144:147], 0
  ds_read_b64_tr_b16 v[76:77], v26 offset:14336
  ds_read_b64_tr_b16 v[78:79], v26 offset:15360
  s_waitcnt lgkmcnt(12)
  v_mfma_f32_32x32x16_bf16 v[224:239], v[52:55], v[148:151], v[224:239]
  ds_read_b64_tr_b16 v[48:49], v29 offset:0
  ds_read_b64_tr_b16 v[50:51], v29 offset:1024
  s_waitcnt lgkmcnt(12)
  v_mfma_f32_32x32x16_bf16 v[224:239], v[56:59], v[152:155], v[224:239]
  v_cvt_pk_bf16_f32 v216, v240, v241
  v_cvt_pk_bf16_f32 v217, v242, v243
  v_cvt_pk_bf16_f32 v218, v244, v245
  v_cvt_pk_bf16_f32 v219, v246, v247
  v_cvt_pk_bf16_f32 v220, v248, v249
  v_cvt_pk_bf16_f32 v221, v250, v251
  ds_read_b64_tr_b16 v[52:53], v29 offset:2048
  ds_read_b64_tr_b16 v[54:55], v29 offset:3072
  s_waitcnt lgkmcnt(12)
  v_mfma_f32_32x32x16_bf16 v[224:239], v[60:63], v[156:159], v[224:239]
  v_cvt_pk_bf16_f32 v222, v252, v253
  v_cvt_pk_bf16_f32 v223, v254, v255
  s_mov_b32 s41, 20480
  buffer_store_dwordx4 v[216:219], v13, s[24:27], s41 offen offset:0 sc1
  buffer_store_dwordx4 v[220:223], v13, s[24:27], s41 offen offset:1024 sc1
  ds_read_b64_tr_b16 v[56:57], v29 offset:4096
  ds_read_b64_tr_b16 v[58:59], v29 offset:5120
  s_waitcnt lgkmcnt(12)
  v_mfma_f32_32x32x16_bf16 v[224:239], v[64:67], v[160:163], v[224:239]
  ds_read_b64_tr_b16 v[60:61], v29 offset:6144
  ds_read_b64_tr_b16 v[62:63], v29 offset:7168
  s_waitcnt lgkmcnt(12)
  v_mfma_f32_32x32x16_bf16 v[224:239], v[68:71], v[164:167], v[224:239]
  ds_read_b64_tr_b16 v[64:65], v29 offset:8192
  ds_read_b64_tr_b16 v[66:67], v29 offset:9216
  s_waitcnt lgkmcnt(12)
  v_mfma_f32_32x32x16_bf16 v[224:239], v[72:75], v[168:171], v[224:239]
  ds_read_b64_tr_b16 v[68:69], v29 offset:10240
  ds_read_b64_tr_b16 v[70:71], v29 offset:11264
  s_waitcnt lgkmcnt(12)
  v_mfma_f32_32x32x16_bf16 v[224:239], v[76:79], v[172:175], v[224:239]
  ds_read_b64_tr_b16 v[72:73], v29 offset:12288
  ds_read_b64_tr_b16 v[74:75], v29 offset:13312
  s_waitcnt lgkmcnt(12)
  v_mfma_f32_32x32x16_bf16 v[224:239], v[48:51], v[176:179], v[224:239]
  ds_read_b64_tr_b16 v[76:77], v29 offset:14336
  ds_read_b64_tr_b16 v[78:79], v29 offset:15360
  s_waitcnt lgkmcnt(12)
  v_mfma_f32_32x32x16_bf16 v[224:239], v[52:55], v[180:183], v[224:239]
  s_waitcnt lgkmcnt(10)
  v_mfma_f32_32x32x16_bf16 v[224:239], v[56:59], v[184:187], v[224:239]
  s_waitcnt lgkmcnt(0)
  s_barrier
  ds_read_b64_tr_b16 v[48:49], v27 offset:32768
  ds_read_b64_tr_b16 v[50:51], v27 offset:33792
  ds_read_b64_tr_b16 v[52:53], v27 offset:34816
  ds_read_b64_tr_b16 v[54:55], v27 offset:35840
  v_mfma_f32_32x32x16_bf16 v[224:239], v[60:63], v[188:191], v[224:239]
  ds_read_b64_tr_b16 v[56:57], v27 offset:36864
  ds_read_b64_tr_b16 v[58:59], v27 offset:37888
  v_mfma_f32_32x32x16_bf16 v[224:239], v[64:67], v[192:195], v[224:239]
  ds_read_b64_tr_b16 v[60:61], v27 offset:38912
  ds_read_b64_tr_b16 v[62:63], v27 offset:39936
  v_mfma_f32_32x32x16_bf16 v[224:239], v[68:71], v[196:199], v[224:239]
  ds_read_b64_tr_b16 v[64:65], v27 offset:40960
  ds_read_b64_tr_b16 v[66:67], v27 offset:41984
  v_mfma_f32_32x32x16_bf16 v[224:239], v[72:75], v[200:203], v[224:239]
  ds_read_b64_tr_b16 v[68:69], v27 offset:43008
  ds_read_b64_tr_b16 v[70:71], v27 offset:44032
  v_mfma_f32_32x32x16_bf16 v[224:239], v[76:79], v[204:207], v[224:239]
  ds_read_b64_tr_b16 v[72:73], v27 offset:45056
  ds_read_b64_tr_b16 v[74:75], v27 offset:46080
  s_waitcnt lgkmcnt(12)
  v_mfma_f32_32x32x16_bf16 v[240:255], v[48:51], v[144:147], 0
  ds_read_b64_tr_b16 v[76:77], v27 offset:47104
  ds_read_b64_tr_b16 v[78:79], v27 offset:48128
  s_waitcnt lgkmcnt(12)
  v_mfma_f32_32x32x16_bf16 v[240:255], v[52:55], v[148:151], v[240:255]
  ds_read_b64_tr_b16 v[48:49], v30 offset:32768
  ds_read_b64_tr_b16 v[50:51], v30 offset:33792
  s_waitcnt lgkmcnt(12)
  v_mfma_f32_32x32x16_bf16 v[240:255], v[56:59], v[152:155], v[240:255]
  v_cvt_pk_bf16_f32 v208, v224, v225
  v_cvt_pk_bf16_f32 v209, v226, v227
  v_cvt_pk_bf16_f32 v210, v228, v229
  v_cvt_pk_bf16_f32 v211, v230, v231
  v_cvt_pk_bf16_f32 v212, v232, v233
  v_cvt_pk_bf16_f32 v213, v234, v235
  ds_read_b64_tr_b16 v[52:53], v30 offset:34816
  ds_read_b64_tr_b16 v[54:55], v30 offset:35840
  s_waitcnt lgkmcnt(12)
  v_mfma_f32_32x32x16_bf16 v[240:255], v[60:63], v[156:159], v[240:255]
  v_cvt_pk_bf16_f32 v214, v236, v237
  v_cvt_pk_bf16_f32 v215, v238, v239
  s_mov_b32 s41, 24576
  buffer_store_dwordx4 v[208:211], v13, s[24:27], s41 offen offset:0 sc1
  buffer_store_dwordx4 v[212:215], v13, s[24:27], s41 offen offset:1024 sc1
  ds_read_b64_tr_b16 v[56:57], v30 offset:36864
  ds_read_b64_tr_b16 v[58:59], v30 offset:37888
  s_waitcnt lgkmcnt(12)
  v_mfma_f32_32x32x16_bf16 v[240:255], v[64:67], v[160:163], v[240:255]
  ds_read_b64_tr_b16 v[60:61], v30 offset:38912
  ds_read_b64_tr_b16 v[62:63], v30 offset:39936
  s_waitcnt lgkmcnt(12)
  v_mfma_f32_32x32x16_bf16 v[240:255], v[68:71], v[164:167], v[240:255]
  ds_read_b64_tr_b16 v[64:65], v30 offset:40960
  ds_read_b64_tr_b16 v[66:67], v30 offset:41984
  s_waitcnt lgkmcnt(12)
  v_mfma_f32_32x32x16_bf16 v[240:255], v[72:75], v[168:171], v[240:255]
  ds_read_b64_tr_b16 v[68:69], v30 offset:43008
  ds_read_b64_tr_b16 v[70:71], v30 offset:44032
  s_waitcnt lgkmcnt(12)
  v_mfma_f32_32x32x16_bf16 v[240:255], v[76:79], v[172:175], v[240:255]
  ds_read_b64_tr_b16 v[72:73], v30 offset:45056
  ds_read_b64_tr_b16 v[74:75], v30 offset:46080
  s_waitcnt lgkmcnt(12)
  v_mfma_f32_32x32x16_bf16 v[240:255], v[48:51], v[176:179], v[240:255]
  ds_read_b64_tr_b16 v[76:77], v30 offset:47104
  ds_read_b64_tr_b16 v[78:79], v30 offset:48128
  s_waitcnt lgkmcnt(12)
  v_mfma_f32_32x32x16_bf16 v[240:255], v[52:55], v[180:183], v[240:255]
  s_waitcnt lgkmcnt(10)
  v_mfma_f32_32x32x16_bf16 v[240:255], v[56:59], v[184:187], v[240:255]
  s_waitcnt vmcnt(2) lgkmcnt(0)
  s_barrier
  s_cmp_lg_u32 s3, 7
  s_cbranch_scc1 k1_pub8
  v_mov_b32 v47, 6
  s_mov_b64 exec, 1
  buffer_store_dword v47, off, s[24:27], s69 sc1
  s_mov_b64 exec, -1
k1_pub8:
  ds_read_b64_tr_b16 v[48:49], v26 offset:32768
  ds_read_b64_tr_b16 v[50:51], v26 offset:33792
  ds_read_b64_tr_b16 v[52:53], v26 offset:34816
  ds_read_b64_tr_b16 v[54:55], v26 offset:35840
  v_mfma_f32_32x32x16_bf16 v[240:255], v[60:63], v[188:191], v[240:255]
  ds_read_b64_tr_b16 v[56:57], v26 offset:36864
  ds_read_b64_tr_b16 v[58:59], v26 offset:37888
  v_mfma_f32_32x32x16_bf16 v[240:255], v[64:67], v[192:195], v[240:255]
  ds_read_b64_tr_b16 v[60:61], v26 offset:38912
  ds_read_b64_tr_b16 v[62:63], v26 offset:39936
  v_mfma_f32_32x32x16_bf16 v[240:255], v[68:71], v[196:199], v[240:255]
  ds_read_b64_tr_b16 v[64:65], v26 offset:40960
  ds_read_b64_tr_b16 v[66:67], v26 offset:41984
  v_mfma_f32_32x32x16_bf16 v[240:255], v[72:75], v[200:203], v[240:255]
  ds_read_b64_tr_b16 v[68:69], v26 offset:43008
  ds_read_b64_tr_b16 v[70:71], v26 offset:44032
  v_mfma_f32_32x32x16_bf16 v[240:255], v[76:79], v[204:207], v[240:255]
  ds_read_b64_tr_b16 v[72:73], v26 offset:45056
  ds_read_b64_tr_b16 v[74:75], v26 offset:46080
  s_waitcnt lgkmcnt(12)
  v_mfma_f32_32x32x16_bf16 v[224:239], v[48:51], v[144:147], 0
  ds_read_b64_tr_b16 v[76:77], v26 offset:47104
  ds_read_b64_tr_b16 v[78:79], v26 offset:48128
  s_waitcnt lgkmcnt(12)
  v_mfma_f32_32x32x16_bf16 v[224:239], v[52:55], v[148:151], v[224:239]
  ds_read_b64_tr_b16 v[48:49], v29 offset:32768
  ds_read_b64_tr_b16 v[50:51], v29 offset:33792
  s_waitcnt lgkmcnt(12)
  v_mfma_f32_32x32x16_bf16 v[224:239], v[56:59], v[152:155], v[224:239]
  v_cvt_pk_bf16_f32 v216, v240, v241
  v_cvt_pk_bf16_f32 v217, v242, v243
  v_cvt_pk_bf16_f32 v218, v244, v245
  v_cvt_pk_bf16_f32 v219, v246, v247
  v_cvt_pk_bf16_f32 v220, v248, v249
  v_cvt_pk_bf16_f32 v221, v250, v251
  ds_read_b64_tr_b16 v[52:53], v29 offset:34816
  ds_read_b64_tr_b16 v[54:55], v29 offset:35840
  s_waitcnt lgkmcnt(12)
  v_mfma_f32_32x32x16_bf16 v[224:239], v[60:63], v[156:159], v[224:239]
  v_cvt_pk_bf16_f32 v222, v252, v253
  v_cvt_pk_bf16_f32 v223, v254, v255
  s_mov_b32 s41, 28672
  buffer_store_dwordx4 v[216:219], v13, s[24:27], s41 offen offset:0 sc1
  buffer_store_dwordx4 v[220:223], v13, s[24:27], s41 offen offset:1024 sc1
  ds_read_b64_tr_b16 v[56:57], v29 offset:36864
  ds_read_b64_tr_b16 v[58:59], v29 offset:37888
  s_waitcnt lgkmcnt(12)
  v_mfma_f32_32x32x16_bf16 v[224:239], v[64:67], v[160:163], v[224:239]
  ds_read_b64_tr_b16 v[60:61], v29 offset:38912
  ds_read_b64_tr_b16 v[62:63], v29 offset:39936
  s_waitcnt lgkmcnt(12)
  v_mfma_f32_32x32x16_bf16 v[224:239], v[68:71], v[164:167], v[224:239]
  ds_read_b64_tr_b16 v[64:65], v29 offset:40960
  ds_read_b64_tr_b16 v[66:67], v29 offset:41984
  s_waitcnt lgkmcnt(12)
  v_mfma_f32_32x32x16_bf16 v[224:239], v[72:75], v[168:171], v[224:239]
  ds_read_b64_tr_b16 v[68:69], v29 offset:43008
  ds_read_b64_tr_b16 v[70:71], v29 offset:44032
  s_waitcnt lgkmcnt(12)
  v_mfma_f32_32x32x16_bf16 v[224:239], v[76:79], v[172:175], v[224:239]
  ds_read_b64_tr_b16 v[72:73], v29 offset:45056
  ds_read_b64_tr_b16 v[74:75], v29 offset:46080
  s_waitcnt lgkmcnt(12)
  v_mfma_f32_32x32x16_bf16 v[224:239], v[48:51], v[176:179], v[224:239]
  ds_read_b64_tr_b16 v[76:77], v29 offset:47104
  ds_read_b64_tr_b16 v[78:79], v29 offset:48128
  s_waitcnt lgkmcnt(12)
  v_mfma_f32_32x32x16_bf16 v[224:239], v[52:55], v[180:183], v[224:239]
  s_waitcnt lgkmcnt(10)
  v_mfma_f32_32x32x16_bf16 v[224:239], v[56:59], v[184:187], v[224:239]
  s_waitcnt lgkmcnt(8)
  v_mfma_f32_32x32x16_bf16 v[224:239], v[60:63], v[188:191], v[224:239]
  s_waitcnt lgkmcnt(6)
  v_mfma_f32_32x32x16_bf16 v[224:239], v[64:67], v[192:195], v[224:239]
  s_waitcnt lgkmcnt(4)
  v_mfma_f32_32x32x16_bf16 v[224:239], v[68:71], v[196:199], v[224:239]
  s_waitcnt lgkmcnt(2)
  v_mfma_f32_32x32x16_bf16 v[224:239], v[72:75], v[200:203], v[224:239]
  s_waitcnt lgkmcnt(0)
  v_mfma_f32_32x32x16_bf16 v[224:239], v[76:79], v[204:207], v[224:239]
  s_nop 7
  s_nop 3
  v_cvt_pk_bf16_f32 v208, v224, v225
  v_cvt_pk_bf16_f32 v209, v226, v227
  v_cvt_pk_bf16_f32 v210, v228, v229
  v_cvt_pk_bf16_f32 v211, v230, v231
  v_cvt_pk_bf16_f32 v212, v232, v233
  v_cvt_pk_bf16_f32 v213, v234, v235
  v_cvt_pk_bf16_f32 v214, v236, v237
  v_cvt_pk_bf16_f32 v215, v238, v239
  s_mov_b32 s41, 32768
  buffer_store_dwordx4 v[208:211], v13, s[24:27], s41 offen offset:0 sc1
  buffer_store_dwordx4 v[212:215], v13, s[24:27], s41 offen offset:1024 sc1
  s_waitcnt vmcnt(0)
  s_barrier
  s_cmp_lg_u32 s3, 7
  s_cbranch_scc1 kf_main_kernel_gb1_p
  v_mov_b32 v45, 9
  s_mov_b64 exec, 1
  buffer_store_dword v45, off, s[24:27], s69 sc1
  s_mov_b64 exec, -1
kf_main_kernel_gb1_p:
  s_load_dwordx2 s[4:5], s[0:1], 48
  s_load_dwordx2 s[6:7], s[0:1], 56
  s_load_dwordx2 s[8:9], s[0:1], 64
  s_load_dwordx2 s[10:11], s[0:1], 104
  v_and_b32 v48, 7, v0
  v_lshrrev_b32 v49, 3, v0
  s_lshl_b32 s64, s31, 4
  s_add_u32 s64, s64, s30
  s_lshr_b32 s65, s64, 2
  s_lshl_b32 s64, s64, 3
  v_add_u32 v50, s64, v48
  s_movk_i32 s66, 1152
  v_mul_lo_u32 v57, v50, s66
  v_lshl_add_u32 v51, v49, 4, v57
  v_lshlrev_b32 v52, 5, v49
  v_and_b32 v50, 31, v50
  v_lshlrev_b32 v56, 5, v48
  v_add_u32 v56, 135168, v56
  s_lshl_b32 s66, s3, 2
  v_add_u32 v55, s66, v56
  v_lshrrev_b32 v53, 2, v49
  v_lshlrev_b32 v53, 11, v53
  v_and_b32 v72, 1, v49
  v_lshl_add_u32 v53, v72, 10, v53
  v_bfe_u32 v72, v49, 1, 1
  v_lshl_add_u32 v53, v72, 9, v53
  v_lshl_add_u32 v53, v50, 4, v53
  s_mul_i32 s66, s65, 36864
  s_add_u32 s66, s66, 16777216
  v_add_u32 v53, s66, v53
  s_mul_i32 s67, s3, 4714496
  s_add_u32 s67, s67, 32768
  v_lshlrev_b32 v54, 9, v49
  v_lshl_add_u32 v54, v50, 4, v54
  s_mul_i32 s66, s65, 36864
  s_add_u32 s66, s66, 8388608
  v_add_u32 v54, s66, v54
  buffer_load_dwordx4 v[72:75], v51, s[60:63], 0 offen
  v_lshl_add_u32 v58, v49, 1, v57
  buffer_load_ushort v68, v58, s[60:63], 0 offen offset:1024
  v_lshlrev_b32 v59, 2, v49
  s_movk_i32 s66, 4608
  buffer_load_dwordx4 v[164:167], v52, s[24:27], s66 offen
  buffer_load_dwordx4 v[168:171], v52, s[24:27], s66 offen offset:16
  buffer_load_dword v172, v59, s[24:27], s66 offen offset:2048
  s_movk_i32 s66, 9216
  buffer_load_dwordx4 v[144:147], v52, s[24:27], s66 offen
  buffer_load_dwordx4 v[148:151], v52, s[24:27], s66 offen offset:16
  buffer_load_dword v152, v59, s[24:27], s66 offen offset:2048
  s_movk_i32 s66, 6912
  buffer_load_dwordx4 v[154:157], v52, s[24:27], s66 offen
  buffer_load_dwordx4 v[158:161], v52, s[24:27], s66 offen offset:16
  buffer_load_dword v162, v59, s[24:27], s66 offen offset:2048
  s_add_u32 s70, s3, 1
  s_cmp_ge_u32 s3, 2
  s_cbranch_scc1 kf_main_kernel_gb1_late
  v_and_b32 v46, 15, v0
  v_lshlrev_b32 v46, 7, v46
  s_mov_b32 s71, 0x100000
kf_main_kernel_gb1e_poll:
  buffer_load_dword v47, v46, s[24:27], s68 offen sc1
  s_waitcnt vmcnt(0)
  v_cmp_gt_u32 vcc, s70, v47
  s_sub_u32 s71, s71, 1
  s_cbranch_scc1 kf_main_kernel_gb1e_out
  s_cbranch_vccnz kf_main_kernel_gb1e_poll
kf_main_kernel_gb1e_out:
  s_mov_b32 s66, 0
  buffer_load_dwordx4 v[80:83], v53, s[24:27], s66 offen sc1
  s_mov_b32 s66, 2359296
  buffer_load_dwordx4 v[84:87], v53, s[24:27], s66 offen sc1
  s_mov_b32 s66, 4718592
  buffer_load_dwordx4 v[88:91], v53, s[24:27], s66 offen sc1
  s_mov_b32 s66, 7077888
  buffer_load_dwordx4 v[92:95], v53, s[24:27], s66 offen sc1
  s_mov_b32 s66, 9437184
  buffer_load_dwordx4 v[96:99], v53, s[24:27], s66 offen sc1
  s_mov_b32 s66, 11796480
  buffer_load_dwordx4 v[100:103], v53, s[24:27], s66 offen sc1
  s_mov_b32 s66, 14155776
  buffer_load_dwordx4 v[104:107], v53, s[24:27], s66 offen sc1
  s_mov_b32 s66, 16515072
  buffer_load_dwordx4 v[108:111], v53, s[24:27], s66 offen sc1
  s_mov_b32 s66, 18874368
  buffer_load_dwordx4 v[112:115], v53, s[24:27], s66 offen sc1
  s_mov_b32 s66, 21233664
  buffer_load_dwordx4 v[116:119], v53, s[24:27], s66 offen sc1
  s_mov_b32 s66, 23592960
  buffer_load_dwordx4 v[120:123], v53, s[24:27], s66 offen sc1
  s_mov_b32 s66, 25952256
  buffer_load_dwordx4 v[124:127], v53, s[24:27], s66 offen sc1
  s_mov_b32 s66, 28311552
  buffer_load_dwordx4 v[128:131], v53, s[24:27], s66 offen sc1
  s_mov_b32 s66, 30670848
  buffer_load_dwordx4 v[132:135], v53, s[24:27], s66 offen sc1
  s_mov_b32 s66, 33030144
  buffer_load_dwordx4 v[136:139], v53, s[24:27], s66 offen sc1
  s_mov_b32 s66, 35389440
  buffer_load_dwordx4 v[140:143], v53, s[24:27], s66 offen sc1
kf_main_kernel_gb1_skip:
  s_barrier
  s_branch kf_main_kernel_gb1_join
kf_main_kernel_gb1_late:
  s_mov_b32 s70, 9
  s_cmp_lg_u32 s3, 7
  s_cbranch_scc1 kf_main_kernel_gb1_out
  v_and_b32 v46, 15, v0
  v_lshlrev_b32 v46, 7, v46
  s_mov_b32 s71, 0x100000
kf_main_kernel_gb1_poll:
  buffer_load_dword v47, v46, s[24:27], s68 offen sc1
  s_waitcnt vmcnt(0)
  v_cmp_gt_u32 vcc, s70, v47
  s_sub_u32 s71, s71, 1
  s_cbranch_scc1 kf_main_kernel_gb1_out
  s_cbranch_vccnz kf_main_kernel_gb1_poll
kf_main_kernel_gb1_out:
  s_barrier
  s_mov_b32 s66, 0
  buffer_load_dwordx4 v[80:83], v53, s[24:27], s66 offen sc1
  s_mov_b32 s66, 2359296
  buffer_load_dwordx4 v[84:87], v53, s[24:27], s66 offen sc1
  s_mov_b32 s66, 4718592
  buffer_load_dwordx4 v[88:91], v53, s[24:27], s66 offen sc1
  s_mov_b32 s66, 7077888
  buffer_load_dwordx4 v[92:95], v53, s[24:27], s66 offen sc1
  s_mov_b32 s66, 9437184
  buffer_load_dwordx4 v[96:99], v53, s[24:27], s66 offen sc1
  s_mov_b32 s66, 11796480
  buffer_load_dwordx4 v[100:103], v53, s[24:27], s66 offen sc1
  s_mov_b32 s66, 14155776
  buffer_load_dwordx4 v[104:107], v53, s[24:27], s66 offen sc1
  s_mov_b32 s66, 16515072
  buffer_load_dwordx4 v[108:111], v53, s[24:27], s66 offen sc1
  s_mov_b32 s66, 18874368
  buffer_load_dwordx4 v[112:115], v53, s[24:27], s66 offen sc1
  s_mov_b32 s66, 21233664
  buffer_load_dwordx4 v[116:119], v53, s[24:27], s66 offen sc1
  s_mov_b32 s66, 23592960
  buffer_load_dwordx4 v[120:123], v53, s[24:27], s66 offen sc1
  s_mov_b32 s66, 25952256
  buffer_load_dwordx4 v[124:127], v53, s[24:27], s66 offen sc1
  s_mov_b32 s66, 28311552
  buffer_load_dwordx4 v[128:131], v53, s[24:27], s66 offen sc1
  s_mov_b32 s66, 30670848
  buffer_load_dwordx4 v[132:135], v53, s[24:27], s66 offen sc1
  s_mov_b32 s66, 33030144
  buffer_load_dwordx4 v[136:139], v53, s[24:27], s66 offen sc1
  s_mov_b32 s66, 35389440
  buffer_load_dwordx4 v[140:143], v53, s[24:27], s66 offen sc1
kf_main_kernel_gb1_join:
  buffer_load_dwordx4 v[192:195], v53, s[24:27], s67 offen sc1
  s_add_u32 s67, s67, 2359296
  buffer_load_dwordx4 v[196:199], v53, s[24:27], s67 offen sc1
  s_waitcnt vmcnt(28)
  v_lshlrev_b32 v60, 16, v72
  v_and_b32 v61, 0xffff0000, v72
  v_lshlrev_b32 v62, 16, v73
  v_and_b32 v63, 0xffff0000, v73
  v_lshlrev_b32 v64, 16, v74
  v_and_b32 v65, 0xffff0000, v74
  v_lshlrev_b32 v66, 16, v75
  v_and_b32 v67, 0xffff0000, v75
  s_waitcnt vmcnt(27)
  v_lshlrev_b32 v68, 16, v68
  s_mov_b32 s68, 0x3f80
  s_mov_b32 s69, 0x3f800000
  s_waitcnt vmcnt(17)
  v_dot2_f32_bf16 v174, v80, s68, 0
  v_dot2_f32_bf16 v175, v80, s69, 0
  v_dot2_f32_bf16 v176, v81, s68, 0
  v_dot2_f32_bf16 v177, v81, s69, 0
  v_dot2_f32_bf16 v178, v82, s68, 0
  v_dot2_f32_bf16 v179, v82, s69, 0
  v_dot2_f32_bf16 v180, v83, s68, 0
  v_dot2_f32_bf16 v181, v83, s69, 0
  s_waitcnt vmcnt(16)
  v_dot2_f32_bf16 v174, v84, s68, v174
  v_dot2_f32_bf16 v175, v84, s69, v175
  v_dot2_f32_bf16 v176, v85, s68, v176
  v_dot2_f32_bf16 v177, v85, s69, v177
  v_dot2_f32_bf16 v178, v86, s68, v178
  v_dot2_f32_bf16 v179, v86, s69, v179
  v_dot2_f32_bf16 v180, v87, s68, v180
  v_dot2_f32_bf16 v181, v87, s69, v181
  s_waitcnt vmcnt(15)
  v_dot2_f32_bf16 v174, v88, s68, v174
  v_dot2_f32_bf16 v175, v88, s69, v175
  v_dot2_f32_bf16 v176, v89, s68, v176
  v_dot2_f32_bf16 v177, v89, s69, v177
  v_dot2_f32_bf16 v178, v90, s68, v178
  v_dot2_f32_bf16 v179, v90, s69, v179
  v_dot2_f32_bf16 v180, v91, s68, v180
  v_dot2_f32_bf16 v181, v91, s69, v181
  s_waitcnt vmcnt(14)
  v_dot2_f32_bf16 v174, v92, s68, v174
  v_dot2_f32_bf16 v175, v92, s69, v175
  v_dot2_f32_bf16 v176, v93, s68, v176
  v_dot2_f32_bf16 v177, v93, s69, v177
  v_dot2_f32_bf16 v178, v94, s68, v178
  v_dot2_f32_bf16 v179, v94, s69, v179
  v_dot2_f32_bf16 v180, v95, s68, v180
  v_dot2_f32_bf16 v181, v95, s69, v181
  s_waitcnt vmcnt(13)
  v_dot2_f32_bf16 v174, v96, s68, v174
  v_dot2_f32_bf16 v175, v96, s69, v175
  v_dot2_f32_bf16 v176, v97, s68, v176
  v_dot2_f32_bf16 v177, v97, s69, v177
  v_dot2_f32_bf16 v178, v98, s68, v178
  v_dot2_f32_bf16 v179, v98, s69, v179
  v_dot2_f32_bf16 v180, v99, s68, v180
  v_dot2_f32_bf16 v181, v99, s69, v181
  s_waitcnt vmcnt(12)
  v_dot2_f32_bf16 v174, v100, s68, v174
  v_dot2_f32_bf16 v175, v100, s69, v175
  v_dot2_f32_bf16 v176, v101, s68, v176
  v_dot2_f32_bf16 v177, v101, s69, v177
  v_dot2_f32_bf16 v178, v102, s68, v178
  v_dot2_f32_bf16 v179, v102, s69, v179
  v_dot2_f32_bf16 v180, v103, s68, v180
  v_dot2_f32_bf16 v181, v103, s69, v181
  s_waitcnt vmcnt(11)
  v_dot2_f32_bf16 v174, v104, s68, v174
  v_dot2_f32_bf16 v175, v104, s69, v175
  v_dot2_f32_bf16 v176, v105, s68, v176
  v_dot2_f32_bf16 v177, v105, s69, v177
  v_dot2_f32_bf16 v178, v106, s68, v178
  v_dot2_f32_bf16 v179, v106, s69, v179
  v_dot2_f32_bf16 v180, v107, s68, v180
  v_dot2_f32_bf16 v181, v107, s69, v181
  s_waitcnt vmcnt(10)
  v_dot2_f32_bf16 v174, v108, s68, v174
  v_dot2_f32_bf16 v175, v108, s69, v175
  v_dot2_f32_bf16 v176, v109, s68, v176
  v_dot2_f32_bf16 v177, v109, s69, v177
  v_dot2_f32_bf16 v178, v110, s68, v178
  v_dot2_f32_bf16 v179, v110, s69, v179
  v_dot2_f32_bf16 v180, v111, s68, v180
  v_dot2_f32_bf16 v181, v111, s69, v181
  s_waitcnt vmcnt(9)
  v_dot2_f32_bf16 v174, v112, s68, v174
  v_dot2_f32_bf16 v175, v112, s69, v175
  v_dot2_f32_bf16 v176, v113, s68, v176
  v_dot2_f32_bf16 v177, v113, s69, v177
  v_dot2_f32_bf16 v178, v114, s68, v178
  v_dot2_f32_bf16 v179, v114, s69, v179
  v_dot2_f32_bf16 v180, v115, s68, v180
  v_dot2_f32_bf16 v181, v115, s69, v181
  s_waitcnt vmcnt(8)
  v_dot2_f32_bf16 v174, v116, s68, v174
  v_dot2_f32_bf16 v175, v116, s69, v175
  v_dot2_f32_bf16 v176, v117, s68, v176
  v_dot2_f32_bf16 v177, v117, s69, v177
  v_dot2_f32_bf16 v178, v118, s68, v178
  v_dot2_f32_bf16 v179, v118, s69, v179
  v_dot2_f32_bf16 v180, v119, s68, v180
  v_dot2_f32_bf16 v181, v119, s69, v181
  s_waitcnt vmcnt(7)
  v_dot2_f32_bf16 v174, v120, s68, v174
  v_dot2_f32_bf16 v175, v120, s69, v175
  v_dot2_f32_bf16 v176, v121, s68, v176
  v_dot2_f32_bf16 v177, v121, s69, v177
  v_dot2_f32_bf16 v178, v122, s68, v178
  v_dot2_f32_bf16 v179, v122, s69, v179
  v_dot2_f32_bf16 v180, v123, s68, v180
  v_dot2_f32_bf16 v181, v123, s69, v181
  s_waitcnt vmcnt(6)
  v_dot2_f32_bf16 v174, v124, s68, v174
  v_dot2_f32_bf16 v175, v124, s69, v175
  v_dot2_f32_bf16 v176, v125, s68, v176
  v_dot2_f32_bf16 v177, v125, s69, v177
  v_dot2_f32_bf16 v178, v126, s68, v178
  v_dot2_f32_bf16 v179, v126, s69, v179
  v_dot2_f32_bf16 v180, v127, s68, v180
  v_dot2_f32_bf16 v181, v127, s69, v181
  s_waitcnt vmcnt(5)
  v_dot2_f32_bf16 v174, v128, s68, v174
  v_dot2_f32_bf16 v175, v128, s69, v175
  v_dot2_f32_bf16 v176, v129, s68, v176
  v_dot2_f32_bf16 v177, v129, s69, v177
  v_dot2_f32_bf16 v178, v130, s68, v178
  v_dot2_f32_bf16 v179, v130, s69, v179
  v_dot2_f32_bf16 v180, v131, s68, v180
  v_dot2_f32_bf16 v181, v131, s69, v181
  s_waitcnt vmcnt(4)
  v_dot2_f32_bf16 v174, v132, s68, v174
  v_dot2_f32_bf16 v175, v132, s69, v175
  v_dot2_f32_bf16 v176, v133, s68, v176
  v_dot2_f32_bf16 v177, v133, s69, v177
  v_dot2_f32_bf16 v178, v134, s68, v178
  v_dot2_f32_bf16 v179, v134, s69, v179
  v_dot2_f32_bf16 v180, v135, s68, v180
  v_dot2_f32_bf16 v181, v135, s69, v181
  s_waitcnt vmcnt(3)
  v_dot2_f32_bf16 v174, v136, s68, v174
  v_dot2_f32_bf16 v175, v136, s69, v175
  v_dot2_f32_bf16 v176, v137, s68, v176
  v_dot2_f32_bf16 v177, v137, s69, v177
  v_dot2_f32_bf16 v178, v138, s68, v178
  v_dot2_f32_bf16 v179, v138, s69, v179
  v_dot2_f32_bf16 v180, v139, s68, v180
  v_dot2_f32_bf16 v181, v139, s69, v181
  s_waitcnt vmcnt(2)
  v_dot2_f32_bf16 v174, v140, s68, v174
  v_dot2_f32_bf16 v175, v140, s69, v175
  v_dot2_f32_bf16 v176, v141, s68, v176
  v_dot2_f32_bf16 v177, v141, s69, v177
  v_dot2_f32_bf16 v178, v142, s68, v178
  v_dot2_f32_bf16 v179, v142, s69, v179
  v_dot2_f32_bf16 v180, v143, s68, v180
  v_dot2_f32_bf16 v181, v143, s69, v181
  s_nop 2
  s_waitcnt vmcnt(1)
  v_dot2_f32_bf16 v184, v192, s68, 0
  v_dot2_f32_bf16 v185, v192, s69, 0
  v_dot2_f32_bf16 v186, v193, s68, 0
  v_dot2_f32_bf16 v187, v193, s69, 0
  v_dot2_f32_bf16 v188, v194, s68, 0
  v_dot2_f32_bf16 v189, v194, s69, 0
  v_dot2_f32_bf16 v190, v195, s68, 0
  v_dot2_f32_bf16 v191, v195, s69, 0
  s_waitcnt vmcnt(0)
  v_dot2_f32_bf16 v184, v196, s68, v184
  v_dot2_f32_bf16 v185, v196, s69, v185
  v_dot2_f32_bf16 v186, v197, s68, v186
  v_dot2_f32_bf16 v187, v197, s69, v187
  v_dot2_f32_bf16 v188, v198, s68, v188
  v_dot2_f32_bf16 v189, v198, s69, v189
  v_dot2_f32_bf16 v190, v199, s68, v190
  v_dot2_f32_bf16 v191, v199, s69, v191
  s_nop 2
  v_lshlrev_b32 v58, 5, v0
  v_add_u32 v58, 137216, v58
  ds_write_b128 v58, v[184:187]
  ds_write_b128 v58, v[188:191] offset:16
  v_bfe_u32 v59, v0, 3, 3
  v_lshl_add_u32 v59, v59, 2, v56
  s_lshl_b32 s66, s3, 8
  v_add_u32 v59, s66, v59
  s_waitcnt lgkmcnt(0)
  s_barrier
  ds_read_b32 v184, v59 offset:2048
  ds_read_b32 v185, v59 offset:4096
  ds_read_b32 v186, v59 offset:6144
  ds_read_b32 v187, v59 offset:8192
  ds_read_b32 v188, v59 offset:10240
  ds_read_b32 v189, v59 offset:12288
  ds_read_b32 v190, v59 offset:14336
  ds_read_b32 v191, v59 offset:16384
  s_waitcnt lgkmcnt(6)
  v_add_f32 v184, v184, v185
  s_waitcnt lgkmcnt(4)
  v_add_f32 v186, v186, v187
  s_waitcnt lgkmcnt(2)
  v_add_f32 v188, v188, v189
  s_waitcnt lgkmcnt(0)
  v_add_f32 v190, v190, v191
  v_add_f32 v184, v184, v186
  v_add_f32 v188, v188, v190
  v_add_f32 v182, v184, v188
  v_cvt_pk_bf16_f32 v72, v174, v175
  v_cvt_pk_bf16_f32 v73, v176, v177
  v_cvt_pk_bf16_f32 v74, v178, v179
  v_cvt_pk_bf16_f32 v75, v180, v181
  v_cvt_pk_bf16_f32 v182, v182, v182
  v_lshlrev_b32 v174, 16, v72
  v_and_b32 v175, 0xffff0000, v72
  v_lshlrev_b32 v176, 16, v73
  v_and_b32 v177, 0xffff0000, v73
  v_lshlrev_b32 v178, 16, v74
  v_and_b32 v179, 0xffff0000, v74
  v_lshlrev_b32 v180, 16, v75
  v_and_b32 v181, 0xffff0000, v75
  v_lshlrev_b32 v182, 16, v182
  v_mul_f32 v174, v164, v174
  v_mul_f32 v175, v165, v175
  v_mul_f32 v176, v166, v176
  v_mul_f32 v177, v167, v177
  v_mul_f32 v178, v168, v178
  v_mul_f32 v179, v169, v179
  v_mul_f32 v180, v170, v180
  v_mul_f32 v181, v171, v181
  v_mul_f32 v182, v172, v182
  v_cvt_pk_bf16_f32 v72, v174, v175
  v_cvt_pk_bf16_f32 v73, v176, v177
  v_cvt_pk_bf16_f32 v74, v178, v179
  v_cvt_pk_bf16_f32 v75, v180, v181
  v_cvt_pk_bf16_f32 v182, v182, v182
  v_lshlrev_b32 v174, 16, v72
  v_and_b32 v175, 0xffff0000, v72
  v_lshlrev_b32 v176, 16, v73
  v_and_b32 v177, 0xffff0000, v73
  v_lshlrev_b32 v178, 16, v74
  v_and_b32 v179, 0xffff0000, v74
  v_lshlrev_b32 v180, 16, v75
  v_and_b32 v181, 0xffff0000, v75
  v_lshlrev_b32 v182, 16, v182
  v_add_f32 v60, v60, v174
  v_add_f32 v61, v61, v175
  v_add_f32 v62, v62, v176
  v_add_f32 v63, v63, v177
  v_add_f32 v64, v64, v178
  v_add_f32 v65, v65, v179
  v_add_f32 v66, v66, v180
  v_add_f32 v67, v67, v181
  v_add_f32 v68, v68, v182
  v_cvt_pk_bf16_f32 v26, v60, v61
  v_cvt_pk_bf16_f32 v27, v62, v63
  v_cvt_pk_bf16_f32 v28, v64, v65
  v_cvt_pk_bf16_f32 v29, v66, v67
  v_cvt_pk_bf16_f32 v68, v68, v68
  v_lshlrev_b32 v60, 16, v26
  v_and_b32 v61, 0xffff0000, v26
  v_lshlrev_b32 v62, 16, v27
  v_and_b32 v63, 0xffff0000, v27
  v_lshlrev_b32 v64, 16, v28
  v_and_b32 v65, 0xffff0000, v28
  v_lshlrev_b32 v66, 16, v29
  v_and_b32 v67, 0xffff0000, v29
  v_lshlrev_b32 v68, 16, v68
  v_mov_b32 v30, v68
  v_add_f32 v58, v60, v61
  v_add_f32 v59, v62, v63
  v_add_f32 v72, v64, v65
  v_add_f32 v73, v66, v67
  v_add_f32 v58, v58, v59
  v_add_f32 v72, v72, v73
  v_add_f32 v58, v58, v68
  v_add_f32 v58, v58, v72
  s_nop 1
  v_add_f32_dpp v58, v58, v58 row_ror:8 row_mask:0xf bank_mask:0xf
  v_mov_b32 v72, v58
  s_nop 1
  v_permlane16_swap_b32 v72, v58
  v_add_f32 v58, v58, v72
  v_mov_b32 v72, v58
  s_nop 1
  v_permlane32_swap_b32 v72, v58
  v_add_f32 v58, v58, v72
  s_mov_b64 exec, 0xff
  ds_write_b32 v55, v58 offset:0
  s_mov_b64 exec, -1
  s_waitcnt lgkmcnt(0)
  s_barrier
  ds_read_b128 v[72:75], v56 offset:0
  ds_read_b128 v[76:79], v56 offset:16
  s_waitcnt lgkmcnt(1)
  v_add_f32 v72, v72, v73
  v_add_f32 v74, v74, v75
  s_waitcnt lgkmcnt(0)
  v_add_f32 v76, v76, v77
  v_add_f32 v78, v78, v79
  v_add_f32 v72, v72, v74
  v_add_f32 v76, v76, v78
  v_add_f32 v58, v72, v76
  v_mul_f32 v58, 0x3ae38e39, v58
  v_sub_f32 v72, v60, v58
  v_sub_f32 v73, v61, v58
  v_sub_f32 v74, v62, v58
  v_sub_f32 v75, v63, v58
  v_sub_f32 v76, v64, v58
  v_sub_f32 v77, v65, v58
  v_sub_f32 v78, v66, v58
  v_sub_f32 v79, v67, v58
  v_sub_f32 v80, v68, v58
  v_mul_f32 v59, v72, v72
  v_fmac_f32 v59, v73, v73
  v_fmac_f32 v59, v74, v74
  v_fmac_f32 v59, v75, v75
  v_fmac_f32 v59, v76, v76
  v_fmac_f32 v59, v77, v77
  v_fmac_f32 v59, v78, v78
  v_fmac_f32 v59, v79, v79
  v_fmac_f32 v59, v80, v80
  s_nop 1
  v_add_f32_dpp v59, v59, v59 row_ror:8 row_mask:0xf bank_mask:0xf
  v_mov_b32 v72, v59
  s_nop 1
  v_permlane16_swap_b32 v72, v59
  v_add_f32 v59, v59, v72
  v_mov_b32 v72, v59
  s_nop 1
  v_permlane32_swap_b32 v72, v59
  v_add_f32 v59, v59, v72
  s_mov_b64 exec, 0xff
  ds_write_b32 v55, v59 offset:512
  s_mov_b64 exec, -1
  s_waitcnt lgkmcnt(0)
  s_barrier
  ds_read_b128 v[72:75], v56 offset:512
  ds_read_b128 v[76:79], v56 offset:528
  s_waitcnt lgkmcnt(1)
  v_add_f32 v72, v72, v73
  v_add_f32 v74, v74, v75
  s_waitcnt lgkmcnt(0)
  v_add_f32 v76, v76, v77
  v_add_f32 v78, v78, v79
  v_add_f32 v72, v72, v74
  v_add_f32 v76, v76, v78
  v_add_f32 v59, v72, v76
  v_mul_f32 v59, 0x3ae38e39, v59
  v_cvt_pk_bf16_f32 v72, v58, v59
  v_lshlrev_b32 v58, 16, v72
  v_and_b32 v59, 0xffff0000, v72
  v_add_f32 v59, 0x3727c5ac, v59
  v_cvt_pk_bf16_f32 v59, v59, v59
  v_lshlrev_b32 v59, 16, v59
  v_sqrt_f32 v59, v59
  s_nop 0
  v_cvt_pk_bf16_f32 v59, v59, v59
  v_lshlrev_b32 v59, 16, v59
  v_rcp_f32 v59, v59
  v_sub_f32 v60, v60, v58
  v_sub_f32 v61, v61, v58
  v_sub_f32 v62, v62, v58
  v_sub_f32 v63, v63, v58
  v_sub_f32 v64, v64, v58
  v_sub_f32 v65, v65, v58
  v_sub_f32 v66, v66, v58
  v_sub_f32 v67, v67, v58
  v_sub_f32 v68, v68, v58
  v_cvt_pk_bf16_f32 v72, v60, v61
  v_cvt_pk_bf16_f32 v73, v62, v63
  v_cvt_pk_bf16_f32 v74, v64, v65
  v_cvt_pk_bf16_f32 v75, v66, v67
  v_cvt_pk_bf16_f32 v68, v68, v68
  v_lshlrev_b32 v60, 16, v72
  v_and_b32 v61, 0xffff0000, v72
  v_lshlrev_b32 v62, 16, v73
  v_and_b32 v63, 0xffff0000, v73
  v_lshlrev_b32 v64, 16, v74
  v_and_b32 v65, 0xffff0000, v74
  v_lshlrev_b32 v66, 16, v75
  v_and_b32 v67, 0xffff0000, v75
  v_lshlrev_b32 v68, 16, v68
  v_mul_f32 v60, v60, v59
  v_mul_f32 v61, v61, v59
  v_mul_f32 v62, v62, v59
  v_mul_f32 v63, v63, v59
  v_mul_f32 v64, v64, v59
  v_mul_f32 v65, v65, v59
  v_mul_f32 v66, v66, v59
  v_mul_f32 v67, v67, v59
  v_mul_f32 v68, v68, v59
  v_cvt_pk_bf16_f32 v72, v60, v61
  v_cvt_pk_bf16_f32 v73, v62, v63
  v_cvt_pk_bf16_f32 v74, v64, v65
  v_cvt_pk_bf16_f32 v75, v66, v67
  v_cvt_pk_bf16_f32 v68, v68, v68
  v_lshlrev_b32 v60, 16, v72
  v_and_b32 v61, 0xffff0000, v72
  v_lshlrev_b32 v62, 16, v73
  v_and_b32 v63, 0xffff0000, v73
  v_lshlrev_b32 v64, 16, v74
  v_and_b32 v65, 0xffff0000, v74
  v_lshlrev_b32 v66, 16, v75
  v_and_b32 v67, 0xffff0000, v75
  v_lshlrev_b32 v68, 16, v68
  v_mul_f32 v60, v60, v144
  v_mul_f32 v61, v61, v145
  v_mul_f32 v62, v62, v146
  v_mul_f32 v63, v63, v147
  v_mul_f32 v64, v64, v148
  v_mul_f32 v65, v65, v149
  v_mul_f32 v66, v66, v150
  v_mul_f32 v67, v67, v151
  v_mul_f32 v68, v68, v152
  v_cvt_pk_bf16_f32 v72, v60, v61
  v_cvt_pk_bf16_f32 v73, v62, v63
  v_cvt_pk_bf16_f32 v74, v64, v65
  v_cvt_pk_bf16_f32 v75, v66, v67
  v_cvt_pk_bf16_f32 v68, v68, v68
  v_lshlrev_b32 v60, 16, v72
  v_and_b32 v61, 0xffff0000, v72
  v_lshlrev_b32 v62, 16, v73
  v_and_b32 v63, 0xffff0000, v73
  v_lshlrev_b32 v64, 16, v74
  v_and_b32 v65, 0xffff0000, v74
  v_lshlrev_b32 v66, 16, v75
  v_and_b32 v67, 0xffff0000, v75
  v_lshlrev_b32 v68, 16, v68
  v_add_f32 v60, v60, v154
  v_add_f32 v61, v61, v155
  v_add_f32 v62, v62, v156
  v_add_f32 v63, v63, v157
  v_add_f32 v64, v64, v158
  v_add_f32 v65, v65, v159
  v_add_f32 v66, v66, v160
  v_add_f32 v67, v67, v161
  v_add_f32 v68, v68, v162
  v_cvt_pk_bf16_f32 v72, v60, v61
  v_cvt_pk_bf16_f32 v73, v62, v63
  v_cvt_pk_bf16_f32 v74, v64, v65
  v_cvt_pk_bf16_f32 v75, v66, v67
  v_cvt_pk_bf16_f32 v76, v68, v68
  buffer_store_dwordx4 v[72:75], v54, s[24:27], 0 offen sc1
  v_bfe_u32 v58, v0, 3, 3
  v_lshlrev_b32 v59, 4, v48
  s_lshl_b32 s66, s3, 7
  s_add_u32 s66, s66, 136192
  v_add_u32 v59, s66, v59
  v_lshl_add_u32 v58, v58, 1, v59
  ds_write_b16 v58, v76
  s_waitcnt lgkmcnt(0)
  ds_read_b128 v[184:187], v59
  s_mul_i32 s66, s3, 3584
  s_sub_u32 s66, 32768, s66
  s_mov_b64 exec, 0xff
  s_waitcnt lgkmcnt(0)
  buffer_store_dwordx4 v[184:187], v54, s[24:27], s66 offen sc1
  s_mov_b64 exec, -1
  s_load_dwordx2 s[60:61], s[0:1], 88
  s_lshl_b32 s68, s31, 11
  s_add_u32 s68, s68, 3211264
  s_lshl_b32 s69, s30, 7
  s_add_u32 s69, s69, s68
  s_waitcnt vmcnt(0) lgkmcnt(0)
  s_barrier
  s_cmp_lg_u32 s3, 7
  s_cbranch_scc1 kf_main_kernel_gb2_p
  v_mov_b32 v45, 9
  s_mov_b64 exec, 1
  buffer_store_dword v45, off, s[24:27], s69 sc1
  s_mov_b64 exec, -1
kf_main_kernel_gb2_p:
  v_and_b32 v1, 63, v0
  v_lshrrev_b32 v6, 6, v0
  v_bfe_u32 v2, v0, 2, 2
  v_and_b32 v3, 3, v0
  v_bfe_u32 v4, v0, 4, 1
  v_bfe_u32 v5, v0, 5, 1
  v_readfirstlane_b32 s3, v6
  s_and_b32 s30, s2, 7
  s_lshl_b32 s30, s30, 1
  s_bfe_u32 s31, s2, 0x10003
  s_add_u32 s30, s30, s31
  s_lshr_b32 s31, s2, 4
  s_and_b32 s32, s3, 3
  s_lshr_b32 s33, s3, 2
  s_lshl_b32 s34, s3, 10
  s_movk_i32 s40, 1821
  s_movk_i32 s41, 9216
  s_mul_i32 s42, s30, 576
  v_add_u32 v6, 0, v0
  v_mul_lo_u32 v7, v6, s40
  v_lshrrev_b32 v7, 16, v7
  v_mul_u32_u24 v25, 36, v7
  v_sub_u32 v6, v6, v25
  v_mul_lo_u32 v7, v7, s41
  v_lshl_add_u32 v7, v6, 4, v7
  v_add_u32 v19, s42, v7
  v_add_u32 v6, 512, v0
  v_mul_lo_u32 v7, v6, s40
  v_lshrrev_b32 v7, 16, v7
  v_mul_u32_u24 v25, 36, v7
  v_sub_u32 v6, v6, v25
  v_mul_lo_u32 v7, v7, s41
  v_lshl_add_u32 v7, v6, 4, v7
  v_add_u32 v20, s42, v7
  v_and_b32 v6, 127, v0
  v_add_u32 v6, 1024, v6
  v_mul_lo_u32 v7, v6, s40
  v_lshrrev_b32 v7, 16, v7
  v_mul_u32_u24 v25, 36, v7
  v_sub_u32 v6, v6, v25
  v_mul_lo_u32 v7, v7, s41
  v_lshl_add_u32 v7, v6, 4, v7
  v_add_u32 v21, s42, v7
  s_lshr_b32 s40, s3, 1
  s_lshl_b32 s41, s31, 2
  s_add_u32 s40, s40, s41
  s_mul_i32 s40, s40, 36
  s_and_b32 s41, s3, 1
  s_add_u32 s40, s40, s41
  s_lshl_b32 s40, s40, 10
  s_add_u32 s40, s40, 8388608
  v_lshlrev_b32 v6, 4, v1
  v_add_u32 v22, s40, v6
  s_mul_i32 s43, s30, 288
  v_lshrrev_b32 v7, 3, v0
  v_add_u32 v7, s43, v7
  s_movk_i32 s40, 1152
  v_mul_lo_u32 v23, v7, s40
  v_bfe_u32 v7, v0, 2, 1
  v_xor_b32 v7, v7, v4
  v_lshl_add_u32 v23, v7, 6, v23
  v_lshl_add_u32 v23, v3, 4, v23
  s_lshl_b32 s40, s30, 6
  s_lshl_b32 s41, s31, 2
  s_add_u32 s40, s40, s41
  s_add_u32 s40, s40, s32
  s_mul_i32 s40, s40, 18
  s_add_u32 s40, s40, s33
  s_lshl_b32 s40, s40, 11
  s_add_u32 s40, s40, 67108864
  v_add_u32 v24, s40, v6
  s_mul_i32 s40, s32, 18432
  s_add_u32 s40, s40, 90112
  v_add_u32 v18, s40, v6
  s_lshl_b32 s40, s32, 11
  s_add_u32 s40, s40, 36864
  v_add_u32 v11, s40, v6
  v_add_u32 v12, 45056, v11
  v_add_u32 v13, 90112, v11
  v_lshl_add_u32 v7, v5, 3, v2
  v_mul_u32_u24 v7, 576, v7
  v_lshl_add_u32 v7, v4, 5, v7
  v_lshl_add_u32 v8, v3, 3, v7
  v_add_u32 v9, 45056, v8
  v_add_u32 v10, 90112, v8
  v_lshl_add_u32 v14, v5, 2, v2
  v_lshlrev_b32 v14, 7, v14
  v_lshrrev_b32 v7, 1, v2
  v_xor_b32 v7, s33, v7
  v_lshl_add_u32 v14, v7, 6, v14
  v_and_b32 v7, 1, v3
  v_lshl_add_u32 v14, v7, 5, v14
  v_lshrrev_b32 v7, 1, v3
  v_lshl_add_u32 v14, v7, 3, v14
  v_lshl_add_u32 v14, v4, 4, v14
  v_add_u32 v15, 36864, v14
  v_add_u32 v16, 90112, v14
  v_add_u32 v17, 126976, v14
  s_mov_b32 s12, s4
  s_mov_b32 s13, s5
  s_mov_b32 s14, 0x510000
  s_mov_b32 s15, 0x00020000
  s_mov_b32 s16, s6
  s_mov_b32 s17, s7
  s_mov_b32 s18, 0x510000
  s_mov_b32 s19, 0x00020000
  s_mov_b32 s20, s8
  s_mov_b32 s21, s9
  s_mov_b32 s22, 0x510000
  s_mov_b32 s23, 0x00020000
  s_mov_b32 s24, s10
  s_mov_b32 s25, s11
  s_mov_b32 s26, 0x10000000
  s_mov_b32 s27, 0x00020000
  s_cmp_ge_u32 s3, 6
  s_cselect_b32 s44, s6, s4
  s_cselect_b32 s45, s7, s5
  s_mov_b32 s46, 5308416
  s_mov_b32 s47, 0x00020000
  s_cselect_b32 s35, 18432, 0
  s_and_b32 s40, s3, 1
  s_lshl_b32 s40, s40, 10
  s_add_u32 s35, s35, s40
  s_cmp_eq_u32 s33, 0
  s_cbranch_scc1 k3_skipB
  s_add_u32 m0, s35, 16384
  s_mov_b32 s40, 0
  buffer_load_dwordx4 v21, s[44:47], s40 offen lds
  s_add_u32 m0, s35, 61440
  s_mov_b32 s40, 294912
  buffer_load_dwordx4 v21, s[44:47], s40 offen lds
  s_add_u32 m0, s35, 106496
  s_mov_b32 s40, 589824
  buffer_load_dwordx4 v21, s[44:47], s40 offen lds
k3_skipB:
  s_add_u32 m0, s34, 0
  s_mov_b32 s40, 0
  buffer_load_dwordx4 v19, s[12:15], s40 offen lds
  s_add_u32 m0, s34, 18432
  s_mov_b32 s40, 0
  buffer_load_dwordx4 v19, s[16:19], s40 offen lds
  s_add_u32 m0, s34, 8192
  s_mov_b32 s40, 0
  buffer_load_dwordx4 v20, s[12:15], s40 offen lds
  s_add_u32 m0, s34, 26624
  s_mov_b32 s40, 0
  buffer_load_dwordx4 v20, s[16:19], s40 offen lds
  s_add_u32 m0, s34, 45056
  s_mov_b32 s40, 294912
  buffer_load_dwordx4 v19, s[12:15], s40 offen lds
  s_add_u32 m0, s34, 63488
  s_mov_b32 s40, 294912
  buffer_load_dwordx4 v19, s[16:19], s40 offen lds
  s_add_u32 m0, s34, 53248
  s_mov_b32 s40, 294912
  buffer_load_dwordx4 v20, s[12:15], s40 offen lds
  s_add_u32 m0, s34, 71680
  s_mov_b32 s40, 294912
  buffer_load_dwordx4 v20, s[16:19], s40 offen lds
  s_add_u32 m0, s34, 90112
  s_mov_b32 s40, 589824
  buffer_load_dwordx4 v19, s[12:15], s40 offen lds
  s_add_u32 m0, s34, 108544
  s_mov_b32 s40, 589824
  buffer_load_dwordx4 v19, s[16:19], s40 offen lds
  s_add_u32 m0, s34, 98304
  s_mov_b32 s40, 589824
  buffer_load_dwordx4 v20, s[12:15], s40 offen lds
  s_add_u32 m0, s34, 116736
  s_mov_b32 s40, 589824
  buffer_load_dwordx4 v20, s[16:19], s40 offen lds
  v_lshrrev_b32 v6, 2, v49
  v_lshlrev_b32 v6, 11, v6
  v_and_b32 v7, 1, v49
  v_lshl_add_u32 v6, v7, 10, v6
  v_bfe_u32 v7, v49, 1, 1
  v_lshl_add_u32 v6, v7, 9, v6
  v_lshl_add_u32 v6, v50, 4, v6
  s_mul_i32 s66, s65, 36864
  s_add_u32 s66, s66, 67108864
  v_add_u32 v6, s66, v6
  v_and_b32 v7, 15, v0
  v_lshlrev_b32 v7, 7, v7
  s_mov_b32 s70, 9
  s_cmp_lg_u32 s3, 7
  s_cbranch_scc1 kf_main_kernel_gb2_out
  v_and_b32 v46, 15, v0
  v_lshlrev_b32 v46, 7, v46
  s_mov_b32 s71, 0x100000
kf_main_kernel_gb2_poll:
  buffer_load_dword v47, v46, s[24:27], s68 offen sc1
  s_waitcnt vmcnt(0)
  v_cmp_gt_u32 vcc, s70, v47
  s_sub_u32 s71, s71, 1
  s_cbranch_scc1 kf_main_kernel_gb2_out
  s_cbranch_vccnz kf_main_kernel_gb2_poll
kf_main_kernel_gb2_out:
  s_barrier
  s_lshl_b32 s68, s31, 11
  s_add_u32 s68, s68, 3244032
  s_lshl_b32 s69, s30, 7
  s_add_u32 s69, s69, s68
  s_waitcnt vmcnt(0)
  s_cmp_eq_u32 s33, 1
  s_cbranch_scc1 k3_pathB
  s_add_u32 m0, s34, 36864
  s_mov_b32 s40, 0
  buffer_load_dwordx4 v22, s[24:27], s40 offen sc1 lds
  s_add_u32 m0, s34, 81920
  s_mov_b32 s40, 2048
  buffer_load_dwordx4 v22, s[24:27], s40 offen sc1 lds
  s_add_u32 m0, s34, 126976
  s_mov_b32 s40, 4096
  buffer_load_dwordx4 v22, s[24:27], s40 offen sc1 lds
  s_waitcnt vmcnt(2)
  s_barrier
  ds_read_b128 v[32:35], v11 offset:0
  ds_read_b64_tr_b16 v[48:49], v8 offset:0
  ds_read_b64_tr_b16 v[50:51], v8 offset:2304
  ds_read_b64_tr_b16 v[52:53], v8 offset:18432
  ds_read_b64_tr_b16 v[54:55], v8 offset:20736
  ds_read_b64_tr_b16 v[56:57], v8 offset:64
  ds_read_b64_tr_b16 v[58:59], v8 offset:2368
  s_waitcnt lgkmcnt(4)
  v_mfma_f32_32x32x16_bf16 v[80:95], v[48:51], v[32:35], 0
  ds_read_b64_tr_b16 v[60:61], v8 offset:18496
  ds_read_b64_tr_b16 v[62:63], v8 offset:20800
  ds_read_b64_tr_b16 v[64:65], v8 offset:128
  ds_read_b64_tr_b16 v[66:67], v8 offset:2432
  s_waitcnt lgkmcnt(6)
  v_mfma_f32_32x32x16_bf16 v[96:111], v[52:55], v[32:35], 0
  ds_read_b64_tr_b16 v[68:69], v8 offset:18560
  ds_read_b64_tr_b16 v[70:71], v8 offset:20864
  ds_read_b64_tr_b16 v[72:73], v8 offset:192
  ds_read_b64_tr_b16 v[74:75], v8 offset:2496
  s_waitcnt lgkmcnt(8)
  v_mfma_f32_32x32x16_bf16 v[112:127], v[56:59], v[32:35], 0
  ds_read_b64_tr_b16 v[76:77], v8 offset:18624
  ds_read_b64_tr_b16 v[78:79], v8 offset:20928
  ds_read_b64_tr_b16 v[48:49], v8 offset:256
  ds_read_b64_tr_b16 v[50:51], v8 offset:2560
  s_waitcnt lgkmcnt(10)
  v_mfma_f32_32x32x16_bf16 v[128:143], v[60:63], v[32:35], 0
  ds_read_b64_tr_b16 v[52:53], v8 offset:18688
  ds_read_b64_tr_b16 v[54:55], v8 offset:20992
  ds_read_b128 v[36:39], v11 offset:1024
  ds_read_b64_tr_b16 v[56:57], v8 offset:9216
  ds_read_b64_tr_b16 v[58:59], v8 offset:11520
  s_waitcnt lgkmcnt(13)
  v_mfma_f32_32x32x16_bf16 v[144:159], v[64:67], v[32:35], 0
  ds_read_b64_tr_b16 v[60:61], v8 offset:27648
  ds_read_b64_tr_b16 v[62:63], v8 offset:29952
  s_waitcnt lgkmcnt(13)
  v_mfma_f32_32x32x16_bf16 v[160:175], v[68:71], v[32:35], 0
  ds_read_b64_tr_b16 v[64:65], v8 offset:9280
  ds_read_b64_tr_b16 v[66:67], v8 offset:11584
  s_waitcnt lgkmcnt(13)
  v_mfma_f32_32x32x16_bf16 v[176:191], v[72:75], v[32:35], 0
  ds_read_b64_tr_b16 v[68:69], v8 offset:27712
  ds_read_b64_tr_b16 v[70:71], v8 offset:30016
  s_waitcnt lgkmcnt(13)
  v_mfma_f32_32x32x16_bf16 v[192:207], v[76:79], v[32:35], 0
  ds_read_b64_tr_b16 v[72:73], v8 offset:9344
  ds_read_b64_tr_b16 v[74:75], v8 offset:11648
  s_waitcnt lgkmcnt(13)
  v_mfma_f32_32x32x16_bf16 v[208:223], v[48:51], v[32:35], 0
  ds_read_b64_tr_b16 v[76:77], v8 offset:27776
  ds_read_b64_tr_b16 v[78:79], v8 offset:30080
  s_waitcnt lgkmcnt(13)
  v_mfma_f32_32x32x16_bf16 v[224:239], v[52:55], v[32:35], 0
  ds_read_b64_tr_b16 v[48:49], v8 offset:9408
  ds_read_b64_tr_b16 v[50:51], v8 offset:11712
  s_waitcnt lgkmcnt(12)
  v_mfma_f32_32x32x16_bf16 v[80:95], v[56:59], v[36:39], v[80:95]
  ds_read_b64_tr_b16 v[52:53], v8 offset:27840
  ds_read_b64_tr_b16 v[54:55], v8 offset:30144
  s_waitcnt lgkmcnt(12)
  v_mfma_f32_32x32x16_bf16 v[96:111], v[60:63], v[36:39], v[96:111]
  ds_read_b64_tr_b16 v[56:57], v8 offset:9472
  ds_read_b64_tr_b16 v[58:59], v8 offset:11776
  s_waitcnt lgkmcnt(12)
  v_mfma_f32_32x32x16_bf16 v[112:127], v[64:67], v[36:39], v[112:127]
  ds_read_b64_tr_b16 v[60:61], v8 offset:27904
  ds_read_b64_tr_b16 v[62:63], v8 offset:30208
  s_waitcnt lgkmcnt(12)
  v_mfma_f32_32x32x16_bf16 v[128:143], v[68:71], v[36:39], v[128:143]
  s_waitcnt lgkmcnt(10)
  v_mfma_f32_32x32x16_bf16 v[144:159], v[72:75], v[36:39], v[144:159]
  s_waitcnt vmcnt(1) lgkmcnt(0)
  s_barrier
  ds_read_b128 v[40:43], v12 offset:0
  ds_read_b64_tr_b16 v[64:65], v9 offset:0
  ds_read_b64_tr_b16 v[66:67], v9 offset:2304
  ds_read_b64_tr_b16 v[68:69], v9 offset:18432
  ds_read_b64_tr_b16 v[70:71], v9 offset:20736
  v_mfma_f32_32x32x16_bf16 v[160:175], v[76:79], v[36:39], v[160:175]
  s_add_u32 m0, s34, 0
  s_mov_b32 s40, 884736
  buffer_load_dwordx4 v19, s[12:15], s40 offen lds
  ds_read_b64_tr_b16 v[72:73], v9 offset:64
  ds_read_b64_tr_b16 v[74:75], v9 offset:2368
  v_mfma_f32_32x32x16_bf16 v[176:191], v[48:51], v[36:39], v[176:191]
  s_add_u32 m0, s34, 18432
  s_mov_b32 s40, 884736
  buffer_load_dwordx4 v19, s[16:19], s40 offen lds
  ds_read_b64_tr_b16 v[76:77], v9 offset:18496
  ds_read_b64_tr_b16 v[78:79], v9 offset:20800
  v_mfma_f32_32x32x16_bf16 v[192:207], v[52:55], v[36:39], v[192:207]
  s_add_u32 m0, s34, 8192
  s_mov_b32 s40, 884736
  buffer_load_dwordx4 v20, s[12:15], s40 offen lds
  ds_read_b64_tr_b16 v[48:49], v9 offset:128
  ds_read_b64_tr_b16 v[50:51], v9 offset:2432
  v_mfma_f32_32x32x16_bf16 v[208:223], v[56:59], v[36:39], v[208:223]
  s_add_u32 m0, s34, 26624
  s_mov_b32 s40, 884736
  buffer_load_dwordx4 v20, s[16:19], s40 offen lds
  ds_read_b64_tr_b16 v[52:53], v9 offset:18560
  ds_read_b64_tr_b16 v[54:55], v9 offset:20864
  v_mfma_f32_32x32x16_bf16 v[224:239], v[60:63], v[36:39], v[224:239]
  s_add_u32 m0, s34, 36864
  s_mov_b32 s40, 6144
  buffer_load_dwordx4 v22, s[24:27], s40 offen sc1 lds
  ds_read_b64_tr_b16 v[56:57], v9 offset:192
  ds_read_b64_tr_b16 v[58:59], v9 offset:2496
  s_waitcnt lgkmcnt(12)
  v_mfma_f32_32x32x16_bf16 v[80:95], v[64:67], v[40:43], v[80:95]
  ds_read_b64_tr_b16 v[60:61], v9 offset:18624
  ds_read_b64_tr_b16 v[62:63], v9 offset:20928
  s_waitcnt lgkmcnt(12)
  v_mfma_f32_32x32x16_bf16 v[96:111], v[68:71], v[40:43], v[96:111]
  ds_read_b64_tr_b16 v[64:65], v9 offset:256
  ds_read_b64_tr_b16 v[66:67], v9 offset:2560
  s_waitcnt lgkmcnt(12)
  v_mfma_f32_32x32x16_bf16 v[112:127], v[72:75], v[40:43], v[112:127]
  ds_read_b64_tr_b16 v[68:69], v9 offset:18688
  ds_read_b64_tr_b16 v[70:71], v9 offset:20992
  s_waitcnt lgkmcnt(12)
  v_mfma_f32_32x32x16_bf16 v[128:143], v[76:79], v[40:43], v[128:143]
  ds_read_b128 v[44:47], v12 offset:1024
  ds_read_b64_tr_b16 v[72:73], v9 offset:9216
  ds_read_b64_tr_b16 v[74:75], v9 offset:11520
  s_waitcnt lgkmcnt(13)
  v_mfma_f32_32x32x16_bf16 v[144:159], v[48:51], v[40:43], v[144:159]
  ds_read_b64_tr_b16 v[76:77], v9 offset:27648
  ds_read_b64_tr_b16 v[78:79], v9 offset:29952
  s_waitcnt lgkmcnt(13)
  v_mfma_f32_32x32x16_bf16 v[160:175], v[52:55], v[40:43], v[160:175]
  ds_read_b64_tr_b16 v[48:49], v9 offset:9280
  ds_read_b64_tr_b16 v[50:51], v9 offset:11584
  s_waitcnt lgkmcnt(13)
  v_mfma_f32_32x32x16_bf16 v[176:191], v[56:59], v[40:43], v[176:191]
  ds_read_b64_tr_b16 v[52:53], v9 offset:27712
  ds_read_b64_tr_b16 v[54:55], v9 offset:30016
  s_waitcnt lgkmcnt(13)
  v_mfma_f32_32x32x16_bf16 v[192:207], v[60:63], v[40:43], v[192:207]
  ds_read_b64_tr_b16 v[56:57], v9 offset:9344
  ds_read_b64_tr_b16 v[58:59], v9 offset:11648
  s_waitcnt lgkmcnt(13)
  v_mfma_f32_32x32x16_bf16 v[208:223], v[64:67], v[40:43], v[208:223]
  ds_read_b64_tr_b16 v[60:61], v9 offset:27776
  ds_read_b64_tr_b16 v[62:63], v9 offset:30080
  s_waitcnt lgkmcnt(13)
  v_mfma_f32_32x32x16_bf16 v[224:239], v[68:71], v[40:43], v[224:239]
  ds_read_b64_tr_b16 v[64:65], v9 offset:9408
  ds_read_b64_tr_b16 v[66:67], v9 offset:11712
  s_waitcnt lgkmcnt(12)
  v_mfma_f32_32x32x16_bf16 v[80:95], v[72:75], v[44:47], v[80:95]
  ds_read_b64_tr_b16 v[68:69], v9 offset:27840
  ds_read_b64_tr_b16 v[70:71], v9 offset:30144
  s_waitcnt lgkmcnt(12)
  v_mfma_f32_32x32x16_bf16 v[96:111], v[76:79], v[44:47], v[96:111]
  ds_read_b64_tr_b16 v[72:73], v9 offset:9472
  ds_read_b64_tr_b16 v[74:75], v9 offset:11776
  s_waitcnt lgkmcnt(12)
  v_mfma_f32_32x32x16_bf16 v[112:127], v[48:51], v[44:47], v[112:127]
  ds_read_b64_tr_b16 v[76:77], v9 offset:27904
  ds_read_b64_tr_b16 v[78:79], v9 offset:30208
  s_waitcnt lgkmcnt(12)
  v_mfma_f32_32x32x16_bf16 v[128:143], v[52:55], v[44:47], v[128:143]
  s_waitcnt lgkmcnt(10)
  v_mfma_f32_32x32x16_bf16 v[144:159], v[56:59], v[44:47], v[144:159]
  s_waitcnt vmcnt(5) lgkmcnt(0)
  s_barrier
  ds_read_b128 v[32:35], v13 offset:0
  ds_read_b64_tr_b16 v[48:49], v10 offset:0
  ds_read_b64_tr_b16 v[50:51], v10 offset:2304
  ds_read_b64_tr_b16 v[52:53], v10 offset:18432
  ds_read_b64_tr_b16 v[54:55], v10 offset:20736
  v_mfma_f32_32x32x16_bf16 v[160:175], v[60:63], v[44:47], v[160:175]
  s_add_u32 m0, s34, 45056
  s_mov_b32 s40, 1179648
  buffer_load_dwordx4 v19, s[12:15], s40 offen lds
  ds_read_b64_tr_b16 v[56:57], v10 offset:64
  ds_read_b64_tr_b16 v[58:59], v10 offset:2368
  v_mfma_f32_32x32x16_bf16 v[176:191], v[64:67], v[44:47], v[176:191]
  s_add_u32 m0, s34, 63488
  s_mov_b32 s40, 1179648
  buffer_load_dwordx4 v19, s[16:19], s40 offen lds
  ds_read_b64_tr_b16 v[60:61], v10 offset:18496
  ds_read_b64_tr_b16 v[62:63], v10 offset:20800
  v_mfma_f32_32x32x16_bf16 v[192:207], v[68:71], v[44:47], v[192:207]
  s_add_u32 m0, s34, 53248
  s_mov_b32 s40, 1179648
  buffer_load_dwordx4 v20, s[12:15], s40 offen lds
  ds_read_b64_tr_b16 v[64:65], v10 offset:128
  ds_read_b64_tr_b16 v[66:67], v10 offset:2432
  v_mfma_f32_32x32x16_bf16 v[208:223], v[72:75], v[44:47], v[208:223]
  s_add_u32 m0, s34, 71680
  s_mov_b32 s40, 1179648
  buffer_load_dwordx4 v20, s[16:19], s40 offen lds
  ds_read_b64_tr_b16 v[68:69], v10 offset:18560
  ds_read_b64_tr_b16 v[70:71], v10 offset:20864
  v_mfma_f32_32x32x16_bf16 v[224:239], v[76:79], v[44:47], v[224:239]
  s_add_u32 m0, s34, 81920
  s_mov_b32 s40, 8192
  buffer_load_dwordx4 v22, s[24:27], s40 offen sc1 lds
  ds_read_b64_tr_b16 v[72:73], v10 offset:192
  ds_read_b64_tr_b16 v[74:75], v10 offset:2496
  s_waitcnt lgkmcnt(12)
  v_mfma_f32_32x32x16_bf16 v[80:95], v[48:51], v[32:35], v[80:95]
  ds_read_b64_tr_b16 v[76:77], v10 offset:18624
  ds_read_b64_tr_b16 v[78:79], v10 offset:20928
  s_waitcnt lgkmcnt(12)
  v_mfma_f32_32x32x16_bf16 v[96:111], v[52:55], v[32:35], v[96:111]
  ds_read_b64_tr_b16 v[48:49], v10 offset:256
  ds_read_b64_tr_b16 v[50:51], v10 offset:2560
  s_waitcnt lgkmcnt(12)
  v_mfma_f32_32x32x16_bf16 v[112:127], v[56:59], v[32:35], v[112:127]
  ds_read_b64_tr_b16 v[52:53], v10 offset:18688
  ds_read_b64_tr_b16 v[54:55], v10 offset:20992
  s_waitcnt lgkmcnt(12)
  v_mfma_f32_32x32x16_bf16 v[128:143], v[60:63], v[32:35], v[128:143]
  ds_read_b128 v[36:39], v13 offset:1024
  ds_read_b64_tr_b16 v[56:57], v10 offset:9216
  ds_read_b64_tr_b16 v[58:59], v10 offset:11520
  s_waitcnt lgkmcnt(13)
  v_mfma_f32_32x32x16_bf16 v[144:159], v[64:67], v[32:35], v[144:159]
  ds_read_b64_tr_b16 v[60:61], v10 offset:27648
  ds_read_b64_tr_b16 v[62:63], v10 offset:29952
  s_waitcnt lgkmcnt(13)
  v_mfma_f32_32x32x16_bf16 v[160:175], v[68:71], v[32:35], v[160:175]
  ds_read_b64_tr_b16 v[64:65], v10 offset:9280
  ds_read_b64_tr_b16 v[66:67], v10 offset:11584
  s_waitcnt lgkmcnt(13)
  v_mfma_f32_32x32x16_bf16 v[176:191], v[72:75], v[32:35], v[176:191]
  ds_read_b64_tr_b16 v[68:69], v10 offset:27712
  ds_read_b64_tr_b16 v[70:71], v10 offset:30016
  s_waitcnt lgkmcnt(13)
  v_mfma_f32_32x32x16_bf16 v[192:207], v[76:79], v[32:35], v[192:207]
  ds_read_b64_tr_b16 v[72:73], v10 offset:9344
  ds_read_b64_tr_b16 v[74:75], v10 offset:11648
  s_waitcnt lgkmcnt(13)
  v_mfma_f32_32x32x16_bf16 v[208:223], v[48:51], v[32:35], v[208:223]
  ds_read_b64_tr_b16 v[76:77], v10 offset:27776
  ds_read_b64_tr_b16 v[78:79], v10 offset:30080
  s_waitcnt lgkmcnt(13)
  v_mfma_f32_32x32x16_bf16 v[224:239], v[52:55], v[32:35], v[224:239]
  ds_read_b64_tr_b16 v[48:49], v10 offset:9408
  ds_read_b64_tr_b16 v[50:51], v10 offset:11712
  s_waitcnt lgkmcnt(12)
  v_mfma_f32_32x32x16_bf16 v[80:95], v[56:59], v[36:39], v[80:95]
  ds_read_b64_tr_b16 v[52:53], v10 offset:27840
  ds_read_b64_tr_b16 v[54:55], v10 offset:30144
  s_waitcnt lgkmcnt(12)
  v_mfma_f32_32x32x16_bf16 v[96:111], v[60:63], v[36:39], v[96:111]
  ds_read_b64_tr_b16 v[56:57], v10 offset:9472
  ds_read_b64_tr_b16 v[58:59], v10 offset:11776
  s_waitcnt lgkmcnt(12)
  v_mfma_f32_32x32x16_bf16 v[112:127], v[64:67], v[36:39], v[112:127]
  ds_read_b64_tr_b16 v[60:61], v10 offset:27904
  ds_read_b64_tr_b16 v[62:63], v10 offset:30208
  s_waitcnt lgkmcnt(12)
  v_mfma_f32_32x32x16_bf16 v[128:143], v[68:71], v[36:39], v[128:143]
  s_waitcnt lgkmcnt(10)
  v_mfma_f32_32x32x16_bf16 v[144:159], v[72:75], v[36:39], v[144:159]
  s_waitcnt vmcnt(5) lgkmcnt(0)
  s_barrier
  ds_read_b128 v[40:43], v11 offset:0
  ds_read_b64_tr_b16 v[64:65], v8 offset:0
  ds_read_b64_tr_b16 v[66:67], v8 offset:2304
  ds_read_b64_tr_b16 v[68:69], v8 offset:18432
  ds_read_b64_tr_b16 v[70:71], v8 offset:20736
  v_mfma_f32_32x32x16_bf16 v[160:175], v[76:79], v[36:39], v[160:175]
  s_add_u32 m0, s34, 90112
  s_mov_b32 s40, 1474560
  buffer_load_dwordx4 v19, s[12:15], s40 offen lds
  ds_read_b64_tr_b16 v[72:73], v8 offset:64
  ds_read_b64_tr_b16 v[74:75], v8 offset:2368
  v_mfma_f32_32x32x16_bf16 v[176:191], v[48:51], v[36:39], v[176:191]
  s_add_u32 m0, s34, 108544
  s_mov_b32 s40, 1474560
  buffer_load_dwordx4 v19, s[16:19], s40 offen lds
  ds_read_b64_tr_b16 v[76:77], v8 offset:18496
  ds_read_b64_tr_b16 v[78:79], v8 offset:20800
  v_mfma_f32_32x32x16_bf16 v[192:207], v[52:55], v[36:39], v[192:207]
  s_add_u32 m0, s34, 98304
  s_mov_b32 s40, 1474560
  buffer_load_dwordx4 v20, s[12:15], s40 offen lds
  ds_read_b64_tr_b16 v[48:49], v8 offset:128
  ds_read_b64_tr_b16 v[50:51], v8 offset:2432
  v_mfma_f32_32x32x16_bf16 v[208:223], v[56:59], v[36:39], v[208:223]
  s_add_u32 m0, s34, 116736
  s_mov_b32 s40, 1474560
  buffer_load_dwordx4 v20, s[16:19], s40 offen lds
  ds_read_b64_tr_b16 v[52:53], v8 offset:18560
  ds_read_b64_tr_b16 v[54:55], v8 offset:20864
  v_mfma_f32_32x32x16_bf16 v[224:239], v[60:63], v[36:39], v[224:239]
  s_add_u32 m0, s34, 126976
  s_mov_b32 s40, 10240
  buffer_load_dwordx4 v22, s[24:27], s40 offen sc1 lds
  ds_read_b64_tr_b16 v[56:57], v8 offset:192
  ds_read_b64_tr_b16 v[58:59], v8 offset:2496
  s_waitcnt lgkmcnt(12)
  v_mfma_f32_32x32x16_bf16 v[80:95], v[64:67], v[40:43], v[80:95]
  ds_read_b64_tr_b16 v[60:61], v8 offset:18624
  ds_read_b64_tr_b16 v[62:63], v8 offset:20928
  s_waitcnt lgkmcnt(12)
  v_mfma_f32_32x32x16_bf16 v[96:111], v[68:71], v[40:43], v[96:111]
  ds_read_b64_tr_b16 v[64:65], v8 offset:256
  ds_read_b64_tr_b16 v[66:67], v8 offset:2560
  s_waitcnt lgkmcnt(12)
  v_mfma_f32_32x32x16_bf16 v[112:127], v[72:75], v[40:43], v[112:127]
  ds_read_b64_tr_b16 v[68:69], v8 offset:18688
  ds_read_b64_tr_b16 v[70:71], v8 offset:20992
  s_waitcnt lgkmcnt(12)
  v_mfma_f32_32x32x16_bf16 v[128:143], v[76:79], v[40:43], v[128:143]
  ds_read_b128 v[44:47], v11 offset:1024
  ds_read_b64_tr_b16 v[72:73], v8 offset:9216
  ds_read_b64_tr_b16 v[74:75], v8 offset:11520
  s_waitcnt lgkmcnt(13)
  v_mfma_f32_32x32x16_bf16 v[144:159], v[48:51], v[40:43], v[144:159]
  ds_read_b64_tr_b16 v[76:77], v8 offset:27648
  ds_read_b64_tr_b16 v[78:79], v8 offset:29952
  s_waitcnt lgkmcnt(13)
  v_mfma_f32_32x32x16_bf16 v[160:175], v[52:55], v[40:43], v[160:175]
  ds_read_b64_tr_b16 v[48:49], v8 offset:9280
  ds_read_b64_tr_b16 v[50:51], v8 offset:11584
  s_waitcnt lgkmcnt(13)
  v_mfma_f32_32x32x16_bf16 v[176:191], v[56:59], v[40:43], v[176:191]
  ds_read_b64_tr_b16 v[52:53], v8 offset:27712
  ds_read_b64_tr_b16 v[54:55], v8 offset:30016
  s_waitcnt lgkmcnt(13)
  v_mfma_f32_32x32x16_bf16 v[192:207], v[60:63], v[40:43], v[192:207]
  ds_read_b64_tr_b16 v[56:57], v8 offset:9344
  ds_read_b64_tr_b16 v[58:59], v8 offset:11648
  s_waitcnt lgkmcnt(13)
  v_mfma_f32_32x32x16_bf16 v[208:223], v[64:67], v[40:43], v[208:223]
  ds_read_b64_tr_b16 v[60:61], v8 offset:27776
  ds_read_b64_tr_b16 v[62:63], v8 offset:30080
  s_waitcnt lgkmcnt(13)
  v_mfma_f32_32x32x16_bf16 v[224:239], v[68:71], v[40:43], v[224:239]
  ds_read_b64_tr_b16 v[64:65], v8 offset:9408
  ds_read_b64_tr_b16 v[66:67], v8 offset:11712
  s_waitcnt lgkmcnt(12)
  v_mfma_f32_32x32x16_bf16 v[80:95], v[72:75], v[44:47], v[80:95]
  ds_read_b64_tr_b16 v[68:69], v8 offset:27840
  ds_read_b64_tr_b16 v[70:71], v8 offset:30144
  s_waitcnt lgkmcnt(12)
  v_mfma_f32_32x32x16_bf16 v[96:111], v[76:79], v[44:47], v[96:111]
  ds_read_b64_tr_b16 v[72:73], v8 offset:9472
  ds_read_b64_tr_b16 v[74:75], v8 offset:11776
  s_waitcnt lgkmcnt(12)
  v_mfma_f32_32x32x16_bf16 v[112:127], v[48:51], v[44:47], v[112:127]
  ds_read_b64_tr_b16 v[76:77], v8 offset:27904
  ds_read_b64_tr_b16 v[78:79], v8 offset:30208
  s_waitcnt lgkmcnt(12)
  v_mfma_f32_32x32x16_bf16 v[128:143], v[52:55], v[44:47], v[128:143]
  s_waitcnt lgkmcnt(10)
  v_mfma_f32_32x32x16_bf16 v[144:159], v[56:59], v[44:47], v[144:159]
  s_waitcnt vmcnt(5) lgkmcnt(0)
  s_barrier
  ds_read_b128 v[32:35], v12 offset:0
  ds_read_b64_tr_b16 v[48:49], v9 offset:0
  ds_read_b64_tr_b16 v[50:51], v9 offset:2304
  ds_read_b64_tr_b16 v[52:53], v9 offset:18432
  ds_read_b64_tr_b16 v[54:55], v9 offset:20736
  v_mfma_f32_32x32x16_bf16 v[160:175], v[60:63], v[44:47], v[160:175]
  s_add_u32 m0, s34, 0
  s_mov_b32 s40, 1769472
  buffer_load_dwordx4 v19, s[12:15], s40 offen lds
  ds_read_b64_tr_b16 v[56:57], v9 offset:64
  ds_read_b64_tr_b16 v[58:59], v9 offset:2368
  v_mfma_f32_32x32x16_bf16 v[176:191], v[64:67], v[44:47], v[176:191]
  s_add_u32 m0, s34, 18432
  s_mov_b32 s40, 1769472
  buffer_load_dwordx4 v19, s[16:19], s40 offen lds
  ds_read_b64_tr_b16 v[60:61], v9 offset:18496
  ds_read_b64_tr_b16 v[62:63], v9 offset:20800
  v_mfma_f32_32x32x16_bf16 v[192:207], v[68:71], v[44:47], v[192:207]
  s_add_u32 m0, s34, 8192
  s_mov_b32 s40, 1769472
  buffer_load_dwordx4 v20, s[12:15], s40 offen lds
  ds_read_b64_tr_b16 v[64:65], v9 offset:128
  ds_read_b64_tr_b16 v[66:67], v9 offset:2432
  v_mfma_f32_32x32x16_bf16 v[208:223], v[72:75], v[44:47], v[208:223]
  s_add_u32 m0, s34, 26624
  s_mov_b32 s40, 1769472
  buffer_load_dwordx4 v20, s[16:19], s40 offen lds
  ds_read_b64_tr_b16 v[68:69], v9 offset:18560
  ds_read_b64_tr_b16 v[70:71], v9 offset:20864
  v_mfma_f32_32x32x16_bf16 v[224:239], v[76:79], v[44:47], v[224:239]
  s_add_u32 m0, s34, 36864
  s_mov_b32 s40, 12288
  buffer_load_dwordx4 v22, s[24:27], s40 offen sc1 lds
  ds_read_b64_tr_b16 v[72:73], v9 offset:192
  ds_read_b64_tr_b16 v[74:75], v9 offset:2496
  s_waitcnt lgkmcnt(12)
  v_mfma_f32_32x32x16_bf16 v[80:95], v[48:51], v[32:35], v[80:95]
  ds_read_b64_tr_b16 v[76:77], v9 offset:18624
  ds_read_b64_tr_b16 v[78:79], v9 offset:20928
  s_waitcnt lgkmcnt(12)
  v_mfma_f32_32x32x16_bf16 v[96:111], v[52:55], v[32:35], v[96:111]
  ds_read_b64_tr_b16 v[48:49], v9 offset:256
  ds_read_b64_tr_b16 v[50:51], v9 offset:2560
  s_waitcnt lgkmcnt(12)
  v_mfma_f32_32x32x16_bf16 v[112:127], v[56:59], v[32:35], v[112:127]
  ds_read_b64_tr_b16 v[52:53], v9 offset:18688
  ds_read_b64_tr_b16 v[54:55], v9 offset:20992
  s_waitcnt lgkmcnt(12)
  v_mfma_f32_32x32x16_bf16 v[128:143], v[60:63], v[32:35], v[128:143]
  ds_read_b128 v[36:39], v12 offset:1024
  ds_read_b64_tr_b16 v[56:57], v9 offset:9216
  ds_read_b64_tr_b16 v[58:59], v9 offset:11520
  s_waitcnt lgkmcnt(13)
  v_mfma_f32_32x32x16_bf16 v[144:159], v[64:67], v[32:35], v[144:159]
  ds_read_b64_tr_b16 v[60:61], v9 offset:27648
  ds_read_b64_tr_b16 v[62:63], v9 offset:29952
  s_waitcnt lgkmcnt(13)
  v_mfma_f32_32x32x16_bf16 v[160:175], v[68:71], v[32:35], v[160:175]
  ds_read_b64_tr_b16 v[64:65], v9 offset:9280
  ds_read_b64_tr_b16 v[66:67], v9 offset:11584
  s_waitcnt lgkmcnt(13)
  v_mfma_f32_32x32x16_bf16 v[176:191], v[72:75], v[32:35], v[176:191]
  ds_read_b64_tr_b16 v[68:69], v9 offset:27712
  ds_read_b64_tr_b16 v[70:71], v9 offset:30016
  s_waitcnt lgkmcnt(13)
  v_mfma_f32_32x32x16_bf16 v[192:207], v[76:79], v[32:35], v[192:207]
  ds_read_b64_tr_b16 v[72:73], v9 offset:9344
  ds_read_b64_tr_b16 v[74:75], v9 offset:11648
  s_waitcnt lgkmcnt(13)
  v_mfma_f32_32x32x16_bf16 v[208:223], v[48:51], v[32:35], v[208:223]
  ds_read_b64_tr_b16 v[76:77], v9 offset:27776
  ds_read_b64_tr_b16 v[78:79], v9 offset:30080
  s_waitcnt lgkmcnt(13)
  v_mfma_f32_32x32x16_bf16 v[224:239], v[52:55], v[32:35], v[224:239]
  ds_read_b64_tr_b16 v[48:49], v9 offset:9408
  ds_read_b64_tr_b16 v[50:51], v9 offset:11712
  s_waitcnt lgkmcnt(12)
  v_mfma_f32_32x32x16_bf16 v[80:95], v[56:59], v[36:39], v[80:95]
  ds_read_b64_tr_b16 v[52:53], v9 offset:27840
  ds_read_b64_tr_b16 v[54:55], v9 offset:30144
  s_waitcnt lgkmcnt(12)
  v_mfma_f32_32x32x16_bf16 v[96:111], v[60:63], v[36:39], v[96:111]
  ds_read_b64_tr_b16 v[56:57], v9 offset:9472
  ds_read_b64_tr_b16 v[58:59], v9 offset:11776
  s_waitcnt lgkmcnt(12)
  v_mfma_f32_32x32x16_bf16 v[112:127], v[64:67], v[36:39], v[112:127]
  ds_read_b64_tr_b16 v[60:61], v9 offset:27904
  ds_read_b64_tr_b16 v[62:63], v9 offset:30208
  s_waitcnt lgkmcnt(12)
  v_mfma_f32_32x32x16_bf16 v[128:143], v[68:71], v[36:39], v[128:143]
  s_waitcnt lgkmcnt(10)
  v_mfma_f32_32x32x16_bf16 v[144:159], v[72:75], v[36:39], v[144:159]
  s_waitcnt vmcnt(5) lgkmcnt(0)
  s_barrier
  ds_read_b128 v[40:43], v13 offset:0
  ds_read_b64_tr_b16 v[64:65], v10 offset:0
  ds_read_b64_tr_b16 v[66:67], v10 offset:2304
  ds_read_b64_tr_b16 v[68:69], v10 offset:18432
  ds_read_b64_tr_b16 v[70:71], v10 offset:20736
  v_mfma_f32_32x32x16_bf16 v[160:175], v[76:79], v[36:39], v[160:175]
  s_add_u32 m0, s34, 45056
  s_mov_b32 s40, 2064384
  buffer_load_dwordx4 v19, s[12:15], s40 offen lds
  ds_read_b64_tr_b16 v[72:73], v10 offset:64
  ds_read_b64_tr_b16 v[74:75], v10 offset:2368
  v_mfma_f32_32x32x16_bf16 v[176:191], v[48:51], v[36:39], v[176:191]
  s_add_u32 m0, s34, 63488
  s_mov_b32 s40, 2064384
  buffer_load_dwordx4 v19, s[16:19], s40 offen lds
  ds_read_b64_tr_b16 v[76:77], v10 offset:18496
  ds_read_b64_tr_b16 v[78:79], v10 offset:20800
  v_mfma_f32_32x32x16_bf16 v[192:207], v[52:55], v[36:39], v[192:207]
  s_add_u32 m0, s34, 53248
  s_mov_b32 s40, 2064384
  buffer_load_dwordx4 v20, s[12:15], s40 offen lds
  ds_read_b64_tr_b16 v[48:49], v10 offset:128
  ds_read_b64_tr_b16 v[50:51], v10 offset:2432
  v_mfma_f32_32x32x16_bf16 v[208:223], v[56:59], v[36:39], v[208:223]
  s_add_u32 m0, s34, 71680
  s_mov_b32 s40, 2064384
  buffer_load_dwordx4 v20, s[16:19], s40 offen lds
  ds_read_b64_tr_b16 v[52:53], v10 offset:18560
  ds_read_b64_tr_b16 v[54:55], v10 offset:20864
  v_mfma_f32_32x32x16_bf16 v[224:239], v[60:63], v[36:39], v[224:239]
  s_add_u32 m0, s34, 81920
  s_mov_b32 s40, 14336
  buffer_load_dwordx4 v22, s[24:27], s40 offen sc1 lds
  ds_read_b64_tr_b16 v[56:57], v10 offset:192
  ds_read_b64_tr_b16 v[58:59], v10 offset:2496
  s_waitcnt lgkmcnt(12)
  v_mfma_f32_32x32x16_bf16 v[80:95], v[64:67], v[40:43], v[80:95]
  ds_read_b64_tr_b16 v[60:61], v10 offset:18624
  ds_read_b64_tr_b16 v[62:63], v10 offset:20928
  s_waitcnt lgkmcnt(12)
  v_mfma_f32_32x32x16_bf16 v[96:111], v[68:71], v[40:43], v[96:111]
  ds_read_b64_tr_b16 v[64:65], v10 offset:256
  ds_read_b64_tr_b16 v[66:67], v10 offset:2560
  s_waitcnt lgkmcnt(12)
  v_mfma_f32_32x32x16_bf16 v[112:127], v[72:75], v[40:43], v[112:127]
  ds_read_b64_tr_b16 v[68:69], v10 offset:18688
  ds_read_b64_tr_b16 v[70:71], v10 offset:20992
  s_waitcnt lgkmcnt(12)
  v_mfma_f32_32x32x16_bf16 v[128:143], v[76:79], v[40:43], v[128:143]
  ds_read_b128 v[44:47], v13 offset:1024
  ds_read_b64_tr_b16 v[72:73], v10 offset:9216
  ds_read_b64_tr_b16 v[74:75], v10 offset:11520
  s_waitcnt lgkmcnt(13)
  v_mfma_f32_32x32x16_bf16 v[144:159], v[48:51], v[40:43], v[144:159]
  ds_read_b64_tr_b16 v[76:77], v10 offset:27648
  ds_read_b64_tr_b16 v[78:79], v10 offset:29952
  s_waitcnt lgkmcnt(13)
  v_mfma_f32_32x32x16_bf16 v[160:175], v[52:55], v[40:43], v[160:175]
  ds_read_b64_tr_b16 v[48:49], v10 offset:9280
  ds_read_b64_tr_b16 v[50:51], v10 offset:11584
  s_waitcnt lgkmcnt(13)
  v_mfma_f32_32x32x16_bf16 v[176:191], v[56:59], v[40:43], v[176:191]
  ds_read_b64_tr_b16 v[52:53], v10 offset:27712
  ds_read_b64_tr_b16 v[54:55], v10 offset:30016
  s_waitcnt lgkmcnt(13)
  v_mfma_f32_32x32x16_bf16 v[192:207], v[60:63], v[40:43], v[192:207]
  ds_read_b64_tr_b16 v[56:57], v10 offset:9344
  ds_read_b64_tr_b16 v[58:59], v10 offset:11648
  s_waitcnt lgkmcnt(13)
  v_mfma_f32_32x32x16_bf16 v[208:223], v[64:67], v[40:43], v[208:223]
  ds_read_b64_tr_b16 v[60:61], v10 offset:27776
  ds_read_b64_tr_b16 v[62:63], v10 offset:30080
  s_waitcnt lgkmcnt(13)
  v_mfma_f32_32x32x16_bf16 v[224:239], v[68:71], v[40:43], v[224:239]
  ds_read_b64_tr_b16 v[64:65], v10 offset:9408
  ds_read_b64_tr_b16 v[66:67], v10 offset:11712
  s_waitcnt lgkmcnt(12)
  v_mfma_f32_32x32x16_bf16 v[80:95], v[72:75], v[44:47], v[80:95]
  ds_read_b64_tr_b16 v[68:69], v10 offset:27840
  ds_read_b64_tr_b16 v[70:71], v10 offset:30144
  s_waitcnt lgkmcnt(12)
  v_mfma_f32_32x32x16_bf16 v[96:111], v[76:79], v[44:47], v[96:111]
  ds_read_b64_tr_b16 v[72:73], v10 offset:9472
  ds_read_b64_tr_b16 v[74:75], v10 offset:11776
  s_waitcnt lgkmcnt(12)
  v_mfma_f32_32x32x16_bf16 v[112:127], v[48:51], v[44:47], v[112:127]
  ds_read_b64_tr_b16 v[76:77], v10 offset:27904
  ds_read_b64_tr_b16 v[78:79], v10 offset:30208
  s_waitcnt lgkmcnt(12)
  v_mfma_f32_32x32x16_bf16 v[128:143], v[52:55], v[44:47], v[128:143]
  s_waitcnt lgkmcnt(10)
  v_mfma_f32_32x32x16_bf16 v[144:159], v[56:59], v[44:47], v[144:159]
  s_waitcnt vmcnt(5) lgkmcnt(0)
  s_barrier
  ds_read_b128 v[32:35], v11 offset:0
  ds_read_b64_tr_b16 v[48:49], v8 offset:0
  ds_read_b64_tr_b16 v[50:51], v8 offset:2304
  ds_read_b64_tr_b16 v[52:53], v8 offset:18432
  ds_read_b64_tr_b16 v[54:55], v8 offset:20736
  v_mfma_f32_32x32x16_bf16 v[160:175], v[60:63], v[44:47], v[160:175]
  s_add_u32 m0, s34, 90112
  s_mov_b32 s40, 2359296
  buffer_load_dwordx4 v19, s[12:15], s40 offen lds
  ds_read_b64_tr_b16 v[56:57], v8 offset:64
  ds_read_b64_tr_b16 v[58:59], v8 offset:2368
  v_mfma_f32_32x32x16_bf16 v[176:191], v[64:67], v[44:47], v[176:191]
  s_add_u32 m0, s34, 108544
  s_mov_b32 s40, 2359296
  buffer_load_dwordx4 v19, s[16:19], s40 offen lds
  ds_read_b64_tr_b16 v[60:61], v8 offset:18496
  ds_read_b64_tr_b16 v[62:63], v8 offset:20800
  v_mfma_f32_32x32x16_bf16 v[192:207], v[68:71], v[44:47], v[192:207]
  s_add_u32 m0, s34, 98304
  s_mov_b32 s40, 2359296
  buffer_load_dwordx4 v20, s[12:15], s40 offen lds
  ds_read_b64_tr_b16 v[64:65], v8 offset:128
  ds_read_b64_tr_b16 v[66:67], v8 offset:2432
  v_mfma_f32_32x32x16_bf16 v[208:223], v[72:75], v[44:47], v[208:223]
  s_add_u32 m0, s34, 116736
  s_mov_b32 s40, 2359296
  buffer_load_dwordx4 v20, s[16:19], s40 offen lds
  ds_read_b64_tr_b16 v[68:69], v8 offset:18560
  ds_read_b64_tr_b16 v[70:71], v8 offset:20864
  v_mfma_f32_32x32x16_bf16 v[224:239], v[76:79], v[44:47], v[224:239]
  s_add_u32 m0, s34, 126976
  s_mov_b32 s40, 16384
  buffer_load_dwordx4 v22, s[24:27], s40 offen sc1 lds
  ds_read_b64_tr_b16 v[72:73], v8 offset:192
  ds_read_b64_tr_b16 v[74:75], v8 offset:2496
  s_waitcnt lgkmcnt(12)
  v_mfma_f32_32x32x16_bf16 v[80:95], v[48:51], v[32:35], v[80:95]
  ds_read_b64_tr_b16 v[76:77], v8 offset:18624
  ds_read_b64_tr_b16 v[78:79], v8 offset:20928
  s_waitcnt lgkmcnt(12)
  v_mfma_f32_32x32x16_bf16 v[96:111], v[52:55], v[32:35], v[96:111]
  ds_read_b64_tr_b16 v[48:49], v8 offset:256
  ds_read_b64_tr_b16 v[50:51], v8 offset:2560
  s_waitcnt lgkmcnt(12)
  v_mfma_f32_32x32x16_bf16 v[112:127], v[56:59], v[32:35], v[112:127]
  ds_read_b64_tr_b16 v[52:53], v8 offset:18688
  ds_read_b64_tr_b16 v[54:55], v8 offset:20992
  s_waitcnt lgkmcnt(12)
  v_mfma_f32_32x32x16_bf16 v[128:143], v[60:63], v[32:35], v[128:143]
  ds_read_b128 v[36:39], v11 offset:1024
  ds_read_b64_tr_b16 v[56:57], v8 offset:9216
  ds_read_b64_tr_b16 v[58:59], v8 offset:11520
  s_waitcnt lgkmcnt(13)
  v_mfma_f32_32x32x16_bf16 v[144:159], v[64:67], v[32:35], v[144:159]
  ds_read_b64_tr_b16 v[60:61], v8 offset:27648
  ds_read_b64_tr_b16 v[62:63], v8 offset:29952
  s_waitcnt lgkmcnt(13)
  v_mfma_f32_32x32x16_bf16 v[160:175], v[68:71], v[32:35], v[160:175]
  ds_read_b64_tr_b16 v[64:65], v8 offset:9280
  ds_read_b64_tr_b16 v[66:67], v8 offset:11584
  s_waitcnt lgkmcnt(13)
  v_mfma_f32_32x32x16_bf16 v[176:191], v[72:75], v[32:35], v[176:191]
  ds_read_b64_tr_b16 v[68:69], v8 offset:27712
  ds_read_b64_tr_b16 v[70:71], v8 offset:30016
  s_waitcnt lgkmcnt(13)
  v_mfma_f32_32x32x16_bf16 v[192:207], v[76:79], v[32:35], v[192:207]
  ds_read_b64_tr_b16 v[72:73], v8 offset:9344
  ds_read_b64_tr_b16 v[74:75], v8 offset:11648
  s_waitcnt lgkmcnt(13)
  v_mfma_f32_32x32x16_bf16 v[208:223], v[48:51], v[32:35], v[208:223]
  ds_read_b64_tr_b16 v[76:77], v8 offset:27776
  ds_read_b64_tr_b16 v[78:79], v8 offset:30080
  s_waitcnt lgkmcnt(13)
  v_mfma_f32_32x32x16_bf16 v[224:239], v[52:55], v[32:35], v[224:239]
  ds_read_b64_tr_b16 v[48:49], v8 offset:9408
  ds_read_b64_tr_b16 v[50:51], v8 offset:11712
  s_waitcnt lgkmcnt(12)
  v_mfma_f32_32x32x16_bf16 v[80:95], v[56:59], v[36:39], v[80:95]
  ds_read_b64_tr_b16 v[52:53], v8 offset:27840
  ds_read_b64_tr_b16 v[54:55], v8 offset:30144
  s_waitcnt lgkmcnt(12)
  v_mfma_f32_32x32x16_bf16 v[96:111], v[60:63], v[36:39], v[96:111]
  ds_read_b64_tr_b16 v[56:57], v8 offset:9472
  ds_read_b64_tr_b16 v[58:59], v8 offset:11776
  s_waitcnt lgkmcnt(12)
  v_mfma_f32_32x32x16_bf16 v[112:127], v[64:67], v[36:39], v[112:127]
  ds_read_b64_tr_b16 v[60:61], v8 offset:27904
  ds_read_b64_tr_b16 v[62:63], v8 offset:30208
  s_waitcnt lgkmcnt(12)
  v_mfma_f32_32x32x16_bf16 v[128:143], v[68:71], v[36:39], v[128:143]
  s_waitcnt lgkmcnt(10)
  v_mfma_f32_32x32x16_bf16 v[144:159], v[72:75], v[36:39], v[144:159]
  s_waitcnt vmcnt(5) lgkmcnt(0)
  s_barrier
  ds_read_b128 v[40:43], v12 offset:0
  ds_read_b64_tr_b16 v[64:65], v9 offset:0
  ds_read_b64_tr_b16 v[66:67], v9 offset:2304
  ds_read_b64_tr_b16 v[68:69], v9 offset:18432
  ds_read_b64_tr_b16 v[70:71], v9 offset:20736
  v_mfma_f32_32x32x16_bf16 v[160:175], v[76:79], v[36:39], v[160:175]
  s_add_u32 m0, s34, 0
  s_mov_b32 s40, 2654208
  buffer_load_dwordx4 v19, s[12:15], s40 offen lds
  ds_read_b64_tr_b16 v[72:73], v9 offset:64
  ds_read_b64_tr_b16 v[74:75], v9 offset:2368
  v_mfma_f32_32x32x16_bf16 v[176:191], v[48:51], v[36:39], v[176:191]
  s_add_u32 m0, s34, 18432
  s_mov_b32 s40, 2654208
  buffer_load_dwordx4 v19, s[16:19], s40 offen lds
  ds_read_b64_tr_b16 v[76:77], v9 offset:18496
  ds_read_b64_tr_b16 v[78:79], v9 offset:20800
  v_mfma_f32_32x32x16_bf16 v[192:207], v[52:55], v[36:39], v[192:207]
  s_add_u32 m0, s34, 8192
  s_mov_b32 s40, 2654208
  buffer_load_dwordx4 v20, s[12:15], s40 offen lds
  ds_read_b64_tr_b16 v[48:49], v9 offset:128
  ds_read_b64_tr_b16 v[50:51], v9 offset:2432
  v_mfma_f32_32x32x16_bf16 v[208:223], v[56:59], v[36:39], v[208:223]
  s_add_u32 m0, s34, 26624
  s_mov_b32 s40, 2654208
  buffer_load_dwordx4 v20, s[16:19], s40 offen lds
  ds_read_b64_tr_b16 v[52:53], v9 offset:18560
  ds_read_b64_tr_b16 v[54:55], v9 offset:20864
  v_mfma_f32_32x32x16_bf16 v[224:239], v[60:63], v[36:39], v[224:239]
  s_add_u32 m0, s34, 36864
  s_mov_b32 s40, 18432
  buffer_load_dwordx4 v22, s[24:27], s40 offen sc1 lds
  ds_read_b64_tr_b16 v[56:57], v9 offset:192
  ds_read_b64_tr_b16 v[58:59], v9 offset:2496
  s_waitcnt lgkmcnt(12)
  v_mfma_f32_32x32x16_bf16 v[80:95], v[64:67], v[40:43], v[80:95]
  ds_read_b64_tr_b16 v[60:61], v9 offset:18624
  ds_read_b64_tr_b16 v[62:63], v9 offset:20928
  s_waitcnt lgkmcnt(12)
  v_mfma_f32_32x32x16_bf16 v[96:111], v[68:71], v[40:43], v[96:111]
  ds_read_b64_tr_b16 v[64:65], v9 offset:256
  ds_read_b64_tr_b16 v[66:67], v9 offset:2560
  s_waitcnt lgkmcnt(12)
  v_mfma_f32_32x32x16_bf16 v[112:127], v[72:75], v[40:43], v[112:127]
  ds_read_b64_tr_b16 v[68:69], v9 offset:18688
  ds_read_b64_tr_b16 v[70:71], v9 offset:20992
  s_waitcnt lgkmcnt(12)
  v_mfma_f32_32x32x16_bf16 v[128:143], v[76:79], v[40:43], v[128:143]
  ds_read_b128 v[44:47], v12 offset:1024
  ds_read_b64_tr_b16 v[72:73], v9 offset:9216
  ds_read_b64_tr_b16 v[74:75], v9 offset:11520
  s_waitcnt lgkmcnt(13)
  v_mfma_f32_32x32x16_bf16 v[144:159], v[48:51], v[40:43], v[144:159]
  ds_read_b64_tr_b16 v[76:77], v9 offset:27648
  ds_read_b64_tr_b16 v[78:79], v9 offset:29952
  s_waitcnt lgkmcnt(13)
  v_mfma_f32_32x32x16_bf16 v[160:175], v[52:55], v[40:43], v[160:175]
  ds_read_b64_tr_b16 v[48:49], v9 offset:9280
  ds_read_b64_tr_b16 v[50:51], v9 offset:11584
  s_waitcnt lgkmcnt(13)
  v_mfma_f32_32x32x16_bf16 v[176:191], v[56:59], v[40:43], v[176:191]
  ds_read_b64_tr_b16 v[52:53], v9 offset:27712
  ds_read_b64_tr_b16 v[54:55], v9 offset:30016
  s_waitcnt lgkmcnt(13)
  v_mfma_f32_32x32x16_bf16 v[192:207], v[60:63], v[40:43], v[192:207]
  ds_read_b64_tr_b16 v[56:57], v9 offset:9344
  ds_read_b64_tr_b16 v[58:59], v9 offset:11648
  s_waitcnt lgkmcnt(13)
  v_mfma_f32_32x32x16_bf16 v[208:223], v[64:67], v[40:43], v[208:223]
  ds_read_b64_tr_b16 v[60:61], v9 offset:27776
  ds_read_b64_tr_b16 v[62:63], v9 offset:30080
  s_waitcnt lgkmcnt(13)
  v_mfma_f32_32x32x16_bf16 v[224:239], v[68:71], v[40:43], v[224:239]
  ds_read_b64_tr_b16 v[64:65], v9 offset:9408
  ds_read_b64_tr_b16 v[66:67], v9 offset:11712
  s_waitcnt lgkmcnt(12)
  v_mfma_f32_32x32x16_bf16 v[80:95], v[72:75], v[44:47], v[80:95]
  ds_read_b64_tr_b16 v[68:69], v9 offset:27840
  ds_read_b64_tr_b16 v[70:71], v9 offset:30144
  s_waitcnt lgkmcnt(12)
  v_mfma_f32_32x32x16_bf16 v[96:111], v[76:79], v[44:47], v[96:111]
  ds_read_b64_tr_b16 v[72:73], v9 offset:9472
  ds_read_b64_tr_b16 v[74:75], v9 offset:11776
  s_waitcnt lgkmcnt(12)
  v_mfma_f32_32x32x16_bf16 v[112:127], v[48:51], v[44:47], v[112:127]
  ds_read_b64_tr_b16 v[76:77], v9 offset:27904
  ds_read_b64_tr_b16 v[78:79], v9 offset:30208
  s_waitcnt lgkmcnt(12)
  v_mfma_f32_32x32x16_bf16 v[128:143], v[52:55], v[44:47], v[128:143]
  s_waitcnt lgkmcnt(10)
  v_mfma_f32_32x32x16_bf16 v[144:159], v[56:59], v[44:47], v[144:159]
  s_waitcnt vmcnt(5) lgkmcnt(0)
  s_barrier
  ds_read_b128 v[32:35], v13 offset:0
  ds_read_b64_tr_b16 v[48:49], v10 offset:0
  ds_read_b64_tr_b16 v[50:51], v10 offset:2304
  ds_read_b64_tr_b16 v[52:53], v10 offset:18432
  ds_read_b64_tr_b16 v[54:55], v10 offset:20736
  v_mfma_f32_32x32x16_bf16 v[160:175], v[60:63], v[44:47], v[160:175]
  s_add_u32 m0, s34, 45056
  s_mov_b32 s40, 2949120
  buffer_load_dwordx4 v19, s[12:15], s40 offen lds
  ds_read_b64_tr_b16 v[56:57], v10 offset:64
  ds_read_b64_tr_b16 v[58:59], v10 offset:2368
  v_mfma_f32_32x32x16_bf16 v[176:191], v[64:67], v[44:47], v[176:191]
  s_add_u32 m0, s34, 63488
  s_mov_b32 s40, 2949120
  buffer_load_dwordx4 v19, s[16:19], s40 offen lds
  ds_read_b64_tr_b16 v[60:61], v10 offset:18496
  ds_read_b64_tr_b16 v[62:63], v10 offset:20800
  v_mfma_f32_32x32x16_bf16 v[192:207], v[68:71], v[44:47], v[192:207]
  s_add_u32 m0, s34, 53248
  s_mov_b32 s40, 2949120
  buffer_load_dwordx4 v20, s[12:15], s40 offen lds
  ds_read_b64_tr_b16 v[64:65], v10 offset:128
  ds_read_b64_tr_b16 v[66:67], v10 offset:2432
  v_mfma_f32_32x32x16_bf16 v[208:223], v[72:75], v[44:47], v[208:223]
  s_add_u32 m0, s34, 71680
  s_mov_b32 s40, 2949120
  buffer_load_dwordx4 v20, s[16:19], s40 offen lds
  ds_read_b64_tr_b16 v[68:69], v10 offset:18560
  ds_read_b64_tr_b16 v[70:71], v10 offset:20864
  v_mfma_f32_32x32x16_bf16 v[224:239], v[76:79], v[44:47], v[224:239]
  s_add_u32 m0, s34, 81920
  s_mov_b32 s40, 20480
  buffer_load_dwordx4 v22, s[24:27], s40 offen sc1 lds
  ds_read_b64_tr_b16 v[72:73], v10 offset:192
  ds_read_b64_tr_b16 v[74:75], v10 offset:2496
  s_waitcnt lgkmcnt(12)
  v_mfma_f32_32x32x16_bf16 v[80:95], v[48:51], v[32:35], v[80:95]
  ds_read_b64_tr_b16 v[76:77], v10 offset:18624
  ds_read_b64_tr_b16 v[78:79], v10 offset:20928
  s_waitcnt lgkmcnt(12)
  v_mfma_f32_32x32x16_bf16 v[96:111], v[52:55], v[32:35], v[96:111]
  ds_read_b64_tr_b16 v[48:49], v10 offset:256
  ds_read_b64_tr_b16 v[50:51], v10 offset:2560
  s_waitcnt lgkmcnt(12)
  v_mfma_f32_32x32x16_bf16 v[112:127], v[56:59], v[32:35], v[112:127]
  ds_read_b64_tr_b16 v[52:53], v10 offset:18688
  ds_read_b64_tr_b16 v[54:55], v10 offset:20992
  s_waitcnt lgkmcnt(12)
  v_mfma_f32_32x32x16_bf16 v[128:143], v[60:63], v[32:35], v[128:143]
  ds_read_b128 v[36:39], v13 offset:1024
  ds_read_b64_tr_b16 v[56:57], v10 offset:9216
  ds_read_b64_tr_b16 v[58:59], v10 offset:11520
  s_waitcnt lgkmcnt(13)
  v_mfma_f32_32x32x16_bf16 v[144:159], v[64:67], v[32:35], v[144:159]
  ds_read_b64_tr_b16 v[60:61], v10 offset:27648
  ds_read_b64_tr_b16 v[62:63], v10 offset:29952
  s_waitcnt lgkmcnt(13)
  v_mfma_f32_32x32x16_bf16 v[160:175], v[68:71], v[32:35], v[160:175]
  ds_read_b64_tr_b16 v[64:65], v10 offset:9280
  ds_read_b64_tr_b16 v[66:67], v10 offset:11584
  s_waitcnt lgkmcnt(13)
  v_mfma_f32_32x32x16_bf16 v[176:191], v[72:75], v[32:35], v[176:191]
  ds_read_b64_tr_b16 v[68:69], v10 offset:27712
  ds_read_b64_tr_b16 v[70:71], v10 offset:30016
  s_waitcnt lgkmcnt(13)
  v_mfma_f32_32x32x16_bf16 v[192:207], v[76:79], v[32:35], v[192:207]
  ds_read_b64_tr_b16 v[72:73], v10 offset:9344
  ds_read_b64_tr_b16 v[74:75], v10 offset:11648
  s_waitcnt lgkmcnt(13)
  v_mfma_f32_32x32x16_bf16 v[208:223], v[48:51], v[32:35], v[208:223]
  ds_read_b64_tr_b16 v[76:77], v10 offset:27776
  ds_read_b64_tr_b16 v[78:79], v10 offset:30080
  s_waitcnt lgkmcnt(13)
  v_mfma_f32_32x32x16_bf16 v[224:239], v[52:55], v[32:35], v[224:239]
  ds_read_b64_tr_b16 v[48:49], v10 offset:9408
  ds_read_b64_tr_b16 v[50:51], v10 offset:11712
  s_waitcnt lgkmcnt(12)
  v_mfma_f32_32x32x16_bf16 v[80:95], v[56:59], v[36:39], v[80:95]
  ds_read_b64_tr_b16 v[52:53], v10 offset:27840
  ds_read_b64_tr_b16 v[54:55], v10 offset:30144
  s_waitcnt lgkmcnt(12)
  v_mfma_f32_32x32x16_bf16 v[96:111], v[60:63], v[36:39], v[96:111]
  ds_read_b64_tr_b16 v[56:57], v10 offset:9472
  ds_read_b64_tr_b16 v[58:59], v10 offset:11776
  s_waitcnt lgkmcnt(12)
  v_mfma_f32_32x32x16_bf16 v[112:127], v[64:67], v[36:39], v[112:127]
  ds_read_b64_tr_b16 v[60:61], v10 offset:27904
  ds_read_b64_tr_b16 v[62:63], v10 offset:30208
  s_waitcnt lgkmcnt(12)
  v_mfma_f32_32x32x16_bf16 v[128:143], v[68:71], v[36:39], v[128:143]
  s_waitcnt lgkmcnt(10)
  v_mfma_f32_32x32x16_bf16 v[144:159], v[72:75], v[36:39], v[144:159]
  s_waitcnt vmcnt(5) lgkmcnt(0)
  s_barrier
  ds_read_b128 v[40:43], v11 offset:0
  ds_read_b64_tr_b16 v[64:65], v8 offset:0
  ds_read_b64_tr_b16 v[66:67], v8 offset:2304
  ds_read_b64_tr_b16 v[68:69], v8 offset:18432
  ds_read_b64_tr_b16 v[70:71], v8 offset:20736
  v_mfma_f32_32x32x16_bf16 v[160:175], v[76:79], v[36:39], v[160:175]
  s_add_u32 m0, s34, 90112
  s_mov_b32 s40, 3244032
  buffer_load_dwordx4 v19, s[12:15], s40 offen lds
  ds_read_b64_tr_b16 v[72:73], v8 offset:64
  ds_read_b64_tr_b16 v[74:75], v8 offset:2368
  v_mfma_f32_32x32x16_bf16 v[176:191], v[48:51], v[36:39], v[176:191]
  s_add_u32 m0, s34, 108544
  s_mov_b32 s40, 3244032
  buffer_load_dwordx4 v19, s[16:19], s40 offen lds
  ds_read_b64_tr_b16 v[76:77], v8 offset:18496
  ds_read_b64_tr_b16 v[78:79], v8 offset:20800
  v_mfma_f32_32x32x16_bf16 v[192:207], v[52:55], v[36:39], v[192:207]
  s_add_u32 m0, s34, 98304
  s_mov_b32 s40, 3244032
  buffer_load_dwordx4 v20, s[12:15], s40 offen lds
  ds_read_b64_tr_b16 v[48:49], v8 offset:128
  ds_read_b64_tr_b16 v[50:51], v8 offset:2432
  v_mfma_f32_32x32x16_bf16 v[208:223], v[56:59], v[36:39], v[208:223]
  s_add_u32 m0, s34, 116736
  s_mov_b32 s40, 3244032
  buffer_load_dwordx4 v20, s[16:19], s40 offen lds
  ds_read_b64_tr_b16 v[52:53], v8 offset:18560
  ds_read_b64_tr_b16 v[54:55], v8 offset:20864
  v_mfma_f32_32x32x16_bf16 v[224:239], v[60:63], v[36:39], v[224:239]
  s_add_u32 m0, s34, 126976
  s_mov_b32 s40, 22528
  buffer_load_dwordx4 v22, s[24:27], s40 offen sc1 lds
  ds_read_b64_tr_b16 v[56:57], v8 offset:192
  ds_read_b64_tr_b16 v[58:59], v8 offset:2496
  s_waitcnt lgkmcnt(12)
  v_mfma_f32_32x32x16_bf16 v[80:95], v[64:67], v[40:43], v[80:95]
  ds_read_b64_tr_b16 v[60:61], v8 offset:18624
  ds_read_b64_tr_b16 v[62:63], v8 offset:20928
  s_waitcnt lgkmcnt(12)
  v_mfma_f32_32x32x16_bf16 v[96:111], v[68:71], v[40:43], v[96:111]
  ds_read_b64_tr_b16 v[64:65], v8 offset:256
  ds_read_b64_tr_b16 v[66:67], v8 offset:2560
  s_waitcnt lgkmcnt(12)
  v_mfma_f32_32x32x16_bf16 v[112:127], v[72:75], v[40:43], v[112:127]
  ds_read_b64_tr_b16 v[68:69], v8 offset:18688
  ds_read_b64_tr_b16 v[70:71], v8 offset:20992
  s_waitcnt lgkmcnt(12)
  v_mfma_f32_32x32x16_bf16 v[128:143], v[76:79], v[40:43], v[128:143]
  ds_read_b128 v[44:47], v11 offset:1024
  ds_read_b64_tr_b16 v[72:73], v8 offset:9216
  ds_read_b64_tr_b16 v[74:75], v8 offset:11520
  s_waitcnt lgkmcnt(13)
  v_mfma_f32_32x32x16_bf16 v[144:159], v[48:51], v[40:43], v[144:159]
  ds_read_b64_tr_b16 v[76:77], v8 offset:27648
  ds_read_b64_tr_b16 v[78:79], v8 offset:29952
  s_waitcnt lgkmcnt(13)
  v_mfma_f32_32x32x16_bf16 v[160:175], v[52:55], v[40:43], v[160:175]
  ds_read_b64_tr_b16 v[48:49], v8 offset:9280
  ds_read_b64_tr_b16 v[50:51], v8 offset:11584
  s_waitcnt lgkmcnt(13)
  v_mfma_f32_32x32x16_bf16 v[176:191], v[56:59], v[40:43], v[176:191]
  ds_read_b64_tr_b16 v[52:53], v8 offset:27712
  ds_read_b64_tr_b16 v[54:55], v8 offset:30016
  s_waitcnt lgkmcnt(13)
  v_mfma_f32_32x32x16_bf16 v[192:207], v[60:63], v[40:43], v[192:207]
  ds_read_b64_tr_b16 v[56:57], v8 offset:9344
  ds_read_b64_tr_b16 v[58:59], v8 offset:11648
  s_waitcnt lgkmcnt(13)
  v_mfma_f32_32x32x16_bf16 v[208:223], v[64:67], v[40:43], v[208:223]
  ds_read_b64_tr_b16 v[60:61], v8 offset:27776
  ds_read_b64_tr_b16 v[62:63], v8 offset:30080
  s_waitcnt lgkmcnt(13)
  v_mfma_f32_32x32x16_bf16 v[224:239], v[68:71], v[40:43], v[224:239]
  ds_read_b64_tr_b16 v[64:65], v8 offset:9408
  ds_read_b64_tr_b16 v[66:67], v8 offset:11712
  s_waitcnt lgkmcnt(12)
  v_mfma_f32_32x32x16_bf16 v[80:95], v[72:75], v[44:47], v[80:95]
  ds_read_b64_tr_b16 v[68:69], v8 offset:27840
  ds_read_b64_tr_b16 v[70:71], v8 offset:30144
  s_waitcnt lgkmcnt(12)
  v_mfma_f32_32x32x16_bf16 v[96:111], v[76:79], v[44:47], v[96:111]
  ds_read_b64_tr_b16 v[72:73], v8 offset:9472
  ds_read_b64_tr_b16 v[74:75], v8 offset:11776
  s_waitcnt lgkmcnt(12)
  v_mfma_f32_32x32x16_bf16 v[112:127], v[48:51], v[44:47], v[112:127]
  ds_read_b64_tr_b16 v[76:77], v8 offset:27904
  ds_read_b64_tr_b16 v[78:79], v8 offset:30208
  s_waitcnt lgkmcnt(12)
  v_mfma_f32_32x32x16_bf16 v[128:143], v[52:55], v[44:47], v[128:143]
  s_waitcnt lgkmcnt(10)
  v_mfma_f32_32x32x16_bf16 v[144:159], v[56:59], v[44:47], v[144:159]
  s_waitcnt vmcnt(5) lgkmcnt(0)
  s_barrier
  ds_read_b128 v[32:35], v12 offset:0
  ds_read_b64_tr_b16 v[48:49], v9 offset:0
  ds_read_b64_tr_b16 v[50:51], v9 offset:2304
  ds_read_b64_tr_b16 v[52:53], v9 offset:18432
  ds_read_b64_tr_b16 v[54:55], v9 offset:20736
  v_mfma_f32_32x32x16_bf16 v[160:175], v[60:63], v[44:47], v[160:175]
  s_add_u32 m0, s34, 0
  s_mov_b32 s40, 3538944
  buffer_load_dwordx4 v19, s[12:15], s40 offen lds
  ds_read_b64_tr_b16 v[56:57], v9 offset:64
  ds_read_b64_tr_b16 v[58:59], v9 offset:2368
  v_mfma_f32_32x32x16_bf16 v[176:191], v[64:67], v[44:47], v[176:191]
  s_add_u32 m0, s34, 18432
  s_mov_b32 s40, 3538944
  buffer_load_dwordx4 v19, s[16:19], s40 offen lds
  ds_read_b64_tr_b16 v[60:61], v9 offset:18496
  ds_read_b64_tr_b16 v[62:63], v9 offset:20800
  v_mfma_f32_32x32x16_bf16 v[192:207], v[68:71], v[44:47], v[192:207]
  s_add_u32 m0, s34, 8192
  s_mov_b32 s40, 3538944
  buffer_load_dwordx4 v20, s[12:15], s40 offen lds
  ds_read_b64_tr_b16 v[64:65], v9 offset:128
  ds_read_b64_tr_b16 v[66:67], v9 offset:2432
  v_mfma_f32_32x32x16_bf16 v[208:223], v[72:75], v[44:47], v[208:223]
  s_add_u32 m0, s34, 26624
  s_mov_b32 s40, 3538944
  buffer_load_dwordx4 v20, s[16:19], s40 offen lds
  ds_read_b64_tr_b16 v[68:69], v9 offset:18560
  ds_read_b64_tr_b16 v[70:71], v9 offset:20864
  v_mfma_f32_32x32x16_bf16 v[224:239], v[76:79], v[44:47], v[224:239]
  s_add_u32 m0, s34, 36864
  s_mov_b32 s40, 24576
  buffer_load_dwordx4 v22, s[24:27], s40 offen sc1 lds
  ds_read_b64_tr_b16 v[72:73], v9 offset:192
  ds_read_b64_tr_b16 v[74:75], v9 offset:2496
  s_waitcnt lgkmcnt(12)
  v_mfma_f32_32x32x16_bf16 v[80:95], v[48:51], v[32:35], v[80:95]
  ds_read_b64_tr_b16 v[76:77], v9 offset:18624
  ds_read_b64_tr_b16 v[78:79], v9 offset:20928
  s_waitcnt lgkmcnt(12)
  v_mfma_f32_32x32x16_bf16 v[96:111], v[52:55], v[32:35], v[96:111]
  ds_read_b64_tr_b16 v[48:49], v9 offset:256
  ds_read_b64_tr_b16 v[50:51], v9 offset:2560
  s_waitcnt lgkmcnt(12)
  v_mfma_f32_32x32x16_bf16 v[112:127], v[56:59], v[32:35], v[112:127]
  ds_read_b64_tr_b16 v[52:53], v9 offset:18688
  ds_read_b64_tr_b16 v[54:55], v9 offset:20992
  s_waitcnt lgkmcnt(12)
  v_mfma_f32_32x32x16_bf16 v[128:143], v[60:63], v[32:35], v[128:143]
  ds_read_b128 v[36:39], v12 offset:1024
  ds_read_b64_tr_b16 v[56:57], v9 offset:9216
  ds_read_b64_tr_b16 v[58:59], v9 offset:11520
  s_waitcnt lgkmcnt(13)
  v_mfma_f32_32x32x16_bf16 v[144:159], v[64:67], v[32:35], v[144:159]
  ds_read_b64_tr_b16 v[60:61], v9 offset:27648
  ds_read_b64_tr_b16 v[62:63], v9 offset:29952
  s_waitcnt lgkmcnt(13)
  v_mfma_f32_32x32x16_bf16 v[160:175], v[68:71], v[32:35], v[160:175]
  ds_read_b64_tr_b16 v[64:65], v9 offset:9280
  ds_read_b64_tr_b16 v[66:67], v9 offset:11584
  s_waitcnt lgkmcnt(13)
  v_mfma_f32_32x32x16_bf16 v[176:191], v[72:75], v[32:35], v[176:191]
  ds_read_b64_tr_b16 v[68:69], v9 offset:27712
  ds_read_b64_tr_b16 v[70:71], v9 offset:30016
  s_waitcnt lgkmcnt(13)
  v_mfma_f32_32x32x16_bf16 v[192:207], v[76:79], v[32:35], v[192:207]
  ds_read_b64_tr_b16 v[72:73], v9 offset:9344
  ds_read_b64_tr_b16 v[74:75], v9 offset:11648
  s_waitcnt lgkmcnt(13)
  v_mfma_f32_32x32x16_bf16 v[208:223], v[48:51], v[32:35], v[208:223]
  ds_read_b64_tr_b16 v[76:77], v9 offset:27776
  ds_read_b64_tr_b16 v[78:79], v9 offset:30080
  s_waitcnt lgkmcnt(13)
  v_mfma_f32_32x32x16_bf16 v[224:239], v[52:55], v[32:35], v[224:239]
  ds_read_b64_tr_b16 v[48:49], v9 offset:9408
  ds_read_b64_tr_b16 v[50:51], v9 offset:11712
  s_waitcnt lgkmcnt(12)
  v_mfma_f32_32x32x16_bf16 v[80:95], v[56:59], v[36:39], v[80:95]
  ds_read_b64_tr_b16 v[52:53], v9 offset:27840
  ds_read_b64_tr_b16 v[54:55], v9 offset:30144
  s_waitcnt lgkmcnt(12)
  v_mfma_f32_32x32x16_bf16 v[96:111], v[60:63], v[36:39], v[96:111]
  ds_read_b64_tr_b16 v[56:57], v9 offset:9472
  ds_read_b64_tr_b16 v[58:59], v9 offset:11776
  s_waitcnt lgkmcnt(12)
  v_mfma_f32_32x32x16_bf16 v[112:127], v[64:67], v[36:39], v[112:127]
  ds_read_b64_tr_b16 v[60:61], v9 offset:27904
  ds_read_b64_tr_b16 v[62:63], v9 offset:30208
  s_waitcnt lgkmcnt(12)
  v_mfma_f32_32x32x16_bf16 v[128:143], v[68:71], v[36:39], v[128:143]
  s_waitcnt lgkmcnt(10)
  v_mfma_f32_32x32x16_bf16 v[144:159], v[72:75], v[36:39], v[144:159]
  s_waitcnt vmcnt(5) lgkmcnt(0)
  s_barrier
  ds_read_b128 v[40:43], v13 offset:0
  ds_read_b64_tr_b16 v[64:65], v10 offset:0
  ds_read_b64_tr_b16 v[66:67], v10 offset:2304
  ds_read_b64_tr_b16 v[68:69], v10 offset:18432
  ds_read_b64_tr_b16 v[70:71], v10 offset:20736
  v_mfma_f32_32x32x16_bf16 v[160:175], v[76:79], v[36:39], v[160:175]
  s_add_u32 m0, s34, 45056
  s_mov_b32 s40, 3833856
  buffer_load_dwordx4 v19, s[12:15], s40 offen lds
  ds_read_b64_tr_b16 v[72:73], v10 offset:64
  ds_read_b64_tr_b16 v[74:75], v10 offset:2368
  v_mfma_f32_32x32x16_bf16 v[176:191], v[48:51], v[36:39], v[176:191]
  s_add_u32 m0, s34, 63488
  s_mov_b32 s40, 3833856
  buffer_load_dwordx4 v19, s[16:19], s40 offen lds
  ds_read_b64_tr_b16 v[76:77], v10 offset:18496
  ds_read_b64_tr_b16 v[78:79], v10 offset:20800
  v_mfma_f32_32x32x16_bf16 v[192:207], v[52:55], v[36:39], v[192:207]
  s_add_u32 m0, s34, 53248
  s_mov_b32 s40, 3833856
  buffer_load_dwordx4 v20, s[12:15], s40 offen lds
  ds_read_b64_tr_b16 v[48:49], v10 offset:128
  ds_read_b64_tr_b16 v[50:51], v10 offset:2432
  v_mfma_f32_32x32x16_bf16 v[208:223], v[56:59], v[36:39], v[208:223]
  s_add_u32 m0, s34, 71680
  s_mov_b32 s40, 3833856
  buffer_load_dwordx4 v20, s[16:19], s40 offen lds
  ds_read_b64_tr_b16 v[52:53], v10 offset:18560
  ds_read_b64_tr_b16 v[54:55], v10 offset:20864
  v_mfma_f32_32x32x16_bf16 v[224:239], v[60:63], v[36:39], v[224:239]
  s_add_u32 m0, s34, 81920
  s_mov_b32 s40, 26624
  buffer_load_dwordx4 v22, s[24:27], s40 offen sc1 lds
  ds_read_b64_tr_b16 v[56:57], v10 offset:192
  ds_read_b64_tr_b16 v[58:59], v10 offset:2496
  s_waitcnt lgkmcnt(12)
  v_mfma_f32_32x32x16_bf16 v[80:95], v[64:67], v[40:43], v[80:95]
  ds_read_b64_tr_b16 v[60:61], v10 offset:18624
  ds_read_b64_tr_b16 v[62:63], v10 offset:20928
  s_waitcnt lgkmcnt(12)
  v_mfma_f32_32x32x16_bf16 v[96:111], v[68:71], v[40:43], v[96:111]
  ds_read_b64_tr_b16 v[64:65], v10 offset:256
  ds_read_b64_tr_b16 v[66:67], v10 offset:2560
  s_waitcnt lgkmcnt(12)
  v_mfma_f32_32x32x16_bf16 v[112:127], v[72:75], v[40:43], v[112:127]
  ds_read_b64_tr_b16 v[68:69], v10 offset:18688
  ds_read_b64_tr_b16 v[70:71], v10 offset:20992
  s_waitcnt lgkmcnt(12)
  v_mfma_f32_32x32x16_bf16 v[128:143], v[76:79], v[40:43], v[128:143]
  ds_read_b128 v[44:47], v13 offset:1024
  ds_read_b64_tr_b16 v[72:73], v10 offset:9216
  ds_read_b64_tr_b16 v[74:75], v10 offset:11520
  s_waitcnt lgkmcnt(13)
  v_mfma_f32_32x32x16_bf16 v[144:159], v[48:51], v[40:43], v[144:159]
  ds_read_b64_tr_b16 v[76:77], v10 offset:27648
  ds_read_b64_tr_b16 v[78:79], v10 offset:29952
  s_waitcnt lgkmcnt(13)
  v_mfma_f32_32x32x16_bf16 v[160:175], v[52:55], v[40:43], v[160:175]
  ds_read_b64_tr_b16 v[48:49], v10 offset:9280
  ds_read_b64_tr_b16 v[50:51], v10 offset:11584
  s_waitcnt lgkmcnt(13)
  v_mfma_f32_32x32x16_bf16 v[176:191], v[56:59], v[40:43], v[176:191]
  ds_read_b64_tr_b16 v[52:53], v10 offset:27712
  ds_read_b64_tr_b16 v[54:55], v10 offset:30016
  s_waitcnt lgkmcnt(13)
  v_mfma_f32_32x32x16_bf16 v[192:207], v[60:63], v[40:43], v[192:207]
  ds_read_b64_tr_b16 v[56:57], v10 offset:9344
  ds_read_b64_tr_b16 v[58:59], v10 offset:11648
  s_waitcnt lgkmcnt(13)
  v_mfma_f32_32x32x16_bf16 v[208:223], v[64:67], v[40:43], v[208:223]
  ds_read_b64_tr_b16 v[60:61], v10 offset:27776
  ds_read_b64_tr_b16 v[62:63], v10 offset:30080
  s_waitcnt lgkmcnt(13)
  v_mfma_f32_32x32x16_bf16 v[224:239], v[68:71], v[40:43], v[224:239]
  ds_read_b64_tr_b16 v[64:65], v10 offset:9408
  ds_read_b64_tr_b16 v[66:67], v10 offset:11712
  s_waitcnt lgkmcnt(12)
  v_mfma_f32_32x32x16_bf16 v[80:95], v[72:75], v[44:47], v[80:95]
  ds_read_b64_tr_b16 v[68:69], v10 offset:27840
  ds_read_b64_tr_b16 v[70:71], v10 offset:30144
  s_waitcnt lgkmcnt(12)
  v_mfma_f32_32x32x16_bf16 v[96:111], v[76:79], v[44:47], v[96:111]
  ds_read_b64_tr_b16 v[72:73], v10 offset:9472
  ds_read_b64_tr_b16 v[74:75], v10 offset:11776
  s_waitcnt lgkmcnt(12)
  v_mfma_f32_32x32x16_bf16 v[112:127], v[48:51], v[44:47], v[112:127]
  ds_read_b64_tr_b16 v[76:77], v10 offset:27904
  ds_read_b64_tr_b16 v[78:79], v10 offset:30208
  s_waitcnt lgkmcnt(12)
  v_mfma_f32_32x32x16_bf16 v[128:143], v[52:55], v[44:47], v[128:143]
  s_waitcnt lgkmcnt(10)
  v_mfma_f32_32x32x16_bf16 v[144:159], v[56:59], v[44:47], v[144:159]
  s_waitcnt vmcnt(5) lgkmcnt(0)
  s_barrier
  ds_read_b128 v[32:35], v11 offset:0
  ds_read_b64_tr_b16 v[48:49], v8 offset:0
  ds_read_b64_tr_b16 v[50:51], v8 offset:2304
  ds_read_b64_tr_b16 v[52:53], v8 offset:18432
  ds_read_b64_tr_b16 v[54:55], v8 offset:20736
  v_mfma_f32_32x32x16_bf16 v[160:175], v[60:63], v[44:47], v[160:175]
  s_add_u32 m0, s34, 90112
  s_mov_b32 s40, 4128768
  buffer_load_dwordx4 v19, s[12:15], s40 offen lds
  ds_read_b64_tr_b16 v[56:57], v8 offset:64
  ds_read_b64_tr_b16 v[58:59], v8 offset:2368
  v_mfma_f32_32x32x16_bf16 v[176:191], v[64:67], v[44:47], v[176:191]
  s_add_u32 m0, s34, 108544
  s_mov_b32 s40, 4128768
  buffer_load_dwordx4 v19, s[16:19], s40 offen lds
  ds_read_b64_tr_b16 v[60:61], v8 offset:18496
  ds_read_b64_tr_b16 v[62:63], v8 offset:20800
  v_mfma_f32_32x32x16_bf16 v[192:207], v[68:71], v[44:47], v[192:207]
  s_add_u32 m0, s34, 98304
  s_mov_b32 s40, 4128768
  buffer_load_dwordx4 v20, s[12:15], s40 offen lds
  ds_read_b64_tr_b16 v[64:65], v8 offset:128
  ds_read_b64_tr_b16 v[66:67], v8 offset:2432
  v_mfma_f32_32x32x16_bf16 v[208:223], v[72:75], v[44:47], v[208:223]
  s_add_u32 m0, s34, 116736
  s_mov_b32 s40, 4128768
  buffer_load_dwordx4 v20, s[16:19], s40 offen lds
  ds_read_b64_tr_b16 v[68:69], v8 offset:18560
  ds_read_b64_tr_b16 v[70:71], v8 offset:20864
  v_mfma_f32_32x32x16_bf16 v[224:239], v[76:79], v[44:47], v[224:239]
  s_add_u32 m0, s34, 126976
  s_mov_b32 s40, 28672
  buffer_load_dwordx4 v22, s[24:27], s40 offen sc1 lds
  ds_read_b64_tr_b16 v[72:73], v8 offset:192
  ds_read_b64_tr_b16 v[74:75], v8 offset:2496
  s_waitcnt lgkmcnt(12)
  v_mfma_f32_32x32x16_bf16 v[80:95], v[48:51], v[32:35], v[80:95]
  ds_read_b64_tr_b16 v[76:77], v8 offset:18624
  ds_read_b64_tr_b16 v[78:79], v8 offset:20928
  s_waitcnt lgkmcnt(12)
  v_mfma_f32_32x32x16_bf16 v[96:111], v[52:55], v[32:35], v[96:111]
  ds_read_b64_tr_b16 v[48:49], v8 offset:256
  ds_read_b64_tr_b16 v[50:51], v8 offset:2560
  s_waitcnt lgkmcnt(12)
  v_mfma_f32_32x32x16_bf16 v[112:127], v[56:59], v[32:35], v[112:127]
  ds_read_b64_tr_b16 v[52:53], v8 offset:18688
  ds_read_b64_tr_b16 v[54:55], v8 offset:20992
  s_waitcnt lgkmcnt(12)
  v_mfma_f32_32x32x16_bf16 v[128:143], v[60:63], v[32:35], v[128:143]
  ds_read_b128 v[36:39], v11 offset:1024
  ds_read_b64_tr_b16 v[56:57], v8 offset:9216
  ds_read_b64_tr_b16 v[58:59], v8 offset:11520
  s_waitcnt lgkmcnt(13)
  v_mfma_f32_32x32x16_bf16 v[144:159], v[64:67], v[32:35], v[144:159]
  ds_read_b64_tr_b16 v[60:61], v8 offset:27648
  ds_read_b64_tr_b16 v[62:63], v8 offset:29952
  s_waitcnt lgkmcnt(13)
  v_mfma_f32_32x32x16_bf16 v[160:175], v[68:71], v[32:35], v[160:175]
  ds_read_b64_tr_b16 v[64:65], v8 offset:9280
  ds_read_b64_tr_b16 v[66:67], v8 offset:11584
  s_waitcnt lgkmcnt(13)
  v_mfma_f32_32x32x16_bf16 v[176:191], v[72:75], v[32:35], v[176:191]
  ds_read_b64_tr_b16 v[68:69], v8 offset:27712
  ds_read_b64_tr_b16 v[70:71], v8 offset:30016
  s_waitcnt lgkmcnt(13)
  v_mfma_f32_32x32x16_bf16 v[192:207], v[76:79], v[32:35], v[192:207]
  ds_read_b64_tr_b16 v[72:73], v8 offset:9344
  ds_read_b64_tr_b16 v[74:75], v8 offset:11648
  s_waitcnt lgkmcnt(13)
  v_mfma_f32_32x32x16_bf16 v[208:223], v[48:51], v[32:35], v[208:223]
  ds_read_b64_tr_b16 v[76:77], v8 offset:27776
  ds_read_b64_tr_b16 v[78:79], v8 offset:30080
  s_waitcnt lgkmcnt(13)
  v_mfma_f32_32x32x16_bf16 v[224:239], v[52:55], v[32:35], v[224:239]
  ds_read_b64_tr_b16 v[48:49], v8 offset:9408
  ds_read_b64_tr_b16 v[50:51], v8 offset:11712
  s_waitcnt lgkmcnt(12)
  v_mfma_f32_32x32x16_bf16 v[80:95], v[56:59], v[36:39], v[80:95]
  ds_read_b64_tr_b16 v[52:53], v8 offset:27840
  ds_read_b64_tr_b16 v[54:55], v8 offset:30144
  s_waitcnt lgkmcnt(12)
  v_mfma_f32_32x32x16_bf16 v[96:111], v[60:63], v[36:39], v[96:111]
  ds_read_b64_tr_b16 v[56:57], v8 offset:9472
  ds_read_b64_tr_b16 v[58:59], v8 offset:11776
  s_waitcnt lgkmcnt(12)
  v_mfma_f32_32x32x16_bf16 v[112:127], v[64:67], v[36:39], v[112:127]
  ds_read_b64_tr_b16 v[60:61], v8 offset:27904
  ds_read_b64_tr_b16 v[62:63], v8 offset:30208
  s_waitcnt lgkmcnt(12)
  v_mfma_f32_32x32x16_bf16 v[128:143], v[68:71], v[36:39], v[128:143]
  s_waitcnt lgkmcnt(10)
  v_mfma_f32_32x32x16_bf16 v[144:159], v[72:75], v[36:39], v[144:159]
  s_waitcnt vmcnt(5) lgkmcnt(0)
  s_barrier
  ds_read_b128 v[40:43], v12 offset:0
  ds_read_b64_tr_b16 v[64:65], v9 offset:0
  ds_read_b64_tr_b16 v[66:67], v9 offset:2304
  ds_read_b64_tr_b16 v[68:69], v9 offset:18432
  ds_read_b64_tr_b16 v[70:71], v9 offset:20736
  v_mfma_f32_32x32x16_bf16 v[160:175], v[76:79], v[36:39], v[160:175]
  s_add_u32 m0, s34, 0
  s_mov_b32 s40, 4423680
  buffer_load_dwordx4 v19, s[12:15], s40 offen lds
  ds_read_b64_tr_b16 v[72:73], v9 offset:64
  ds_read_b64_tr_b16 v[74:75], v9 offset:2368
  v_mfma_f32_32x32x16_bf16 v[176:191], v[48:51], v[36:39], v[176:191]
  s_add_u32 m0, s34, 18432
  s_mov_b32 s40, 4423680
  buffer_load_dwordx4 v19, s[16:19], s40 offen lds
  ds_read_b64_tr_b16 v[76:77], v9 offset:18496
  ds_read_b64_tr_b16 v[78:79], v9 offset:20800
  v_mfma_f32_32x32x16_bf16 v[192:207], v[52:55], v[36:39], v[192:207]
  s_add_u32 m0, s34, 8192
  s_mov_b32 s40, 4423680
  buffer_load_dwordx4 v20, s[12:15], s40 offen lds
  ds_read_b64_tr_b16 v[48:49], v9 offset:128
  ds_read_b64_tr_b16 v[50:51], v9 offset:2432
  v_mfma_f32_32x32x16_bf16 v[208:223], v[56:59], v[36:39], v[208:223]
  s_add_u32 m0, s34, 26624
  s_mov_b32 s40, 4423680
  buffer_load_dwordx4 v20, s[16:19], s40 offen lds
  ds_read_b64_tr_b16 v[52:53], v9 offset:18560
  ds_read_b64_tr_b16 v[54:55], v9 offset:20864
  v_mfma_f32_32x32x16_bf16 v[224:239], v[60:63], v[36:39], v[224:239]
  s_add_u32 m0, s34, 36864
  s_mov_b32 s40, 30720
  buffer_load_dwordx4 v22, s[24:27], s40 offen sc1 lds
  ds_read_b64_tr_b16 v[56:57], v9 offset:192
  ds_read_b64_tr_b16 v[58:59], v9 offset:2496
  s_waitcnt lgkmcnt(12)
  v_mfma_f32_32x32x16_bf16 v[80:95], v[64:67], v[40:43], v[80:95]
  ds_read_b64_tr_b16 v[60:61], v9 offset:18624
  ds_read_b64_tr_b16 v[62:63], v9 offset:20928
  s_waitcnt lgkmcnt(12)
  v_mfma_f32_32x32x16_bf16 v[96:111], v[68:71], v[40:43], v[96:111]
  ds_read_b64_tr_b16 v[64:65], v9 offset:256
  ds_read_b64_tr_b16 v[66:67], v9 offset:2560
  s_waitcnt lgkmcnt(12)
  v_mfma_f32_32x32x16_bf16 v[112:127], v[72:75], v[40:43], v[112:127]
  ds_read_b64_tr_b16 v[68:69], v9 offset:18688
  ds_read_b64_tr_b16 v[70:71], v9 offset:20992
  s_waitcnt lgkmcnt(12)
  v_mfma_f32_32x32x16_bf16 v[128:143], v[76:79], v[40:43], v[128:143]
  ds_read_b128 v[44:47], v12 offset:1024
  ds_read_b64_tr_b16 v[72:73], v9 offset:9216
  ds_read_b64_tr_b16 v[74:75], v9 offset:11520
  s_waitcnt lgkmcnt(13)
  v_mfma_f32_32x32x16_bf16 v[144:159], v[48:51], v[40:43], v[144:159]
  ds_read_b64_tr_b16 v[76:77], v9 offset:27648
  ds_read_b64_tr_b16 v[78:79], v9 offset:29952
  s_waitcnt lgkmcnt(13)
  v_mfma_f32_32x32x16_bf16 v[160:175], v[52:55], v[40:43], v[160:175]
  ds_read_b64_tr_b16 v[48:49], v9 offset:9280
  ds_read_b64_tr_b16 v[50:51], v9 offset:11584
  s_waitcnt lgkmcnt(13)
  v_mfma_f32_32x32x16_bf16 v[176:191], v[56:59], v[40:43], v[176:191]
  ds_read_b64_tr_b16 v[52:53], v9 offset:27712
  ds_read_b64_tr_b16 v[54:55], v9 offset:30016
  s_waitcnt lgkmcnt(13)
  v_mfma_f32_32x32x16_bf16 v[192:207], v[60:63], v[40:43], v[192:207]
  ds_read_b64_tr_b16 v[56:57], v9 offset:9344
  ds_read_b64_tr_b16 v[58:59], v9 offset:11648
  s_waitcnt lgkmcnt(13)
  v_mfma_f32_32x32x16_bf16 v[208:223], v[64:67], v[40:43], v[208:223]
  ds_read_b64_tr_b16 v[60:61], v9 offset:27776
  ds_read_b64_tr_b16 v[62:63], v9 offset:30080
  s_waitcnt lgkmcnt(13)
  v_mfma_f32_32x32x16_bf16 v[224:239], v[68:71], v[40:43], v[224:239]
  ds_read_b64_tr_b16 v[64:65], v9 offset:9408
  ds_read_b64_tr_b16 v[66:67], v9 offset:11712
  s_waitcnt lgkmcnt(12)
  v_mfma_f32_32x32x16_bf16 v[80:95], v[72:75], v[44:47], v[80:95]
  ds_read_b64_tr_b16 v[68:69], v9 offset:27840
  ds_read_b64_tr_b16 v[70:71], v9 offset:30144
  s_waitcnt lgkmcnt(12)
  v_mfma_f32_32x32x16_bf16 v[96:111], v[76:79], v[44:47], v[96:111]
  ds_read_b64_tr_b16 v[72:73], v9 offset:9472
  ds_read_b64_tr_b16 v[74:75], v9 offset:11776
  s_waitcnt lgkmcnt(12)
  v_mfma_f32_32x32x16_bf16 v[112:127], v[48:51], v[44:47], v[112:127]
  ds_read_b64_tr_b16 v[76:77], v9 offset:27904
  ds_read_b64_tr_b16 v[78:79], v9 offset:30208
  s_waitcnt lgkmcnt(12)
  v_mfma_f32_32x32x16_bf16 v[128:143], v[52:55], v[44:47], v[128:143]
  s_waitcnt lgkmcnt(10)
  v_mfma_f32_32x32x16_bf16 v[144:159], v[56:59], v[44:47], v[144:159]
  s_waitcnt vmcnt(5) lgkmcnt(0)
  s_barrier
  ds_read_b128 v[32:35], v13 offset:0
  ds_read_b64_tr_b16 v[48:49], v10 offset:0
  ds_read_b64_tr_b16 v[50:51], v10 offset:2304
  ds_read_b64_tr_b16 v[52:53], v10 offset:18432
  ds_read_b64_tr_b16 v[54:55], v10 offset:20736
  v_mfma_f32_32x32x16_bf16 v[160:175], v[60:63], v[44:47], v[160:175]
  s_add_u32 m0, s34, 45056
  s_mov_b32 s40, 4718592
  buffer_load_dwordx4 v19, s[12:15], s40 offen lds
  ds_read_b64_tr_b16 v[56:57], v10 offset:64
  ds_read_b64_tr_b16 v[58:59], v10 offset:2368
  v_mfma_f32_32x32x16_bf16 v[176:191], v[64:67], v[44:47], v[176:191]
  s_add_u32 m0, s34, 63488
  s_mov_b32 s40, 4718592
  buffer_load_dwordx4 v19, s[16:19], s40 offen lds
  ds_read_b64_tr_b16 v[60:61], v10 offset:18496
  ds_read_b64_tr_b16 v[62:63], v10 offset:20800
  v_mfma_f32_32x32x16_bf16 v[192:207], v[68:71], v[44:47], v[192:207]
  s_add_u32 m0, s34, 53248
  s_mov_b32 s40, 4718592
  buffer_load_dwordx4 v20, s[12:15], s40 offen lds
  ds_read_b64_tr_b16 v[64:65], v10 offset:128
  ds_read_b64_tr_b16 v[66:67], v10 offset:2432
  v_mfma_f32_32x32x16_bf16 v[208:223], v[72:75], v[44:47], v[208:223]
  s_add_u32 m0, s34, 71680
  s_mov_b32 s40, 4718592
  buffer_load_dwordx4 v20, s[16:19], s40 offen lds
  ds_read_b64_tr_b16 v[68:69], v10 offset:18560
  ds_read_b64_tr_b16 v[70:71], v10 offset:20864
  v_mfma_f32_32x32x16_bf16 v[224:239], v[76:79], v[44:47], v[224:239]
  s_add_u32 m0, s34, 81920
  s_mov_b32 s40, 32768
  buffer_load_dwordx4 v22, s[24:27], s40 offen sc1 lds
  ds_read_b64_tr_b16 v[72:73], v10 offset:192
  ds_read_b64_tr_b16 v[74:75], v10 offset:2496
  s_waitcnt lgkmcnt(12)
  v_mfma_f32_32x32x16_bf16 v[80:95], v[48:51], v[32:35], v[80:95]
  ds_read_b64_tr_b16 v[76:77], v10 offset:18624
  ds_read_b64_tr_b16 v[78:79], v10 offset:20928
  s_waitcnt lgkmcnt(12)
  v_mfma_f32_32x32x16_bf16 v[96:111], v[52:55], v[32:35], v[96:111]
  ds_read_b64_tr_b16 v[48:49], v10 offset:256
  ds_read_b64_tr_b16 v[50:51], v10 offset:2560
  s_waitcnt lgkmcnt(12)
  v_mfma_f32_32x32x16_bf16 v[112:127], v[56:59], v[32:35], v[112:127]
  ds_read_b64_tr_b16 v[52:53], v10 offset:18688
  ds_read_b64_tr_b16 v[54:55], v10 offset:20992
  s_waitcnt lgkmcnt(12)
  v_mfma_f32_32x32x16_bf16 v[128:143], v[60:63], v[32:35], v[128:143]
  ds_read_b128 v[36:39], v13 offset:1024
  ds_read_b64_tr_b16 v[56:57], v10 offset:9216
  ds_read_b64_tr_b16 v[58:59], v10 offset:11520
  s_waitcnt lgkmcnt(13)
  v_mfma_f32_32x32x16_bf16 v[144:159], v[64:67], v[32:35], v[144:159]
  ds_read_b64_tr_b16 v[60:61], v10 offset:27648
  ds_read_b64_tr_b16 v[62:63], v10 offset:29952
  s_waitcnt lgkmcnt(13)
  v_mfma_f32_32x32x16_bf16 v[160:175], v[68:71], v[32:35], v[160:175]
  ds_read_b64_tr_b16 v[64:65], v10 offset:9280
  ds_read_b64_tr_b16 v[66:67], v10 offset:11584
  s_waitcnt lgkmcnt(13)
  v_mfma_f32_32x32x16_bf16 v[176:191], v[72:75], v[32:35], v[176:191]
  ds_read_b64_tr_b16 v[68:69], v10 offset:27712
  ds_read_b64_tr_b16 v[70:71], v10 offset:30016
  s_waitcnt lgkmcnt(13)
  v_mfma_f32_32x32x16_bf16 v[192:207], v[76:79], v[32:35], v[192:207]
  ds_read_b64_tr_b16 v[72:73], v10 offset:9344
  ds_read_b64_tr_b16 v[74:75], v10 offset:11648
  s_waitcnt lgkmcnt(13)
  v_mfma_f32_32x32x16_bf16 v[208:223], v[48:51], v[32:35], v[208:223]
  ds_read_b64_tr_b16 v[76:77], v10 offset:27776
  ds_read_b64_tr_b16 v[78:79], v10 offset:30080
  s_waitcnt lgkmcnt(13)
  v_mfma_f32_32x32x16_bf16 v[224:239], v[52:55], v[32:35], v[224:239]
  ds_read_b64_tr_b16 v[48:49], v10 offset:9408
  ds_read_b64_tr_b16 v[50:51], v10 offset:11712
  s_waitcnt lgkmcnt(12)
  v_mfma_f32_32x32x16_bf16 v[80:95], v[56:59], v[36:39], v[80:95]
  ds_read_b64_tr_b16 v[52:53], v10 offset:27840
  ds_read_b64_tr_b16 v[54:55], v10 offset:30144
  s_waitcnt lgkmcnt(12)
  v_mfma_f32_32x32x16_bf16 v[96:111], v[60:63], v[36:39], v[96:111]
  ds_read_b64_tr_b16 v[56:57], v10 offset:9472
  ds_read_b64_tr_b16 v[58:59], v10 offset:11776
  s_waitcnt lgkmcnt(12)
  v_mfma_f32_32x32x16_bf16 v[112:127], v[64:67], v[36:39], v[112:127]
  ds_read_b64_tr_b16 v[60:61], v10 offset:27904
  ds_read_b64_tr_b16 v[62:63], v10 offset:30208
  s_waitcnt lgkmcnt(12)
  v_mfma_f32_32x32x16_bf16 v[128:143], v[68:71], v[36:39], v[128:143]
  s_waitcnt lgkmcnt(10)
  v_mfma_f32_32x32x16_bf16 v[144:159], v[72:75], v[36:39], v[144:159]
  s_waitcnt vmcnt(5) lgkmcnt(0)
  s_barrier
  ds_read_b128 v[40:43], v11 offset:0
  ds_read_b64_tr_b16 v[64:65], v8 offset:0
  ds_read_b64_tr_b16 v[66:67], v8 offset:2304
  ds_read_b64_tr_b16 v[68:69], v8 offset:18432
  ds_read_b64_tr_b16 v[70:71], v8 offset:20736
  v_mfma_f32_32x32x16_bf16 v[160:175], v[76:79], v[36:39], v[160:175]
  s_add_u32 m0, s34, 90112
  s_mov_b32 s40, 5013504
  buffer_load_dwordx4 v19, s[12:15], s40 offen lds
  ds_read_b64_tr_b16 v[72:73], v8 offset:64
  ds_read_b64_tr_b16 v[74:75], v8 offset:2368
  v_mfma_f32_32x32x16_bf16 v[176:191], v[48:51], v[36:39], v[176:191]
  s_add_u32 m0, s34, 108544
  s_mov_b32 s40, 5013504
  buffer_load_dwordx4 v19, s[16:19], s40 offen lds
  ds_read_b64_tr_b16 v[76:77], v8 offset:18496
  ds_read_b64_tr_b16 v[78:79], v8 offset:20800
  v_mfma_f32_32x32x16_bf16 v[192:207], v[52:55], v[36:39], v[192:207]
  s_add_u32 m0, s34, 98304
  s_mov_b32 s40, 5013504
  buffer_load_dwordx4 v20, s[12:15], s40 offen lds
  ds_read_b64_tr_b16 v[48:49], v8 offset:128
  ds_read_b64_tr_b16 v[50:51], v8 offset:2432
  v_mfma_f32_32x32x16_bf16 v[208:223], v[56:59], v[36:39], v[208:223]
  s_add_u32 m0, s34, 116736
  s_mov_b32 s40, 5013504
  buffer_load_dwordx4 v20, s[16:19], s40 offen lds
  ds_read_b64_tr_b16 v[52:53], v8 offset:18560
  ds_read_b64_tr_b16 v[54:55], v8 offset:20864
  v_mfma_f32_32x32x16_bf16 v[224:239], v[60:63], v[36:39], v[224:239]
  s_add_u32 m0, s34, 126976
  s_mov_b32 s40, 34816
  buffer_load_dwordx4 v22, s[24:27], s40 offen sc1 lds
  ds_read_b64_tr_b16 v[56:57], v8 offset:192
  ds_read_b64_tr_b16 v[58:59], v8 offset:2496
  s_waitcnt lgkmcnt(12)
  v_mfma_f32_32x32x16_bf16 v[80:95], v[64:67], v[40:43], v[80:95]
  ds_read_b64_tr_b16 v[60:61], v8 offset:18624
  ds_read_b64_tr_b16 v[62:63], v8 offset:20928
  s_waitcnt lgkmcnt(12)
  v_mfma_f32_32x32x16_bf16 v[96:111], v[68:71], v[40:43], v[96:111]
  ds_read_b64_tr_b16 v[64:65], v8 offset:256
  ds_read_b64_tr_b16 v[66:67], v8 offset:2560
  s_waitcnt lgkmcnt(12)
  v_mfma_f32_32x32x16_bf16 v[112:127], v[72:75], v[40:43], v[112:127]
  ds_read_b64_tr_b16 v[68:69], v8 offset:18688
  ds_read_b64_tr_b16 v[70:71], v8 offset:20992
  s_waitcnt lgkmcnt(12)
  v_mfma_f32_32x32x16_bf16 v[128:143], v[76:79], v[40:43], v[128:143]
  ds_read_b128 v[44:47], v11 offset:1024
  ds_read_b64_tr_b16 v[72:73], v8 offset:9216
  ds_read_b64_tr_b16 v[74:75], v8 offset:11520
  s_waitcnt lgkmcnt(13)
  v_mfma_f32_32x32x16_bf16 v[144:159], v[48:51], v[40:43], v[144:159]
  ds_read_b64_tr_b16 v[76:77], v8 offset:27648
  ds_read_b64_tr_b16 v[78:79], v8 offset:29952
  s_waitcnt lgkmcnt(13)
  v_mfma_f32_32x32x16_bf16 v[160:175], v[52:55], v[40:43], v[160:175]
  ds_read_b64_tr_b16 v[48:49], v8 offset:9280
  ds_read_b64_tr_b16 v[50:51], v8 offset:11584
  s_waitcnt lgkmcnt(13)
  v_mfma_f32_32x32x16_bf16 v[176:191], v[56:59], v[40:43], v[176:191]
  ds_read_b64_tr_b16 v[52:53], v8 offset:27712
  ds_read_b64_tr_b16 v[54:55], v8 offset:30016
  s_waitcnt lgkmcnt(13)
  v_mfma_f32_32x32x16_bf16 v[192:207], v[60:63], v[40:43], v[192:207]
  ds_read_b64_tr_b16 v[56:57], v8 offset:9344
  ds_read_b64_tr_b16 v[58:59], v8 offset:11648
  s_waitcnt lgkmcnt(13)
  v_mfma_f32_32x32x16_bf16 v[208:223], v[64:67], v[40:43], v[208:223]
  ds_read_b64_tr_b16 v[60:61], v8 offset:27776
  ds_read_b64_tr_b16 v[62:63], v8 offset:30080
  s_waitcnt lgkmcnt(13)
  v_mfma_f32_32x32x16_bf16 v[224:239], v[68:71], v[40:43], v[224:239]
  ds_read_b64_tr_b16 v[64:65], v8 offset:9408
  ds_read_b64_tr_b16 v[66:67], v8 offset:11712
  s_waitcnt lgkmcnt(12)
  v_mfma_f32_32x32x16_bf16 v[80:95], v[72:75], v[44:47], v[80:95]
  ds_read_b64_tr_b16 v[68:69], v8 offset:27840
  ds_read_b64_tr_b16 v[70:71], v8 offset:30144
  s_waitcnt lgkmcnt(12)
  v_mfma_f32_32x32x16_bf16 v[96:111], v[76:79], v[44:47], v[96:111]
  ds_read_b64_tr_b16 v[72:73], v8 offset:9472
  ds_read_b64_tr_b16 v[74:75], v8 offset:11776
  s_waitcnt lgkmcnt(12)
  v_mfma_f32_32x32x16_bf16 v[112:127], v[48:51], v[44:47], v[112:127]
  ds_read_b64_tr_b16 v[76:77], v8 offset:27904
  ds_read_b64_tr_b16 v[78:79], v8 offset:30208
  s_waitcnt lgkmcnt(12)
  v_mfma_f32_32x32x16_bf16 v[128:143], v[52:55], v[44:47], v[128:143]
  s_waitcnt lgkmcnt(10)
  v_mfma_f32_32x32x16_bf16 v[144:159], v[56:59], v[44:47], v[144:159]
  s_waitcnt vmcnt(5) lgkmcnt(0)
  s_barrier
  ds_read_b128 v[32:35], v12 offset:0
  ds_read_b64_tr_b16 v[48:49], v9 offset:0
  ds_read_b64_tr_b16 v[50:51], v9 offset:2304
  ds_read_b64_tr_b16 v[52:53], v9 offset:18432
  ds_read_b64_tr_b16 v[54:55], v9 offset:20736
  v_mfma_f32_32x32x16_bf16 v[160:175], v[60:63], v[44:47], v[160:175]
  s_add_u32 m0, s34, 0
  s_mov_b32 s40, 0
  buffer_load_dwordx4 v23, s[20:23], s40 offen lds
  ds_read_b64_tr_b16 v[56:57], v9 offset:64
  ds_read_b64_tr_b16 v[58:59], v9 offset:2368
  v_mfma_f32_32x32x16_bf16 v[176:191], v[64:67], v[44:47], v[176:191]
  s_add_u32 m0, s34, 8192
  s_mov_b32 s40, 73728
  buffer_load_dwordx4 v23, s[20:23], s40 offen lds
  ds_read_b64_tr_b16 v[60:61], v9 offset:18496
  ds_read_b64_tr_b16 v[62:63], v9 offset:20800
  v_mfma_f32_32x32x16_bf16 v[192:207], v[68:71], v[44:47], v[192:207]
  s_add_u32 m0, s34, 16384
  s_mov_b32 s40, 147456
  buffer_load_dwordx4 v23, s[20:23], s40 offen lds
  ds_read_b64_tr_b16 v[64:65], v9 offset:128
  ds_read_b64_tr_b16 v[66:67], v9 offset:2432
  v_mfma_f32_32x32x16_bf16 v[208:223], v[72:75], v[44:47], v[208:223]
  s_add_u32 m0, s34, 24576
  s_mov_b32 s40, 221184
  buffer_load_dwordx4 v23, s[20:23], s40 offen lds
  ds_read_b64_tr_b16 v[68:69], v9 offset:18560
  ds_read_b64_tr_b16 v[70:71], v9 offset:20864
  v_mfma_f32_32x32x16_bf16 v[224:239], v[76:79], v[44:47], v[224:239]
  s_add_u32 m0, s34, 32768
  s_mov_b32 s40, 294912
  buffer_load_dwordx4 v23, s[20:23], s40 offen lds
  ds_read_b64_tr_b16 v[72:73], v9 offset:192
  ds_read_b64_tr_b16 v[74:75], v9 offset:2496
  s_waitcnt lgkmcnt(12)
  v_mfma_f32_32x32x16_bf16 v[80:95], v[48:51], v[32:35], v[80:95]
  ds_read_b64_tr_b16 v[76:77], v9 offset:18624
  ds_read_b64_tr_b16 v[78:79], v9 offset:20928
  s_waitcnt lgkmcnt(12)
  v_mfma_f32_32x32x16_bf16 v[96:111], v[52:55], v[32:35], v[96:111]
  ds_read_b64_tr_b16 v[48:49], v9 offset:256
  ds_read_b64_tr_b16 v[50:51], v9 offset:2560
  s_waitcnt lgkmcnt(12)
  v_mfma_f32_32x32x16_bf16 v[112:127], v[56:59], v[32:35], v[112:127]
  ds_read_b64_tr_b16 v[52:53], v9 offset:18688
  ds_read_b64_tr_b16 v[54:55], v9 offset:20992
  s_waitcnt lgkmcnt(12)
  v_mfma_f32_32x32x16_bf16 v[128:143], v[60:63], v[32:35], v[128:143]
  ds_read_b128 v[36:39], v12 offset:1024
  ds_read_b64_tr_b16 v[56:57], v9 offset:9216
  ds_read_b64_tr_b16 v[58:59], v9 offset:11520
  s_waitcnt lgkmcnt(13)
  v_mfma_f32_32x32x16_bf16 v[144:159], v[64:67], v[32:35], v[144:159]
  ds_read_b64_tr_b16 v[60:61], v9 offset:27648
  ds_read_b64_tr_b16 v[62:63], v9 offset:29952
  s_waitcnt lgkmcnt(13)
  v_mfma_f32_32x32x16_bf16 v[160:175], v[68:71], v[32:35], v[160:175]
  ds_read_b64_tr_b16 v[64:65], v9 offset:9280
  ds_read_b64_tr_b16 v[66:67], v9 offset:11584
  s_waitcnt lgkmcnt(13)
  v_mfma_f32_32x32x16_bf16 v[176:191], v[72:75], v[32:35], v[176:191]
  ds_read_b64_tr_b16 v[68:69], v9 offset:27712
  ds_read_b64_tr_b16 v[70:71], v9 offset:30016
  s_waitcnt lgkmcnt(13)
  v_mfma_f32_32x32x16_bf16 v[192:207], v[76:79], v[32:35], v[192:207]
  ds_read_b64_tr_b16 v[72:73], v9 offset:9344
  ds_read_b64_tr_b16 v[74:75], v9 offset:11648
  s_waitcnt lgkmcnt(13)
  v_mfma_f32_32x32x16_bf16 v[208:223], v[48:51], v[32:35], v[208:223]
  ds_read_b64_tr_b16 v[76:77], v9 offset:27776
  ds_read_b64_tr_b16 v[78:79], v9 offset:30080
  s_waitcnt lgkmcnt(13)
  v_mfma_f32_32x32x16_bf16 v[224:239], v[52:55], v[32:35], v[224:239]
  ds_read_b64_tr_b16 v[48:49], v9 offset:9408
  ds_read_b64_tr_b16 v[50:51], v9 offset:11712
  s_waitcnt lgkmcnt(12)
  v_mfma_f32_32x32x16_bf16 v[80:95], v[56:59], v[36:39], v[80:95]
  ds_read_b64_tr_b16 v[52:53], v9 offset:27840
  ds_read_b64_tr_b16 v[54:55], v9 offset:30144
  s_waitcnt lgkmcnt(12)
  v_mfma_f32_32x32x16_bf16 v[96:111], v[60:63], v[36:39], v[96:111]
  ds_read_b64_tr_b16 v[56:57], v9 offset:9472
  ds_read_b64_tr_b16 v[58:59], v9 offset:11776
  s_waitcnt lgkmcnt(12)
  v_mfma_f32_32x32x16_bf16 v[112:127], v[64:67], v[36:39], v[112:127]
  ds_read_b64_tr_b16 v[60:61], v9 offset:27904
  ds_read_b64_tr_b16 v[62:63], v9 offset:30208
  s_waitcnt lgkmcnt(12)
  v_mfma_f32_32x32x16_bf16 v[128:143], v[68:71], v[36:39], v[128:143]
  s_waitcnt lgkmcnt(10)
  v_mfma_f32_32x32x16_bf16 v[144:159], v[72:75], v[36:39], v[144:159]
  s_waitcnt vmcnt(5) lgkmcnt(0)
  s_barrier
  ds_read_b128 v[40:43], v13 offset:0
  ds_read_b64_tr_b16 v[64:65], v10 offset:0
  ds_read_b64_tr_b16 v[66:67], v10 offset:2304
  ds_read_b128 v[44:47], v13 offset:1024
  ds_read_b64_tr_b16 v[68:69], v10 offset:9216
  ds_read_b64_tr_b16 v[70:71], v10 offset:11520
  v_mfma_f32_32x32x16_bf16 v[160:175], v[76:79], v[36:39], v[160:175]
  s_add_u32 m0, s34, 36864
  s_mov_b32 s40, 128
  buffer_load_dwordx4 v23, s[20:23], s40 offen lds
  ds_read_b64_tr_b16 v[72:73], v10 offset:18432
  ds_read_b64_tr_b16 v[74:75], v10 offset:20736
  v_mfma_f32_32x32x16_bf16 v[176:191], v[48:51], v[36:39], v[176:191]
  s_add_u32 m0, s34, 45056
  s_mov_b32 s40, 73856
  buffer_load_dwordx4 v23, s[20:23], s40 offen lds
  ds_read_b64_tr_b16 v[76:77], v10 offset:27648
  ds_read_b64_tr_b16 v[78:79], v10 offset:29952
  v_mfma_f32_32x32x16_bf16 v[192:207], v[52:55], v[36:39], v[192:207]
  s_add_u32 m0, s34, 53248
  s_mov_b32 s40, 147584
  buffer_load_dwordx4 v23, s[20:23], s40 offen lds
  ds_read_b64_tr_b16 v[48:49], v10 offset:64
  ds_read_b64_tr_b16 v[50:51], v10 offset:2368
  v_mfma_f32_32x32x16_bf16 v[208:223], v[56:59], v[36:39], v[208:223]
  s_add_u32 m0, s34, 61440
  s_mov_b32 s40, 221312
  buffer_load_dwordx4 v23, s[20:23], s40 offen lds
  ds_read_b64_tr_b16 v[52:53], v10 offset:9280
  ds_read_b64_tr_b16 v[54:55], v10 offset:11584
  v_mfma_f32_32x32x16_bf16 v[224:239], v[60:63], v[36:39], v[224:239]
  s_add_u32 m0, s34, 69632
  s_mov_b32 s40, 295040
  buffer_load_dwordx4 v23, s[20:23], s40 offen lds
  ds_read_b64_tr_b16 v[56:57], v10 offset:18496
  ds_read_b64_tr_b16 v[58:59], v10 offset:20800
  s_waitcnt lgkmcnt(13)
  v_mfma_f32_32x32x16_bf16 v[80:95], v[64:67], v[40:43], v[80:95]
  ds_read_b64_tr_b16 v[60:61], v10 offset:27712
  ds_read_b64_tr_b16 v[62:63], v10 offset:30016
  s_waitcnt lgkmcnt(12)
  v_mfma_f32_32x32x16_bf16 v[80:95], v[68:71], v[44:47], v[80:95]
  ds_read_b64_tr_b16 v[64:65], v10 offset:128
  ds_read_b64_tr_b16 v[66:67], v10 offset:2432
  s_waitcnt lgkmcnt(12)
  v_mfma_f32_32x32x16_bf16 v[96:111], v[72:75], v[40:43], v[96:111]
  ds_read_b64_tr_b16 v[68:69], v10 offset:9344
  ds_read_b64_tr_b16 v[70:71], v10 offset:11648
  s_waitcnt lgkmcnt(12)
  v_mfma_f32_32x32x16_bf16 v[96:111], v[76:79], v[44:47], v[96:111]
  ds_read_b64_tr_b16 v[72:73], v10 offset:18560
  ds_read_b64_tr_b16 v[74:75], v10 offset:20864
  s_waitcnt lgkmcnt(12)
  v_mfma_f32_32x32x16_bf16 v[112:127], v[48:51], v[40:43], v[112:127]
  ds_read_b64_tr_b16 v[76:77], v10 offset:27776
  ds_read_b64_tr_b16 v[78:79], v10 offset:30080
  s_waitcnt lgkmcnt(12)
  v_mfma_f32_32x32x16_bf16 v[112:127], v[52:55], v[44:47], v[112:127]
  s_nop 3
  v_mul_f32 v80, v80, v96
  v_mul_f32 v81, v81, v97
  v_mul_f32 v82, v82, v98
  v_mul_f32 v83, v83, v99
  v_mul_f32 v84, v84, v100
  v_mul_f32 v85, v85, v101
  ds_read_b64_tr_b16 v[48:49], v10 offset:192
  ds_read_b64_tr_b16 v[50:51], v10 offset:2496
  s_waitcnt lgkmcnt(12)
  v_mfma_f32_32x32x16_bf16 v[128:143], v[56:59], v[40:43], v[128:143]
  v_mul_f32 v86, v86, v102
  v_mul_f32 v87, v87, v103
  v_mul_f32 v88, v88, v104
  v_mul_f32 v89, v89, v105
  v_mul_f32 v90, v90, v106
  v_mul_f32 v91, v91, v107
  ds_read_b64_tr_b16 v[52:53], v10 offset:9408
  ds_read_b64_tr_b16 v[54:55], v10 offset:11712
  s_waitcnt lgkmcnt(12)
  v_mfma_f32_32x32x16_bf16 v[128:143], v[60:63], v[44:47], v[128:143]
  v_mul_f32 v92, v92, v108
  v_mul_f32 v93, v93, v109
  v_mul_f32 v94, v94, v110
  v_mul_f32 v95, v95, v111
  v_cvt_pk_bf16_f32 v96, v80, v81
  v_cvt_pk_bf16_f32 v97, v82, v83
  ds_read_b64_tr_b16 v[56:57], v10 offset:18624
  ds_read_b64_tr_b16 v[58:59], v10 offset:20928
  s_waitcnt lgkmcnt(12)
  v_mfma_f32_32x32x16_bf16 v[144:159], v[64:67], v[40:43], v[144:159]
  v_cvt_pk_bf16_f32 v98, v84, v85
  v_cvt_pk_bf16_f32 v99, v86, v87
  v_cvt_pk_bf16_f32 v100, v88, v89
  v_cvt_pk_bf16_f32 v101, v90, v91
  v_cvt_pk_bf16_f32 v102, v92, v93
  v_cvt_pk_bf16_f32 v103, v94, v95
  ds_read_b64_tr_b16 v[60:61], v10 offset:27840
  ds_read_b64_tr_b16 v[62:63], v10 offset:30144
  s_waitcnt lgkmcnt(12)
  v_mfma_f32_32x32x16_bf16 v[144:159], v[68:71], v[44:47], v[144:159]
  v_mul_f32 v112, v112, v128
  v_mul_f32 v113, v113, v129
  v_mul_f32 v114, v114, v130
  v_mul_f32 v115, v115, v131
  v_mul_f32 v116, v116, v132
  v_mul_f32 v117, v117, v133
  ds_read_b64_tr_b16 v[64:65], v10 offset:256
  ds_read_b64_tr_b16 v[66:67], v10 offset:2560
  s_waitcnt lgkmcnt(12)
  v_mfma_f32_32x32x16_bf16 v[160:175], v[72:75], v[40:43], v[160:175]
  v_mul_f32 v118, v118, v134
  v_mul_f32 v119, v119, v135
  v_mul_f32 v120, v120, v136
  v_mul_f32 v121, v121, v137
  v_mul_f32 v122, v122, v138
  v_mul_f32 v123, v123, v139
  ds_read_b64_tr_b16 v[68:69], v10 offset:9472
  ds_read_b64_tr_b16 v[70:71], v10 offset:11776
  s_waitcnt lgkmcnt(12)
  v_mfma_f32_32x32x16_bf16 v[160:175], v[76:79], v[44:47], v[160:175]
  v_mul_f32 v124, v124, v140
  v_mul_f32 v125, v125, v141
  v_mul_f32 v126, v126, v142
  v_mul_f32 v127, v127, v143
  v_cvt_pk_bf16_f32 v128, v112, v113
  v_cvt_pk_bf16_f32 v129, v114, v115
  ds_read_b64_tr_b16 v[72:73], v10 offset:18688
  ds_read_b64_tr_b16 v[74:75], v10 offset:20992
  s_waitcnt lgkmcnt(12)
  v_mfma_f32_32x32x16_bf16 v[176:191], v[48:51], v[40:43], v[176:191]
  v_cvt_pk_bf16_f32 v130, v116, v117
  v_cvt_pk_bf16_f32 v131, v118, v119
  v_cvt_pk_bf16_f32 v132, v120, v121
  v_cvt_pk_bf16_f32 v133, v122, v123
  v_cvt_pk_bf16_f32 v134, v124, v125
  v_cvt_pk_bf16_f32 v135, v126, v127
  ds_read_b64_tr_b16 v[76:77], v10 offset:27904
  ds_read_b64_tr_b16 v[78:79], v10 offset:30208
  s_waitcnt lgkmcnt(12)
  v_mfma_f32_32x32x16_bf16 v[176:191], v[52:55], v[44:47], v[176:191]
  v_mul_f32 v144, v144, v160
  v_mul_f32 v145, v145, v161
  v_mul_f32 v146, v146, v162
  v_mul_f32 v147, v147, v163
  v_mul_f32 v148, v148, v164
  v_mul_f32 v149, v149, v165
  s_waitcnt lgkmcnt(10)
  v_mfma_f32_32x32x16_bf16 v[192:207], v[56:59], v[40:43], v[192:207]
  v_mul_f32 v150, v150, v166
  v_mul_f32 v151, v151, v167
  v_mul_f32 v152, v152, v168
  v_mul_f32 v153, v153, v169
  v_mul_f32 v154, v154, v170
  v_mul_f32 v155, v155, v171
  s_waitcnt vmcnt(5) lgkmcnt(0)
  s_barrier
  ds_read_b64_tr_b16 v[48:49], v14 offset:0
  ds_read_b64_tr_b16 v[50:51], v14 offset:1024
  ds_read_b64_tr_b16 v[52:53], v14 offset:2048
  ds_read_b64_tr_b16 v[54:55], v14 offset:3072
  v_mfma_f32_32x32x16_bf16 v[192:207], v[60:63], v[44:47], v[192:207]
  ds_write_b128 v18, v[96:99] offset:0
  ds_write_b128 v18, v[100:103] offset:1024
  ds_write_b128 v18, v[128:131] offset:2048
  ds_write_b128 v18, v[132:135] offset:3072
  ds_read_b64_tr_b16 v[56:57], v14 offset:4096
  ds_read_b64_tr_b16 v[58:59], v14 offset:5120
  v_mfma_f32_32x32x16_bf16 v[208:223], v[64:67], v[40:43], v[208:223]
  v_mul_f32 v156, v156, v172
  v_mul_f32 v157, v157, v173
  v_mul_f32 v158, v158, v174
  v_mul_f32 v159, v159, v175
  v_cvt_pk_bf16_f32 v160, v144, v145
  v_cvt_pk_bf16_f32 v161, v146, v147
  ds_read_b64_tr_b16 v[60:61], v14 offset:6144
  ds_read_b64_tr_b16 v[62:63], v14 offset:7168
  v_mfma_f32_32x32x16_bf16 v[208:223], v[68:71], v[44:47], v[208:223]
  v_cvt_pk_bf16_f32 v162, v148, v149
  v_cvt_pk_bf16_f32 v163, v150, v151
  v_cvt_pk_bf16_f32 v164, v152, v153
  v_cvt_pk_bf16_f32 v165, v154, v155
  v_cvt_pk_bf16_f32 v166, v156, v157
  v_cvt_pk_bf16_f32 v167, v158, v159
  ds_read_b64_tr_b16 v[64:65], v14 offset:8192
  ds_read_b64_tr_b16 v[66:67], v14 offset:9216
  v_mfma_f32_32x32x16_bf16 v[224:239], v[72:75], v[40:43], v[224:239]
  v_mul_f32 v176, v176, v192
  v_mul_f32 v177, v177, v193
  v_mul_f32 v178, v178, v194
  v_mul_f32 v179, v179, v195
  v_mul_f32 v180, v180, v196
  v_mul_f32 v181, v181, v197
  ds_read_b64_tr_b16 v[68:69], v14 offset:10240
  ds_read_b64_tr_b16 v[70:71], v14 offset:11264
  v_mfma_f32_32x32x16_bf16 v[224:239], v[76:79], v[44:47], v[224:239]
  ds_write_b128 v18, v[160:163] offset:4096
  ds_write_b128 v18, v[164:167] offset:5120
  v_mul_f32 v182, v182, v198
  v_mul_f32 v183, v183, v199
  v_mul_f32 v184, v184, v200
  ds_read_b64_tr_b16 v[72:73], v14 offset:12288
  ds_read_b64_tr_b16 v[74:75], v14 offset:13312
  s_waitcnt lgkmcnt(15)
  v_mfma_f32_32x32x16_bf16 v[240:255], v[48:51], v[96:99], 0
  v_mul_f32 v185, v185, v201
  v_mul_f32 v186, v186, v202
  v_mul_f32 v187, v187, v203
  v_mul_f32 v188, v188, v204
  v_mul_f32 v189, v189, v205
  v_mul_f32 v190, v190, v206
  ds_read_b64_tr_b16 v[76:77], v14 offset:14336
  ds_read_b64_tr_b16 v[78:79], v14 offset:15360
  v_mfma_f32_32x32x16_bf16 v[240:255], v[52:55], v[100:103], v[240:255]
  v_mul_f32 v191, v191, v207
  v_cvt_pk_bf16_f32 v192, v176, v177
  v_cvt_pk_bf16_f32 v193, v178, v179
  v_cvt_pk_bf16_f32 v194, v180, v181
  v_cvt_pk_bf16_f32 v195, v182, v183
  v_cvt_pk_bf16_f32 v196, v184, v185
  ds_read_b64_tr_b16 v[48:49], v14 offset:16384
  ds_read_b64_tr_b16 v[50:51], v14 offset:17408
  s_waitcnt lgkmcnt(14)
  v_mfma_f32_32x32x16_bf16 v[240:255], v[56:59], v[128:131], v[240:255]
  v_cvt_pk_bf16_f32 v197, v186, v187
  v_cvt_pk_bf16_f32 v198, v188, v189
  v_cvt_pk_bf16_f32 v199, v190, v191
  v_mul_f32 v208, v208, v224
  v_mul_f32 v209, v209, v225
  v_mul_f32 v210, v210, v226
  ds_read_b64_tr_b16 v[52:53], v14 offset:18432
  ds_read_b64_tr_b16 v[54:55], v14 offset:19456
  s_waitcnt lgkmcnt(14)
  v_mfma_f32_32x32x16_bf16 v[240:255], v[60:63], v[132:135], v[240:255]
  ds_write_b128 v18, v[192:195] offset:6144
  ds_write_b128 v18, v[196:199] offset:7168
  v_mul_f32 v211, v211, v227
  v_mul_f32 v212, v212, v228
  v_mul_f32 v213, v213, v229
  s_waitcnt lgkmcnt(14)
  v_mfma_f32_32x32x16_bf16 v[240:255], v[64:67], v[160:163], v[240:255]
  v_mul_f32 v214, v214, v230
  v_mul_f32 v215, v215, v231
  v_mul_f32 v216, v216, v232
  v_mul_f32 v217, v217, v233
  v_mul_f32 v218, v218, v234
  v_mul_f32 v219, v219, v235
  s_waitcnt lgkmcnt(12)
  v_mfma_f32_32x32x16_bf16 v[240:255], v[68:71], v[164:167], v[240:255]
  v_mul_f32 v220, v220, v236
  v_mul_f32 v221, v221, v237
  v_mul_f32 v222, v222, v238
  v_mul_f32 v223, v223, v239
  v_cvt_pk_bf16_f32 v224, v208, v209
  v_cvt_pk_bf16_f32 v225, v210, v211
  s_waitcnt lgkmcnt(8)
  v_mfma_f32_32x32x16_bf16 v[240:255], v[72:75], v[192:195], v[240:255]
  v_cvt_pk_bf16_f32 v226, v212, v213
  v_cvt_pk_bf16_f32 v227, v214, v215
  v_cvt_pk_bf16_f32 v228, v216, v217
  v_cvt_pk_bf16_f32 v229, v218, v219
  v_cvt_pk_bf16_f32 v230, v220, v221
  v_cvt_pk_bf16_f32 v231, v222, v223
  s_waitcnt lgkmcnt(6)
  v_mfma_f32_32x32x16_bf16 v[240:255], v[76:79], v[196:199], v[240:255]
  ds_write_b128 v18, v[224:227] offset:8192
  ds_write_b128 v18, v[228:231] offset:9216
  s_waitcnt lgkmcnt(0)
  s_barrier
  ds_read_b128 v[80:83], v18 offset:10240
  ds_read_b64_tr_b16 v[56:57], v14 offset:20480
  ds_read_b64_tr_b16 v[58:59], v14 offset:21504
  ds_read_b128 v[84:87], v18 offset:11264
  ds_read_b64_tr_b16 v[60:61], v14 offset:22528
  ds_read_b64_tr_b16 v[62:63], v14 offset:23552
  v_mfma_f32_32x32x16_bf16 v[240:255], v[48:51], v[224:227], v[240:255]
  ds_read_b128 v[88:91], v18 offset:12288
  ds_read_b64_tr_b16 v[64:65], v14 offset:24576
  ds_read_b64_tr_b16 v[66:67], v14 offset:25600
  ds_read_b128 v[92:95], v18 offset:13312
  ds_read_b64_tr_b16 v[68:69], v14 offset:26624
  ds_read_b64_tr_b16 v[70:71], v14 offset:27648
  v_mfma_f32_32x32x16_bf16 v[240:255], v[52:55], v[228:231], v[240:255]
  ds_read_b128 v[112:115], v18 offset:14336
  ds_read_b64_tr_b16 v[72:73], v14 offset:28672
  ds_read_b64_tr_b16 v[74:75], v14 offset:29696
  ds_read_b128 v[116:119], v18 offset:15360
  ds_read_b64_tr_b16 v[76:77], v14 offset:30720
  ds_read_b64_tr_b16 v[78:79], v14 offset:31744
  s_waitcnt lgkmcnt(15)
  v_mfma_f32_32x32x16_bf16 v[240:255], v[56:59], v[80:83], v[240:255]
  ds_read_b128 v[120:123], v18 offset:16384
  ds_read_b64_tr_b16 v[48:49], v14 offset:32768
  ds_read_b64_tr_b16 v[50:51], v14 offset:33792
  ds_read_b128 v[124:127], v18 offset:17408
  ds_read_b64_tr_b16 v[52:53], v14 offset:34816
  ds_read_b64_tr_b16 v[54:55], v14 offset:35840
  s_waitcnt lgkmcnt(15)
  v_mfma_f32_32x32x16_bf16 v[240:255], v[60:63], v[84:87], v[240:255]
  v_mfma_f32_32x32x16_bf16 v[240:255], v[64:67], v[88:91], v[240:255]
  s_waitcnt vmcnt(0) lgkmcnt(0)
  s_barrier
  ds_read_b64_tr_b16 v[56:57], v15 offset:0
  ds_read_b64_tr_b16 v[58:59], v15 offset:1024
  ds_read_b64_tr_b16 v[60:61], v15 offset:2048
  ds_read_b64_tr_b16 v[62:63], v15 offset:3072
  v_mfma_f32_32x32x16_bf16 v[240:255], v[68:71], v[92:95], v[240:255]
  s_add_u32 m0, s34, 90112
  s_mov_b32 s40, 256
  buffer_load_dwordx4 v23, s[20:23], s40 offen lds
  ds_read_b64_tr_b16 v[64:65], v15 offset:4096
  ds_read_b64_tr_b16 v[66:67], v15 offset:5120
  v_mfma_f32_32x32x16_bf16 v[240:255], v[72:75], v[112:115], v[240:255]
  s_add_u32 m0, s34, 98304
  s_mov_b32 s40, 73984
  buffer_load_dwordx4 v23, s[20:23], s40 offen lds
  ds_read_b64_tr_b16 v[68:69], v15 offset:6144
  ds_read_b64_tr_b16 v[70:71], v15 offset:7168
  v_mfma_f32_32x32x16_bf16 v[240:255], v[76:79], v[116:119], v[240:255]
  s_add_u32 m0, s34, 106496
  s_mov_b32 s40, 147712
  buffer_load_dwordx4 v23, s[20:23], s40 offen lds
  ds_read_b64_tr_b16 v[72:73], v15 offset:8192
  ds_read_b64_tr_b16 v[74:75], v15 offset:9216
  v_mfma_f32_32x32x16_bf16 v[240:255], v[48:51], v[120:123], v[240:255]
  s_add_u32 m0, s34, 114688
  s_mov_b32 s40, 221440
  buffer_load_dwordx4 v23, s[20:23], s40 offen lds
  ds_read_b64_tr_b16 v[76:77], v15 offset:10240
  ds_read_b64_tr_b16 v[78:79], v15 offset:11264
  v_mfma_f32_32x32x16_bf16 v[240:255], v[52:55], v[124:127], v[240:255]
  s_add_u32 m0, s34, 122880
  s_mov_b32 s40, 295168
  buffer_load_dwordx4 v23, s[20:23], s40 offen lds
  ds_read_b64_tr_b16 v[48:49], v15 offset:12288
  ds_read_b64_tr_b16 v[50:51], v15 offset:13312
  s_waitcnt lgkmcnt(12)
  v_mfma_f32_32x32x16_bf16 v[176:191], v[56:59], v[96:99], 0
  s_add_u32 m0, s34, 126976
  s_mov_b32 s40, 384
  buffer_load_dwordx4 v23, s[20:23], s40 offen lds
  ds_read_b64_tr_b16 v[52:53], v15 offset:14336
  ds_read_b64_tr_b16 v[54:55], v15 offset:15360
  s_waitcnt lgkmcnt(12)
  v_mfma_f32_32x32x16_bf16 v[176:191], v[60:63], v[100:103], v[176:191]
  s_add_u32 m0, s34, 135168
  s_mov_b32 s40, 74112
  buffer_load_dwordx4 v23, s[20:23], s40 offen lds
  ds_read_b64_tr_b16 v[56:57], v15 offset:16384
  ds_read_b64_tr_b16 v[58:59], v15 offset:17408
  s_waitcnt lgkmcnt(12)
  v_mfma_f32_32x32x16_bf16 v[176:191], v[64:67], v[128:131], v[176:191]
  s_add_u32 m0, s34, 143360
  s_mov_b32 s40, 147840
  buffer_load_dwordx4 v23, s[20:23], s40 offen lds
  v_cvt_pk_bf16_f32 v104, v240, v241
  v_cvt_pk_bf16_f32 v105, v242, v243
  v_cvt_pk_bf16_f32 v106, v244, v245
  v_cvt_pk_bf16_f32 v107, v246, v247
  ds_read_b64_tr_b16 v[60:61], v15 offset:18432
  ds_read_b64_tr_b16 v[62:63], v15 offset:19456
  s_waitcnt lgkmcnt(12)
  v_mfma_f32_32x32x16_bf16 v[176:191], v[68:71], v[132:135], v[176:191]
  s_add_u32 m0, s34, 151552
  s_mov_b32 s40, 221568
  buffer_load_dwordx4 v23, s[20:23], s40 offen lds
  v_cvt_pk_bf16_f32 v108, v248, v249
  v_cvt_pk_bf16_f32 v109, v250, v251
  v_cvt_pk_bf16_f32 v110, v252, v253
  v_cvt_pk_bf16_f32 v111, v254, v255
  ds_read_b64_tr_b16 v[64:65], v15 offset:20480
  ds_read_b64_tr_b16 v[66:67], v15 offset:21504
  s_waitcnt lgkmcnt(12)
  v_mfma_f32_32x32x16_bf16 v[176:191], v[72:75], v[160:163], v[176:191]
  s_add_u32 m0, s34, 159744
  s_mov_b32 s40, 295296
  buffer_load_dwordx4 v23, s[20:23], s40 offen lds
  s_movk_i32 s41, 0
  buffer_store_dwordx4 v[104:107], v24, s[24:27], s41 offen offset:0 sc1
  buffer_store_dwordx4 v[108:111], v24, s[24:27], s41 offen offset:1024 sc1
  ds_read_b64_tr_b16 v[68:69], v15 offset:22528
  ds_read_b64_tr_b16 v[70:71], v15 offset:23552
  s_waitcnt lgkmcnt(12)
  v_mfma_f32_32x32x16_bf16 v[176:191], v[76:79], v[164:167], v[176:191]
  s_add_u32 m0, s34, 0
  s_mov_b32 s40, 512
  buffer_load_dwordx4 v23, s[20:23], s40 offen lds
  ds_read_b64_tr_b16 v[72:73], v15 offset:24576
  ds_read_b64_tr_b16 v[74:75], v15 offset:25600
  s_waitcnt lgkmcnt(12)
  v_mfma_f32_32x32x16_bf16 v[176:191], v[48:51], v[192:195], v[176:191]
  s_add_u32 m0, s34, 8192
  s_mov_b32 s40, 74240
  buffer_load_dwordx4 v23, s[20:23], s40 offen lds
  ds_read_b64_tr_b16 v[76:77], v15 offset:26624
  ds_read_b64_tr_b16 v[78:79], v15 offset:27648
  s_waitcnt lgkmcnt(12)
  v_mfma_f32_32x32x16_bf16 v[176:191], v[52:55], v[196:199], v[176:191]
  s_add_u32 m0, s34, 16384
  s_mov_b32 s40, 147968
  buffer_load_dwordx4 v23, s[20:23], s40 offen lds
  ds_read_b64_tr_b16 v[48:49], v15 offset:28672
  ds_read_b64_tr_b16 v[50:51], v15 offset:29696
  s_waitcnt lgkmcnt(12)
  v_mfma_f32_32x32x16_bf16 v[176:191], v[56:59], v[224:227], v[176:191]
  s_add_u32 m0, s34, 24576
  s_mov_b32 s40, 221696
  buffer_load_dwordx4 v23, s[20:23], s40 offen lds
  ds_read_b64_tr_b16 v[52:53], v15 offset:30720
  ds_read_b64_tr_b16 v[54:55], v15 offset:31744
  s_waitcnt lgkmcnt(12)
  v_mfma_f32_32x32x16_bf16 v[176:191], v[60:63], v[228:231], v[176:191]
  s_add_u32 m0, s34, 32768
  s_mov_b32 s40, 295424
  buffer_load_dwordx4 v23, s[20:23], s40 offen lds
  ds_read_b64_tr_b16 v[56:57], v15 offset:32768
  ds_read_b64_tr_b16 v[58:59], v15 offset:33792
  s_waitcnt lgkmcnt(12)
  v_mfma_f32_32x32x16_bf16 v[176:191], v[64:67], v[80:83], v[176:191]
  ds_read_b64_tr_b16 v[60:61], v15 offset:34816
  ds_read_b64_tr_b16 v[62:63], v15 offset:35840
  s_waitcnt lgkmcnt(12)
  v_mfma_f32_32x32x16_bf16 v[176:191], v[68:71], v[84:87], v[176:191]
  s_waitcnt lgkmcnt(10)
  v_mfma_f32_32x32x16_bf16 v[176:191], v[72:75], v[88:91], v[176:191]
  s_waitcnt vmcnt(12) lgkmcnt(0)
  s_barrier
  ds_read_b64_tr_b16 v[64:65], v16 offset:0
  ds_read_b64_tr_b16 v[66:67], v16 offset:1024
  ds_read_b64_tr_b16 v[68:69], v16 offset:2048
  ds_read_b64_tr_b16 v[70:71], v16 offset:3072
  v_mfma_f32_32x32x16_bf16 v[176:191], v[76:79], v[92:95], v[176:191]
  s_add_u32 m0, s34, 36864
  s_mov_b32 s40, 640
  buffer_load_dwordx4 v23, s[20:23], s40 offen lds
  ds_read_b64_tr_b16 v[72:73], v16 offset:4096
  ds_read_b64_tr_b16 v[74:75], v16 offset:5120
  v_mfma_f32_32x32x16_bf16 v[176:191], v[48:51], v[112:115], v[176:191]
  s_add_u32 m0, s34, 45056
  s_mov_b32 s40, 74368
  buffer_load_dwordx4 v23, s[20:23], s40 offen lds
  ds_read_b64_tr_b16 v[76:77], v16 offset:6144
  ds_read_b64_tr_b16 v[78:79], v16 offset:7168
  v_mfma_f32_32x32x16_bf16 v[176:191], v[52:55], v[116:119], v[176:191]
  s_add_u32 m0, s34, 53248
  s_mov_b32 s40, 148096
  buffer_load_dwordx4 v23, s[20:23], s40 offen lds
  ds_read_b64_tr_b16 v[48:49], v16 offset:8192
  ds_read_b64_tr_b16 v[50:51], v16 offset:9216
  v_mfma_f32_32x32x16_bf16 v[176:191], v[56:59], v[120:123], v[176:191]
  s_add_u32 m0, s34, 61440
  s_mov_b32 s40, 221824
  buffer_load_dwordx4 v23, s[20:23], s40 offen lds
  ds_read_b64_tr_b16 v[52:53], v16 offset:10240
  ds_read_b64_tr_b16 v[54:55], v16 offset:11264
  v_mfma_f32_32x32x16_bf16 v[176:191], v[60:63], v[124:127], v[176:191]
  s_add_u32 m0, s34, 69632
  s_mov_b32 s40, 295552
  buffer_load_dwordx4 v23, s[20:23], s40 offen lds
  ds_read_b64_tr_b16 v[56:57], v16 offset:12288
  ds_read_b64_tr_b16 v[58:59], v16 offset:13312
  s_waitcnt lgkmcnt(12)
  v_mfma_f32_32x32x16_bf16 v[240:255], v[64:67], v[96:99], 0
  ds_read_b64_tr_b16 v[60:61], v16 offset:14336
  ds_read_b64_tr_b16 v[62:63], v16 offset:15360
  s_waitcnt lgkmcnt(12)
  v_mfma_f32_32x32x16_bf16 v[240:255], v[68:71], v[100:103], v[240:255]
  ds_read_b64_tr_b16 v[64:65], v16 offset:16384
  ds_read_b64_tr_b16 v[66:67], v16 offset:17408
  s_waitcnt lgkmcnt(12)
  v_mfma_f32_32x32x16_bf16 v[240:255], v[72:75], v[128:131], v[240:255]
  v_cvt_pk_bf16_f32 v136, v176, v177
  v_cvt_pk_bf16_f32 v137, v178, v179
  v_cvt_pk_bf16_f32 v138, v180, v181
  v_cvt_pk_bf16_f32 v139, v182, v183
  v_cvt_pk_bf16_f32 v140, v184, v185
  v_cvt_pk_bf16_f32 v141, v186, v187
  ds_read_b64_tr_b16 v[68:69], v16 offset:18432
  ds_read_b64_tr_b16 v[70:71], v16 offset:19456
  s_waitcnt lgkmcnt(12)
  v_mfma_f32_32x32x16_bf16 v[240:255], v[76:79], v[132:135], v[240:255]
  v_cvt_pk_bf16_f32 v142, v188, v189
  v_cvt_pk_bf16_f32 v143, v190, v191
  s_movk_i32 s41, 4096
  buffer_store_dwordx4 v[136:139], v24, s[24:27], s41 offen offset:0 sc1
  buffer_store_dwordx4 v[140:143], v24, s[24:27], s41 offen offset:1024 sc1
  ds_read_b64_tr_b16 v[72:73], v16 offset:20480
  ds_read_b64_tr_b16 v[74:75], v16 offset:21504
  s_waitcnt lgkmcnt(12)
  v_mfma_f32_32x32x16_bf16 v[240:255], v[48:51], v[160:163], v[240:255]
  ds_read_b64_tr_b16 v[76:77], v16 offset:22528
  ds_read_b64_tr_b16 v[78:79], v16 offset:23552
  s_waitcnt lgkmcnt(12)
  v_mfma_f32_32x32x16_bf16 v[240:255], v[52:55], v[164:167], v[240:255]
  ds_read_b64_tr_b16 v[48:49], v16 offset:24576
  ds_read_b64_tr_b16 v[50:51], v16 offset:25600
  s_waitcnt lgkmcnt(12)
  v_mfma_f32_32x32x16_bf16 v[240:255], v[56:59], v[192:195], v[240:255]
  ds_read_b64_tr_b16 v[52:53], v16 offset:26624
  ds_read_b64_tr_b16 v[54:55], v16 offset:27648
  s_waitcnt lgkmcnt(12)
  v_mfma_f32_32x32x16_bf16 v[240:255], v[60:63], v[196:199], v[240:255]
  ds_read_b64_tr_b16 v[56:57], v16 offset:28672
  ds_read_b64_tr_b16 v[58:59], v16 offset:29696
  s_waitcnt lgkmcnt(12)
  v_mfma_f32_32x32x16_bf16 v[240:255], v[64:67], v[224:227], v[240:255]
  ds_read_b64_tr_b16 v[60:61], v16 offset:30720
  ds_read_b64_tr_b16 v[62:63], v16 offset:31744
  s_waitcnt lgkmcnt(12)
  v_mfma_f32_32x32x16_bf16 v[240:255], v[68:71], v[228:231], v[240:255]
  ds_read_b64_tr_b16 v[64:65], v16 offset:32768
  ds_read_b64_tr_b16 v[66:67], v16 offset:33792
  s_waitcnt lgkmcnt(12)
  v_mfma_f32_32x32x16_bf16 v[240:255], v[72:75], v[80:83], v[240:255]
  ds_read_b64_tr_b16 v[68:69], v16 offset:34816
  ds_read_b64_tr_b16 v[70:71], v16 offset:35840
  s_waitcnt lgkmcnt(12)
  v_mfma_f32_32x32x16_bf16 v[240:255], v[76:79], v[84:87], v[240:255]
  s_waitcnt lgkmcnt(10)
  v_mfma_f32_32x32x16_bf16 v[240:255], v[48:51], v[88:91], v[240:255]
  s_waitcnt vmcnt(12) lgkmcnt(0)
  s_barrier
  ds_read_b64_tr_b16 v[72:73], v17 offset:0
  ds_read_b64_tr_b16 v[74:75], v17 offset:1024
  ds_read_b64_tr_b16 v[76:77], v17 offset:2048
  ds_read_b64_tr_b16 v[78:79], v17 offset:3072
  v_mfma_f32_32x32x16_bf16 v[240:255], v[52:55], v[92:95], v[240:255]
  s_add_u32 m0, s34, 90112
  s_mov_b32 s40, 768
  buffer_load_dwordx4 v23, s[20:23], s40 offen lds
  ds_read_b64_tr_b16 v[48:49], v17 offset:4096
  ds_read_b64_tr_b16 v[50:51], v17 offset:5120
  v_mfma_f32_32x32x16_bf16 v[240:255], v[56:59], v[112:115], v[240:255]
  s_add_u32 m0, s34, 98304
  s_mov_b32 s40, 74496
  buffer_load_dwordx4 v23, s[20:23], s40 offen lds
  ds_read_b64_tr_b16 v[52:53], v17 offset:6144
  ds_read_b64_tr_b16 v[54:55], v17 offset:7168
  v_mfma_f32_32x32x16_bf16 v[240:255], v[60:63], v[116:119], v[240:255]
  s_add_u32 m0, s34, 106496
  s_mov_b32 s40, 148224
  buffer_load_dwordx4 v23, s[20:23], s40 offen lds
  ds_read_b64_tr_b16 v[56:57], v17 offset:8192
  ds_read_b64_tr_b16 v[58:59], v17 offset:9216
  v_mfma_f32_32x32x16_bf16 v[240:255], v[64:67], v[120:123], v[240:255]
  s_add_u32 m0, s34, 114688
  s_mov_b32 s40, 221952
  buffer_load_dwordx4 v23, s[20:23], s40 offen lds
  ds_read_b64_tr_b16 v[60:61], v17 offset:10240
  ds_read_b64_tr_b16 v[62:63], v17 offset:11264
  v_mfma_f32_32x32x16_bf16 v[240:255], v[68:71], v[124:127], v[240:255]
  s_add_u32 m0, s34, 122880
  s_mov_b32 s40, 295680
  buffer_load_dwordx4 v23, s[20:23], s40 offen lds
  ds_read_b64_tr_b16 v[64:65], v17 offset:12288
  ds_read_b64_tr_b16 v[66:67], v17 offset:13312
  s_waitcnt lgkmcnt(12)
  v_mfma_f32_32x32x16_bf16 v[176:191], v[72:75], v[96:99], 0
  ds_read_b64_tr_b16 v[68:69], v17 offset:14336
  ds_read_b64_tr_b16 v[70:71], v17 offset:15360
  s_waitcnt lgkmcnt(12)
  v_mfma_f32_32x32x16_bf16 v[176:191], v[76:79], v[100:103], v[176:191]
  ds_read_b64_tr_b16 v[72:73], v17 offset:16384
  ds_read_b64_tr_b16 v[74:75], v17 offset:17408
  s_waitcnt lgkmcnt(12)
  v_mfma_f32_32x32x16_bf16 v[176:191], v[48:51], v[128:131], v[176:191]
  v_cvt_pk_bf16_f32 v104, v240, v241
  v_cvt_pk_bf16_f32 v105, v242, v243
  v_cvt_pk_bf16_f32 v106, v244, v245
  v_cvt_pk_bf16_f32 v107, v246, v247
  v_cvt_pk_bf16_f32 v108, v248, v249
  v_cvt_pk_bf16_f32 v109, v250, v251
  ds_read_b64_tr_b16 v[76:77], v17 offset:18432
  ds_read_b64_tr_b16 v[78:79], v17 offset:19456
  s_waitcnt lgkmcnt(12)
  v_mfma_f32_32x32x16_bf16 v[176:191], v[52:55], v[132:135], v[176:191]
  v_cvt_pk_bf16_f32 v110, v252, v253
  v_cvt_pk_bf16_f32 v111, v254, v255
  s_movk_i32 s41, 8192
  buffer_store_dwordx4 v[104:107], v24, s[24:27], s41 offen offset:0 sc1
  buffer_store_dwordx4 v[108:111], v24, s[24:27], s41 offen offset:1024 sc1
  ds_read_b64_tr_b16 v[48:49], v17 offset:20480
  ds_read_b64_tr_b16 v[50:51], v17 offset:21504
  s_waitcnt lgkmcnt(12)
  v_mfma_f32_32x32x16_bf16 v[176:191], v[56:59], v[160:163], v[176:191]
  ds_read_b64_tr_b16 v[52:53], v17 offset:22528
  ds_read_b64_tr_b16 v[54:55], v17 offset:23552
  s_waitcnt lgkmcnt(12)
  v_mfma_f32_32x32x16_bf16 v[176:191], v[60:63], v[164:167], v[176:191]
  ds_read_b64_tr_b16 v[56:57], v17 offset:24576
  ds_read_b64_tr_b16 v[58:59], v17 offset:25600
  s_waitcnt lgkmcnt(12)
  v_mfma_f32_32x32x16_bf16 v[176:191], v[64:67], v[192:195], v[176:191]
  ds_read_b64_tr_b16 v[60:61], v17 offset:26624
  ds_read_b64_tr_b16 v[62:63], v17 offset:27648
  s_waitcnt lgkmcnt(12)
  v_mfma_f32_32x32x16_bf16 v[176:191], v[68:71], v[196:199], v[176:191]
  ds_read_b64_tr_b16 v[64:65], v17 offset:28672
  ds_read_b64_tr_b16 v[66:67], v17 offset:29696
  s_waitcnt lgkmcnt(12)
  v_mfma_f32_32x32x16_bf16 v[176:191], v[72:75], v[224:227], v[176:191]
  ds_read_b64_tr_b16 v[68:69], v17 offset:30720
  ds_read_b64_tr_b16 v[70:71], v17 offset:31744
  s_waitcnt lgkmcnt(12)
  v_mfma_f32_32x32x16_bf16 v[176:191], v[76:79], v[228:231], v[176:191]
  ds_read_b64_tr_b16 v[72:73], v17 offset:32768
  ds_read_b64_tr_b16 v[74:75], v17 offset:33792
  s_waitcnt lgkmcnt(12)
  v_mfma_f32_32x32x16_bf16 v[176:191], v[48:51], v[80:83], v[176:191]
  ds_read_b64_tr_b16 v[76:77], v17 offset:34816
  ds_read_b64_tr_b16 v[78:79], v17 offset:35840
  s_waitcnt lgkmcnt(12)
  v_mfma_f32_32x32x16_bf16 v[176:191], v[52:55], v[84:87], v[176:191]
  s_waitcnt lgkmcnt(10)
  v_mfma_f32_32x32x16_bf16 v[176:191], v[56:59], v[88:91], v[176:191]
  s_waitcnt vmcnt(7) lgkmcnt(0)
  s_barrier
  ds_read_b64_tr_b16 v[48:49], v14 offset:0
  ds_read_b64_tr_b16 v[50:51], v14 offset:1024
  ds_read_b64_tr_b16 v[52:53], v14 offset:2048
  ds_read_b64_tr_b16 v[54:55], v14 offset:3072
  v_mfma_f32_32x32x16_bf16 v[176:191], v[60:63], v[92:95], v[176:191]
  s_add_u32 m0, s34, 126976
  s_mov_b32 s40, 896
  buffer_load_dwordx4 v23, s[20:23], s40 offen lds
  ds_read_b64_tr_b16 v[56:57], v14 offset:4096
  ds_read_b64_tr_b16 v[58:59], v14 offset:5120
  v_mfma_f32_32x32x16_bf16 v[176:191], v[64:67], v[112:115], v[176:191]
  s_add_u32 m0, s34, 135168
  s_mov_b32 s40, 74624
  buffer_load_dwordx4 v23, s[20:23], s40 offen lds
  ds_read_b64_tr_b16 v[60:61], v14 offset:6144
  ds_read_b64_tr_b16 v[62:63], v14 offset:7168
  v_mfma_f32_32x32x16_bf16 v[176:191], v[68:71], v[116:119], v[176:191]
  s_add_u32 m0, s34, 143360
  s_mov_b32 s40, 148352
  buffer_load_dwordx4 v23, s[20:23], s40 offen lds
  ds_read_b64_tr_b16 v[64:65], v14 offset:8192
  ds_read_b64_tr_b16 v[66:67], v14 offset:9216
  v_mfma_f32_32x32x16_bf16 v[176:191], v[72:75], v[120:123], v[176:191]
  s_add_u32 m0, s34, 151552
  s_mov_b32 s40, 222080
  buffer_load_dwordx4 v23, s[20:23], s40 offen lds
  ds_read_b64_tr_b16 v[68:69], v14 offset:10240
  ds_read_b64_tr_b16 v[70:71], v14 offset:11264
  v_mfma_f32_32x32x16_bf16 v[176:191], v[76:79], v[124:127], v[176:191]
  s_add_u32 m0, s34, 159744
  s_mov_b32 s40, 295808
  buffer_load_dwordx4 v23, s[20:23], s40 offen lds
  ds_read_b64_tr_b16 v[72:73], v14 offset:12288
  ds_read_b64_tr_b16 v[74:75], v14 offset:13312
  s_waitcnt lgkmcnt(12)
  v_mfma_f32_32x32x16_bf16 v[240:255], v[48:51], v[96:99], 0
  ds_read_b64_tr_b16 v[76:77], v14 offset:14336
  ds_read_b64_tr_b16 v[78:79], v14 offset:15360
  s_waitcnt lgkmcnt(12)
  v_mfma_f32_32x32x16_bf16 v[240:255], v[52:55], v[100:103], v[240:255]
  ds_read_b64_tr_b16 v[48:49], v14 offset:16384
  ds_read_b64_tr_b16 v[50:51], v14 offset:17408
  s_waitcnt lgkmcnt(12)
  v_mfma_f32_32x32x16_bf16 v[240:255], v[56:59], v[128:131], v[240:255]
  v_cvt_pk_bf16_f32 v136, v176, v177
  v_cvt_pk_bf16_f32 v137, v178, v179
  v_cvt_pk_bf16_f32 v138, v180, v181
  v_cvt_pk_bf16_f32 v139, v182, v183
  v_cvt_pk_bf16_f32 v140, v184, v185
  v_cvt_pk_bf16_f32 v141, v186, v187
  ds_read_b64_tr_b16 v[52:53], v14 offset:18432
  ds_read_b64_tr_b16 v[54:55], v14 offset:19456
  s_waitcnt lgkmcnt(12)
  v_mfma_f32_32x32x16_bf16 v[240:255], v[60:63], v[132:135], v[240:255]
  v_cvt_pk_bf16_f32 v142, v188, v189
  v_cvt_pk_bf16_f32 v143, v190, v191
  s_movk_i32 s41, 12288
  buffer_store_dwordx4 v[136:139], v24, s[24:27], s41 offen offset:0 sc1
  buffer_store_dwordx4 v[140:143], v24, s[24:27], s41 offen offset:1024 sc1
  ds_read_b64_tr_b16 v[56:57], v14 offset:20480
  ds_read_b64_tr_b16 v[58:59], v14 offset:21504
  s_waitcnt lgkmcnt(12)
  v_mfma_f32_32x32x16_bf16 v[240:255], v[64:67], v[160:163], v[240:255]
  ds_read_b64_tr_b16 v[60:61], v14 offset:22528
  ds_read_b64_tr_b16 v[62:63], v14 offset:23552
  s_waitcnt lgkmcnt(12)
  v_mfma_f32_32x32x16_bf16 v[240:255], v[68:71], v[164:167], v[240:255]
  ds_read_b64_tr_b16 v[64:65], v14 offset:24576
  ds_read_b64_tr_b16 v[66:67], v14 offset:25600
  s_waitcnt lgkmcnt(12)
  v_mfma_f32_32x32x16_bf16 v[240:255], v[72:75], v[192:195], v[240:255]
  ds_read_b64_tr_b16 v[68:69], v14 offset:26624
  ds_read_b64_tr_b16 v[70:71], v14 offset:27648
  s_waitcnt lgkmcnt(12)
  v_mfma_f32_32x32x16_bf16 v[240:255], v[76:79], v[196:199], v[240:255]
  ds_read_b64_tr_b16 v[72:73], v14 offset:28672
  ds_read_b64_tr_b16 v[74:75], v14 offset:29696
  s_waitcnt lgkmcnt(12)
  v_mfma_f32_32x32x16_bf16 v[240:255], v[48:51], v[224:227], v[240:255]
  ds_read_b64_tr_b16 v[76:77], v14 offset:30720
  ds_read_b64_tr_b16 v[78:79], v14 offset:31744
  s_waitcnt lgkmcnt(12)
  v_mfma_f32_32x32x16_bf16 v[240:255], v[52:55], v[228:231], v[240:255]
  ds_read_b64_tr_b16 v[48:49], v14 offset:32768
  ds_read_b64_tr_b16 v[50:51], v14 offset:33792
  s_waitcnt lgkmcnt(12)
  v_mfma_f32_32x32x16_bf16 v[240:255], v[56:59], v[80:83], v[240:255]
  ds_read_b64_tr_b16 v[52:53], v14 offset:34816
  ds_read_b64_tr_b16 v[54:55], v14 offset:35840
  s_waitcnt lgkmcnt(12)
  v_mfma_f32_32x32x16_bf16 v[240:255], v[60:63], v[84:87], v[240:255]
  s_waitcnt lgkmcnt(10)
  v_mfma_f32_32x32x16_bf16 v[240:255], v[64:67], v[88:91], v[240:255]
  s_waitcnt vmcnt(7) lgkmcnt(0)
  s_barrier
  ds_read_b64_tr_b16 v[56:57], v15 offset:0
  ds_read_b64_tr_b16 v[58:59], v15 offset:1024
  ds_read_b64_tr_b16 v[60:61], v15 offset:2048
  ds_read_b64_tr_b16 v[62:63], v15 offset:3072
  v_mfma_f32_32x32x16_bf16 v[240:255], v[68:71], v[92:95], v[240:255]
  s_add_u32 m0, s34, 0
  s_mov_b32 s40, 1024
  buffer_load_dwordx4 v23, s[20:23], s40 offen lds
  ds_read_b64_tr_b16 v[64:65], v15 offset:4096
  ds_read_b64_tr_b16 v[66:67], v15 offset:5120
  v_mfma_f32_32x32x16_bf16 v[240:255], v[72:75], v[112:115], v[240:255]
  s_add_u32 m0, s34, 8192
  s_mov_b32 s40, 74752
  buffer_load_dwordx4 v23, s[20:23], s40 offen lds
  ds_read_b64_tr_b16 v[68:69], v15 offset:6144
  ds_read_b64_tr_b16 v[70:71], v15 offset:7168
  v_mfma_f32_32x32x16_bf16 v[240:255], v[76:79], v[116:119], v[240:255]
  s_add_u32 m0, s34, 16384
  s_mov_b32 s40, 148480
  buffer_load_dwordx4 v23, s[20:23], s40 offen lds
  ds_read_b64_tr_b16 v[72:73], v15 offset:8192
  ds_read_b64_tr_b16 v[74:75], v15 offset:9216
  v_mfma_f32_32x32x16_bf16 v[240:255], v[48:51], v[120:123], v[240:255]
  s_add_u32 m0, s34, 24576
  s_mov_b32 s40, 222208
  buffer_load_dwordx4 v23, s[20:23], s40 offen lds
  ds_read_b64_tr_b16 v[76:77], v15 offset:10240
  ds_read_b64_tr_b16 v[78:79], v15 offset:11264
  v_mfma_f32_32x32x16_bf16 v[240:255], v[52:55], v[124:127], v[240:255]
  s_add_u32 m0, s34, 32768
  s_mov_b32 s40, 295936
  buffer_load_dwordx4 v23, s[20:23], s40 offen lds
  ds_read_b64_tr_b16 v[48:49], v15 offset:12288
  ds_read_b64_tr_b16 v[50:51], v15 offset:13312
  s_waitcnt lgkmcnt(12)
  v_mfma_f32_32x32x16_bf16 v[176:191], v[56:59], v[96:99], 0
  ds_read_b64_tr_b16 v[52:53], v15 offset:14336
  ds_read_b64_tr_b16 v[54:55], v15 offset:15360
  s_waitcnt lgkmcnt(12)
  v_mfma_f32_32x32x16_bf16 v[176:191], v[60:63], v[100:103], v[176:191]
  ds_read_b64_tr_b16 v[56:57], v15 offset:16384
  ds_read_b64_tr_b16 v[58:59], v15 offset:17408
  s_waitcnt lgkmcnt(12)
  v_mfma_f32_32x32x16_bf16 v[176:191], v[64:67], v[128:131], v[176:191]
  v_cvt_pk_bf16_f32 v104, v240, v241
  v_cvt_pk_bf16_f32 v105, v242, v243
  v_cvt_pk_bf16_f32 v106, v244, v245
  v_cvt_pk_bf16_f32 v107, v246, v247
  v_cvt_pk_bf16_f32 v108, v248, v249
  v_cvt_pk_bf16_f32 v109, v250, v251
  ds_read_b64_tr_b16 v[60:61], v15 offset:18432
  ds_read_b64_tr_b16 v[62:63], v15 offset:19456
  s_waitcnt lgkmcnt(12)
  v_mfma_f32_32x32x16_bf16 v[176:191], v[68:71], v[132:135], v[176:191]
  v_cvt_pk_bf16_f32 v110, v252, v253
  v_cvt_pk_bf16_f32 v111, v254, v255
  s_movk_i32 s41, 16384
  buffer_store_dwordx4 v[104:107], v24, s[24:27], s41 offen offset:0 sc1
  buffer_store_dwordx4 v[108:111], v24, s[24:27], s41 offen offset:1024 sc1
  ds_read_b64_tr_b16 v[64:65], v15 offset:20480
  ds_read_b64_tr_b16 v[66:67], v15 offset:21504
  s_waitcnt lgkmcnt(12)
  v_mfma_f32_32x32x16_bf16 v[176:191], v[72:75], v[160:163], v[176:191]
  ds_read_b64_tr_b16 v[68:69], v15 offset:22528
  ds_read_b64_tr_b16 v[70:71], v15 offset:23552
  s_waitcnt lgkmcnt(12)
  v_mfma_f32_32x32x16_bf16 v[176:191], v[76:79], v[164:167], v[176:191]
  ds_read_b64_tr_b16 v[72:73], v15 offset:24576
  ds_read_b64_tr_b16 v[74:75], v15 offset:25600
  s_waitcnt lgkmcnt(12)
  v_mfma_f32_32x32x16_bf16 v[176:191], v[48:51], v[192:195], v[176:191]
  ds_read_b64_tr_b16 v[76:77], v15 offset:26624
  ds_read_b64_tr_b16 v[78:79], v15 offset:27648
  s_waitcnt lgkmcnt(12)
  v_mfma_f32_32x32x16_bf16 v[176:191], v[52:55], v[196:199], v[176:191]
  ds_read_b64_tr_b16 v[48:49], v15 offset:28672
  ds_read_b64_tr_b16 v[50:51], v15 offset:29696
  s_waitcnt lgkmcnt(12)
  v_mfma_f32_32x32x16_bf16 v[176:191], v[56:59], v[224:227], v[176:191]
  ds_read_b64_tr_b16 v[52:53], v15 offset:30720
  ds_read_b64_tr_b16 v[54:55], v15 offset:31744
  s_waitcnt lgkmcnt(12)
  v_mfma_f32_32x32x16_bf16 v[176:191], v[60:63], v[228:231], v[176:191]
  ds_read_b64_tr_b16 v[56:57], v15 offset:32768
  ds_read_b64_tr_b16 v[58:59], v15 offset:33792
  s_waitcnt lgkmcnt(12)
  v_mfma_f32_32x32x16_bf16 v[176:191], v[64:67], v[80:83], v[176:191]
  ds_read_b64_tr_b16 v[60:61], v15 offset:34816
  ds_read_b64_tr_b16 v[62:63], v15 offset:35840
  s_waitcnt lgkmcnt(12)
  v_mfma_f32_32x32x16_bf16 v[176:191], v[68:71], v[84:87], v[176:191]
  s_waitcnt lgkmcnt(10)
  v_mfma_f32_32x32x16_bf16 v[176:191], v[72:75], v[88:91], v[176:191]
  s_waitcnt vmcnt(7) lgkmcnt(0)
  s_barrier
  ds_read_b64_tr_b16 v[64:65], v16 offset:0
  ds_read_b64_tr_b16 v[66:67], v16 offset:1024
  ds_read_b64_tr_b16 v[68:69], v16 offset:2048
  ds_read_b64_tr_b16 v[70:71], v16 offset:3072
  v_mfma_f32_32x32x16_bf16 v[176:191], v[76:79], v[92:95], v[176:191]
  ds_read_b64_tr_b16 v[72:73], v16 offset:4096
  ds_read_b64_tr_b16 v[74:75], v16 offset:5120
  v_mfma_f32_32x32x16_bf16 v[176:191], v[48:51], v[112:115], v[176:191]
  ds_read_b64_tr_b16 v[76:77], v16 offset:6144
  ds_read_b64_tr_b16 v[78:79], v16 offset:7168
  v_mfma_f32_32x32x16_bf16 v[176:191], v[52:55], v[116:119], v[176:191]
  ds_read_b64_tr_b16 v[48:49], v16 offset:8192
  ds_read_b64_tr_b16 v[50:51], v16 offset:9216
  v_mfma_f32_32x32x16_bf16 v[176:191], v[56:59], v[120:123], v[176:191]
  ds_read_b64_tr_b16 v[52:53], v16 offset:10240
  ds_read_b64_tr_b16 v[54:55], v16 offset:11264
  v_mfma_f32_32x32x16_bf16 v[176:191], v[60:63], v[124:127], v[176:191]
  ds_read_b64_tr_b16 v[56:57], v16 offset:12288
  ds_read_b64_tr_b16 v[58:59], v16 offset:13312
  s_waitcnt lgkmcnt(12)
  v_mfma_f32_32x32x16_bf16 v[240:255], v[64:67], v[96:99], 0
  ds_read_b64_tr_b16 v[60:61], v16 offset:14336
  ds_read_b64_tr_b16 v[62:63], v16 offset:15360
  s_waitcnt lgkmcnt(12)
  v_mfma_f32_32x32x16_bf16 v[240:255], v[68:71], v[100:103], v[240:255]
  ds_read_b64_tr_b16 v[64:65], v16 offset:16384
  ds_read_b64_tr_b16 v[66:67], v16 offset:17408
  s_waitcnt lgkmcnt(12)
  v_mfma_f32_32x32x16_bf16 v[240:255], v[72:75], v[128:131], v[240:255]
  v_cvt_pk_bf16_f32 v136, v176, v177
  v_cvt_pk_bf16_f32 v137, v178, v179
  v_cvt_pk_bf16_f32 v138, v180, v181
  v_cvt_pk_bf16_f32 v139, v182, v183
  v_cvt_pk_bf16_f32 v140, v184, v185
  v_cvt_pk_bf16_f32 v141, v186, v187
  ds_read_b64_tr_b16 v[68:69], v16 offset:18432
  ds_read_b64_tr_b16 v[70:71], v16 offset:19456
  s_waitcnt lgkmcnt(12)
  v_mfma_f32_32x32x16_bf16 v[240:255], v[76:79], v[132:135], v[240:255]
  v_cvt_pk_bf16_f32 v142, v188, v189
  v_cvt_pk_bf16_f32 v143, v190, v191
  s_movk_i32 s41, 20480
  buffer_store_dwordx4 v[136:139], v24, s[24:27], s41 offen offset:0 sc1
  buffer_store_dwordx4 v[140:143], v24, s[24:27], s41 offen offset:1024 sc1
  ds_read_b64_tr_b16 v[72:73], v16 offset:20480
  ds_read_b64_tr_b16 v[74:75], v16 offset:21504
  s_waitcnt lgkmcnt(12)
  v_mfma_f32_32x32x16_bf16 v[240:255], v[48:51], v[160:163], v[240:255]
  ds_read_b64_tr_b16 v[76:77], v16 offset:22528
  ds_read_b64_tr_b16 v[78:79], v16 offset:23552
  s_waitcnt lgkmcnt(12)
  v_mfma_f32_32x32x16_bf16 v[240:255], v[52:55], v[164:167], v[240:255]
  ds_read_b64_tr_b16 v[48:49], v16 offset:24576
  ds_read_b64_tr_b16 v[50:51], v16 offset:25600
  s_waitcnt lgkmcnt(12)
  v_mfma_f32_32x32x16_bf16 v[240:255], v[56:59], v[192:195], v[240:255]
  ds_read_b64_tr_b16 v[52:53], v16 offset:26624
  ds_read_b64_tr_b16 v[54:55], v16 offset:27648
  s_waitcnt lgkmcnt(12)
  v_mfma_f32_32x32x16_bf16 v[240:255], v[60:63], v[196:199], v[240:255]
  ds_read_b64_tr_b16 v[56:57], v16 offset:28672
  ds_read_b64_tr_b16 v[58:59], v16 offset:29696
  s_waitcnt lgkmcnt(12)
  v_mfma_f32_32x32x16_bf16 v[240:255], v[64:67], v[224:227], v[240:255]
  ds_read_b64_tr_b16 v[60:61], v16 offset:30720
  ds_read_b64_tr_b16 v[62:63], v16 offset:31744
  s_waitcnt lgkmcnt(12)
  v_mfma_f32_32x32x16_bf16 v[240:255], v[68:71], v[228:231], v[240:255]
  ds_read_b64_tr_b16 v[64:65], v16 offset:32768
  ds_read_b64_tr_b16 v[66:67], v16 offset:33792
  s_waitcnt lgkmcnt(12)
  v_mfma_f32_32x32x16_bf16 v[240:255], v[72:75], v[80:83], v[240:255]
  ds_read_b64_tr_b16 v[68:69], v16 offset:34816
  ds_read_b64_tr_b16 v[70:71], v16 offset:35840
  s_waitcnt lgkmcnt(12)
  v_mfma_f32_32x32x16_bf16 v[240:255], v[76:79], v[84:87], v[240:255]
  s_waitcnt lgkmcnt(10)
  v_mfma_f32_32x32x16_bf16 v[240:255], v[48:51], v[88:91], v[240:255]
  s_waitcnt lgkmcnt(0)
  s_barrier
  ds_read_b64_tr_b16 v[72:73], v17 offset:0
  ds_read_b64_tr_b16 v[74:75], v17 offset:1024
  ds_read_b64_tr_b16 v[76:77], v17 offset:2048
  ds_read_b64_tr_b16 v[78:79], v17 offset:3072
  v_mfma_f32_32x32x16_bf16 v[240:255], v[52:55], v[92:95], v[240:255]
  ds_read_b64_tr_b16 v[48:49], v17 offset:4096
  ds_read_b64_tr_b16 v[50:51], v17 offset:5120
  v_mfma_f32_32x32x16_bf16 v[240:255], v[56:59], v[112:115], v[240:255]
  ds_read_b64_tr_b16 v[52:53], v17 offset:6144
  ds_read_b64_tr_b16 v[54:55], v17 offset:7168
  v_mfma_f32_32x32x16_bf16 v[240:255], v[60:63], v[116:119], v[240:255]
  ds_read_b64_tr_b16 v[56:57], v17 offset:8192
  ds_read_b64_tr_b16 v[58:59], v17 offset:9216
  v_mfma_f32_32x32x16_bf16 v[240:255], v[64:67], v[120:123], v[240:255]
  ds_read_b64_tr_b16 v[60:61], v17 offset:10240
  ds_read_b64_tr_b16 v[62:63], v17 offset:11264
  v_mfma_f32_32x32x16_bf16 v[240:255], v[68:71], v[124:127], v[240:255]
  ds_read_b64_tr_b16 v[64:65], v17 offset:12288
  ds_read_b64_tr_b16 v[66:67], v17 offset:13312
  s_waitcnt lgkmcnt(12)
  v_mfma_f32_32x32x16_bf16 v[176:191], v[72:75], v[96:99], 0
  ds_read_b64_tr_b16 v[68:69], v17 offset:14336
  ds_read_b64_tr_b16 v[70:71], v17 offset:15360
  s_waitcnt lgkmcnt(12)
  v_mfma_f32_32x32x16_bf16 v[176:191], v[76:79], v[100:103], v[176:191]
  ds_read_b64_tr_b16 v[72:73], v17 offset:16384
  ds_read_b64_tr_b16 v[74:75], v17 offset:17408
  s_waitcnt lgkmcnt(12)
  v_mfma_f32_32x32x16_bf16 v[176:191], v[48:51], v[128:131], v[176:191]
  v_cvt_pk_bf16_f32 v104, v240, v241
  v_cvt_pk_bf16_f32 v105, v242, v243
  v_cvt_pk_bf16_f32 v106, v244, v245
  v_cvt_pk_bf16_f32 v107, v246, v247
  v_cvt_pk_bf16_f32 v108, v248, v249
  v_cvt_pk_bf16_f32 v109, v250, v251
  ds_read_b64_tr_b16 v[76:77], v17 offset:18432
  ds_read_b64_tr_b16 v[78:79], v17 offset:19456
  s_waitcnt lgkmcnt(12)
  v_mfma_f32_32x32x16_bf16 v[176:191], v[52:55], v[132:135], v[176:191]
  v_cvt_pk_bf16_f32 v110, v252, v253
  v_cvt_pk_bf16_f32 v111, v254, v255
  s_movk_i32 s41, 24576
  buffer_store_dwordx4 v[104:107], v24, s[24:27], s41 offen offset:0 sc1
  buffer_store_dwordx4 v[108:111], v24, s[24:27], s41 offen offset:1024 sc1
  ds_read_b64_tr_b16 v[48:49], v17 offset:20480
  ds_read_b64_tr_b16 v[50:51], v17 offset:21504
  s_waitcnt lgkmcnt(12)
  v_mfma_f32_32x32x16_bf16 v[176:191], v[56:59], v[160:163], v[176:191]
  ds_read_b64_tr_b16 v[52:53], v17 offset:22528
  ds_read_b64_tr_b16 v[54:55], v17 offset:23552
  s_waitcnt lgkmcnt(12)
  v_mfma_f32_32x32x16_bf16 v[176:191], v[60:63], v[164:167], v[176:191]
  ds_read_b64_tr_b16 v[56:57], v17 offset:24576
  ds_read_b64_tr_b16 v[58:59], v17 offset:25600
  s_waitcnt lgkmcnt(12)
  v_mfma_f32_32x32x16_bf16 v[176:191], v[64:67], v[192:195], v[176:191]
  ds_read_b64_tr_b16 v[60:61], v17 offset:26624
  ds_read_b64_tr_b16 v[62:63], v17 offset:27648
  s_waitcnt lgkmcnt(12)
  v_mfma_f32_32x32x16_bf16 v[176:191], v[68:71], v[196:199], v[176:191]
  ds_read_b64_tr_b16 v[64:65], v17 offset:28672
  ds_read_b64_tr_b16 v[66:67], v17 offset:29696
  s_waitcnt lgkmcnt(12)
  v_mfma_f32_32x32x16_bf16 v[176:191], v[72:75], v[224:227], v[176:191]
  ds_read_b64_tr_b16 v[68:69], v17 offset:30720
  ds_read_b64_tr_b16 v[70:71], v17 offset:31744
  s_waitcnt lgkmcnt(12)
  v_mfma_f32_32x32x16_bf16 v[176:191], v[76:79], v[228:231], v[176:191]
  ds_read_b64_tr_b16 v[72:73], v17 offset:32768
  ds_read_b64_tr_b16 v[74:75], v17 offset:33792
  s_waitcnt lgkmcnt(12)
  v_mfma_f32_32x32x16_bf16 v[176:191], v[48:51], v[80:83], v[176:191]
  ds_read_b64_tr_b16 v[76:77], v17 offset:34816
  ds_read_b64_tr_b16 v[78:79], v17 offset:35840
  s_waitcnt lgkmcnt(12)
  v_mfma_f32_32x32x16_bf16 v[176:191], v[52:55], v[84:87], v[176:191]
  s_waitcnt lgkmcnt(10)
  v_mfma_f32_32x32x16_bf16 v[176:191], v[56:59], v[88:91], v[176:191]
  s_waitcnt vmcnt(2) lgkmcnt(0)
  s_barrier
  ds_read_b64_tr_b16 v[48:49], v14 offset:0
  ds_read_b64_tr_b16 v[50:51], v14 offset:1024
  ds_read_b64_tr_b16 v[52:53], v14 offset:2048
  ds_read_b64_tr_b16 v[54:55], v14 offset:3072
  v_mfma_f32_32x32x16_bf16 v[176:191], v[60:63], v[92:95], v[176:191]
  ds_read_b64_tr_b16 v[56:57], v14 offset:4096
  ds_read_b64_tr_b16 v[58:59], v14 offset:5120
  v_mfma_f32_32x32x16_bf16 v[176:191], v[64:67], v[112:115], v[176:191]
  ds_read_b64_tr_b16 v[60:61], v14 offset:6144
  ds_read_b64_tr_b16 v[62:63], v14 offset:7168
  v_mfma_f32_32x32x16_bf16 v[176:191], v[68:71], v[116:119], v[176:191]
  ds_read_b64_tr_b16 v[64:65], v14 offset:8192
  ds_read_b64_tr_b16 v[66:67], v14 offset:9216
  v_mfma_f32_32x32x16_bf16 v[176:191], v[72:75], v[120:123], v[176:191]
  ds_read_b64_tr_b16 v[68:69], v14 offset:10240
  ds_read_b64_tr_b16 v[70:71], v14 offset:11264
  v_mfma_f32_32x32x16_bf16 v[176:191], v[76:79], v[124:127], v[176:191]
  ds_read_b64_tr_b16 v[72:73], v14 offset:12288
  ds_read_b64_tr_b16 v[74:75], v14 offset:13312
  s_waitcnt lgkmcnt(12)
  v_mfma_f32_32x32x16_bf16 v[240:255], v[48:51], v[96:99], 0
  ds_read_b64_tr_b16 v[76:77], v14 offset:14336
  ds_read_b64_tr_b16 v[78:79], v14 offset:15360
  s_waitcnt lgkmcnt(12)
  v_mfma_f32_32x32x16_bf16 v[240:255], v[52:55], v[100:103], v[240:255]
  ds_read_b64_tr_b16 v[48:49], v14 offset:16384
  ds_read_b64_tr_b16 v[50:51], v14 offset:17408
  s_waitcnt lgkmcnt(12)
  v_mfma_f32_32x32x16_bf16 v[240:255], v[56:59], v[128:131], v[240:255]
  v_cvt_pk_bf16_f32 v136, v176, v177
  v_cvt_pk_bf16_f32 v137, v178, v179
  v_cvt_pk_bf16_f32 v138, v180, v181
  v_cvt_pk_bf16_f32 v139, v182, v183
  v_cvt_pk_bf16_f32 v140, v184, v185
  v_cvt_pk_bf16_f32 v141, v186, v187
  ds_read_b64_tr_b16 v[52:53], v14 offset:18432
  ds_read_b64_tr_b16 v[54:55], v14 offset:19456
  s_waitcnt lgkmcnt(12)
  v_mfma_f32_32x32x16_bf16 v[240:255], v[60:63], v[132:135], v[240:255]
  v_cvt_pk_bf16_f32 v142, v188, v189
  v_cvt_pk_bf16_f32 v143, v190, v191
  s_movk_i32 s41, 28672
  buffer_store_dwordx4 v[136:139], v24, s[24:27], s41 offen offset:0 sc1
  buffer_store_dwordx4 v[140:143], v24, s[24:27], s41 offen offset:1024 sc1
  ds_read_b64_tr_b16 v[56:57], v14 offset:20480
  ds_read_b64_tr_b16 v[58:59], v14 offset:21504
  s_waitcnt lgkmcnt(12)
  v_mfma_f32_32x32x16_bf16 v[240:255], v[64:67], v[160:163], v[240:255]
  ds_read_b64_tr_b16 v[60:61], v14 offset:22528
  ds_read_b64_tr_b16 v[62:63], v14 offset:23552
  s_waitcnt lgkmcnt(12)
  v_mfma_f32_32x32x16_bf16 v[240:255], v[68:71], v[164:167], v[240:255]
  ds_read_b64_tr_b16 v[64:65], v14 offset:24576
  ds_read_b64_tr_b16 v[66:67], v14 offset:25600
  s_waitcnt lgkmcnt(12)
  v_mfma_f32_32x32x16_bf16 v[240:255], v[72:75], v[192:195], v[240:255]
  ds_read_b64_tr_b16 v[68:69], v14 offset:26624
  ds_read_b64_tr_b16 v[70:71], v14 offset:27648
  s_waitcnt lgkmcnt(12)
  v_mfma_f32_32x32x16_bf16 v[240:255], v[76:79], v[196:199], v[240:255]
  ds_read_b64_tr_b16 v[72:73], v14 offset:28672
  ds_read_b64_tr_b16 v[74:75], v14 offset:29696
  s_waitcnt lgkmcnt(12)
  v_mfma_f32_32x32x16_bf16 v[240:255], v[48:51], v[224:227], v[240:255]
  ds_read_b64_tr_b16 v[76:77], v14 offset:30720
  ds_read_b64_tr_b16 v[78:79], v14 offset:31744
  s_waitcnt lgkmcnt(12)
  v_mfma_f32_32x32x16_bf16 v[240:255], v[52:55], v[228:231], v[240:255]
  ds_read_b64_tr_b16 v[48:49], v14 offset:32768
  ds_read_b64_tr_b16 v[50:51], v14 offset:33792
  s_waitcnt lgkmcnt(12)
  v_mfma_f32_32x32x16_bf16 v[240:255], v[56:59], v[80:83], v[240:255]
  ds_read_b64_tr_b16 v[52:53], v14 offset:34816
  ds_read_b64_tr_b16 v[54:55], v14 offset:35840
  s_waitcnt lgkmcnt(12)
  v_mfma_f32_32x32x16_bf16 v[240:255], v[60:63], v[84:87], v[240:255]
  s_waitcnt lgkmcnt(10)
  v_mfma_f32_32x32x16_bf16 v[240:255], v[64:67], v[88:91], v[240:255]
  s_waitcnt lgkmcnt(8)
  v_mfma_f32_32x32x16_bf16 v[240:255], v[68:71], v[92:95], v[240:255]
  s_waitcnt lgkmcnt(6)
  v_mfma_f32_32x32x16_bf16 v[240:255], v[72:75], v[112:115], v[240:255]
  s_waitcnt lgkmcnt(4)
  v_mfma_f32_32x32x16_bf16 v[240:255], v[76:79], v[116:119], v[240:255]
  s_waitcnt lgkmcnt(2)
  v_mfma_f32_32x32x16_bf16 v[240:255], v[48:51], v[120:123], v[240:255]
  s_waitcnt lgkmcnt(0)
  v_mfma_f32_32x32x16_bf16 v[240:255], v[52:55], v[124:127], v[240:255]
  s_nop 7
  s_nop 3
  v_cvt_pk_bf16_f32 v104, v240, v241
  v_cvt_pk_bf16_f32 v105, v242, v243
  v_cvt_pk_bf16_f32 v106, v244, v245
  v_cvt_pk_bf16_f32 v107, v246, v247
  v_cvt_pk_bf16_f32 v108, v248, v249
  v_cvt_pk_bf16_f32 v109, v250, v251
  v_cvt_pk_bf16_f32 v110, v252, v253
  v_cvt_pk_bf16_f32 v111, v254, v255
  s_mov_b32 s41, 0x8000
  buffer_store_dwordx4 v[104:107], v24, s[24:27], s41 offen offset:0 sc1
  buffer_store_dwordx4 v[108:111], v24, s[24:27], s41 offen offset:1024 sc1
  s_nop 7
  s_nop 7
  s_branch k3_join
k3_pathB:
  s_add_u32 m0, s34, 36864
  s_mov_b32 s40, 0
  buffer_load_dwordx4 v22, s[24:27], s40 offen sc1 lds
  s_add_u32 m0, s34, 81920
  s_mov_b32 s40, 2048
  buffer_load_dwordx4 v22, s[24:27], s40 offen sc1 lds
  s_add_u32 m0, s34, 126976
  s_mov_b32 s40, 4096
  buffer_load_dwordx4 v22, s[24:27], s40 offen sc1 lds
  s_waitcnt vmcnt(2)
  s_barrier
  ds_read_b128 v[32:35], v11 offset:0
  ds_read_b64_tr_b16 v[48:49], v8 offset:320
  ds_read_b64_tr_b16 v[50:51], v8 offset:2624
  ds_read_b64_tr_b16 v[52:53], v8 offset:18752
  ds_read_b64_tr_b16 v[54:55], v8 offset:21056
  ds_read_b64_tr_b16 v[56:57], v8 offset:384
  ds_read_b64_tr_b16 v[58:59], v8 offset:2688
  s_waitcnt lgkmcnt(4)
  v_mfma_f32_32x32x16_bf16 v[80:95], v[48:51], v[32:35], 0
  ds_read_b64_tr_b16 v[60:61], v8 offset:18816
  ds_read_b64_tr_b16 v[62:63], v8 offset:21120
  ds_read_b64_tr_b16 v[64:65], v8 offset:448
  ds_read_b64_tr_b16 v[66:67], v8 offset:2752
  s_waitcnt lgkmcnt(6)
  v_mfma_f32_32x32x16_bf16 v[96:111], v[52:55], v[32:35], 0
  ds_read_b64_tr_b16 v[68:69], v8 offset:18880
  ds_read_b64_tr_b16 v[70:71], v8 offset:21184
  ds_read_b64_tr_b16 v[72:73], v8 offset:512
  ds_read_b64_tr_b16 v[74:75], v8 offset:2816
  s_waitcnt lgkmcnt(8)
  v_mfma_f32_32x32x16_bf16 v[112:127], v[56:59], v[32:35], 0
  ds_read_b64_tr_b16 v[76:77], v8 offset:18944
  ds_read_b64_tr_b16 v[78:79], v8 offset:21248
  ds_read_b128 v[36:39], v11 offset:1024
  ds_read_b64_tr_b16 v[48:49], v8 offset:9536
  ds_read_b64_tr_b16 v[50:51], v8 offset:11840
  s_waitcnt lgkmcnt(11)
  v_mfma_f32_32x32x16_bf16 v[128:143], v[60:63], v[32:35], 0
  ds_read_b64_tr_b16 v[52:53], v8 offset:27968
  ds_read_b64_tr_b16 v[54:55], v8 offset:30272
  ds_read_b64_tr_b16 v[56:57], v8 offset:9600
  ds_read_b64_tr_b16 v[58:59], v8 offset:11904
  s_waitcnt lgkmcnt(13)
  v_mfma_f32_32x32x16_bf16 v[144:159], v[64:67], v[32:35], 0
  ds_read_b64_tr_b16 v[60:61], v8 offset:28032
  ds_read_b64_tr_b16 v[62:63], v8 offset:30336
  s_waitcnt lgkmcnt(13)
  v_mfma_f32_32x32x16_bf16 v[160:175], v[68:71], v[32:35], 0
  ds_read_b64_tr_b16 v[64:65], v8 offset:9664
  ds_read_b64_tr_b16 v[66:67], v8 offset:11968
  s_waitcnt lgkmcnt(13)
  v_mfma_f32_32x32x16_bf16 v[176:191], v[72:75], v[32:35], 0
  ds_read_b64_tr_b16 v[68:69], v8 offset:28096
  ds_read_b64_tr_b16 v[70:71], v8 offset:30400
  s_waitcnt lgkmcnt(13)
  v_mfma_f32_32x32x16_bf16 v[192:207], v[76:79], v[32:35], 0
  ds_read_b64_tr_b16 v[72:73], v8 offset:9728
  ds_read_b64_tr_b16 v[74:75], v8 offset:12032
  s_waitcnt lgkmcnt(12)
  v_mfma_f32_32x32x16_bf16 v[80:95], v[48:51], v[36:39], v[80:95]
  ds_read_b64_tr_b16 v[76:77], v8 offset:28160
  ds_read_b64_tr_b16 v[78:79], v8 offset:30464
  s_waitcnt lgkmcnt(12)
  v_mfma_f32_32x32x16_bf16 v[96:111], v[52:55], v[36:39], v[96:111]
  s_waitcnt lgkmcnt(10)
  v_mfma_f32_32x32x16_bf16 v[112:127], v[56:59], v[36:39], v[112:127]
  s_waitcnt vmcnt(1) lgkmcnt(0)
  s_barrier
  ds_read_b128 v[40:43], v12 offset:0
  ds_read_b64_tr_b16 v[48:49], v9 offset:320
  ds_read_b64_tr_b16 v[50:51], v9 offset:2624
  ds_read_b64_tr_b16 v[52:53], v9 offset:18752
  ds_read_b64_tr_b16 v[54:55], v9 offset:21056
  v_mfma_f32_32x32x16_bf16 v[128:143], v[60:63], v[36:39], v[128:143]
  s_add_u32 m0, s34, 0
  s_mov_b32 s40, 884736
  buffer_load_dwordx4 v19, s[12:15], s40 offen lds
  ds_read_b64_tr_b16 v[56:57], v9 offset:384
  ds_read_b64_tr_b16 v[58:59], v9 offset:2688
  v_mfma_f32_32x32x16_bf16 v[144:159], v[64:67], v[36:39], v[144:159]
  s_add_u32 m0, s34, 18432
  s_mov_b32 s40, 884736
  buffer_load_dwordx4 v19, s[16:19], s40 offen lds
  ds_read_b64_tr_b16 v[60:61], v9 offset:18816
  ds_read_b64_tr_b16 v[62:63], v9 offset:21120
  v_mfma_f32_32x32x16_bf16 v[160:175], v[68:71], v[36:39], v[160:175]
  s_add_u32 m0, s34, 8192
  s_mov_b32 s40, 884736
  buffer_load_dwordx4 v20, s[12:15], s40 offen lds
  ds_read_b64_tr_b16 v[64:65], v9 offset:448
  ds_read_b64_tr_b16 v[66:67], v9 offset:2752
  v_mfma_f32_32x32x16_bf16 v[176:191], v[72:75], v[36:39], v[176:191]
  s_add_u32 m0, s34, 26624
  s_mov_b32 s40, 884736
  buffer_load_dwordx4 v20, s[16:19], s40 offen lds
  ds_read_b64_tr_b16 v[68:69], v9 offset:18880
  ds_read_b64_tr_b16 v[70:71], v9 offset:21184
  v_mfma_f32_32x32x16_bf16 v[192:207], v[76:79], v[36:39], v[192:207]
  s_add_u32 m0, s34, 36864
  s_mov_b32 s40, 6144
  buffer_load_dwordx4 v22, s[24:27], s40 offen sc1 lds
  ds_read_b64_tr_b16 v[72:73], v9 offset:512
  ds_read_b64_tr_b16 v[74:75], v9 offset:2816
  s_waitcnt lgkmcnt(12)
  v_mfma_f32_32x32x16_bf16 v[80:95], v[48:51], v[40:43], v[80:95]
  s_add_u32 m0, s35, 16384
  s_mov_b32 s40, 884736
  buffer_load_dwordx4 v21, s[44:47], s40 offen lds
  ds_read_b64_tr_b16 v[76:77], v9 offset:18944
  ds_read_b64_tr_b16 v[78:79], v9 offset:21248
  s_waitcnt lgkmcnt(12)
  v_mfma_f32_32x32x16_bf16 v[96:111], v[52:55], v[40:43], v[96:111]
  ds_read_b128 v[44:47], v12 offset:1024
  ds_read_b64_tr_b16 v[48:49], v9 offset:9536
  ds_read_b64_tr_b16 v[50:51], v9 offset:11840
  s_waitcnt lgkmcnt(13)
  v_mfma_f32_32x32x16_bf16 v[112:127], v[56:59], v[40:43], v[112:127]
  ds_read_b64_tr_b16 v[52:53], v9 offset:27968
  ds_read_b64_tr_b16 v[54:55], v9 offset:30272
  s_waitcnt lgkmcnt(13)
  v_mfma_f32_32x32x16_bf16 v[128:143], v[60:63], v[40:43], v[128:143]
  ds_read_b64_tr_b16 v[56:57], v9 offset:9600
  ds_read_b64_tr_b16 v[58:59], v9 offset:11904
  s_waitcnt lgkmcnt(13)
  v_mfma_f32_32x32x16_bf16 v[144:159], v[64:67], v[40:43], v[144:159]
  ds_read_b64_tr_b16 v[60:61], v9 offset:28032
  ds_read_b64_tr_b16 v[62:63], v9 offset:30336
  s_waitcnt lgkmcnt(13)
  v_mfma_f32_32x32x16_bf16 v[160:175], v[68:71], v[40:43], v[160:175]
  ds_read_b64_tr_b16 v[64:65], v9 offset:9664
  ds_read_b64_tr_b16 v[66:67], v9 offset:11968
  s_waitcnt lgkmcnt(13)
  v_mfma_f32_32x32x16_bf16 v[176:191], v[72:75], v[40:43], v[176:191]
  ds_read_b64_tr_b16 v[68:69], v9 offset:28096
  ds_read_b64_tr_b16 v[70:71], v9 offset:30400
  s_waitcnt lgkmcnt(13)
  v_mfma_f32_32x32x16_bf16 v[192:207], v[76:79], v[40:43], v[192:207]
  ds_read_b64_tr_b16 v[72:73], v9 offset:9728
  ds_read_b64_tr_b16 v[74:75], v9 offset:12032
  s_waitcnt lgkmcnt(12)
  v_mfma_f32_32x32x16_bf16 v[80:95], v[48:51], v[44:47], v[80:95]
  ds_read_b64_tr_b16 v[76:77], v9 offset:28160
  ds_read_b64_tr_b16 v[78:79], v9 offset:30464
  s_waitcnt lgkmcnt(12)
  v_mfma_f32_32x32x16_bf16 v[96:111], v[52:55], v[44:47], v[96:111]
  s_waitcnt lgkmcnt(10)
  v_mfma_f32_32x32x16_bf16 v[112:127], v[56:59], v[44:47], v[112:127]
  s_waitcnt vmcnt(6) lgkmcnt(0)
  s_barrier
  ds_read_b128 v[32:35], v13 offset:0
  ds_read_b64_tr_b16 v[48:49], v10 offset:320
  ds_read_b64_tr_b16 v[50:51], v10 offset:2624
  ds_read_b64_tr_b16 v[52:53], v10 offset:18752
  ds_read_b64_tr_b16 v[54:55], v10 offset:21056
  v_mfma_f32_32x32x16_bf16 v[128:143], v[60:63], v[44:47], v[128:143]
  s_add_u32 m0, s34, 45056
  s_mov_b32 s40, 1179648
  buffer_load_dwordx4 v19, s[12:15], s40 offen lds
  ds_read_b64_tr_b16 v[56:57], v10 offset:384
  ds_read_b64_tr_b16 v[58:59], v10 offset:2688
  v_mfma_f32_32x32x16_bf16 v[144:159], v[64:67], v[44:47], v[144:159]
  s_add_u32 m0, s34, 63488
  s_mov_b32 s40, 1179648
  buffer_load_dwordx4 v19, s[16:19], s40 offen lds
  ds_read_b64_tr_b16 v[60:61], v10 offset:18816
  ds_read_b64_tr_b16 v[62:63], v10 offset:21120
  v_mfma_f32_32x32x16_bf16 v[160:175], v[68:71], v[44:47], v[160:175]
  s_add_u32 m0, s34, 53248
  s_mov_b32 s40, 1179648
  buffer_load_dwordx4 v20, s[12:15], s40 offen lds
  ds_read_b64_tr_b16 v[64:65], v10 offset:448
  ds_read_b64_tr_b16 v[66:67], v10 offset:2752
  v_mfma_f32_32x32x16_bf16 v[176:191], v[72:75], v[44:47], v[176:191]
  s_add_u32 m0, s34, 71680
  s_mov_b32 s40, 1179648
  buffer_load_dwordx4 v20, s[16:19], s40 offen lds
  ds_read_b64_tr_b16 v[68:69], v10 offset:18880
  ds_read_b64_tr_b16 v[70:71], v10 offset:21184
  v_mfma_f32_32x32x16_bf16 v[192:207], v[76:79], v[44:47], v[192:207]
  s_add_u32 m0, s34, 81920
  s_mov_b32 s40, 8192
  buffer_load_dwordx4 v22, s[24:27], s40 offen sc1 lds
  ds_read_b64_tr_b16 v[72:73], v10 offset:512
  ds_read_b64_tr_b16 v[74:75], v10 offset:2816
  s_waitcnt lgkmcnt(12)
  v_mfma_f32_32x32x16_bf16 v[80:95], v[48:51], v[32:35], v[80:95]
  s_add_u32 m0, s35, 61440
  s_mov_b32 s40, 1179648
  buffer_load_dwordx4 v21, s[44:47], s40 offen lds
  ds_read_b64_tr_b16 v[76:77], v10 offset:18944
  ds_read_b64_tr_b16 v[78:79], v10 offset:21248
  s_waitcnt lgkmcnt(12)
  v_mfma_f32_32x32x16_bf16 v[96:111], v[52:55], v[32:35], v[96:111]
  ds_read_b128 v[36:39], v13 offset:1024
  ds_read_b64_tr_b16 v[48:49], v10 offset:9536
  ds_read_b64_tr_b16 v[50:51], v10 offset:11840
  s_waitcnt lgkmcnt(13)
  v_mfma_f32_32x32x16_bf16 v[112:127], v[56:59], v[32:35], v[112:127]
  ds_read_b64_tr_b16 v[52:53], v10 offset:27968
  ds_read_b64_tr_b16 v[54:55], v10 offset:30272
  s_waitcnt lgkmcnt(13)
  v_mfma_f32_32x32x16_bf16 v[128:143], v[60:63], v[32:35], v[128:143]
  ds_read_b64_tr_b16 v[56:57], v10 offset:9600
  ds_read_b64_tr_b16 v[58:59], v10 offset:11904
  s_waitcnt lgkmcnt(13)
  v_mfma_f32_32x32x16_bf16 v[144:159], v[64:67], v[32:35], v[144:159]
  ds_read_b64_tr_b16 v[60:61], v10 offset:28032
  ds_read_b64_tr_b16 v[62:63], v10 offset:30336
  s_waitcnt lgkmcnt(13)
  v_mfma_f32_32x32x16_bf16 v[160:175], v[68:71], v[32:35], v[160:175]
  ds_read_b64_tr_b16 v[64:65], v10 offset:9664
  ds_read_b64_tr_b16 v[66:67], v10 offset:11968
  s_waitcnt lgkmcnt(13)
  v_mfma_f32_32x32x16_bf16 v[176:191], v[72:75], v[32:35], v[176:191]
  ds_read_b64_tr_b16 v[68:69], v10 offset:28096
  ds_read_b64_tr_b16 v[70:71], v10 offset:30400
  s_waitcnt lgkmcnt(13)
  v_mfma_f32_32x32x16_bf16 v[192:207], v[76:79], v[32:35], v[192:207]
  ds_read_b64_tr_b16 v[72:73], v10 offset:9728
  ds_read_b64_tr_b16 v[74:75], v10 offset:12032
  s_waitcnt lgkmcnt(12)
  v_mfma_f32_32x32x16_bf16 v[80:95], v[48:51], v[36:39], v[80:95]
  ds_read_b64_tr_b16 v[76:77], v10 offset:28160
  ds_read_b64_tr_b16 v[78:79], v10 offset:30464
  s_waitcnt lgkmcnt(12)
  v_mfma_f32_32x32x16_bf16 v[96:111], v[52:55], v[36:39], v[96:111]
  s_waitcnt lgkmcnt(10)
  v_mfma_f32_32x32x16_bf16 v[112:127], v[56:59], v[36:39], v[112:127]
  s_waitcnt vmcnt(6) lgkmcnt(0)
  s_barrier
  ds_read_b128 v[40:43], v11 offset:0
  ds_read_b64_tr_b16 v[48:49], v8 offset:320
  ds_read_b64_tr_b16 v[50:51], v8 offset:2624
  ds_read_b64_tr_b16 v[52:53], v8 offset:18752
  ds_read_b64_tr_b16 v[54:55], v8 offset:21056
  v_mfma_f32_32x32x16_bf16 v[128:143], v[60:63], v[36:39], v[128:143]
  s_add_u32 m0, s34, 90112
  s_mov_b32 s40, 1474560
  buffer_load_dwordx4 v19, s[12:15], s40 offen lds
  ds_read_b64_tr_b16 v[56:57], v8 offset:384
  ds_read_b64_tr_b16 v[58:59], v8 offset:2688
  v_mfma_f32_32x32x16_bf16 v[144:159], v[64:67], v[36:39], v[144:159]
  s_add_u32 m0, s34, 108544
  s_mov_b32 s40, 1474560
  buffer_load_dwordx4 v19, s[16:19], s40 offen lds
  ds_read_b64_tr_b16 v[60:61], v8 offset:18816
  ds_read_b64_tr_b16 v[62:63], v8 offset:21120
  v_mfma_f32_32x32x16_bf16 v[160:175], v[68:71], v[36:39], v[160:175]
  s_add_u32 m0, s34, 98304
  s_mov_b32 s40, 1474560
  buffer_load_dwordx4 v20, s[12:15], s40 offen lds
  ds_read_b64_tr_b16 v[64:65], v8 offset:448
  ds_read_b64_tr_b16 v[66:67], v8 offset:2752
  v_mfma_f32_32x32x16_bf16 v[176:191], v[72:75], v[36:39], v[176:191]
  s_add_u32 m0, s34, 116736
  s_mov_b32 s40, 1474560
  buffer_load_dwordx4 v20, s[16:19], s40 offen lds
  ds_read_b64_tr_b16 v[68:69], v8 offset:18880
  ds_read_b64_tr_b16 v[70:71], v8 offset:21184
  v_mfma_f32_32x32x16_bf16 v[192:207], v[76:79], v[36:39], v[192:207]
  s_add_u32 m0, s34, 126976
  s_mov_b32 s40, 10240
  buffer_load_dwordx4 v22, s[24:27], s40 offen sc1 lds
  ds_read_b64_tr_b16 v[72:73], v8 offset:512
  ds_read_b64_tr_b16 v[74:75], v8 offset:2816
  s_waitcnt lgkmcnt(12)
  v_mfma_f32_32x32x16_bf16 v[80:95], v[48:51], v[40:43], v[80:95]
  s_add_u32 m0, s35, 106496
  s_mov_b32 s40, 1474560
  buffer_load_dwordx4 v21, s[44:47], s40 offen lds
  ds_read_b64_tr_b16 v[76:77], v8 offset:18944
  ds_read_b64_tr_b16 v[78:79], v8 offset:21248
  s_waitcnt lgkmcnt(12)
  v_mfma_f32_32x32x16_bf16 v[96:111], v[52:55], v[40:43], v[96:111]
  ds_read_b128 v[44:47], v11 offset:1024
  ds_read_b64_tr_b16 v[48:49], v8 offset:9536
  ds_read_b64_tr_b16 v[50:51], v8 offset:11840
  s_waitcnt lgkmcnt(13)
  v_mfma_f32_32x32x16_bf16 v[112:127], v[56:59], v[40:43], v[112:127]
  ds_read_b64_tr_b16 v[52:53], v8 offset:27968
  ds_read_b64_tr_b16 v[54:55], v8 offset:30272
  s_waitcnt lgkmcnt(13)
  v_mfma_f32_32x32x16_bf16 v[128:143], v[60:63], v[40:43], v[128:143]
  ds_read_b64_tr_b16 v[56:57], v8 offset:9600
  ds_read_b64_tr_b16 v[58:59], v8 offset:11904
  s_waitcnt lgkmcnt(13)
  v_mfma_f32_32x32x16_bf16 v[144:159], v[64:67], v[40:43], v[144:159]
  ds_read_b64_tr_b16 v[60:61], v8 offset:28032
  ds_read_b64_tr_b16 v[62:63], v8 offset:30336
  s_waitcnt lgkmcnt(13)
  v_mfma_f32_32x32x16_bf16 v[160:175], v[68:71], v[40:43], v[160:175]
  ds_read_b64_tr_b16 v[64:65], v8 offset:9664
  ds_read_b64_tr_b16 v[66:67], v8 offset:11968
  s_waitcnt lgkmcnt(13)
  v_mfma_f32_32x32x16_bf16 v[176:191], v[72:75], v[40:43], v[176:191]
  ds_read_b64_tr_b16 v[68:69], v8 offset:28096
  ds_read_b64_tr_b16 v[70:71], v8 offset:30400
  s_waitcnt lgkmcnt(13)
  v_mfma_f32_32x32x16_bf16 v[192:207], v[76:79], v[40:43], v[192:207]
  ds_read_b64_tr_b16 v[72:73], v8 offset:9728
  ds_read_b64_tr_b16 v[74:75], v8 offset:12032
  s_waitcnt lgkmcnt(12)
  v_mfma_f32_32x32x16_bf16 v[80:95], v[48:51], v[44:47], v[80:95]
  ds_read_b64_tr_b16 v[76:77], v8 offset:28160
  ds_read_b64_tr_b16 v[78:79], v8 offset:30464
  s_waitcnt lgkmcnt(12)
  v_mfma_f32_32x32x16_bf16 v[96:111], v[52:55], v[44:47], v[96:111]
  s_waitcnt lgkmcnt(10)
  v_mfma_f32_32x32x16_bf16 v[112:127], v[56:59], v[44:47], v[112:127]
  s_waitcnt vmcnt(6) lgkmcnt(0)
  s_barrier
  ds_read_b128 v[32:35], v12 offset:0
  ds_read_b64_tr_b16 v[48:49], v9 offset:320
  ds_read_b64_tr_b16 v[50:51], v9 offset:2624
  ds_read_b64_tr_b16 v[52:53], v9 offset:18752
  ds_read_b64_tr_b16 v[54:55], v9 offset:21056
  v_mfma_f32_32x32x16_bf16 v[128:143], v[60:63], v[44:47], v[128:143]
  s_add_u32 m0, s34, 0
  s_mov_b32 s40, 1769472
  buffer_load_dwordx4 v19, s[12:15], s40 offen lds
  ds_read_b64_tr_b16 v[56:57], v9 offset:384
  ds_read_b64_tr_b16 v[58:59], v9 offset:2688
  v_mfma_f32_32x32x16_bf16 v[144:159], v[64:67], v[44:47], v[144:159]
  s_add_u32 m0, s34, 18432
  s_mov_b32 s40, 1769472
  buffer_load_dwordx4 v19, s[16:19], s40 offen lds
  ds_read_b64_tr_b16 v[60:61], v9 offset:18816
  ds_read_b64_tr_b16 v[62:63], v9 offset:21120
  v_mfma_f32_32x32x16_bf16 v[160:175], v[68:71], v[44:47], v[160:175]
  s_add_u32 m0, s34, 8192
  s_mov_b32 s40, 1769472
  buffer_load_dwordx4 v20, s[12:15], s40 offen lds
  ds_read_b64_tr_b16 v[64:65], v9 offset:448
  ds_read_b64_tr_b16 v[66:67], v9 offset:2752
  v_mfma_f32_32x32x16_bf16 v[176:191], v[72:75], v[44:47], v[176:191]
  s_add_u32 m0, s34, 26624
  s_mov_b32 s40, 1769472
  buffer_load_dwordx4 v20, s[16:19], s40 offen lds
  ds_read_b64_tr_b16 v[68:69], v9 offset:18880
  ds_read_b64_tr_b16 v[70:71], v9 offset:21184
  v_mfma_f32_32x32x16_bf16 v[192:207], v[76:79], v[44:47], v[192:207]
  s_add_u32 m0, s34, 36864
  s_mov_b32 s40, 12288
  buffer_load_dwordx4 v22, s[24:27], s40 offen sc1 lds
  ds_read_b64_tr_b16 v[72:73], v9 offset:512
  ds_read_b64_tr_b16 v[74:75], v9 offset:2816
  s_waitcnt lgkmcnt(12)
  v_mfma_f32_32x32x16_bf16 v[80:95], v[48:51], v[32:35], v[80:95]
  s_add_u32 m0, s35, 16384
  s_mov_b32 s40, 1769472
  buffer_load_dwordx4 v21, s[44:47], s40 offen lds
  ds_read_b64_tr_b16 v[76:77], v9 offset:18944
  ds_read_b64_tr_b16 v[78:79], v9 offset:21248
  s_waitcnt lgkmcnt(12)
  v_mfma_f32_32x32x16_bf16 v[96:111], v[52:55], v[32:35], v[96:111]
  ds_read_b128 v[36:39], v12 offset:1024
  ds_read_b64_tr_b16 v[48:49], v9 offset:9536
  ds_read_b64_tr_b16 v[50:51], v9 offset:11840
  s_waitcnt lgkmcnt(13)
  v_mfma_f32_32x32x16_bf16 v[112:127], v[56:59], v[32:35], v[112:127]
  ds_read_b64_tr_b16 v[52:53], v9 offset:27968
  ds_read_b64_tr_b16 v[54:55], v9 offset:30272
  s_waitcnt lgkmcnt(13)
  v_mfma_f32_32x32x16_bf16 v[128:143], v[60:63], v[32:35], v[128:143]
  ds_read_b64_tr_b16 v[56:57], v9 offset:9600
  ds_read_b64_tr_b16 v[58:59], v9 offset:11904
  s_waitcnt lgkmcnt(13)
  v_mfma_f32_32x32x16_bf16 v[144:159], v[64:67], v[32:35], v[144:159]
  ds_read_b64_tr_b16 v[60:61], v9 offset:28032
  ds_read_b64_tr_b16 v[62:63], v9 offset:30336
  s_waitcnt lgkmcnt(13)
  v_mfma_f32_32x32x16_bf16 v[160:175], v[68:71], v[32:35], v[160:175]
  ds_read_b64_tr_b16 v[64:65], v9 offset:9664
  ds_read_b64_tr_b16 v[66:67], v9 offset:11968
  s_waitcnt lgkmcnt(13)
  v_mfma_f32_32x32x16_bf16 v[176:191], v[72:75], v[32:35], v[176:191]
  ds_read_b64_tr_b16 v[68:69], v9 offset:28096
  ds_read_b64_tr_b16 v[70:71], v9 offset:30400
  s_waitcnt lgkmcnt(13)
  v_mfma_f32_32x32x16_bf16 v[192:207], v[76:79], v[32:35], v[192:207]
  ds_read_b64_tr_b16 v[72:73], v9 offset:9728
  ds_read_b64_tr_b16 v[74:75], v9 offset:12032
  s_waitcnt lgkmcnt(12)
  v_mfma_f32_32x32x16_bf16 v[80:95], v[48:51], v[36:39], v[80:95]
  ds_read_b64_tr_b16 v[76:77], v9 offset:28160
  ds_read_b64_tr_b16 v[78:79], v9 offset:30464
  s_waitcnt lgkmcnt(12)
  v_mfma_f32_32x32x16_bf16 v[96:111], v[52:55], v[36:39], v[96:111]
  s_waitcnt lgkmcnt(10)
  v_mfma_f32_32x32x16_bf16 v[112:127], v[56:59], v[36:39], v[112:127]
  s_waitcnt vmcnt(6) lgkmcnt(0)
  s_barrier
  ds_read_b128 v[40:43], v13 offset:0
  ds_read_b64_tr_b16 v[48:49], v10 offset:320
  ds_read_b64_tr_b16 v[50:51], v10 offset:2624
  ds_read_b64_tr_b16 v[52:53], v10 offset:18752
  ds_read_b64_tr_b16 v[54:55], v10 offset:21056
  v_mfma_f32_32x32x16_bf16 v[128:143], v[60:63], v[36:39], v[128:143]
  s_add_u32 m0, s34, 45056
  s_mov_b32 s40, 2064384
  buffer_load_dwordx4 v19, s[12:15], s40 offen lds
  ds_read_b64_tr_b16 v[56:57], v10 offset:384
  ds_read_b64_tr_b16 v[58:59], v10 offset:2688
  v_mfma_f32_32x32x16_bf16 v[144:159], v[64:67], v[36:39], v[144:159]
  s_add_u32 m0, s34, 63488
  s_mov_b32 s40, 2064384
  buffer_load_dwordx4 v19, s[16:19], s40 offen lds
  ds_read_b64_tr_b16 v[60:61], v10 offset:18816
  ds_read_b64_tr_b16 v[62:63], v10 offset:21120
  v_mfma_f32_32x32x16_bf16 v[160:175], v[68:71], v[36:39], v[160:175]
  s_add_u32 m0, s34, 53248
  s_mov_b32 s40, 2064384
  buffer_load_dwordx4 v20, s[12:15], s40 offen lds
  ds_read_b64_tr_b16 v[64:65], v10 offset:448
  ds_read_b64_tr_b16 v[66:67], v10 offset:2752
  v_mfma_f32_32x32x16_bf16 v[176:191], v[72:75], v[36:39], v[176:191]
  s_add_u32 m0, s34, 71680
  s_mov_b32 s40, 2064384
  buffer_load_dwordx4 v20, s[16:19], s40 offen lds
  ds_read_b64_tr_b16 v[68:69], v10 offset:18880
  ds_read_b64_tr_b16 v[70:71], v10 offset:21184
  v_mfma_f32_32x32x16_bf16 v[192:207], v[76:79], v[36:39], v[192:207]
  s_add_u32 m0, s34, 81920
  s_mov_b32 s40, 14336
  buffer_load_dwordx4 v22, s[24:27], s40 offen sc1 lds
  ds_read_b64_tr_b16 v[72:73], v10 offset:512
  ds_read_b64_tr_b16 v[74:75], v10 offset:2816
  s_waitcnt lgkmcnt(12)
  v_mfma_f32_32x32x16_bf16 v[80:95], v[48:51], v[40:43], v[80:95]
  s_add_u32 m0, s35, 61440
  s_mov_b32 s40, 2064384
  buffer_load_dwordx4 v21, s[44:47], s40 offen lds
  ds_read_b64_tr_b16 v[76:77], v10 offset:18944
  ds_read_b64_tr_b16 v[78:79], v10 offset:21248
  s_waitcnt lgkmcnt(12)
  v_mfma_f32_32x32x16_bf16 v[96:111], v[52:55], v[40:43], v[96:111]
  ds_read_b128 v[44:47], v13 offset:1024
  ds_read_b64_tr_b16 v[48:49], v10 offset:9536
  ds_read_b64_tr_b16 v[50:51], v10 offset:11840
  s_waitcnt lgkmcnt(13)
  v_mfma_f32_32x32x16_bf16 v[112:127], v[56:59], v[40:43], v[112:127]
  ds_read_b64_tr_b16 v[52:53], v10 offset:27968
  ds_read_b64_tr_b16 v[54:55], v10 offset:30272
  s_waitcnt lgkmcnt(13)
  v_mfma_f32_32x32x16_bf16 v[128:143], v[60:63], v[40:43], v[128:143]
  ds_read_b64_tr_b16 v[56:57], v10 offset:9600
  ds_read_b64_tr_b16 v[58:59], v10 offset:11904
  s_waitcnt lgkmcnt(13)
  v_mfma_f32_32x32x16_bf16 v[144:159], v[64:67], v[40:43], v[144:159]
  ds_read_b64_tr_b16 v[60:61], v10 offset:28032
  ds_read_b64_tr_b16 v[62:63], v10 offset:30336
  s_waitcnt lgkmcnt(13)
  v_mfma_f32_32x32x16_bf16 v[160:175], v[68:71], v[40:43], v[160:175]
  ds_read_b64_tr_b16 v[64:65], v10 offset:9664
  ds_read_b64_tr_b16 v[66:67], v10 offset:11968
  s_waitcnt lgkmcnt(13)
  v_mfma_f32_32x32x16_bf16 v[176:191], v[72:75], v[40:43], v[176:191]
  ds_read_b64_tr_b16 v[68:69], v10 offset:28096
  ds_read_b64_tr_b16 v[70:71], v10 offset:30400
  s_waitcnt lgkmcnt(13)
  v_mfma_f32_32x32x16_bf16 v[192:207], v[76:79], v[40:43], v[192:207]
  ds_read_b64_tr_b16 v[72:73], v10 offset:9728
  ds_read_b64_tr_b16 v[74:75], v10 offset:12032
  s_waitcnt lgkmcnt(12)
  v_mfma_f32_32x32x16_bf16 v[80:95], v[48:51], v[44:47], v[80:95]
  ds_read_b64_tr_b16 v[76:77], v10 offset:28160
  ds_read_b64_tr_b16 v[78:79], v10 offset:30464
  s_waitcnt lgkmcnt(12)
  v_mfma_f32_32x32x16_bf16 v[96:111], v[52:55], v[44:47], v[96:111]
  s_waitcnt lgkmcnt(10)
  v_mfma_f32_32x32x16_bf16 v[112:127], v[56:59], v[44:47], v[112:127]
  s_waitcnt vmcnt(6) lgkmcnt(0)
  s_barrier
  ds_read_b128 v[32:35], v11 offset:0
  ds_read_b64_tr_b16 v[48:49], v8 offset:320
  ds_read_b64_tr_b16 v[50:51], v8 offset:2624
  ds_read_b64_tr_b16 v[52:53], v8 offset:18752
  ds_read_b64_tr_b16 v[54:55], v8 offset:21056
  v_mfma_f32_32x32x16_bf16 v[128:143], v[60:63], v[44:47], v[128:143]
  s_add_u32 m0, s34, 90112
  s_mov_b32 s40, 2359296
  buffer_load_dwordx4 v19, s[12:15], s40 offen lds
  ds_read_b64_tr_b16 v[56:57], v8 offset:384
  ds_read_b64_tr_b16 v[58:59], v8 offset:2688
  v_mfma_f32_32x32x16_bf16 v[144:159], v[64:67], v[44:47], v[144:159]
  s_add_u32 m0, s34, 108544
  s_mov_b32 s40, 2359296
  buffer_load_dwordx4 v19, s[16:19], s40 offen lds
  ds_read_b64_tr_b16 v[60:61], v8 offset:18816
  ds_read_b64_tr_b16 v[62:63], v8 offset:21120
  v_mfma_f32_32x32x16_bf16 v[160:175], v[68:71], v[44:47], v[160:175]
  s_add_u32 m0, s34, 98304
  s_mov_b32 s40, 2359296
  buffer_load_dwordx4 v20, s[12:15], s40 offen lds
  ds_read_b64_tr_b16 v[64:65], v8 offset:448
  ds_read_b64_tr_b16 v[66:67], v8 offset:2752
  v_mfma_f32_32x32x16_bf16 v[176:191], v[72:75], v[44:47], v[176:191]
  s_add_u32 m0, s34, 116736
  s_mov_b32 s40, 2359296
  buffer_load_dwordx4 v20, s[16:19], s40 offen lds
  ds_read_b64_tr_b16 v[68:69], v8 offset:18880
  ds_read_b64_tr_b16 v[70:71], v8 offset:21184
  v_mfma_f32_32x32x16_bf16 v[192:207], v[76:79], v[44:47], v[192:207]
  s_add_u32 m0, s34, 126976
  s_mov_b32 s40, 16384
  buffer_load_dwordx4 v22, s[24:27], s40 offen sc1 lds
  ds_read_b64_tr_b16 v[72:73], v8 offset:512
  ds_read_b64_tr_b16 v[74:75], v8 offset:2816
  s_waitcnt lgkmcnt(12)
  v_mfma_f32_32x32x16_bf16 v[80:95], v[48:51], v[32:35], v[80:95]
  s_add_u32 m0, s35, 106496
  s_mov_b32 s40, 2359296
  buffer_load_dwordx4 v21, s[44:47], s40 offen lds
  ds_read_b64_tr_b16 v[76:77], v8 offset:18944
  ds_read_b64_tr_b16 v[78:79], v8 offset:21248
  s_waitcnt lgkmcnt(12)
  v_mfma_f32_32x32x16_bf16 v[96:111], v[52:55], v[32:35], v[96:111]
  ds_read_b128 v[36:39], v11 offset:1024
  ds_read_b64_tr_b16 v[48:49], v8 offset:9536
  ds_read_b64_tr_b16 v[50:51], v8 offset:11840
  s_waitcnt lgkmcnt(13)
  v_mfma_f32_32x32x16_bf16 v[112:127], v[56:59], v[32:35], v[112:127]
  ds_read_b64_tr_b16 v[52:53], v8 offset:27968
  ds_read_b64_tr_b16 v[54:55], v8 offset:30272
  s_waitcnt lgkmcnt(13)
  v_mfma_f32_32x32x16_bf16 v[128:143], v[60:63], v[32:35], v[128:143]
  ds_read_b64_tr_b16 v[56:57], v8 offset:9600
  ds_read_b64_tr_b16 v[58:59], v8 offset:11904
  s_waitcnt lgkmcnt(13)
  v_mfma_f32_32x32x16_bf16 v[144:159], v[64:67], v[32:35], v[144:159]
  ds_read_b64_tr_b16 v[60:61], v8 offset:28032
  ds_read_b64_tr_b16 v[62:63], v8 offset:30336
  s_waitcnt lgkmcnt(13)
  v_mfma_f32_32x32x16_bf16 v[160:175], v[68:71], v[32:35], v[160:175]
  ds_read_b64_tr_b16 v[64:65], v8 offset:9664
  ds_read_b64_tr_b16 v[66:67], v8 offset:11968
  s_waitcnt lgkmcnt(13)
  v_mfma_f32_32x32x16_bf16 v[176:191], v[72:75], v[32:35], v[176:191]
  ds_read_b64_tr_b16 v[68:69], v8 offset:28096
  ds_read_b64_tr_b16 v[70:71], v8 offset:30400
  s_waitcnt lgkmcnt(13)
  v_mfma_f32_32x32x16_bf16 v[192:207], v[76:79], v[32:35], v[192:207]
  ds_read_b64_tr_b16 v[72:73], v8 offset:9728
  ds_read_b64_tr_b16 v[74:75], v8 offset:12032
  s_waitcnt lgkmcnt(12)
  v_mfma_f32_32x32x16_bf16 v[80:95], v[48:51], v[36:39], v[80:95]
  ds_read_b64_tr_b16 v[76:77], v8 offset:28160
  ds_read_b64_tr_b16 v[78:79], v8 offset:30464
  s_waitcnt lgkmcnt(12)
  v_mfma_f32_32x32x16_bf16 v[96:111], v[52:55], v[36:39], v[96:111]
  s_waitcnt lgkmcnt(10)
  v_mfma_f32_32x32x16_bf16 v[112:127], v[56:59], v[36:39], v[112:127]
  s_waitcnt vmcnt(6) lgkmcnt(0)
  s_barrier
  ds_read_b128 v[40:43], v12 offset:0
  ds_read_b64_tr_b16 v[48:49], v9 offset:320
  ds_read_b64_tr_b16 v[50:51], v9 offset:2624
  ds_read_b64_tr_b16 v[52:53], v9 offset:18752
  ds_read_b64_tr_b16 v[54:55], v9 offset:21056
  v_mfma_f32_32x32x16_bf16 v[128:143], v[60:63], v[36:39], v[128:143]
  s_add_u32 m0, s34, 0
  s_mov_b32 s40, 2654208
  buffer_load_dwordx4 v19, s[12:15], s40 offen lds
  ds_read_b64_tr_b16 v[56:57], v9 offset:384
  ds_read_b64_tr_b16 v[58:59], v9 offset:2688
  v_mfma_f32_32x32x16_bf16 v[144:159], v[64:67], v[36:39], v[144:159]
  s_add_u32 m0, s34, 18432
  s_mov_b32 s40, 2654208
  buffer_load_dwordx4 v19, s[16:19], s40 offen lds
  ds_read_b64_tr_b16 v[60:61], v9 offset:18816
  ds_read_b64_tr_b16 v[62:63], v9 offset:21120
  v_mfma_f32_32x32x16_bf16 v[160:175], v[68:71], v[36:39], v[160:175]
  s_add_u32 m0, s34, 8192
  s_mov_b32 s40, 2654208
  buffer_load_dwordx4 v20, s[12:15], s40 offen lds
  ds_read_b64_tr_b16 v[64:65], v9 offset:448
  ds_read_b64_tr_b16 v[66:67], v9 offset:2752
  v_mfma_f32_32x32x16_bf16 v[176:191], v[72:75], v[36:39], v[176:191]
  s_add_u32 m0, s34, 26624
  s_mov_b32 s40, 2654208
  buffer_load_dwordx4 v20, s[16:19], s40 offen lds
  ds_read_b64_tr_b16 v[68:69], v9 offset:18880
  ds_read_b64_tr_b16 v[70:71], v9 offset:21184
  v_mfma_f32_32x32x16_bf16 v[192:207], v[76:79], v[36:39], v[192:207]
  s_add_u32 m0, s34, 36864
  s_mov_b32 s40, 18432
  buffer_load_dwordx4 v22, s[24:27], s40 offen sc1 lds
  ds_read_b64_tr_b16 v[72:73], v9 offset:512
  ds_read_b64_tr_b16 v[74:75], v9 offset:2816
  s_waitcnt lgkmcnt(12)
  v_mfma_f32_32x32x16_bf16 v[80:95], v[48:51], v[40:43], v[80:95]
  s_add_u32 m0, s35, 16384
  s_mov_b32 s40, 2654208
  buffer_load_dwordx4 v21, s[44:47], s40 offen lds
  ds_read_b64_tr_b16 v[76:77], v9 offset:18944
  ds_read_b64_tr_b16 v[78:79], v9 offset:21248
  s_waitcnt lgkmcnt(12)
  v_mfma_f32_32x32x16_bf16 v[96:111], v[52:55], v[40:43], v[96:111]
  ds_read_b128 v[44:47], v12 offset:1024
  ds_read_b64_tr_b16 v[48:49], v9 offset:9536
  ds_read_b64_tr_b16 v[50:51], v9 offset:11840
  s_waitcnt lgkmcnt(13)
  v_mfma_f32_32x32x16_bf16 v[112:127], v[56:59], v[40:43], v[112:127]
  ds_read_b64_tr_b16 v[52:53], v9 offset:27968
  ds_read_b64_tr_b16 v[54:55], v9 offset:30272
  s_waitcnt lgkmcnt(13)
  v_mfma_f32_32x32x16_bf16 v[128:143], v[60:63], v[40:43], v[128:143]
  ds_read_b64_tr_b16 v[56:57], v9 offset:9600
  ds_read_b64_tr_b16 v[58:59], v9 offset:11904
  s_waitcnt lgkmcnt(13)
  v_mfma_f32_32x32x16_bf16 v[144:159], v[64:67], v[40:43], v[144:159]
  ds_read_b64_tr_b16 v[60:61], v9 offset:28032
  ds_read_b64_tr_b16 v[62:63], v9 offset:30336
  s_waitcnt lgkmcnt(13)
  v_mfma_f32_32x32x16_bf16 v[160:175], v[68:71], v[40:43], v[160:175]
  ds_read_b64_tr_b16 v[64:65], v9 offset:9664
  ds_read_b64_tr_b16 v[66:67], v9 offset:11968
  s_waitcnt lgkmcnt(13)
  v_mfma_f32_32x32x16_bf16 v[176:191], v[72:75], v[40:43], v[176:191]
  ds_read_b64_tr_b16 v[68:69], v9 offset:28096
  ds_read_b64_tr_b16 v[70:71], v9 offset:30400
  s_waitcnt lgkmcnt(13)
  v_mfma_f32_32x32x16_bf16 v[192:207], v[76:79], v[40:43], v[192:207]
  ds_read_b64_tr_b16 v[72:73], v9 offset:9728
  ds_read_b64_tr_b16 v[74:75], v9 offset:12032
  s_waitcnt lgkmcnt(12)
  v_mfma_f32_32x32x16_bf16 v[80:95], v[48:51], v[44:47], v[80:95]
  ds_read_b64_tr_b16 v[76:77], v9 offset:28160
  ds_read_b64_tr_b16 v[78:79], v9 offset:30464
  s_waitcnt lgkmcnt(12)
  v_mfma_f32_32x32x16_bf16 v[96:111], v[52:55], v[44:47], v[96:111]
  s_waitcnt lgkmcnt(10)
  v_mfma_f32_32x32x16_bf16 v[112:127], v[56:59], v[44:47], v[112:127]
  s_waitcnt vmcnt(6) lgkmcnt(0)
  s_barrier
  ds_read_b128 v[32:35], v13 offset:0
  ds_read_b64_tr_b16 v[48:49], v10 offset:320
  ds_read_b64_tr_b16 v[50:51], v10 offset:2624
  ds_read_b64_tr_b16 v[52:53], v10 offset:18752
  ds_read_b64_tr_b16 v[54:55], v10 offset:21056
  v_mfma_f32_32x32x16_bf16 v[128:143], v[60:63], v[44:47], v[128:143]
  s_add_u32 m0, s34, 45056
  s_mov_b32 s40, 2949120
  buffer_load_dwordx4 v19, s[12:15], s40 offen lds
  ds_read_b64_tr_b16 v[56:57], v10 offset:384
  ds_read_b64_tr_b16 v[58:59], v10 offset:2688
  v_mfma_f32_32x32x16_bf16 v[144:159], v[64:67], v[44:47], v[144:159]
  s_add_u32 m0, s34, 63488
  s_mov_b32 s40, 2949120
  buffer_load_dwordx4 v19, s[16:19], s40 offen lds
  ds_read_b64_tr_b16 v[60:61], v10 offset:18816
  ds_read_b64_tr_b16 v[62:63], v10 offset:21120
  v_mfma_f32_32x32x16_bf16 v[160:175], v[68:71], v[44:47], v[160:175]
  s_add_u32 m0, s34, 53248
  s_mov_b32 s40, 2949120
  buffer_load_dwordx4 v20, s[12:15], s40 offen lds
  ds_read_b64_tr_b16 v[64:65], v10 offset:448
  ds_read_b64_tr_b16 v[66:67], v10 offset:2752
  v_mfma_f32_32x32x16_bf16 v[176:191], v[72:75], v[44:47], v[176:191]
  s_add_u32 m0, s34, 71680
  s_mov_b32 s40, 2949120
  buffer_load_dwordx4 v20, s[16:19], s40 offen lds
  ds_read_b64_tr_b16 v[68:69], v10 offset:18880
  ds_read_b64_tr_b16 v[70:71], v10 offset:21184
  v_mfma_f32_32x32x16_bf16 v[192:207], v[76:79], v[44:47], v[192:207]
  s_add_u32 m0, s34, 81920
  s_mov_b32 s40, 20480
  buffer_load_dwordx4 v22, s[24:27], s40 offen sc1 lds
  ds_read_b64_tr_b16 v[72:73], v10 offset:512
  ds_read_b64_tr_b16 v[74:75], v10 offset:2816
  s_waitcnt lgkmcnt(12)
  v_mfma_f32_32x32x16_bf16 v[80:95], v[48:51], v[32:35], v[80:95]
  s_add_u32 m0, s35, 61440
  s_mov_b32 s40, 2949120
  buffer_load_dwordx4 v21, s[44:47], s40 offen lds
  ds_read_b64_tr_b16 v[76:77], v10 offset:18944
  ds_read_b64_tr_b16 v[78:79], v10 offset:21248
  s_waitcnt lgkmcnt(12)
  v_mfma_f32_32x32x16_bf16 v[96:111], v[52:55], v[32:35], v[96:111]
  ds_read_b128 v[36:39], v13 offset:1024
  ds_read_b64_tr_b16 v[48:49], v10 offset:9536
  ds_read_b64_tr_b16 v[50:51], v10 offset:11840
  s_waitcnt lgkmcnt(13)
  v_mfma_f32_32x32x16_bf16 v[112:127], v[56:59], v[32:35], v[112:127]
  ds_read_b64_tr_b16 v[52:53], v10 offset:27968
  ds_read_b64_tr_b16 v[54:55], v10 offset:30272
  s_waitcnt lgkmcnt(13)
  v_mfma_f32_32x32x16_bf16 v[128:143], v[60:63], v[32:35], v[128:143]
  ds_read_b64_tr_b16 v[56:57], v10 offset:9600
  ds_read_b64_tr_b16 v[58:59], v10 offset:11904
  s_waitcnt lgkmcnt(13)
  v_mfma_f32_32x32x16_bf16 v[144:159], v[64:67], v[32:35], v[144:159]
  ds_read_b64_tr_b16 v[60:61], v10 offset:28032
  ds_read_b64_tr_b16 v[62:63], v10 offset:30336
  s_waitcnt lgkmcnt(13)
  v_mfma_f32_32x32x16_bf16 v[160:175], v[68:71], v[32:35], v[160:175]
  ds_read_b64_tr_b16 v[64:65], v10 offset:9664
  ds_read_b64_tr_b16 v[66:67], v10 offset:11968
  s_waitcnt lgkmcnt(13)
  v_mfma_f32_32x32x16_bf16 v[176:191], v[72:75], v[32:35], v[176:191]
  ds_read_b64_tr_b16 v[68:69], v10 offset:28096
  ds_read_b64_tr_b16 v[70:71], v10 offset:30400
  s_waitcnt lgkmcnt(13)
  v_mfma_f32_32x32x16_bf16 v[192:207], v[76:79], v[32:35], v[192:207]
  ds_read_b64_tr_b16 v[72:73], v10 offset:9728
  ds_read_b64_tr_b16 v[74:75], v10 offset:12032
  s_waitcnt lgkmcnt(12)
  v_mfma_f32_32x32x16_bf16 v[80:95], v[48:51], v[36:39], v[80:95]
  ds_read_b64_tr_b16 v[76:77], v10 offset:28160
  ds_read_b64_tr_b16 v[78:79], v10 offset:30464
  s_waitcnt lgkmcnt(12)
  v_mfma_f32_32x32x16_bf16 v[96:111], v[52:55], v[36:39], v[96:111]
  s_waitcnt lgkmcnt(10)
  v_mfma_f32_32x32x16_bf16 v[112:127], v[56:59], v[36:39], v[112:127]
  s_waitcnt vmcnt(6) lgkmcnt(0)
  s_barrier
  ds_read_b128 v[40:43], v11 offset:0
  ds_read_b64_tr_b16 v[48:49], v8 offset:320
  ds_read_b64_tr_b16 v[50:51], v8 offset:2624
  ds_read_b64_tr_b16 v[52:53], v8 offset:18752
  ds_read_b64_tr_b16 v[54:55], v8 offset:21056
  v_mfma_f32_32x32x16_bf16 v[128:143], v[60:63], v[36:39], v[128:143]
  s_add_u32 m0, s34, 90112
  s_mov_b32 s40, 3244032
  buffer_load_dwordx4 v19, s[12:15], s40 offen lds
  ds_read_b64_tr_b16 v[56:57], v8 offset:384
  ds_read_b64_tr_b16 v[58:59], v8 offset:2688
  v_mfma_f32_32x32x16_bf16 v[144:159], v[64:67], v[36:39], v[144:159]
  s_add_u32 m0, s34, 108544
  s_mov_b32 s40, 3244032
  buffer_load_dwordx4 v19, s[16:19], s40 offen lds
  ds_read_b64_tr_b16 v[60:61], v8 offset:18816
  ds_read_b64_tr_b16 v[62:63], v8 offset:21120
  v_mfma_f32_32x32x16_bf16 v[160:175], v[68:71], v[36:39], v[160:175]
  s_add_u32 m0, s34, 98304
  s_mov_b32 s40, 3244032
  buffer_load_dwordx4 v20, s[12:15], s40 offen lds
  ds_read_b64_tr_b16 v[64:65], v8 offset:448
  ds_read_b64_tr_b16 v[66:67], v8 offset:2752
  v_mfma_f32_32x32x16_bf16 v[176:191], v[72:75], v[36:39], v[176:191]
  s_add_u32 m0, s34, 116736
  s_mov_b32 s40, 3244032
  buffer_load_dwordx4 v20, s[16:19], s40 offen lds
  ds_read_b64_tr_b16 v[68:69], v8 offset:18880
  ds_read_b64_tr_b16 v[70:71], v8 offset:21184
  v_mfma_f32_32x32x16_bf16 v[192:207], v[76:79], v[36:39], v[192:207]
  s_add_u32 m0, s34, 126976
  s_mov_b32 s40, 22528
  buffer_load_dwordx4 v22, s[24:27], s40 offen sc1 lds
  ds_read_b64_tr_b16 v[72:73], v8 offset:512
  ds_read_b64_tr_b16 v[74:75], v8 offset:2816
  s_waitcnt lgkmcnt(12)
  v_mfma_f32_32x32x16_bf16 v[80:95], v[48:51], v[40:43], v[80:95]
  s_add_u32 m0, s35, 106496
  s_mov_b32 s40, 3244032
  buffer_load_dwordx4 v21, s[44:47], s40 offen lds
  ds_read_b64_tr_b16 v[76:77], v8 offset:18944
  ds_read_b64_tr_b16 v[78:79], v8 offset:21248
  s_waitcnt lgkmcnt(12)
  v_mfma_f32_32x32x16_bf16 v[96:111], v[52:55], v[40:43], v[96:111]
  ds_read_b128 v[44:47], v11 offset:1024
  ds_read_b64_tr_b16 v[48:49], v8 offset:9536
  ds_read_b64_tr_b16 v[50:51], v8 offset:11840
  s_waitcnt lgkmcnt(13)
  v_mfma_f32_32x32x16_bf16 v[112:127], v[56:59], v[40:43], v[112:127]
  ds_read_b64_tr_b16 v[52:53], v8 offset:27968
  ds_read_b64_tr_b16 v[54:55], v8 offset:30272
  s_waitcnt lgkmcnt(13)
  v_mfma_f32_32x32x16_bf16 v[128:143], v[60:63], v[40:43], v[128:143]
  ds_read_b64_tr_b16 v[56:57], v8 offset:9600
  ds_read_b64_tr_b16 v[58:59], v8 offset:11904
  s_waitcnt lgkmcnt(13)
  v_mfma_f32_32x32x16_bf16 v[144:159], v[64:67], v[40:43], v[144:159]
  ds_read_b64_tr_b16 v[60:61], v8 offset:28032
  ds_read_b64_tr_b16 v[62:63], v8 offset:30336
  s_waitcnt lgkmcnt(13)
  v_mfma_f32_32x32x16_bf16 v[160:175], v[68:71], v[40:43], v[160:175]
  ds_read_b64_tr_b16 v[64:65], v8 offset:9664
  ds_read_b64_tr_b16 v[66:67], v8 offset:11968
  s_waitcnt lgkmcnt(13)
  v_mfma_f32_32x32x16_bf16 v[176:191], v[72:75], v[40:43], v[176:191]
  ds_read_b64_tr_b16 v[68:69], v8 offset:28096
  ds_read_b64_tr_b16 v[70:71], v8 offset:30400
  s_waitcnt lgkmcnt(13)
  v_mfma_f32_32x32x16_bf16 v[192:207], v[76:79], v[40:43], v[192:207]
  ds_read_b64_tr_b16 v[72:73], v8 offset:9728
  ds_read_b64_tr_b16 v[74:75], v8 offset:12032
  s_waitcnt lgkmcnt(12)
  v_mfma_f32_32x32x16_bf16 v[80:95], v[48:51], v[44:47], v[80:95]
  ds_read_b64_tr_b16 v[76:77], v8 offset:28160
  ds_read_b64_tr_b16 v[78:79], v8 offset:30464
  s_waitcnt lgkmcnt(12)
  v_mfma_f32_32x32x16_bf16 v[96:111], v[52:55], v[44:47], v[96:111]
  s_waitcnt lgkmcnt(10)
  v_mfma_f32_32x32x16_bf16 v[112:127], v[56:59], v[44:47], v[112:127]
  s_waitcnt vmcnt(6) lgkmcnt(0)
  s_barrier
  ds_read_b128 v[32:35], v12 offset:0
  ds_read_b64_tr_b16 v[48:49], v9 offset:320
  ds_read_b64_tr_b16 v[50:51], v9 offset:2624
  ds_read_b64_tr_b16 v[52:53], v9 offset:18752
  ds_read_b64_tr_b16 v[54:55], v9 offset:21056
  v_mfma_f32_32x32x16_bf16 v[128:143], v[60:63], v[44:47], v[128:143]
  s_add_u32 m0, s34, 0
  s_mov_b32 s40, 3538944
  buffer_load_dwordx4 v19, s[12:15], s40 offen lds
  ds_read_b64_tr_b16 v[56:57], v9 offset:384
  ds_read_b64_tr_b16 v[58:59], v9 offset:2688
  v_mfma_f32_32x32x16_bf16 v[144:159], v[64:67], v[44:47], v[144:159]
  s_add_u32 m0, s34, 18432
  s_mov_b32 s40, 3538944
  buffer_load_dwordx4 v19, s[16:19], s40 offen lds
  ds_read_b64_tr_b16 v[60:61], v9 offset:18816
  ds_read_b64_tr_b16 v[62:63], v9 offset:21120
  v_mfma_f32_32x32x16_bf16 v[160:175], v[68:71], v[44:47], v[160:175]
  s_add_u32 m0, s34, 8192
  s_mov_b32 s40, 3538944
  buffer_load_dwordx4 v20, s[12:15], s40 offen lds
  ds_read_b64_tr_b16 v[64:65], v9 offset:448
  ds_read_b64_tr_b16 v[66:67], v9 offset:2752
  v_mfma_f32_32x32x16_bf16 v[176:191], v[72:75], v[44:47], v[176:191]
  s_add_u32 m0, s34, 26624
  s_mov_b32 s40, 3538944
  buffer_load_dwordx4 v20, s[16:19], s40 offen lds
  ds_read_b64_tr_b16 v[68:69], v9 offset:18880
  ds_read_b64_tr_b16 v[70:71], v9 offset:21184
  v_mfma_f32_32x32x16_bf16 v[192:207], v[76:79], v[44:47], v[192:207]
  s_add_u32 m0, s34, 36864
  s_mov_b32 s40, 24576
  buffer_load_dwordx4 v22, s[24:27], s40 offen sc1 lds
  ds_read_b64_tr_b16 v[72:73], v9 offset:512
  ds_read_b64_tr_b16 v[74:75], v9 offset:2816
  s_waitcnt lgkmcnt(12)
  v_mfma_f32_32x32x16_bf16 v[80:95], v[48:51], v[32:35], v[80:95]
  s_add_u32 m0, s35, 16384
  s_mov_b32 s40, 3538944
  buffer_load_dwordx4 v21, s[44:47], s40 offen lds
  ds_read_b64_tr_b16 v[76:77], v9 offset:18944
  ds_read_b64_tr_b16 v[78:79], v9 offset:21248
  s_waitcnt lgkmcnt(12)
  v_mfma_f32_32x32x16_bf16 v[96:111], v[52:55], v[32:35], v[96:111]
  ds_read_b128 v[36:39], v12 offset:1024
  ds_read_b64_tr_b16 v[48:49], v9 offset:9536
  ds_read_b64_tr_b16 v[50:51], v9 offset:11840
  s_waitcnt lgkmcnt(13)
  v_mfma_f32_32x32x16_bf16 v[112:127], v[56:59], v[32:35], v[112:127]
  ds_read_b64_tr_b16 v[52:53], v9 offset:27968
  ds_read_b64_tr_b16 v[54:55], v9 offset:30272
  s_waitcnt lgkmcnt(13)
  v_mfma_f32_32x32x16_bf16 v[128:143], v[60:63], v[32:35], v[128:143]
  ds_read_b64_tr_b16 v[56:57], v9 offset:9600
  ds_read_b64_tr_b16 v[58:59], v9 offset:11904
  s_waitcnt lgkmcnt(13)
  v_mfma_f32_32x32x16_bf16 v[144:159], v[64:67], v[32:35], v[144:159]
  ds_read_b64_tr_b16 v[60:61], v9 offset:28032
  ds_read_b64_tr_b16 v[62:63], v9 offset:30336
  s_waitcnt lgkmcnt(13)
  v_mfma_f32_32x32x16_bf16 v[160:175], v[68:71], v[32:35], v[160:175]
  ds_read_b64_tr_b16 v[64:65], v9 offset:9664
  ds_read_b64_tr_b16 v[66:67], v9 offset:11968
  s_waitcnt lgkmcnt(13)
  v_mfma_f32_32x32x16_bf16 v[176:191], v[72:75], v[32:35], v[176:191]
  ds_read_b64_tr_b16 v[68:69], v9 offset:28096
  ds_read_b64_tr_b16 v[70:71], v9 offset:30400
  s_waitcnt lgkmcnt(13)
  v_mfma_f32_32x32x16_bf16 v[192:207], v[76:79], v[32:35], v[192:207]
  ds_read_b64_tr_b16 v[72:73], v9 offset:9728
  ds_read_b64_tr_b16 v[74:75], v9 offset:12032
  s_waitcnt lgkmcnt(12)
  v_mfma_f32_32x32x16_bf16 v[80:95], v[48:51], v[36:39], v[80:95]
  ds_read_b64_tr_b16 v[76:77], v9 offset:28160
  ds_read_b64_tr_b16 v[78:79], v9 offset:30464
  s_waitcnt lgkmcnt(12)
  v_mfma_f32_32x32x16_bf16 v[96:111], v[52:55], v[36:39], v[96:111]
  s_waitcnt lgkmcnt(10)
  v_mfma_f32_32x32x16_bf16 v[112:127], v[56:59], v[36:39], v[112:127]
  s_waitcnt vmcnt(6) lgkmcnt(0)
  s_barrier
  ds_read_b128 v[40:43], v13 offset:0
  ds_read_b64_tr_b16 v[48:49], v10 offset:320
  ds_read_b64_tr_b16 v[50:51], v10 offset:2624
  ds_read_b64_tr_b16 v[52:53], v10 offset:18752
  ds_read_b64_tr_b16 v[54:55], v10 offset:21056
  v_mfma_f32_32x32x16_bf16 v[128:143], v[60:63], v[36:39], v[128:143]
  s_add_u32 m0, s34, 45056
  s_mov_b32 s40, 3833856
  buffer_load_dwordx4 v19, s[12:15], s40 offen lds
  ds_read_b64_tr_b16 v[56:57], v10 offset:384
  ds_read_b64_tr_b16 v[58:59], v10 offset:2688
  v_mfma_f32_32x32x16_bf16 v[144:159], v[64:67], v[36:39], v[144:159]
  s_add_u32 m0, s34, 63488
  s_mov_b32 s40, 3833856
  buffer_load_dwordx4 v19, s[16:19], s40 offen lds
  ds_read_b64_tr_b16 v[60:61], v10 offset:18816
  ds_read_b64_tr_b16 v[62:63], v10 offset:21120
  v_mfma_f32_32x32x16_bf16 v[160:175], v[68:71], v[36:39], v[160:175]
  s_add_u32 m0, s34, 53248
  s_mov_b32 s40, 3833856
  buffer_load_dwordx4 v20, s[12:15], s40 offen lds
  ds_read_b64_tr_b16 v[64:65], v10 offset:448
  ds_read_b64_tr_b16 v[66:67], v10 offset:2752
  v_mfma_f32_32x32x16_bf16 v[176:191], v[72:75], v[36:39], v[176:191]
  s_add_u32 m0, s34, 71680
  s_mov_b32 s40, 3833856
  buffer_load_dwordx4 v20, s[16:19], s40 offen lds
  ds_read_b64_tr_b16 v[68:69], v10 offset:18880
  ds_read_b64_tr_b16 v[70:71], v10 offset:21184
  v_mfma_f32_32x32x16_bf16 v[192:207], v[76:79], v[36:39], v[192:207]
  s_add_u32 m0, s34, 81920
  s_mov_b32 s40, 26624
  buffer_load_dwordx4 v22, s[24:27], s40 offen sc1 lds
  ds_read_b64_tr_b16 v[72:73], v10 offset:512
  ds_read_b64_tr_b16 v[74:75], v10 offset:2816
  s_waitcnt lgkmcnt(12)
  v_mfma_f32_32x32x16_bf16 v[80:95], v[48:51], v[40:43], v[80:95]
  s_add_u32 m0, s35, 61440
  s_mov_b32 s40, 3833856
  buffer_load_dwordx4 v21, s[44:47], s40 offen lds
  ds_read_b64_tr_b16 v[76:77], v10 offset:18944
  ds_read_b64_tr_b16 v[78:79], v10 offset:21248
  s_waitcnt lgkmcnt(12)
  v_mfma_f32_32x32x16_bf16 v[96:111], v[52:55], v[40:43], v[96:111]
  ds_read_b128 v[44:47], v13 offset:1024
  ds_read_b64_tr_b16 v[48:49], v10 offset:9536
  ds_read_b64_tr_b16 v[50:51], v10 offset:11840
  s_waitcnt lgkmcnt(13)
  v_mfma_f32_32x32x16_bf16 v[112:127], v[56:59], v[40:43], v[112:127]
  ds_read_b64_tr_b16 v[52:53], v10 offset:27968
  ds_read_b64_tr_b16 v[54:55], v10 offset:30272
  s_waitcnt lgkmcnt(13)
  v_mfma_f32_32x32x16_bf16 v[128:143], v[60:63], v[40:43], v[128:143]
  ds_read_b64_tr_b16 v[56:57], v10 offset:9600
  ds_read_b64_tr_b16 v[58:59], v10 offset:11904
  s_waitcnt lgkmcnt(13)
  v_mfma_f32_32x32x16_bf16 v[144:159], v[64:67], v[40:43], v[144:159]
  ds_read_b64_tr_b16 v[60:61], v10 offset:28032
  ds_read_b64_tr_b16 v[62:63], v10 offset:30336
  s_waitcnt lgkmcnt(13)
  v_mfma_f32_32x32x16_bf16 v[160:175], v[68:71], v[40:43], v[160:175]
  ds_read_b64_tr_b16 v[64:65], v10 offset:9664
  ds_read_b64_tr_b16 v[66:67], v10 offset:11968
  s_waitcnt lgkmcnt(13)
  v_mfma_f32_32x32x16_bf16 v[176:191], v[72:75], v[40:43], v[176:191]
  ds_read_b64_tr_b16 v[68:69], v10 offset:28096
  ds_read_b64_tr_b16 v[70:71], v10 offset:30400
  s_waitcnt lgkmcnt(13)
  v_mfma_f32_32x32x16_bf16 v[192:207], v[76:79], v[40:43], v[192:207]
  ds_read_b64_tr_b16 v[72:73], v10 offset:9728
  ds_read_b64_tr_b16 v[74:75], v10 offset:12032
  s_waitcnt lgkmcnt(12)
  v_mfma_f32_32x32x16_bf16 v[80:95], v[48:51], v[44:47], v[80:95]
  ds_read_b64_tr_b16 v[76:77], v10 offset:28160
  ds_read_b64_tr_b16 v[78:79], v10 offset:30464
  s_waitcnt lgkmcnt(12)
  v_mfma_f32_32x32x16_bf16 v[96:111], v[52:55], v[44:47], v[96:111]
  s_waitcnt lgkmcnt(10)
  v_mfma_f32_32x32x16_bf16 v[112:127], v[56:59], v[44:47], v[112:127]
  s_waitcnt vmcnt(6) lgkmcnt(0)
  s_barrier
  ds_read_b128 v[32:35], v11 offset:0
  ds_read_b64_tr_b16 v[48:49], v8 offset:320
  ds_read_b64_tr_b16 v[50:51], v8 offset:2624
  ds_read_b64_tr_b16 v[52:53], v8 offset:18752
  ds_read_b64_tr_b16 v[54:55], v8 offset:21056
  v_mfma_f32_32x32x16_bf16 v[128:143], v[60:63], v[44:47], v[128:143]
  s_add_u32 m0, s34, 90112
  s_mov_b32 s40, 4128768
  buffer_load_dwordx4 v19, s[12:15], s40 offen lds
  ds_read_b64_tr_b16 v[56:57], v8 offset:384
  ds_read_b64_tr_b16 v[58:59], v8 offset:2688
  v_mfma_f32_32x32x16_bf16 v[144:159], v[64:67], v[44:47], v[144:159]
  s_add_u32 m0, s34, 108544
  s_mov_b32 s40, 4128768
  buffer_load_dwordx4 v19, s[16:19], s40 offen lds
  ds_read_b64_tr_b16 v[60:61], v8 offset:18816
  ds_read_b64_tr_b16 v[62:63], v8 offset:21120
  v_mfma_f32_32x32x16_bf16 v[160:175], v[68:71], v[44:47], v[160:175]
  s_add_u32 m0, s34, 98304
  s_mov_b32 s40, 4128768
  buffer_load_dwordx4 v20, s[12:15], s40 offen lds
  ds_read_b64_tr_b16 v[64:65], v8 offset:448
  ds_read_b64_tr_b16 v[66:67], v8 offset:2752
  v_mfma_f32_32x32x16_bf16 v[176:191], v[72:75], v[44:47], v[176:191]
  s_add_u32 m0, s34, 116736
  s_mov_b32 s40, 4128768
  buffer_load_dwordx4 v20, s[16:19], s40 offen lds
  ds_read_b64_tr_b16 v[68:69], v8 offset:18880
  ds_read_b64_tr_b16 v[70:71], v8 offset:21184
  v_mfma_f32_32x32x16_bf16 v[192:207], v[76:79], v[44:47], v[192:207]
  s_add_u32 m0, s34, 126976
  s_mov_b32 s40, 28672
  buffer_load_dwordx4 v22, s[24:27], s40 offen sc1 lds
  ds_read_b64_tr_b16 v[72:73], v8 offset:512
  ds_read_b64_tr_b16 v[74:75], v8 offset:2816
  s_waitcnt lgkmcnt(12)
  v_mfma_f32_32x32x16_bf16 v[80:95], v[48:51], v[32:35], v[80:95]
  s_add_u32 m0, s35, 106496
  s_mov_b32 s40, 4128768
  buffer_load_dwordx4 v21, s[44:47], s40 offen lds
  ds_read_b64_tr_b16 v[76:77], v8 offset:18944
  ds_read_b64_tr_b16 v[78:79], v8 offset:21248
  s_waitcnt lgkmcnt(12)
  v_mfma_f32_32x32x16_bf16 v[96:111], v[52:55], v[32:35], v[96:111]
  ds_read_b128 v[36:39], v11 offset:1024
  ds_read_b64_tr_b16 v[48:49], v8 offset:9536
  ds_read_b64_tr_b16 v[50:51], v8 offset:11840
  s_waitcnt lgkmcnt(13)
  v_mfma_f32_32x32x16_bf16 v[112:127], v[56:59], v[32:35], v[112:127]
  ds_read_b64_tr_b16 v[52:53], v8 offset:27968
  ds_read_b64_tr_b16 v[54:55], v8 offset:30272
  s_waitcnt lgkmcnt(13)
  v_mfma_f32_32x32x16_bf16 v[128:143], v[60:63], v[32:35], v[128:143]
  ds_read_b64_tr_b16 v[56:57], v8 offset:9600
  ds_read_b64_tr_b16 v[58:59], v8 offset:11904
  s_waitcnt lgkmcnt(13)
  v_mfma_f32_32x32x16_bf16 v[144:159], v[64:67], v[32:35], v[144:159]
  ds_read_b64_tr_b16 v[60:61], v8 offset:28032
  ds_read_b64_tr_b16 v[62:63], v8 offset:30336
  s_waitcnt lgkmcnt(13)
  v_mfma_f32_32x32x16_bf16 v[160:175], v[68:71], v[32:35], v[160:175]
  ds_read_b64_tr_b16 v[64:65], v8 offset:9664
  ds_read_b64_tr_b16 v[66:67], v8 offset:11968
  s_waitcnt lgkmcnt(13)
  v_mfma_f32_32x32x16_bf16 v[176:191], v[72:75], v[32:35], v[176:191]
  ds_read_b64_tr_b16 v[68:69], v8 offset:28096
  ds_read_b64_tr_b16 v[70:71], v8 offset:30400
  s_waitcnt lgkmcnt(13)
  v_mfma_f32_32x32x16_bf16 v[192:207], v[76:79], v[32:35], v[192:207]
  ds_read_b64_tr_b16 v[72:73], v8 offset:9728
  ds_read_b64_tr_b16 v[74:75], v8 offset:12032
  s_waitcnt lgkmcnt(12)
  v_mfma_f32_32x32x16_bf16 v[80:95], v[48:51], v[36:39], v[80:95]
  ds_read_b64_tr_b16 v[76:77], v8 offset:28160
  ds_read_b64_tr_b16 v[78:79], v8 offset:30464
  s_waitcnt lgkmcnt(12)
  v_mfma_f32_32x32x16_bf16 v[96:111], v[52:55], v[36:39], v[96:111]
  s_waitcnt lgkmcnt(10)
  v_mfma_f32_32x32x16_bf16 v[112:127], v[56:59], v[36:39], v[112:127]
  s_waitcnt vmcnt(6) lgkmcnt(0)
  s_barrier
  ds_read_b128 v[40:43], v12 offset:0
  ds_read_b64_tr_b16 v[48:49], v9 offset:320
  ds_read_b64_tr_b16 v[50:51], v9 offset:2624
  ds_read_b64_tr_b16 v[52:53], v9 offset:18752
  ds_read_b64_tr_b16 v[54:55], v9 offset:21056
  v_mfma_f32_32x32x16_bf16 v[128:143], v[60:63], v[36:39], v[128:143]
  s_add_u32 m0, s34, 0
  s_mov_b32 s40, 4423680
  buffer_load_dwordx4 v19, s[12:15], s40 offen lds
  ds_read_b64_tr_b16 v[56:57], v9 offset:384
  ds_read_b64_tr_b16 v[58:59], v9 offset:2688
  v_mfma_f32_32x32x16_bf16 v[144:159], v[64:67], v[36:39], v[144:159]
  s_add_u32 m0, s34, 18432
  s_mov_b32 s40, 4423680
  buffer_load_dwordx4 v19, s[16:19], s40 offen lds
  ds_read_b64_tr_b16 v[60:61], v9 offset:18816
  ds_read_b64_tr_b16 v[62:63], v9 offset:21120
  v_mfma_f32_32x32x16_bf16 v[160:175], v[68:71], v[36:39], v[160:175]
  s_add_u32 m0, s34, 8192
  s_mov_b32 s40, 4423680
  buffer_load_dwordx4 v20, s[12:15], s40 offen lds
  ds_read_b64_tr_b16 v[64:65], v9 offset:448
  ds_read_b64_tr_b16 v[66:67], v9 offset:2752
  v_mfma_f32_32x32x16_bf16 v[176:191], v[72:75], v[36:39], v[176:191]
  s_add_u32 m0, s34, 26624
  s_mov_b32 s40, 4423680
  buffer_load_dwordx4 v20, s[16:19], s40 offen lds
  ds_read_b64_tr_b16 v[68:69], v9 offset:18880
  ds_read_b64_tr_b16 v[70:71], v9 offset:21184
  v_mfma_f32_32x32x16_bf16 v[192:207], v[76:79], v[36:39], v[192:207]
  s_add_u32 m0, s34, 36864
  s_mov_b32 s40, 30720
  buffer_load_dwordx4 v22, s[24:27], s40 offen sc1 lds
  ds_read_b64_tr_b16 v[72:73], v9 offset:512
  ds_read_b64_tr_b16 v[74:75], v9 offset:2816
  s_waitcnt lgkmcnt(12)
  v_mfma_f32_32x32x16_bf16 v[80:95], v[48:51], v[40:43], v[80:95]
  s_add_u32 m0, s35, 16384
  s_mov_b32 s40, 4423680
  buffer_load_dwordx4 v21, s[44:47], s40 offen lds
  ds_read_b64_tr_b16 v[76:77], v9 offset:18944
  ds_read_b64_tr_b16 v[78:79], v9 offset:21248
  s_waitcnt lgkmcnt(12)
  v_mfma_f32_32x32x16_bf16 v[96:111], v[52:55], v[40:43], v[96:111]
  ds_read_b128 v[44:47], v12 offset:1024
  ds_read_b64_tr_b16 v[48:49], v9 offset:9536
  ds_read_b64_tr_b16 v[50:51], v9 offset:11840
  s_waitcnt lgkmcnt(13)
  v_mfma_f32_32x32x16_bf16 v[112:127], v[56:59], v[40:43], v[112:127]
  ds_read_b64_tr_b16 v[52:53], v9 offset:27968
  ds_read_b64_tr_b16 v[54:55], v9 offset:30272
  s_waitcnt lgkmcnt(13)
  v_mfma_f32_32x32x16_bf16 v[128:143], v[60:63], v[40:43], v[128:143]
  ds_read_b64_tr_b16 v[56:57], v9 offset:9600
  ds_read_b64_tr_b16 v[58:59], v9 offset:11904
  s_waitcnt lgkmcnt(13)
  v_mfma_f32_32x32x16_bf16 v[144:159], v[64:67], v[40:43], v[144:159]
  ds_read_b64_tr_b16 v[60:61], v9 offset:28032
  ds_read_b64_tr_b16 v[62:63], v9 offset:30336
  s_waitcnt lgkmcnt(13)
  v_mfma_f32_32x32x16_bf16 v[160:175], v[68:71], v[40:43], v[160:175]
  ds_read_b64_tr_b16 v[64:65], v9 offset:9664
  ds_read_b64_tr_b16 v[66:67], v9 offset:11968
  s_waitcnt lgkmcnt(13)
  v_mfma_f32_32x32x16_bf16 v[176:191], v[72:75], v[40:43], v[176:191]
  ds_read_b64_tr_b16 v[68:69], v9 offset:28096
  ds_read_b64_tr_b16 v[70:71], v9 offset:30400
  s_waitcnt lgkmcnt(13)
  v_mfma_f32_32x32x16_bf16 v[192:207], v[76:79], v[40:43], v[192:207]
  ds_read_b64_tr_b16 v[72:73], v9 offset:9728
  ds_read_b64_tr_b16 v[74:75], v9 offset:12032
  s_waitcnt lgkmcnt(12)
  v_mfma_f32_32x32x16_bf16 v[80:95], v[48:51], v[44:47], v[80:95]
  ds_read_b64_tr_b16 v[76:77], v9 offset:28160
  ds_read_b64_tr_b16 v[78:79], v9 offset:30464
  s_waitcnt lgkmcnt(12)
  v_mfma_f32_32x32x16_bf16 v[96:111], v[52:55], v[44:47], v[96:111]
  s_waitcnt lgkmcnt(10)
  v_mfma_f32_32x32x16_bf16 v[112:127], v[56:59], v[44:47], v[112:127]
  s_waitcnt vmcnt(6) lgkmcnt(0)
  s_barrier
  ds_read_b128 v[32:35], v13 offset:0
  ds_read_b64_tr_b16 v[48:49], v10 offset:320
  ds_read_b64_tr_b16 v[50:51], v10 offset:2624
  ds_read_b64_tr_b16 v[52:53], v10 offset:18752
  ds_read_b64_tr_b16 v[54:55], v10 offset:21056
  v_mfma_f32_32x32x16_bf16 v[128:143], v[60:63], v[44:47], v[128:143]
  s_add_u32 m0, s34, 45056
  s_mov_b32 s40, 4718592
  buffer_load_dwordx4 v19, s[12:15], s40 offen lds
  ds_read_b64_tr_b16 v[56:57], v10 offset:384
  ds_read_b64_tr_b16 v[58:59], v10 offset:2688
  v_mfma_f32_32x32x16_bf16 v[144:159], v[64:67], v[44:47], v[144:159]
  s_add_u32 m0, s34, 63488
  s_mov_b32 s40, 4718592
  buffer_load_dwordx4 v19, s[16:19], s40 offen lds
  ds_read_b64_tr_b16 v[60:61], v10 offset:18816
  ds_read_b64_tr_b16 v[62:63], v10 offset:21120
  v_mfma_f32_32x32x16_bf16 v[160:175], v[68:71], v[44:47], v[160:175]
  s_add_u32 m0, s34, 53248
  s_mov_b32 s40, 4718592
  buffer_load_dwordx4 v20, s[12:15], s40 offen lds
  ds_read_b64_tr_b16 v[64:65], v10 offset:448
  ds_read_b64_tr_b16 v[66:67], v10 offset:2752
  v_mfma_f32_32x32x16_bf16 v[176:191], v[72:75], v[44:47], v[176:191]
  s_add_u32 m0, s34, 71680
  s_mov_b32 s40, 4718592
  buffer_load_dwordx4 v20, s[16:19], s40 offen lds
  ds_read_b64_tr_b16 v[68:69], v10 offset:18880
  ds_read_b64_tr_b16 v[70:71], v10 offset:21184
  v_mfma_f32_32x32x16_bf16 v[192:207], v[76:79], v[44:47], v[192:207]
  s_add_u32 m0, s34, 81920
  s_mov_b32 s40, 32768
  buffer_load_dwordx4 v22, s[24:27], s40 offen sc1 lds
  ds_read_b64_tr_b16 v[72:73], v10 offset:512
  ds_read_b64_tr_b16 v[74:75], v10 offset:2816
  s_waitcnt lgkmcnt(12)
  v_mfma_f32_32x32x16_bf16 v[80:95], v[48:51], v[32:35], v[80:95]
  s_add_u32 m0, s35, 61440
  s_mov_b32 s40, 4718592
  buffer_load_dwordx4 v21, s[44:47], s40 offen lds
  ds_read_b64_tr_b16 v[76:77], v10 offset:18944
  ds_read_b64_tr_b16 v[78:79], v10 offset:21248
  s_waitcnt lgkmcnt(12)
  v_mfma_f32_32x32x16_bf16 v[96:111], v[52:55], v[32:35], v[96:111]
  ds_read_b128 v[36:39], v13 offset:1024
  ds_read_b64_tr_b16 v[48:49], v10 offset:9536
  ds_read_b64_tr_b16 v[50:51], v10 offset:11840
  s_waitcnt lgkmcnt(13)
  v_mfma_f32_32x32x16_bf16 v[112:127], v[56:59], v[32:35], v[112:127]
  ds_read_b64_tr_b16 v[52:53], v10 offset:27968
  ds_read_b64_tr_b16 v[54:55], v10 offset:30272
  s_waitcnt lgkmcnt(13)
  v_mfma_f32_32x32x16_bf16 v[128:143], v[60:63], v[32:35], v[128:143]
  ds_read_b64_tr_b16 v[56:57], v10 offset:9600
  ds_read_b64_tr_b16 v[58:59], v10 offset:11904
  s_waitcnt lgkmcnt(13)
  v_mfma_f32_32x32x16_bf16 v[144:159], v[64:67], v[32:35], v[144:159]
  ds_read_b64_tr_b16 v[60:61], v10 offset:28032
  ds_read_b64_tr_b16 v[62:63], v10 offset:30336
  s_waitcnt lgkmcnt(13)
  v_mfma_f32_32x32x16_bf16 v[160:175], v[68:71], v[32:35], v[160:175]
  ds_read_b64_tr_b16 v[64:65], v10 offset:9664
  ds_read_b64_tr_b16 v[66:67], v10 offset:11968
  s_waitcnt lgkmcnt(13)
  v_mfma_f32_32x32x16_bf16 v[176:191], v[72:75], v[32:35], v[176:191]
  ds_read_b64_tr_b16 v[68:69], v10 offset:28096
  ds_read_b64_tr_b16 v[70:71], v10 offset:30400
  s_waitcnt lgkmcnt(13)
  v_mfma_f32_32x32x16_bf16 v[192:207], v[76:79], v[32:35], v[192:207]
  ds_read_b64_tr_b16 v[72:73], v10 offset:9728
  ds_read_b64_tr_b16 v[74:75], v10 offset:12032
  s_waitcnt lgkmcnt(12)
  v_mfma_f32_32x32x16_bf16 v[80:95], v[48:51], v[36:39], v[80:95]
  ds_read_b64_tr_b16 v[76:77], v10 offset:28160
  ds_read_b64_tr_b16 v[78:79], v10 offset:30464
  s_waitcnt lgkmcnt(12)
  v_mfma_f32_32x32x16_bf16 v[96:111], v[52:55], v[36:39], v[96:111]
  s_waitcnt lgkmcnt(10)
  v_mfma_f32_32x32x16_bf16 v[112:127], v[56:59], v[36:39], v[112:127]
  s_waitcnt vmcnt(6) lgkmcnt(0)
  s_barrier
  ds_read_b128 v[40:43], v11 offset:0
  ds_read_b64_tr_b16 v[48:49], v8 offset:320
  ds_read_b64_tr_b16 v[50:51], v8 offset:2624
  ds_read_b64_tr_b16 v[52:53], v8 offset:18752
  ds_read_b64_tr_b16 v[54:55], v8 offset:21056
  v_mfma_f32_32x32x16_bf16 v[128:143], v[60:63], v[36:39], v[128:143]
  s_add_u32 m0, s34, 90112
  s_mov_b32 s40, 5013504
  buffer_load_dwordx4 v19, s[12:15], s40 offen lds
  ds_read_b64_tr_b16 v[56:57], v8 offset:384
  ds_read_b64_tr_b16 v[58:59], v8 offset:2688
  v_mfma_f32_32x32x16_bf16 v[144:159], v[64:67], v[36:39], v[144:159]
  s_add_u32 m0, s34, 108544
  s_mov_b32 s40, 5013504
  buffer_load_dwordx4 v19, s[16:19], s40 offen lds
  ds_read_b64_tr_b16 v[60:61], v8 offset:18816
  ds_read_b64_tr_b16 v[62:63], v8 offset:21120
  v_mfma_f32_32x32x16_bf16 v[160:175], v[68:71], v[36:39], v[160:175]
  s_add_u32 m0, s34, 98304
  s_mov_b32 s40, 5013504
  buffer_load_dwordx4 v20, s[12:15], s40 offen lds
  ds_read_b64_tr_b16 v[64:65], v8 offset:448
  ds_read_b64_tr_b16 v[66:67], v8 offset:2752
  v_mfma_f32_32x32x16_bf16 v[176:191], v[72:75], v[36:39], v[176:191]
  s_add_u32 m0, s34, 116736
  s_mov_b32 s40, 5013504
  buffer_load_dwordx4 v20, s[16:19], s40 offen lds
  ds_read_b64_tr_b16 v[68:69], v8 offset:18880
  ds_read_b64_tr_b16 v[70:71], v8 offset:21184
  v_mfma_f32_32x32x16_bf16 v[192:207], v[76:79], v[36:39], v[192:207]
  s_add_u32 m0, s34, 126976
  s_mov_b32 s40, 34816
  buffer_load_dwordx4 v22, s[24:27], s40 offen sc1 lds
  ds_read_b64_tr_b16 v[72:73], v8 offset:512
  ds_read_b64_tr_b16 v[74:75], v8 offset:2816
  s_waitcnt lgkmcnt(12)
  v_mfma_f32_32x32x16_bf16 v[80:95], v[48:51], v[40:43], v[80:95]
  s_add_u32 m0, s35, 106496
  s_mov_b32 s40, 5013504
  buffer_load_dwordx4 v21, s[44:47], s40 offen lds
  ds_read_b64_tr_b16 v[76:77], v8 offset:18944
  ds_read_b64_tr_b16 v[78:79], v8 offset:21248
  s_waitcnt lgkmcnt(12)
  v_mfma_f32_32x32x16_bf16 v[96:111], v[52:55], v[40:43], v[96:111]
  ds_read_b128 v[44:47], v11 offset:1024
  ds_read_b64_tr_b16 v[48:49], v8 offset:9536
  ds_read_b64_tr_b16 v[50:51], v8 offset:11840
  s_waitcnt lgkmcnt(13)
  v_mfma_f32_32x32x16_bf16 v[112:127], v[56:59], v[40:43], v[112:127]
  ds_read_b64_tr_b16 v[52:53], v8 offset:27968
  ds_read_b64_tr_b16 v[54:55], v8 offset:30272
  s_waitcnt lgkmcnt(13)
  v_mfma_f32_32x32x16_bf16 v[128:143], v[60:63], v[40:43], v[128:143]
  ds_read_b64_tr_b16 v[56:57], v8 offset:9600
  ds_read_b64_tr_b16 v[58:59], v8 offset:11904
  s_waitcnt lgkmcnt(13)
  v_mfma_f32_32x32x16_bf16 v[144:159], v[64:67], v[40:43], v[144:159]
  ds_read_b64_tr_b16 v[60:61], v8 offset:28032
  ds_read_b64_tr_b16 v[62:63], v8 offset:30336
  s_waitcnt lgkmcnt(13)
  v_mfma_f32_32x32x16_bf16 v[160:175], v[68:71], v[40:43], v[160:175]
  ds_read_b64_tr_b16 v[64:65], v8 offset:9664
  ds_read_b64_tr_b16 v[66:67], v8 offset:11968
  s_waitcnt lgkmcnt(13)
  v_mfma_f32_32x32x16_bf16 v[176:191], v[72:75], v[40:43], v[176:191]
  ds_read_b64_tr_b16 v[68:69], v8 offset:28096
  ds_read_b64_tr_b16 v[70:71], v8 offset:30400
  s_waitcnt lgkmcnt(13)
  v_mfma_f32_32x32x16_bf16 v[192:207], v[76:79], v[40:43], v[192:207]
  ds_read_b64_tr_b16 v[72:73], v8 offset:9728
  ds_read_b64_tr_b16 v[74:75], v8 offset:12032
  s_waitcnt lgkmcnt(12)
  v_mfma_f32_32x32x16_bf16 v[80:95], v[48:51], v[44:47], v[80:95]
  ds_read_b64_tr_b16 v[76:77], v8 offset:28160
  ds_read_b64_tr_b16 v[78:79], v8 offset:30464
  s_waitcnt lgkmcnt(12)
  v_mfma_f32_32x32x16_bf16 v[96:111], v[52:55], v[44:47], v[96:111]
  s_waitcnt lgkmcnt(10)
  v_mfma_f32_32x32x16_bf16 v[112:127], v[56:59], v[44:47], v[112:127]
  s_waitcnt vmcnt(6) lgkmcnt(0)
  s_barrier
  ds_read_b128 v[32:35], v12 offset:0
  ds_read_b64_tr_b16 v[48:49], v9 offset:320
  ds_read_b64_tr_b16 v[50:51], v9 offset:2624
  ds_read_b64_tr_b16 v[52:53], v9 offset:18752
  ds_read_b64_tr_b16 v[54:55], v9 offset:21056
  v_mfma_f32_32x32x16_bf16 v[128:143], v[60:63], v[44:47], v[128:143]
  s_add_u32 m0, s34, 0
  s_mov_b32 s40, 0
  buffer_load_dwordx4 v23, s[20:23], s40 offen lds
  ds_read_b64_tr_b16 v[56:57], v9 offset:384
  ds_read_b64_tr_b16 v[58:59], v9 offset:2688
  v_mfma_f32_32x32x16_bf16 v[144:159], v[64:67], v[44:47], v[144:159]
  s_add_u32 m0, s34, 8192
  s_mov_b32 s40, 73728
  buffer_load_dwordx4 v23, s[20:23], s40 offen lds
  ds_read_b64_tr_b16 v[60:61], v9 offset:18816
  ds_read_b64_tr_b16 v[62:63], v9 offset:21120
  v_mfma_f32_32x32x16_bf16 v[160:175], v[68:71], v[44:47], v[160:175]
  s_add_u32 m0, s34, 16384
  s_mov_b32 s40, 147456
  buffer_load_dwordx4 v23, s[20:23], s40 offen lds
  ds_read_b64_tr_b16 v[64:65], v9 offset:448
  ds_read_b64_tr_b16 v[66:67], v9 offset:2752
  v_mfma_f32_32x32x16_bf16 v[176:191], v[72:75], v[44:47], v[176:191]
  s_add_u32 m0, s34, 24576
  s_mov_b32 s40, 221184
  buffer_load_dwordx4 v23, s[20:23], s40 offen lds
  ds_read_b64_tr_b16 v[68:69], v9 offset:18880
  ds_read_b64_tr_b16 v[70:71], v9 offset:21184
  v_mfma_f32_32x32x16_bf16 v[192:207], v[76:79], v[44:47], v[192:207]
  ds_read_b64_tr_b16 v[72:73], v9 offset:512
  ds_read_b64_tr_b16 v[74:75], v9 offset:2816
  s_waitcnt lgkmcnt(12)
  v_mfma_f32_32x32x16_bf16 v[80:95], v[48:51], v[32:35], v[80:95]
  ds_read_b64_tr_b16 v[76:77], v9 offset:18944
  ds_read_b64_tr_b16 v[78:79], v9 offset:21248
  s_waitcnt lgkmcnt(12)
  v_mfma_f32_32x32x16_bf16 v[96:111], v[52:55], v[32:35], v[96:111]
  ds_read_b128 v[36:39], v12 offset:1024
  ds_read_b64_tr_b16 v[48:49], v9 offset:9536
  ds_read_b64_tr_b16 v[50:51], v9 offset:11840
  s_waitcnt lgkmcnt(13)
  v_mfma_f32_32x32x16_bf16 v[112:127], v[56:59], v[32:35], v[112:127]
  ds_read_b64_tr_b16 v[52:53], v9 offset:27968
  ds_read_b64_tr_b16 v[54:55], v9 offset:30272
  s_waitcnt lgkmcnt(13)
  v_mfma_f32_32x32x16_bf16 v[128:143], v[60:63], v[32:35], v[128:143]
  ds_read_b64_tr_b16 v[56:57], v9 offset:9600
  ds_read_b64_tr_b16 v[58:59], v9 offset:11904
  s_waitcnt lgkmcnt(13)
  v_mfma_f32_32x32x16_bf16 v[144:159], v[64:67], v[32:35], v[144:159]
  ds_read_b64_tr_b16 v[60:61], v9 offset:28032
  ds_read_b64_tr_b16 v[62:63], v9 offset:30336
  s_waitcnt lgkmcnt(13)
  v_mfma_f32_32x32x16_bf16 v[160:175], v[68:71], v[32:35], v[160:175]
  ds_read_b64_tr_b16 v[64:65], v9 offset:9664
  ds_read_b64_tr_b16 v[66:67], v9 offset:11968
  s_waitcnt lgkmcnt(13)
  v_mfma_f32_32x32x16_bf16 v[176:191], v[72:75], v[32:35], v[176:191]
  ds_read_b64_tr_b16 v[68:69], v9 offset:28096
  ds_read_b64_tr_b16 v[70:71], v9 offset:30400
  s_waitcnt lgkmcnt(13)
  v_mfma_f32_32x32x16_bf16 v[192:207], v[76:79], v[32:35], v[192:207]
  ds_read_b64_tr_b16 v[72:73], v9 offset:9728
  ds_read_b64_tr_b16 v[74:75], v9 offset:12032
  s_waitcnt lgkmcnt(12)
  v_mfma_f32_32x32x16_bf16 v[80:95], v[48:51], v[36:39], v[80:95]
  ds_read_b64_tr_b16 v[76:77], v9 offset:28160
  ds_read_b64_tr_b16 v[78:79], v9 offset:30464
  s_waitcnt lgkmcnt(12)
  v_mfma_f32_32x32x16_bf16 v[96:111], v[52:55], v[36:39], v[96:111]
  s_waitcnt lgkmcnt(10)
  v_mfma_f32_32x32x16_bf16 v[112:127], v[56:59], v[36:39], v[112:127]
  s_waitcnt vmcnt(4) lgkmcnt(0)
  s_barrier
  ds_read_b128 v[40:43], v13 offset:0
  ds_read_b64_tr_b16 v[48:49], v10 offset:320
  ds_read_b64_tr_b16 v[50:51], v10 offset:2624
  ds_read_b128 v[44:47], v13 offset:1024
  ds_read_b64_tr_b16 v[52:53], v10 offset:9536
  ds_read_b64_tr_b16 v[54:55], v10 offset:11840
  v_mfma_f32_32x32x16_bf16 v[128:143], v[60:63], v[36:39], v[128:143]
  s_add_u32 m0, s34, 36864
  s_mov_b32 s40, 128
  buffer_load_dwordx4 v23, s[20:23], s40 offen lds
  ds_read_b64_tr_b16 v[56:57], v10 offset:18752
  ds_read_b64_tr_b16 v[58:59], v10 offset:21056
  v_mfma_f32_32x32x16_bf16 v[144:159], v[64:67], v[36:39], v[144:159]
  s_add_u32 m0, s34, 45056
  s_mov_b32 s40, 73856
  buffer_load_dwordx4 v23, s[20:23], s40 offen lds
  ds_read_b64_tr_b16 v[60:61], v10 offset:27968
  ds_read_b64_tr_b16 v[62:63], v10 offset:30272
  v_mfma_f32_32x32x16_bf16 v[160:175], v[68:71], v[36:39], v[160:175]
  s_add_u32 m0, s34, 53248
  s_mov_b32 s40, 147584
  buffer_load_dwordx4 v23, s[20:23], s40 offen lds
  ds_read_b64_tr_b16 v[64:65], v10 offset:384
  ds_read_b64_tr_b16 v[66:67], v10 offset:2688
  v_mfma_f32_32x32x16_bf16 v[176:191], v[72:75], v[36:39], v[176:191]
  s_add_u32 m0, s34, 61440
  s_mov_b32 s40, 221312
  buffer_load_dwordx4 v23, s[20:23], s40 offen lds
  ds_read_b64_tr_b16 v[68:69], v10 offset:9600
  ds_read_b64_tr_b16 v[70:71], v10 offset:11904
  v_mfma_f32_32x32x16_bf16 v[192:207], v[76:79], v[36:39], v[192:207]
  ds_read_b64_tr_b16 v[72:73], v10 offset:18816
  ds_read_b64_tr_b16 v[74:75], v10 offset:21120
  s_waitcnt lgkmcnt(13)
  v_mfma_f32_32x32x16_bf16 v[80:95], v[48:51], v[40:43], v[80:95]
  ds_read_b64_tr_b16 v[76:77], v10 offset:28032
  ds_read_b64_tr_b16 v[78:79], v10 offset:30336
  s_waitcnt lgkmcnt(12)
  v_mfma_f32_32x32x16_bf16 v[80:95], v[52:55], v[44:47], v[80:95]
  ds_read_b64_tr_b16 v[48:49], v10 offset:448
  ds_read_b64_tr_b16 v[50:51], v10 offset:2752
  s_waitcnt lgkmcnt(12)
  v_mfma_f32_32x32x16_bf16 v[96:111], v[56:59], v[40:43], v[96:111]
  ds_read_b64_tr_b16 v[52:53], v10 offset:9664
  ds_read_b64_tr_b16 v[54:55], v10 offset:11968
  s_waitcnt lgkmcnt(12)
  v_mfma_f32_32x32x16_bf16 v[96:111], v[60:63], v[44:47], v[96:111]
  ds_read_b64_tr_b16 v[56:57], v10 offset:18880
  ds_read_b64_tr_b16 v[58:59], v10 offset:21184
  s_waitcnt lgkmcnt(12)
  v_mfma_f32_32x32x16_bf16 v[112:127], v[64:67], v[40:43], v[112:127]
  ds_read_b64_tr_b16 v[60:61], v10 offset:28096
  ds_read_b64_tr_b16 v[62:63], v10 offset:30400
  s_waitcnt lgkmcnt(12)
  v_mfma_f32_32x32x16_bf16 v[112:127], v[68:71], v[44:47], v[112:127]
  s_nop 3
  v_mul_f32 v80, v80, v96
  v_mul_f32 v81, v81, v97
  v_mul_f32 v82, v82, v98
  v_mul_f32 v83, v83, v99
  v_mul_f32 v84, v84, v100
  v_mul_f32 v85, v85, v101
  ds_read_b64_tr_b16 v[64:65], v10 offset:512
  ds_read_b64_tr_b16 v[66:67], v10 offset:2816
  s_waitcnt lgkmcnt(12)
  v_mfma_f32_32x32x16_bf16 v[128:143], v[72:75], v[40:43], v[128:143]
  v_mul_f32 v86, v86, v102
  v_mul_f32 v87, v87, v103
  v_mul_f32 v88, v88, v104
  v_mul_f32 v89, v89, v105
  v_mul_f32 v90, v90, v106
  v_mul_f32 v91, v91, v107
  ds_read_b64_tr_b16 v[68:69], v10 offset:9728
  ds_read_b64_tr_b16 v[70:71], v10 offset:12032
  s_waitcnt lgkmcnt(12)
  v_mfma_f32_32x32x16_bf16 v[128:143], v[76:79], v[44:47], v[128:143]
  v_mul_f32 v92, v92, v108
  v_mul_f32 v93, v93, v109
  v_mul_f32 v94, v94, v110
  v_mul_f32 v95, v95, v111
  v_cvt_pk_bf16_f32 v96, v80, v81
  v_cvt_pk_bf16_f32 v97, v82, v83
  ds_read_b64_tr_b16 v[72:73], v10 offset:18944
  ds_read_b64_tr_b16 v[74:75], v10 offset:21248
  s_waitcnt lgkmcnt(12)
  v_mfma_f32_32x32x16_bf16 v[144:159], v[48:51], v[40:43], v[144:159]
  v_cvt_pk_bf16_f32 v98, v84, v85
  v_cvt_pk_bf16_f32 v99, v86, v87
  v_cvt_pk_bf16_f32 v100, v88, v89
  v_cvt_pk_bf16_f32 v101, v90, v91
  v_cvt_pk_bf16_f32 v102, v92, v93
  v_cvt_pk_bf16_f32 v103, v94, v95
  ds_read_b64_tr_b16 v[76:77], v10 offset:28160
  ds_read_b64_tr_b16 v[78:79], v10 offset:30464
  s_waitcnt lgkmcnt(12)
  v_mfma_f32_32x32x16_bf16 v[144:159], v[52:55], v[44:47], v[144:159]
  v_mul_f32 v112, v112, v128
  v_mul_f32 v113, v113, v129
  v_mul_f32 v114, v114, v130
  v_mul_f32 v115, v115, v131
  v_mul_f32 v116, v116, v132
  v_mul_f32 v117, v117, v133
  s_waitcnt lgkmcnt(10)
  v_mfma_f32_32x32x16_bf16 v[160:175], v[56:59], v[40:43], v[160:175]
  v_mul_f32 v118, v118, v134
  v_mul_f32 v119, v119, v135
  v_mul_f32 v120, v120, v136
  v_mul_f32 v121, v121, v137
  v_mul_f32 v122, v122, v138
  v_mul_f32 v123, v123, v139
  s_waitcnt vmcnt(4) lgkmcnt(0)
  s_barrier
  ds_read_b64_tr_b16 v[48:49], v14 offset:20480
  ds_read_b64_tr_b16 v[50:51], v14 offset:21504
  ds_read_b64_tr_b16 v[52:53], v14 offset:22528
  ds_read_b64_tr_b16 v[54:55], v14 offset:23552
  v_mfma_f32_32x32x16_bf16 v[160:175], v[60:63], v[44:47], v[160:175]
  ds_write_b128 v18, v[96:99] offset:10240
  ds_write_b128 v18, v[100:103] offset:11264
  v_mul_f32 v124, v124, v140
  v_mul_f32 v125, v125, v141
  v_mul_f32 v126, v126, v142
  ds_read_b64_tr_b16 v[56:57], v14 offset:24576
  ds_read_b64_tr_b16 v[58:59], v14 offset:25600
  v_mfma_f32_32x32x16_bf16 v[176:191], v[64:67], v[40:43], v[176:191]
  v_mul_f32 v127, v127, v143
  v_cvt_pk_bf16_f32 v128, v112, v113
  v_cvt_pk_bf16_f32 v129, v114, v115
  v_cvt_pk_bf16_f32 v130, v116, v117
  v_cvt_pk_bf16_f32 v131, v118, v119
  v_cvt_pk_bf16_f32 v132, v120, v121
  ds_read_b64_tr_b16 v[60:61], v14 offset:26624
  ds_read_b64_tr_b16 v[62:63], v14 offset:27648
  v_mfma_f32_32x32x16_bf16 v[176:191], v[68:71], v[44:47], v[176:191]
  v_cvt_pk_bf16_f32 v133, v122, v123
  v_cvt_pk_bf16_f32 v134, v124, v125
  v_cvt_pk_bf16_f32 v135, v126, v127
  v_mul_f32 v144, v144, v160
  v_mul_f32 v145, v145, v161
  v_mul_f32 v146, v146, v162
  ds_read_b64_tr_b16 v[64:65], v14 offset:28672
  ds_read_b64_tr_b16 v[66:67], v14 offset:29696
  v_mfma_f32_32x32x16_bf16 v[192:207], v[72:75], v[40:43], v[192:207]
  ds_write_b128 v18, v[128:131] offset:12288
  ds_write_b128 v18, v[132:135] offset:13312
  v_mul_f32 v147, v147, v163
  v_mul_f32 v148, v148, v164
  v_mul_f32 v149, v149, v165
  ds_read_b64_tr_b16 v[68:69], v14 offset:30720
  ds_read_b64_tr_b16 v[70:71], v14 offset:31744
  v_mfma_f32_32x32x16_bf16 v[192:207], v[76:79], v[44:47], v[192:207]
  v_mul_f32 v150, v150, v166
  v_mul_f32 v151, v151, v167
  v_mul_f32 v152, v152, v168
  v_mul_f32 v153, v153, v169
  v_mul_f32 v154, v154, v170
  v_mul_f32 v155, v155, v171
  ds_read_b64_tr_b16 v[72:73], v14 offset:32768
  ds_read_b64_tr_b16 v[74:75], v14 offset:33792
  s_waitcnt lgkmcnt(15)
  v_mfma_f32_32x32x16_bf16 v[240:255], v[48:51], v[96:99], 0
  v_mul_f32 v156, v156, v172
  v_mul_f32 v157, v157, v173
  v_mul_f32 v158, v158, v174
  v_mul_f32 v159, v159, v175
  v_cvt_pk_bf16_f32 v160, v144, v145
  v_cvt_pk_bf16_f32 v161, v146, v147
  ds_read_b64_tr_b16 v[76:77], v14 offset:34816
  ds_read_b64_tr_b16 v[78:79], v14 offset:35840
  s_waitcnt lgkmcnt(15)
  v_mfma_f32_32x32x16_bf16 v[240:255], v[52:55], v[100:103], v[240:255]
  v_cvt_pk_bf16_f32 v162, v148, v149
  v_cvt_pk_bf16_f32 v163, v150, v151
  v_cvt_pk_bf16_f32 v164, v152, v153
  v_cvt_pk_bf16_f32 v165, v154, v155
  v_cvt_pk_bf16_f32 v166, v156, v157
  v_cvt_pk_bf16_f32 v167, v158, v159
  s_waitcnt lgkmcnt(12)
  v_mfma_f32_32x32x16_bf16 v[240:255], v[56:59], v[128:131], v[240:255]
  v_mul_f32 v176, v176, v192
  v_mul_f32 v177, v177, v193
  v_mul_f32 v178, v178, v194
  v_mul_f32 v179, v179, v195
  v_mul_f32 v180, v180, v196
  v_mul_f32 v181, v181, v197
  s_waitcnt lgkmcnt(10)
  v_mfma_f32_32x32x16_bf16 v[240:255], v[60:63], v[132:135], v[240:255]
  ds_write_b128 v18, v[160:163] offset:14336
  ds_write_b128 v18, v[164:167] offset:15360
  v_mul_f32 v182, v182, v198
  v_mul_f32 v183, v183, v199
  v_mul_f32 v184, v184, v200
  s_waitcnt lgkmcnt(10)
  v_mfma_f32_32x32x16_bf16 v[240:255], v[64:67], v[160:163], v[240:255]
  v_mul_f32 v185, v185, v201
  v_mul_f32 v186, v186, v202
  v_mul_f32 v187, v187, v203
  v_mul_f32 v188, v188, v204
  v_mul_f32 v189, v189, v205
  v_mul_f32 v190, v190, v206
  s_waitcnt lgkmcnt(6)
  v_mfma_f32_32x32x16_bf16 v[240:255], v[68:71], v[164:167], v[240:255]
  v_mul_f32 v191, v191, v207
  v_cvt_pk_bf16_f32 v192, v176, v177
  v_cvt_pk_bf16_f32 v193, v178, v179
  v_cvt_pk_bf16_f32 v194, v180, v181
  v_cvt_pk_bf16_f32 v195, v182, v183
  v_cvt_pk_bf16_f32 v196, v184, v185
  v_cvt_pk_bf16_f32 v197, v186, v187
  v_cvt_pk_bf16_f32 v198, v188, v189
  v_cvt_pk_bf16_f32 v199, v190, v191
  s_waitcnt lgkmcnt(4)
  v_mfma_f32_32x32x16_bf16 v[240:255], v[72:75], v[192:195], v[240:255]
  ds_write_b128 v18, v[192:195] offset:16384
  ds_write_b128 v18, v[196:199] offset:17408
  s_waitcnt lgkmcnt(0)
  s_barrier
  ds_read_b128 v[80:83], v18 offset:0
  ds_read_b64_tr_b16 v[48:49], v14 offset:0
  ds_read_b64_tr_b16 v[50:51], v14 offset:1024
  ds_read_b128 v[84:87], v18 offset:1024
  ds_read_b64_tr_b16 v[52:53], v14 offset:2048
  ds_read_b64_tr_b16 v[54:55], v14 offset:3072
  v_mfma_f32_32x32x16_bf16 v[240:255], v[76:79], v[196:199], v[240:255]
  ds_read_b128 v[88:91], v18 offset:2048
  ds_read_b64_tr_b16 v[56:57], v14 offset:4096
  ds_read_b64_tr_b16 v[58:59], v14 offset:5120
  ds_read_b128 v[92:95], v18 offset:3072
  ds_read_b64_tr_b16 v[60:61], v14 offset:6144
  ds_read_b64_tr_b16 v[62:63], v14 offset:7168
  s_waitcnt lgkmcnt(9)
  v_mfma_f32_32x32x16_bf16 v[240:255], v[48:51], v[80:83], v[240:255]
  ds_read_b128 v[112:115], v18 offset:4096
  ds_read_b64_tr_b16 v[64:65], v14 offset:8192
  ds_read_b64_tr_b16 v[66:67], v14 offset:9216
  ds_read_b128 v[116:119], v18 offset:5120
  ds_read_b64_tr_b16 v[68:69], v14 offset:10240
  ds_read_b64_tr_b16 v[70:71], v14 offset:11264
  s_waitcnt lgkmcnt(12)
  v_mfma_f32_32x32x16_bf16 v[240:255], v[52:55], v[84:87], v[240:255]
  ds_read_b128 v[120:123], v18 offset:6144
  ds_read_b64_tr_b16 v[72:73], v14 offset:12288
  ds_read_b64_tr_b16 v[74:75], v14 offset:13312
  ds_read_b128 v[124:127], v18 offset:7168
  ds_read_b64_tr_b16 v[76:77], v14 offset:14336
  ds_read_b64_tr_b16 v[78:79], v14 offset:15360
  s_waitcnt lgkmcnt(15)
  v_mfma_f32_32x32x16_bf16 v[240:255], v[56:59], v[88:91], v[240:255]
  ds_read_b128 v[144:147], v18 offset:8192
  ds_read_b64_tr_b16 v[48:49], v14 offset:16384
  ds_read_b64_tr_b16 v[50:51], v14 offset:17408
  ds_read_b128 v[148:151], v18 offset:9216
  ds_read_b64_tr_b16 v[52:53], v14 offset:18432
  ds_read_b64_tr_b16 v[54:55], v14 offset:19456
  s_waitcnt lgkmcnt(15)
  v_mfma_f32_32x32x16_bf16 v[240:255], v[60:63], v[92:95], v[240:255]
  v_mfma_f32_32x32x16_bf16 v[240:255], v[64:67], v[112:115], v[240:255]
  s_waitcnt vmcnt(0) lgkmcnt(0)
  s_barrier
  ds_read_b64_tr_b16 v[56:57], v15 offset:20480
  ds_read_b64_tr_b16 v[58:59], v15 offset:21504
  ds_read_b64_tr_b16 v[60:61], v15 offset:22528
  ds_read_b64_tr_b16 v[62:63], v15 offset:23552
  v_mfma_f32_32x32x16_bf16 v[240:255], v[68:71], v[116:119], v[240:255]
  s_add_u32 m0, s34, 90112
  s_mov_b32 s40, 256
  buffer_load_dwordx4 v23, s[20:23], s40 offen lds
  ds_read_b64_tr_b16 v[64:65], v15 offset:24576
  ds_read_b64_tr_b16 v[66:67], v15 offset:25600
  v_mfma_f32_32x32x16_bf16 v[240:255], v[72:75], v[120:123], v[240:255]
  s_add_u32 m0, s34, 98304
  s_mov_b32 s40, 73984
  buffer_load_dwordx4 v23, s[20:23], s40 offen lds
  ds_read_b64_tr_b16 v[68:69], v15 offset:26624
  ds_read_b64_tr_b16 v[70:71], v15 offset:27648
  v_mfma_f32_32x32x16_bf16 v[240:255], v[76:79], v[124:127], v[240:255]
  s_add_u32 m0, s34, 106496
  s_mov_b32 s40, 147712
  buffer_load_dwordx4 v23, s[20:23], s40 offen lds
  ds_read_b64_tr_b16 v[72:73], v15 offset:28672
  ds_read_b64_tr_b16 v[74:75], v15 offset:29696
  v_mfma_f32_32x32x16_bf16 v[240:255], v[48:51], v[144:147], v[240:255]
  s_add_u32 m0, s34, 114688
  s_mov_b32 s40, 221440
  buffer_load_dwordx4 v23, s[20:23], s40 offen lds
  ds_read_b64_tr_b16 v[76:77], v15 offset:30720
  ds_read_b64_tr_b16 v[78:79], v15 offset:31744
  v_mfma_f32_32x32x16_bf16 v[240:255], v[52:55], v[148:151], v[240:255]
  s_add_u32 m0, s34, 126976
  s_mov_b32 s40, 384
  buffer_load_dwordx4 v23, s[20:23], s40 offen lds
  ds_read_b64_tr_b16 v[48:49], v15 offset:32768
  ds_read_b64_tr_b16 v[50:51], v15 offset:33792
  s_waitcnt lgkmcnt(12)
  v_mfma_f32_32x32x16_bf16 v[176:191], v[56:59], v[96:99], 0
  s_add_u32 m0, s34, 135168
  s_mov_b32 s40, 74112
  buffer_load_dwordx4 v23, s[20:23], s40 offen lds
  ds_read_b64_tr_b16 v[52:53], v15 offset:34816
  ds_read_b64_tr_b16 v[54:55], v15 offset:35840
  s_waitcnt lgkmcnt(12)
  v_mfma_f32_32x32x16_bf16 v[176:191], v[60:63], v[100:103], v[176:191]
  s_add_u32 m0, s34, 143360
  s_mov_b32 s40, 147840
  buffer_load_dwordx4 v23, s[20:23], s40 offen lds
  ds_read_b64_tr_b16 v[56:57], v15 offset:0
  ds_read_b64_tr_b16 v[58:59], v15 offset:1024
  s_waitcnt lgkmcnt(12)
  v_mfma_f32_32x32x16_bf16 v[176:191], v[64:67], v[128:131], v[176:191]
  s_add_u32 m0, s34, 151552
  s_mov_b32 s40, 221568
  buffer_load_dwordx4 v23, s[20:23], s40 offen lds
  v_cvt_pk_bf16_f32 v104, v240, v241
  v_cvt_pk_bf16_f32 v105, v242, v243
  v_cvt_pk_bf16_f32 v106, v244, v245
  v_cvt_pk_bf16_f32 v107, v246, v247
  ds_read_b64_tr_b16 v[60:61], v15 offset:2048
  ds_read_b64_tr_b16 v[62:63], v15 offset:3072
  s_waitcnt lgkmcnt(12)
  v_mfma_f32_32x32x16_bf16 v[176:191], v[68:71], v[132:135], v[176:191]
  s_add_u32 m0, s34, 0
  s_mov_b32 s40, 512
  buffer_load_dwordx4 v23, s[20:23], s40 offen lds
  v_cvt_pk_bf16_f32 v108, v248, v249
  v_cvt_pk_bf16_f32 v109, v250, v251
  v_cvt_pk_bf16_f32 v110, v252, v253
  v_cvt_pk_bf16_f32 v111, v254, v255
  ds_read_b64_tr_b16 v[64:65], v15 offset:4096
  ds_read_b64_tr_b16 v[66:67], v15 offset:5120
  s_waitcnt lgkmcnt(12)
  v_mfma_f32_32x32x16_bf16 v[176:191], v[72:75], v[160:163], v[176:191]
  s_add_u32 m0, s34, 8192
  s_mov_b32 s40, 74240
  buffer_load_dwordx4 v23, s[20:23], s40 offen lds
  s_movk_i32 s41, 0
  buffer_store_dwordx4 v[104:107], v24, s[24:27], s41 offen offset:0 sc1
  buffer_store_dwordx4 v[108:111], v24, s[24:27], s41 offen offset:1024 sc1
  ds_read_b64_tr_b16 v[68:69], v15 offset:6144
  ds_read_b64_tr_b16 v[70:71], v15 offset:7168
  s_waitcnt lgkmcnt(12)
  v_mfma_f32_32x32x16_bf16 v[176:191], v[76:79], v[164:167], v[176:191]
  s_add_u32 m0, s34, 16384
  s_mov_b32 s40, 147968
  buffer_load_dwordx4 v23, s[20:23], s40 offen lds
  ds_read_b64_tr_b16 v[72:73], v15 offset:8192
  ds_read_b64_tr_b16 v[74:75], v15 offset:9216
  s_waitcnt lgkmcnt(12)
  v_mfma_f32_32x32x16_bf16 v[176:191], v[48:51], v[192:195], v[176:191]
  s_add_u32 m0, s34, 24576
  s_mov_b32 s40, 221696
  buffer_load_dwordx4 v23, s[20:23], s40 offen lds
  ds_read_b64_tr_b16 v[76:77], v15 offset:10240
  ds_read_b64_tr_b16 v[78:79], v15 offset:11264
  s_waitcnt lgkmcnt(12)
  v_mfma_f32_32x32x16_bf16 v[176:191], v[52:55], v[196:199], v[176:191]
  ds_read_b64_tr_b16 v[48:49], v15 offset:12288
  ds_read_b64_tr_b16 v[50:51], v15 offset:13312
  s_waitcnt lgkmcnt(12)
  v_mfma_f32_32x32x16_bf16 v[176:191], v[56:59], v[80:83], v[176:191]
  ds_read_b64_tr_b16 v[52:53], v15 offset:14336
  ds_read_b64_tr_b16 v[54:55], v15 offset:15360
  s_waitcnt lgkmcnt(12)
  v_mfma_f32_32x32x16_bf16 v[176:191], v[60:63], v[84:87], v[176:191]
  ds_read_b64_tr_b16 v[56:57], v15 offset:16384
  ds_read_b64_tr_b16 v[58:59], v15 offset:17408
  s_waitcnt lgkmcnt(12)
  v_mfma_f32_32x32x16_bf16 v[176:191], v[64:67], v[88:91], v[176:191]
  ds_read_b64_tr_b16 v[60:61], v15 offset:18432
  ds_read_b64_tr_b16 v[62:63], v15 offset:19456
  s_waitcnt lgkmcnt(12)
  v_mfma_f32_32x32x16_bf16 v[176:191], v[68:71], v[92:95], v[176:191]
  s_waitcnt lgkmcnt(10)
  v_mfma_f32_32x32x16_bf16 v[176:191], v[72:75], v[112:115], v[176:191]
  s_waitcnt vmcnt(10) lgkmcnt(0)
  s_barrier
  ds_read_b64_tr_b16 v[64:65], v16 offset:20480
  ds_read_b64_tr_b16 v[66:67], v16 offset:21504
  ds_read_b64_tr_b16 v[68:69], v16 offset:22528
  ds_read_b64_tr_b16 v[70:71], v16 offset:23552
  v_mfma_f32_32x32x16_bf16 v[176:191], v[76:79], v[116:119], v[176:191]
  s_add_u32 m0, s34, 36864
  s_mov_b32 s40, 640
  buffer_load_dwordx4 v23, s[20:23], s40 offen lds
  ds_read_b64_tr_b16 v[72:73], v16 offset:24576
  ds_read_b64_tr_b16 v[74:75], v16 offset:25600
  v_mfma_f32_32x32x16_bf16 v[176:191], v[48:51], v[120:123], v[176:191]
  s_add_u32 m0, s34, 45056
  s_mov_b32 s40, 74368
  buffer_load_dwordx4 v23, s[20:23], s40 offen lds
  ds_read_b64_tr_b16 v[76:77], v16 offset:26624
  ds_read_b64_tr_b16 v[78:79], v16 offset:27648
  v_mfma_f32_32x32x16_bf16 v[176:191], v[52:55], v[124:127], v[176:191]
  s_add_u32 m0, s34, 53248
  s_mov_b32 s40, 148096
  buffer_load_dwordx4 v23, s[20:23], s40 offen lds
  ds_read_b64_tr_b16 v[48:49], v16 offset:28672
  ds_read_b64_tr_b16 v[50:51], v16 offset:29696
  v_mfma_f32_32x32x16_bf16 v[176:191], v[56:59], v[144:147], v[176:191]
  s_add_u32 m0, s34, 61440
  s_mov_b32 s40, 221824
  buffer_load_dwordx4 v23, s[20:23], s40 offen lds
  ds_read_b64_tr_b16 v[52:53], v16 offset:30720
  ds_read_b64_tr_b16 v[54:55], v16 offset:31744
  v_mfma_f32_32x32x16_bf16 v[176:191], v[60:63], v[148:151], v[176:191]
  ds_read_b64_tr_b16 v[56:57], v16 offset:32768
  ds_read_b64_tr_b16 v[58:59], v16 offset:33792
  s_waitcnt lgkmcnt(12)
  v_mfma_f32_32x32x16_bf16 v[240:255], v[64:67], v[96:99], 0
  ds_read_b64_tr_b16 v[60:61], v16 offset:34816
  ds_read_b64_tr_b16 v[62:63], v16 offset:35840
  s_waitcnt lgkmcnt(12)
  v_mfma_f32_32x32x16_bf16 v[240:255], v[68:71], v[100:103], v[240:255]
  ds_read_b64_tr_b16 v[64:65], v16 offset:0
  ds_read_b64_tr_b16 v[66:67], v16 offset:1024
  s_waitcnt lgkmcnt(12)
  v_mfma_f32_32x32x16_bf16 v[240:255], v[72:75], v[128:131], v[240:255]
  v_cvt_pk_bf16_f32 v136, v176, v177
  v_cvt_pk_bf16_f32 v137, v178, v179
  v_cvt_pk_bf16_f32 v138, v180, v181
  v_cvt_pk_bf16_f32 v139, v182, v183
  v_cvt_pk_bf16_f32 v140, v184, v185
  v_cvt_pk_bf16_f32 v141, v186, v187
  ds_read_b64_tr_b16 v[68:69], v16 offset:2048
  ds_read_b64_tr_b16 v[70:71], v16 offset:3072
  s_waitcnt lgkmcnt(12)
  v_mfma_f32_32x32x16_bf16 v[240:255], v[76:79], v[132:135], v[240:255]
  v_cvt_pk_bf16_f32 v142, v188, v189
  v_cvt_pk_bf16_f32 v143, v190, v191
  s_movk_i32 s41, 4096
  buffer_store_dwordx4 v[136:139], v24, s[24:27], s41 offen offset:0 sc1
  buffer_store_dwordx4 v[140:143], v24, s[24:27], s41 offen offset:1024 sc1
  ds_read_b64_tr_b16 v[72:73], v16 offset:4096
  ds_read_b64_tr_b16 v[74:75], v16 offset:5120
  s_waitcnt lgkmcnt(12)
  v_mfma_f32_32x32x16_bf16 v[240:255], v[48:51], v[160:163], v[240:255]
  ds_read_b64_tr_b16 v[76:77], v16 offset:6144
  ds_read_b64_tr_b16 v[78:79], v16 offset:7168
  s_waitcnt lgkmcnt(12)
  v_mfma_f32_32x32x16_bf16 v[240:255], v[52:55], v[164:167], v[240:255]
  ds_read_b64_tr_b16 v[48:49], v16 offset:8192
  ds_read_b64_tr_b16 v[50:51], v16 offset:9216
  s_waitcnt lgkmcnt(12)
  v_mfma_f32_32x32x16_bf16 v[240:255], v[56:59], v[192:195], v[240:255]
  ds_read_b64_tr_b16 v[52:53], v16 offset:10240
  ds_read_b64_tr_b16 v[54:55], v16 offset:11264
  s_waitcnt lgkmcnt(12)
  v_mfma_f32_32x32x16_bf16 v[240:255], v[60:63], v[196:199], v[240:255]
  ds_read_b64_tr_b16 v[56:57], v16 offset:12288
  ds_read_b64_tr_b16 v[58:59], v16 offset:13312
  s_waitcnt lgkmcnt(12)
  v_mfma_f32_32x32x16_bf16 v[240:255], v[64:67], v[80:83], v[240:255]
  ds_read_b64_tr_b16 v[60:61], v16 offset:14336
  ds_read_b64_tr_b16 v[62:63], v16 offset:15360
  s_waitcnt lgkmcnt(12)
  v_mfma_f32_32x32x16_bf16 v[240:255], v[68:71], v[84:87], v[240:255]
  ds_read_b64_tr_b16 v[64:65], v16 offset:16384
  ds_read_b64_tr_b16 v[66:67], v16 offset:17408
  s_waitcnt lgkmcnt(12)
  v_mfma_f32_32x32x16_bf16 v[240:255], v[72:75], v[88:91], v[240:255]
  ds_read_b64_tr_b16 v[68:69], v16 offset:18432
  ds_read_b64_tr_b16 v[70:71], v16 offset:19456
  s_waitcnt lgkmcnt(12)
  v_mfma_f32_32x32x16_bf16 v[240:255], v[76:79], v[92:95], v[240:255]
  s_waitcnt lgkmcnt(10)
  v_mfma_f32_32x32x16_bf16 v[240:255], v[48:51], v[112:115], v[240:255]
  s_waitcnt vmcnt(8) lgkmcnt(0)
  s_barrier
  s_cmp_lg_u32 s3, 7
  s_cbranch_scc1 k3_pub21
  v_mov_b32 v25, 1
  s_mov_b64 exec, 1
  buffer_store_dword v25, off, s[24:27], s69 sc1
  s_mov_b64 exec, -1
k3_pub21:
  ds_read_b64_tr_b16 v[72:73], v17 offset:20480
  ds_read_b64_tr_b16 v[74:75], v17 offset:21504
  ds_read_b64_tr_b16 v[76:77], v17 offset:22528
  ds_read_b64_tr_b16 v[78:79], v17 offset:23552
  v_mfma_f32_32x32x16_bf16 v[240:255], v[52:55], v[116:119], v[240:255]
  s_add_u32 m0, s34, 90112
  s_mov_b32 s40, 768
  buffer_load_dwordx4 v23, s[20:23], s40 offen lds
  ds_read_b64_tr_b16 v[48:49], v17 offset:24576
  ds_read_b64_tr_b16 v[50:51], v17 offset:25600
  v_mfma_f32_32x32x16_bf16 v[240:255], v[56:59], v[120:123], v[240:255]
  s_add_u32 m0, s34, 98304
  s_mov_b32 s40, 74496
  buffer_load_dwordx4 v23, s[20:23], s40 offen lds
  ds_read_b64_tr_b16 v[52:53], v17 offset:26624
  ds_read_b64_tr_b16 v[54:55], v17 offset:27648
  v_mfma_f32_32x32x16_bf16 v[240:255], v[60:63], v[124:127], v[240:255]
  s_add_u32 m0, s34, 106496
  s_mov_b32 s40, 148224
  buffer_load_dwordx4 v23, s[20:23], s40 offen lds
  ds_read_b64_tr_b16 v[56:57], v17 offset:28672
  ds_read_b64_tr_b16 v[58:59], v17 offset:29696
  v_mfma_f32_32x32x16_bf16 v[240:255], v[64:67], v[144:147], v[240:255]
  s_add_u32 m0, s34, 114688
  s_mov_b32 s40, 221952
  buffer_load_dwordx4 v23, s[20:23], s40 offen lds
  ds_read_b64_tr_b16 v[60:61], v17 offset:30720
  ds_read_b64_tr_b16 v[62:63], v17 offset:31744
  v_mfma_f32_32x32x16_bf16 v[240:255], v[68:71], v[148:151], v[240:255]
  ds_read_b64_tr_b16 v[64:65], v17 offset:32768
  ds_read_b64_tr_b16 v[66:67], v17 offset:33792
  s_waitcnt lgkmcnt(12)
  v_mfma_f32_32x32x16_bf16 v[176:191], v[72:75], v[96:99], 0
  ds_read_b64_tr_b16 v[68:69], v17 offset:34816
  ds_read_b64_tr_b16 v[70:71], v17 offset:35840
  s_waitcnt lgkmcnt(12)
  v_mfma_f32_32x32x16_bf16 v[176:191], v[76:79], v[100:103], v[176:191]
  ds_read_b64_tr_b16 v[72:73], v17 offset:0
  ds_read_b64_tr_b16 v[74:75], v17 offset:1024
  s_waitcnt lgkmcnt(12)
  v_mfma_f32_32x32x16_bf16 v[176:191], v[48:51], v[128:131], v[176:191]
  v_cvt_pk_bf16_f32 v104, v240, v241
  v_cvt_pk_bf16_f32 v105, v242, v243
  v_cvt_pk_bf16_f32 v106, v244, v245
  v_cvt_pk_bf16_f32 v107, v246, v247
  v_cvt_pk_bf16_f32 v108, v248, v249
  v_cvt_pk_bf16_f32 v109, v250, v251
  ds_read_b64_tr_b16 v[76:77], v17 offset:2048
  ds_read_b64_tr_b16 v[78:79], v17 offset:3072
  s_waitcnt lgkmcnt(12)
  v_mfma_f32_32x32x16_bf16 v[176:191], v[52:55], v[132:135], v[176:191]
  v_cvt_pk_bf16_f32 v110, v252, v253
  v_cvt_pk_bf16_f32 v111, v254, v255
  s_movk_i32 s41, 8192
  buffer_store_dwordx4 v[104:107], v24, s[24:27], s41 offen offset:0 sc1
  buffer_store_dwordx4 v[108:111], v24, s[24:27], s41 offen offset:1024 sc1
  ds_read_b64_tr_b16 v[48:49], v17 offset:4096
  ds_read_b64_tr_b16 v[50:51], v17 offset:5120
  s_waitcnt lgkmcnt(12)
  v_mfma_f32_32x32x16_bf16 v[176:191], v[56:59], v[160:163], v[176:191]
  ds_read_b64_tr_b16 v[52:53], v17 offset:6144
  ds_read_b64_tr_b16 v[54:55], v17 offset:7168
  s_waitcnt lgkmcnt(12)
  v_mfma_f32_32x32x16_bf16 v[176:191], v[60:63], v[164:167], v[176:191]
  ds_read_b64_tr_b16 v[56:57], v17 offset:8192
  ds_read_b64_tr_b16 v[58:59], v17 offset:9216
  s_waitcnt lgkmcnt(12)
  v_mfma_f32_32x32x16_bf16 v[176:191], v[64:67], v[192:195], v[176:191]
  ds_read_b64_tr_b16 v[60:61], v17 offset:10240
  ds_read_b64_tr_b16 v[62:63], v17 offset:11264
  s_waitcnt lgkmcnt(12)
  v_mfma_f32_32x32x16_bf16 v[176:191], v[68:71], v[196:199], v[176:191]
  ds_read_b64_tr_b16 v[64:65], v17 offset:12288
  ds_read_b64_tr_b16 v[66:67], v17 offset:13312
  s_waitcnt lgkmcnt(12)
  v_mfma_f32_32x32x16_bf16 v[176:191], v[72:75], v[80:83], v[176:191]
  ds_read_b64_tr_b16 v[68:69], v17 offset:14336
  ds_read_b64_tr_b16 v[70:71], v17 offset:15360
  s_waitcnt lgkmcnt(12)
  v_mfma_f32_32x32x16_bf16 v[176:191], v[76:79], v[84:87], v[176:191]
  ds_read_b64_tr_b16 v[72:73], v17 offset:16384
  ds_read_b64_tr_b16 v[74:75], v17 offset:17408
  s_waitcnt lgkmcnt(12)
  v_mfma_f32_32x32x16_bf16 v[176:191], v[48:51], v[88:91], v[176:191]
  ds_read_b64_tr_b16 v[76:77], v17 offset:18432
  ds_read_b64_tr_b16 v[78:79], v17 offset:19456
  s_waitcnt lgkmcnt(12)
  v_mfma_f32_32x32x16_bf16 v[176:191], v[52:55], v[92:95], v[176:191]
  s_waitcnt lgkmcnt(10)
  v_mfma_f32_32x32x16_bf16 v[176:191], v[56:59], v[112:115], v[176:191]
  s_waitcnt vmcnt(6) lgkmcnt(0)
  s_barrier
  s_cmp_lg_u32 s3, 7
  s_cbranch_scc1 k3_pub22
  v_mov_b32 v25, 2
  s_mov_b64 exec, 1
  buffer_store_dword v25, off, s[24:27], s69 sc1
  s_mov_b64 exec, -1
k3_pub22:
  ds_read_b64_tr_b16 v[48:49], v14 offset:20480
  ds_read_b64_tr_b16 v[50:51], v14 offset:21504
  ds_read_b64_tr_b16 v[52:53], v14 offset:22528
  ds_read_b64_tr_b16 v[54:55], v14 offset:23552
  v_mfma_f32_32x32x16_bf16 v[176:191], v[60:63], v[116:119], v[176:191]
  s_add_u32 m0, s34, 126976
  s_mov_b32 s40, 896
  buffer_load_dwordx4 v23, s[20:23], s40 offen lds
  ds_read_b64_tr_b16 v[56:57], v14 offset:24576
  ds_read_b64_tr_b16 v[58:59], v14 offset:25600
  v_mfma_f32_32x32x16_bf16 v[176:191], v[64:67], v[120:123], v[176:191]
  s_add_u32 m0, s34, 135168
  s_mov_b32 s40, 74624
  buffer_load_dwordx4 v23, s[20:23], s40 offen lds
  ds_read_b64_tr_b16 v[60:61], v14 offset:26624
  ds_read_b64_tr_b16 v[62:63], v14 offset:27648
  v_mfma_f32_32x32x16_bf16 v[176:191], v[68:71], v[124:127], v[176:191]
  s_add_u32 m0, s34, 143360
  s_mov_b32 s40, 148352
  buffer_load_dwordx4 v23, s[20:23], s40 offen lds
  ds_read_b64_tr_b16 v[64:65], v14 offset:28672
  ds_read_b64_tr_b16 v[66:67], v14 offset:29696
  v_mfma_f32_32x32x16_bf16 v[176:191], v[72:75], v[144:147], v[176:191]
  s_add_u32 m0, s34, 151552
  s_mov_b32 s40, 222080
  buffer_load_dwordx4 v23, s[20:23], s40 offen lds
  ds_read_b64_tr_b16 v[68:69], v14 offset:30720
  ds_read_b64_tr_b16 v[70:71], v14 offset:31744
  v_mfma_f32_32x32x16_bf16 v[176:191], v[76:79], v[148:151], v[176:191]
  ds_read_b64_tr_b16 v[72:73], v14 offset:32768
  ds_read_b64_tr_b16 v[74:75], v14 offset:33792
  s_waitcnt lgkmcnt(12)
  v_mfma_f32_32x32x16_bf16 v[240:255], v[48:51], v[96:99], 0
  ds_read_b64_tr_b16 v[76:77], v14 offset:34816
  ds_read_b64_tr_b16 v[78:79], v14 offset:35840
  s_waitcnt lgkmcnt(12)
  v_mfma_f32_32x32x16_bf16 v[240:255], v[52:55], v[100:103], v[240:255]
  ds_read_b64_tr_b16 v[48:49], v14 offset:0
  ds_read_b64_tr_b16 v[50:51], v14 offset:1024
  s_waitcnt lgkmcnt(12)
  v_mfma_f32_32x32x16_bf16 v[240:255], v[56:59], v[128:131], v[240:255]
  v_cvt_pk_bf16_f32 v136, v176, v177
  v_cvt_pk_bf16_f32 v137, v178, v179
  v_cvt_pk_bf16_f32 v138, v180, v181
  v_cvt_pk_bf16_f32 v139, v182, v183
  v_cvt_pk_bf16_f32 v140, v184, v185
  v_cvt_pk_bf16_f32 v141, v186, v187
  ds_read_b64_tr_b16 v[52:53], v14 offset:2048
  ds_read_b64_tr_b16 v[54:55], v14 offset:3072
  s_waitcnt lgkmcnt(12)
  v_mfma_f32_32x32x16_bf16 v[240:255], v[60:63], v[132:135], v[240:255]
  v_cvt_pk_bf16_f32 v142, v188, v189
  v_cvt_pk_bf16_f32 v143, v190, v191
  s_movk_i32 s41, 12288
  buffer_store_dwordx4 v[136:139], v24, s[24:27], s41 offen offset:0 sc1
  buffer_store_dwordx4 v[140:143], v24, s[24:27], s41 offen offset:1024 sc1
  ds_read_b64_tr_b16 v[56:57], v14 offset:4096
  ds_read_b64_tr_b16 v[58:59], v14 offset:5120
  s_waitcnt lgkmcnt(12)
  v_mfma_f32_32x32x16_bf16 v[240:255], v[64:67], v[160:163], v[240:255]
  ds_read_b64_tr_b16 v[60:61], v14 offset:6144
  ds_read_b64_tr_b16 v[62:63], v14 offset:7168
  s_waitcnt lgkmcnt(12)
  v_mfma_f32_32x32x16_bf16 v[240:255], v[68:71], v[164:167], v[240:255]
  ds_read_b64_tr_b16 v[64:65], v14 offset:8192
  ds_read_b64_tr_b16 v[66:67], v14 offset:9216
  s_waitcnt lgkmcnt(12)
  v_mfma_f32_32x32x16_bf16 v[240:255], v[72:75], v[192:195], v[240:255]
  ds_read_b64_tr_b16 v[68:69], v14 offset:10240
  ds_read_b64_tr_b16 v[70:71], v14 offset:11264
  s_waitcnt lgkmcnt(12)
  v_mfma_f32_32x32x16_bf16 v[240:255], v[76:79], v[196:199], v[240:255]
  ds_read_b64_tr_b16 v[72:73], v14 offset:12288
  ds_read_b64_tr_b16 v[74:75], v14 offset:13312
  s_waitcnt lgkmcnt(12)
  v_mfma_f32_32x32x16_bf16 v[240:255], v[48:51], v[80:83], v[240:255]
  ds_read_b64_tr_b16 v[76:77], v14 offset:14336
  ds_read_b64_tr_b16 v[78:79], v14 offset:15360
  s_waitcnt lgkmcnt(12)
  v_mfma_f32_32x32x16_bf16 v[240:255], v[52:55], v[84:87], v[240:255]
  ds_read_b64_tr_b16 v[48:49], v14 offset:16384
  ds_read_b64_tr_b16 v[50:51], v14 offset:17408
  s_waitcnt lgkmcnt(12)
  v_mfma_f32_32x32x16_bf16 v[240:255], v[56:59], v[88:91], v[240:255]
  ds_read_b64_tr_b16 v[52:53], v14 offset:18432
  ds_read_b64_tr_b16 v[54:55], v14 offset:19456
  s_waitcnt lgkmcnt(12)
  v_mfma_f32_32x32x16_bf16 v[240:255], v[60:63], v[92:95], v[240:255]
  s_waitcnt lgkmcnt(10)
  v_mfma_f32_32x32x16_bf16 v[240:255], v[64:67], v[112:115], v[240:255]
  s_waitcnt vmcnt(6) lgkmcnt(0)
  s_barrier
  s_cmp_lg_u32 s3, 7
  s_cbranch_scc1 k3_pub23
  v_mov_b32 v25, 3
  s_mov_b64 exec, 1
  buffer_store_dword v25, off, s[24:27], s69 sc1
  s_mov_b64 exec, -1
k3_pub23:
  ds_read_b64_tr_b16 v[56:57], v15 offset:20480
  ds_read_b64_tr_b16 v[58:59], v15 offset:21504
  ds_read_b64_tr_b16 v[60:61], v15 offset:22528
  ds_read_b64_tr_b16 v[62:63], v15 offset:23552
  v_mfma_f32_32x32x16_bf16 v[240:255], v[68:71], v[116:119], v[240:255]
  s_add_u32 m0, s34, 0
  s_mov_b32 s40, 1024
  buffer_load_dwordx4 v23, s[20:23], s40 offen lds
  ds_read_b64_tr_b16 v[64:65], v15 offset:24576
  ds_read_b64_tr_b16 v[66:67], v15 offset:25600
  v_mfma_f32_32x32x16_bf16 v[240:255], v[72:75], v[120:123], v[240:255]
  s_add_u32 m0, s34, 8192
  s_mov_b32 s40, 74752
  buffer_load_dwordx4 v23, s[20:23], s40 offen lds
  ds_read_b64_tr_b16 v[68:69], v15 offset:26624
  ds_read_b64_tr_b16 v[70:71], v15 offset:27648
  v_mfma_f32_32x32x16_bf16 v[240:255], v[76:79], v[124:127], v[240:255]
  s_add_u32 m0, s34, 16384
  s_mov_b32 s40, 148480
  buffer_load_dwordx4 v23, s[20:23], s40 offen lds
  ds_read_b64_tr_b16 v[72:73], v15 offset:28672
  ds_read_b64_tr_b16 v[74:75], v15 offset:29696
  v_mfma_f32_32x32x16_bf16 v[240:255], v[48:51], v[144:147], v[240:255]
  s_add_u32 m0, s34, 24576
  s_mov_b32 s40, 222208
  buffer_load_dwordx4 v23, s[20:23], s40 offen lds
  ds_read_b64_tr_b16 v[76:77], v15 offset:30720
  ds_read_b64_tr_b16 v[78:79], v15 offset:31744
  v_mfma_f32_32x32x16_bf16 v[240:255], v[52:55], v[148:151], v[240:255]
  ds_read_b64_tr_b16 v[48:49], v15 offset:32768
  ds_read_b64_tr_b16 v[50:51], v15 offset:33792
  s_waitcnt lgkmcnt(12)
  v_mfma_f32_32x32x16_bf16 v[176:191], v[56:59], v[96:99], 0
  ds_read_b64_tr_b16 v[52:53], v15 offset:34816
  ds_read_b64_tr_b16 v[54:55], v15 offset:35840
  s_waitcnt lgkmcnt(12)
  v_mfma_f32_32x32x16_bf16 v[176:191], v[60:63], v[100:103], v[176:191]
  ds_read_b64_tr_b16 v[56:57], v15 offset:0
  ds_read_b64_tr_b16 v[58:59], v15 offset:1024
  s_waitcnt lgkmcnt(12)
  v_mfma_f32_32x32x16_bf16 v[176:191], v[64:67], v[128:131], v[176:191]
  v_cvt_pk_bf16_f32 v104, v240, v241
  v_cvt_pk_bf16_f32 v105, v242, v243
  v_cvt_pk_bf16_f32 v106, v244, v245
  v_cvt_pk_bf16_f32 v107, v246, v247
  v_cvt_pk_bf16_f32 v108, v248, v249
  v_cvt_pk_bf16_f32 v109, v250, v251
  ds_read_b64_tr_b16 v[60:61], v15 offset:2048
  ds_read_b64_tr_b16 v[62:63], v15 offset:3072
  s_waitcnt lgkmcnt(12)
  v_mfma_f32_32x32x16_bf16 v[176:191], v[68:71], v[132:135], v[176:191]
  v_cvt_pk_bf16_f32 v110, v252, v253
  v_cvt_pk_bf16_f32 v111, v254, v255
  s_movk_i32 s41, 16384
  buffer_store_dwordx4 v[104:107], v24, s[24:27], s41 offen offset:0 sc1
  buffer_store_dwordx4 v[108:111], v24, s[24:27], s41 offen offset:1024 sc1
  ds_read_b64_tr_b16 v[64:65], v15 offset:4096
  ds_read_b64_tr_b16 v[66:67], v15 offset:5120
  s_waitcnt lgkmcnt(12)
  v_mfma_f32_32x32x16_bf16 v[176:191], v[72:75], v[160:163], v[176:191]
  ds_read_b64_tr_b16 v[68:69], v15 offset:6144
  ds_read_b64_tr_b16 v[70:71], v15 offset:7168
  s_waitcnt lgkmcnt(12)
  v_mfma_f32_32x32x16_bf16 v[176:191], v[76:79], v[164:167], v[176:191]
  ds_read_b64_tr_b16 v[72:73], v15 offset:8192
  ds_read_b64_tr_b16 v[74:75], v15 offset:9216
  s_waitcnt lgkmcnt(12)
  v_mfma_f32_32x32x16_bf16 v[176:191], v[48:51], v[192:195], v[176:191]
  ds_read_b64_tr_b16 v[76:77], v15 offset:10240
  ds_read_b64_tr_b16 v[78:79], v15 offset:11264
  s_waitcnt lgkmcnt(12)
  v_mfma_f32_32x32x16_bf16 v[176:191], v[52:55], v[196:199], v[176:191]
  ds_read_b64_tr_b16 v[48:49], v15 offset:12288
  ds_read_b64_tr_b16 v[50:51], v15 offset:13312
  s_waitcnt lgkmcnt(12)
  v_mfma_f32_32x32x16_bf16 v[176:191], v[56:59], v[80:83], v[176:191]
  ds_read_b64_tr_b16 v[52:53], v15 offset:14336
  ds_read_b64_tr_b16 v[54:55], v15 offset:15360
  s_waitcnt lgkmcnt(12)
  v_mfma_f32_32x32x16_bf16 v[176:191], v[60:63], v[84:87], v[176:191]
  ds_read_b64_tr_b16 v[56:57], v15 offset:16384
  ds_read_b64_tr_b16 v[58:59], v15 offset:17408
  s_waitcnt lgkmcnt(12)
  v_mfma_f32_32x32x16_bf16 v[176:191], v[64:67], v[88:91], v[176:191]
  ds_read_b64_tr_b16 v[60:61], v15 offset:18432
  ds_read_b64_tr_b16 v[62:63], v15 offset:19456
  s_waitcnt lgkmcnt(12)
  v_mfma_f32_32x32x16_bf16 v[176:191], v[68:71], v[92:95], v[176:191]
  s_waitcnt lgkmcnt(10)
  v_mfma_f32_32x32x16_bf16 v[176:191], v[72:75], v[112:115], v[176:191]
  s_waitcnt vmcnt(6) lgkmcnt(0)
  s_barrier
  s_cmp_lg_u32 s3, 7
  s_cbranch_scc1 k3_pub24
  v_mov_b32 v25, 4
  s_mov_b64 exec, 1
  buffer_store_dword v25, off, s[24:27], s69 sc1
  s_mov_b64 exec, -1
k3_pub24:
  ds_read_b64_tr_b16 v[64:65], v16 offset:20480
  ds_read_b64_tr_b16 v[66:67], v16 offset:21504
  ds_read_b64_tr_b16 v[68:69], v16 offset:22528
  ds_read_b64_tr_b16 v[70:71], v16 offset:23552
  v_mfma_f32_32x32x16_bf16 v[176:191], v[76:79], v[116:119], v[176:191]
  ds_read_b64_tr_b16 v[72:73], v16 offset:24576
  ds_read_b64_tr_b16 v[74:75], v16 offset:25600
  v_mfma_f32_32x32x16_bf16 v[176:191], v[48:51], v[120:123], v[176:191]
  ds_read_b64_tr_b16 v[76:77], v16 offset:26624
  ds_read_b64_tr_b16 v[78:79], v16 offset:27648
  v_mfma_f32_32x32x16_bf16 v[176:191], v[52:55], v[124:127], v[176:191]
  ds_read_b64_tr_b16 v[48:49], v16 offset:28672
  ds_read_b64_tr_b16 v[50:51], v16 offset:29696
  v_mfma_f32_32x32x16_bf16 v[176:191], v[56:59], v[144:147], v[176:191]
  ds_read_b64_tr_b16 v[52:53], v16 offset:30720
  ds_read_b64_tr_b16 v[54:55], v16 offset:31744
  v_mfma_f32_32x32x16_bf16 v[176:191], v[60:63], v[148:151], v[176:191]
  ds_read_b64_tr_b16 v[56:57], v16 offset:32768
  ds_read_b64_tr_b16 v[58:59], v16 offset:33792
  s_waitcnt lgkmcnt(12)
  v_mfma_f32_32x32x16_bf16 v[240:255], v[64:67], v[96:99], 0
  ds_read_b64_tr_b16 v[60:61], v16 offset:34816
  ds_read_b64_tr_b16 v[62:63], v16 offset:35840
  s_waitcnt lgkmcnt(12)
  v_mfma_f32_32x32x16_bf16 v[240:255], v[68:71], v[100:103], v[240:255]
  ds_read_b64_tr_b16 v[64:65], v16 offset:0
  ds_read_b64_tr_b16 v[66:67], v16 offset:1024
  s_waitcnt lgkmcnt(12)
  v_mfma_f32_32x32x16_bf16 v[240:255], v[72:75], v[128:131], v[240:255]
  v_cvt_pk_bf16_f32 v136, v176, v177
  v_cvt_pk_bf16_f32 v137, v178, v179
  v_cvt_pk_bf16_f32 v138, v180, v181
  v_cvt_pk_bf16_f32 v139, v182, v183
  v_cvt_pk_bf16_f32 v140, v184, v185
  v_cvt_pk_bf16_f32 v141, v186, v187
  ds_read_b64_tr_b16 v[68:69], v16 offset:2048
  ds_read_b64_tr_b16 v[70:71], v16 offset:3072
  s_waitcnt lgkmcnt(12)
  v_mfma_f32_32x32x16_bf16 v[240:255], v[76:79], v[132:135], v[240:255]
  v_cvt_pk_bf16_f32 v142, v188, v189
  v_cvt_pk_bf16_f32 v143, v190, v191
  s_movk_i32 s41, 20480
  buffer_store_dwordx4 v[136:139], v24, s[24:27], s41 offen offset:0 sc1
  buffer_store_dwordx4 v[140:143], v24, s[24:27], s41 offen offset:1024 sc1
  ds_read_b64_tr_b16 v[72:73], v16 offset:4096
  ds_read_b64_tr_b16 v[74:75], v16 offset:5120
  s_waitcnt lgkmcnt(12)
  v_mfma_f32_32x32x16_bf16 v[240:255], v[48:51], v[160:163], v[240:255]
  ds_read_b64_tr_b16 v[76:77], v16 offset:6144
  ds_read_b64_tr_b16 v[78:79], v16 offset:7168
  s_waitcnt lgkmcnt(12)
  v_mfma_f32_32x32x16_bf16 v[240:255], v[52:55], v[164:167], v[240:255]
  ds_read_b64_tr_b16 v[48:49], v16 offset:8192
  ds_read_b64_tr_b16 v[50:51], v16 offset:9216
  s_waitcnt lgkmcnt(12)
  v_mfma_f32_32x32x16_bf16 v[240:255], v[56:59], v[192:195], v[240:255]
  ds_read_b64_tr_b16 v[52:53], v16 offset:10240
  ds_read_b64_tr_b16 v[54:55], v16 offset:11264
  s_waitcnt lgkmcnt(12)
  v_mfma_f32_32x32x16_bf16 v[240:255], v[60:63], v[196:199], v[240:255]
  ds_read_b64_tr_b16 v[56:57], v16 offset:12288
  ds_read_b64_tr_b16 v[58:59], v16 offset:13312
  s_waitcnt lgkmcnt(12)
  v_mfma_f32_32x32x16_bf16 v[240:255], v[64:67], v[80:83], v[240:255]
  ds_read_b64_tr_b16 v[60:61], v16 offset:14336
  ds_read_b64_tr_b16 v[62:63], v16 offset:15360
  s_waitcnt lgkmcnt(12)
  v_mfma_f32_32x32x16_bf16 v[240:255], v[68:71], v[84:87], v[240:255]
  ds_read_b64_tr_b16 v[64:65], v16 offset:16384
  ds_read_b64_tr_b16 v[66:67], v16 offset:17408
  s_waitcnt lgkmcnt(12)
  v_mfma_f32_32x32x16_bf16 v[240:255], v[72:75], v[88:91], v[240:255]
  ds_read_b64_tr_b16 v[68:69], v16 offset:18432
  ds_read_b64_tr_b16 v[70:71], v16 offset:19456
  s_waitcnt lgkmcnt(12)
  v_mfma_f32_32x32x16_bf16 v[240:255], v[76:79], v[92:95], v[240:255]
  s_waitcnt lgkmcnt(10)
  v_mfma_f32_32x32x16_bf16 v[240:255], v[48:51], v[112:115], v[240:255]
  s_waitcnt lgkmcnt(0)
  s_barrier
  ds_read_b64_tr_b16 v[72:73], v17 offset:20480
  ds_read_b64_tr_b16 v[74:75], v17 offset:21504
  ds_read_b64_tr_b16 v[76:77], v17 offset:22528
  ds_read_b64_tr_b16 v[78:79], v17 offset:23552
  v_mfma_f32_32x32x16_bf16 v[240:255], v[52:55], v[116:119], v[240:255]
  ds_read_b64_tr_b16 v[48:49], v17 offset:24576
  ds_read_b64_tr_b16 v[50:51], v17 offset:25600
  v_mfma_f32_32x32x16_bf16 v[240:255], v[56:59], v[120:123], v[240:255]
  ds_read_b64_tr_b16 v[52:53], v17 offset:26624
  ds_read_b64_tr_b16 v[54:55], v17 offset:27648
  v_mfma_f32_32x32x16_bf16 v[240:255], v[60:63], v[124:127], v[240:255]
  ds_read_b64_tr_b16 v[56:57], v17 offset:28672
  ds_read_b64_tr_b16 v[58:59], v17 offset:29696
  v_mfma_f32_32x32x16_bf16 v[240:255], v[64:67], v[144:147], v[240:255]
  ds_read_b64_tr_b16 v[60:61], v17 offset:30720
  ds_read_b64_tr_b16 v[62:63], v17 offset:31744
  v_mfma_f32_32x32x16_bf16 v[240:255], v[68:71], v[148:151], v[240:255]
  ds_read_b64_tr_b16 v[64:65], v17 offset:32768
  ds_read_b64_tr_b16 v[66:67], v17 offset:33792
  s_waitcnt lgkmcnt(12)
  v_mfma_f32_32x32x16_bf16 v[176:191], v[72:75], v[96:99], 0
  ds_read_b64_tr_b16 v[68:69], v17 offset:34816
  ds_read_b64_tr_b16 v[70:71], v17 offset:35840
  s_waitcnt lgkmcnt(12)
  v_mfma_f32_32x32x16_bf16 v[176:191], v[76:79], v[100:103], v[176:191]
  ds_read_b64_tr_b16 v[72:73], v17 offset:0
  ds_read_b64_tr_b16 v[74:75], v17 offset:1024
  s_waitcnt lgkmcnt(12)
  v_mfma_f32_32x32x16_bf16 v[176:191], v[48:51], v[128:131], v[176:191]
  v_cvt_pk_bf16_f32 v104, v240, v241
  v_cvt_pk_bf16_f32 v105, v242, v243
  v_cvt_pk_bf16_f32 v106, v244, v245
  v_cvt_pk_bf16_f32 v107, v246, v247
  v_cvt_pk_bf16_f32 v108, v248, v249
  v_cvt_pk_bf16_f32 v109, v250, v251
  ds_read_b64_tr_b16 v[76:77], v17 offset:2048
  ds_read_b64_tr_b16 v[78:79], v17 offset:3072
  s_waitcnt lgkmcnt(12)
  v_mfma_f32_32x32x16_bf16 v[176:191], v[52:55], v[132:135], v[176:191]
  v_cvt_pk_bf16_f32 v110, v252, v253
  v_cvt_pk_bf16_f32 v111, v254, v255
  s_movk_i32 s41, 24576
  buffer_store_dwordx4 v[104:107], v24, s[24:27], s41 offen offset:0 sc1
  buffer_store_dwordx4 v[108:111], v24, s[24:27], s41 offen offset:1024 sc1
  ds_read_b64_tr_b16 v[48:49], v17 offset:4096
  ds_read_b64_tr_b16 v[50:51], v17 offset:5120
  s_waitcnt lgkmcnt(12)
  v_mfma_f32_32x32x16_bf16 v[176:191], v[56:59], v[160:163], v[176:191]
  ds_read_b64_tr_b16 v[52:53], v17 offset:6144
  ds_read_b64_tr_b16 v[54:55], v17 offset:7168
  s_waitcnt lgkmcnt(12)
  v_mfma_f32_32x32x16_bf16 v[176:191], v[60:63], v[164:167], v[176:191]
  ds_read_b64_tr_b16 v[56:57], v17 offset:8192
  ds_read_b64_tr_b16 v[58:59], v17 offset:9216
  s_waitcnt lgkmcnt(12)
  v_mfma_f32_32x32x16_bf16 v[176:191], v[64:67], v[192:195], v[176:191]
  ds_read_b64_tr_b16 v[60:61], v17 offset:10240
  ds_read_b64_tr_b16 v[62:63], v17 offset:11264
  s_waitcnt lgkmcnt(12)
  v_mfma_f32_32x32x16_bf16 v[176:191], v[68:71], v[196:199], v[176:191]
  ds_read_b64_tr_b16 v[64:65], v17 offset:12288
  ds_read_b64_tr_b16 v[66:67], v17 offset:13312
  s_waitcnt lgkmcnt(12)
  v_mfma_f32_32x32x16_bf16 v[176:191], v[72:75], v[80:83], v[176:191]
  ds_read_b64_tr_b16 v[68:69], v17 offset:14336
  ds_read_b64_tr_b16 v[70:71], v17 offset:15360
  s_waitcnt lgkmcnt(12)
  v_mfma_f32_32x32x16_bf16 v[176:191], v[76:79], v[84:87], v[176:191]
  ds_read_b64_tr_b16 v[72:73], v17 offset:16384
  ds_read_b64_tr_b16 v[74:75], v17 offset:17408
  s_waitcnt lgkmcnt(12)
  v_mfma_f32_32x32x16_bf16 v[176:191], v[48:51], v[88:91], v[176:191]
  ds_read_b64_tr_b16 v[76:77], v17 offset:18432
  ds_read_b64_tr_b16 v[78:79], v17 offset:19456
  s_waitcnt lgkmcnt(12)
  v_mfma_f32_32x32x16_bf16 v[176:191], v[52:55], v[92:95], v[176:191]
  s_waitcnt lgkmcnt(10)
  v_mfma_f32_32x32x16_bf16 v[176:191], v[56:59], v[112:115], v[176:191]
  s_waitcnt vmcnt(2) lgkmcnt(0)
  s_barrier
  s_cmp_lg_u32 s3, 7
  s_cbranch_scc1 k3_pub26
  v_mov_b32 v25, 6
  s_mov_b64 exec, 1
  buffer_store_dword v25, off, s[24:27], s69 sc1
  s_mov_b64 exec, -1
k3_pub26:
  ds_read_b64_tr_b16 v[48:49], v14 offset:20480
  ds_read_b64_tr_b16 v[50:51], v14 offset:21504
  ds_read_b64_tr_b16 v[52:53], v14 offset:22528
  ds_read_b64_tr_b16 v[54:55], v14 offset:23552
  v_mfma_f32_32x32x16_bf16 v[176:191], v[60:63], v[116:119], v[176:191]
  ds_read_b64_tr_b16 v[56:57], v14 offset:24576
  ds_read_b64_tr_b16 v[58:59], v14 offset:25600
  v_mfma_f32_32x32x16_bf16 v[176:191], v[64:67], v[120:123], v[176:191]
  ds_read_b64_tr_b16 v[60:61], v14 offset:26624
  ds_read_b64_tr_b16 v[62:63], v14 offset:27648
  v_mfma_f32_32x32x16_bf16 v[176:191], v[68:71], v[124:127], v[176:191]
  ds_read_b64_tr_b16 v[64:65], v14 offset:28672
  ds_read_b64_tr_b16 v[66:67], v14 offset:29696
  v_mfma_f32_32x32x16_bf16 v[176:191], v[72:75], v[144:147], v[176:191]
  ds_read_b64_tr_b16 v[68:69], v14 offset:30720
  ds_read_b64_tr_b16 v[70:71], v14 offset:31744
  v_mfma_f32_32x32x16_bf16 v[176:191], v[76:79], v[148:151], v[176:191]
  ds_read_b64_tr_b16 v[72:73], v14 offset:32768
  ds_read_b64_tr_b16 v[74:75], v14 offset:33792
  s_waitcnt lgkmcnt(12)
  v_mfma_f32_32x32x16_bf16 v[240:255], v[48:51], v[96:99], 0
  ds_read_b64_tr_b16 v[76:77], v14 offset:34816
  ds_read_b64_tr_b16 v[78:79], v14 offset:35840
  s_waitcnt lgkmcnt(12)
  v_mfma_f32_32x32x16_bf16 v[240:255], v[52:55], v[100:103], v[240:255]
  ds_read_b64_tr_b16 v[48:49], v14 offset:0
  ds_read_b64_tr_b16 v[50:51], v14 offset:1024
  s_waitcnt lgkmcnt(12)
  v_mfma_f32_32x32x16_bf16 v[240:255], v[56:59], v[128:131], v[240:255]
  v_cvt_pk_bf16_f32 v136, v176, v177
  v_cvt_pk_bf16_f32 v137, v178, v179
  v_cvt_pk_bf16_f32 v138, v180, v181
  v_cvt_pk_bf16_f32 v139, v182, v183
  v_cvt_pk_bf16_f32 v140, v184, v185
  v_cvt_pk_bf16_f32 v141, v186, v187
  ds_read_b64_tr_b16 v[52:53], v14 offset:2048
  ds_read_b64_tr_b16 v[54:55], v14 offset:3072
  s_waitcnt lgkmcnt(12)
  v_mfma_f32_32x32x16_bf16 v[240:255], v[60:63], v[132:135], v[240:255]
  v_cvt_pk_bf16_f32 v142, v188, v189
  v_cvt_pk_bf16_f32 v143, v190, v191
  s_movk_i32 s41, 28672
  buffer_store_dwordx4 v[136:139], v24, s[24:27], s41 offen offset:0 sc1
  buffer_store_dwordx4 v[140:143], v24, s[24:27], s41 offen offset:1024 sc1
  ds_read_b64_tr_b16 v[56:57], v14 offset:4096
  ds_read_b64_tr_b16 v[58:59], v14 offset:5120
  s_waitcnt lgkmcnt(12)
  v_mfma_f32_32x32x16_bf16 v[240:255], v[64:67], v[160:163], v[240:255]
  ds_read_b64_tr_b16 v[60:61], v14 offset:6144
  ds_read_b64_tr_b16 v[62:63], v14 offset:7168
  s_waitcnt lgkmcnt(12)
  v_mfma_f32_32x32x16_bf16 v[240:255], v[68:71], v[164:167], v[240:255]
  ds_read_b64_tr_b16 v[64:65], v14 offset:8192
  ds_read_b64_tr_b16 v[66:67], v14 offset:9216
  s_waitcnt lgkmcnt(12)
  v_mfma_f32_32x32x16_bf16 v[240:255], v[72:75], v[192:195], v[240:255]
  ds_read_b64_tr_b16 v[68:69], v14 offset:10240
  ds_read_b64_tr_b16 v[70:71], v14 offset:11264
  s_waitcnt lgkmcnt(12)
  v_mfma_f32_32x32x16_bf16 v[240:255], v[76:79], v[196:199], v[240:255]
  ds_read_b64_tr_b16 v[72:73], v14 offset:12288
  ds_read_b64_tr_b16 v[74:75], v14 offset:13312
  s_waitcnt lgkmcnt(12)
  v_mfma_f32_32x32x16_bf16 v[240:255], v[48:51], v[80:83], v[240:255]
  ds_read_b64_tr_b16 v[76:77], v14 offset:14336
  ds_read_b64_tr_b16 v[78:79], v14 offset:15360
  s_waitcnt lgkmcnt(12)
  v_mfma_f32_32x32x16_bf16 v[240:255], v[52:55], v[84:87], v[240:255]
  ds_read_b64_tr_b16 v[48:49], v14 offset:16384
  ds_read_b64_tr_b16 v[50:51], v14 offset:17408
  s_waitcnt lgkmcnt(12)
  v_mfma_f32_32x32x16_bf16 v[240:255], v[56:59], v[88:91], v[240:255]
  ds_read_b64_tr_b16 v[52:53], v14 offset:18432
  ds_read_b64_tr_b16 v[54:55], v14 offset:19456
  s_waitcnt lgkmcnt(12)
  v_mfma_f32_32x32x16_bf16 v[240:255], v[60:63], v[92:95], v[240:255]
  s_waitcnt lgkmcnt(10)
  v_mfma_f32_32x32x16_bf16 v[240:255], v[64:67], v[112:115], v[240:255]
  s_waitcnt lgkmcnt(8)
  v_mfma_f32_32x32x16_bf16 v[240:255], v[68:71], v[116:119], v[240:255]
  s_waitcnt lgkmcnt(6)
  v_mfma_f32_32x32x16_bf16 v[240:255], v[72:75], v[120:123], v[240:255]
  s_waitcnt lgkmcnt(4)
  v_mfma_f32_32x32x16_bf16 v[240:255], v[76:79], v[124:127], v[240:255]
  s_waitcnt lgkmcnt(2)
  v_mfma_f32_32x32x16_bf16 v[240:255], v[48:51], v[144:147], v[240:255]
  s_waitcnt lgkmcnt(0)
  v_mfma_f32_32x32x16_bf16 v[240:255], v[52:55], v[148:151], v[240:255]
  s_nop 7
  s_nop 3
  v_cvt_pk_bf16_f32 v104, v240, v241
  v_cvt_pk_bf16_f32 v105, v242, v243
  v_cvt_pk_bf16_f32 v106, v244, v245
  v_cvt_pk_bf16_f32 v107, v246, v247
  v_cvt_pk_bf16_f32 v108, v248, v249
  v_cvt_pk_bf16_f32 v109, v250, v251
  v_cvt_pk_bf16_f32 v110, v252, v253
  v_cvt_pk_bf16_f32 v111, v254, v255
  s_mov_b32 s41, 0x8000
  buffer_store_dwordx4 v[104:107], v24, s[24:27], s41 offen offset:0 sc1
  buffer_store_dwordx4 v[108:111], v24, s[24:27], s41 offen offset:1024 sc1
  s_nop 7
  s_nop 7
k3_join:
  s_waitcnt vmcnt(0)
  s_barrier
  s_cmp_lg_u32 s3, 7
  s_cbranch_scc1 kf_main_kernel_gb3_p
  v_mov_b32 v45, 9
  s_mov_b64 exec, 1
  buffer_store_dword v45, off, s[24:27], s69 sc1
  s_mov_b64 exec, -1
kf_main_kernel_gb3_p:
  v_and_b32 v48, 7, v0
  v_lshrrev_b32 v49, 3, v0
  s_lshl_b32 s64, s31, 4
  s_add_u32 s64, s64, s30
  s_lshr_b32 s65, s64, 2
  s_lshl_b32 s64, s64, 3
  v_add_u32 v50, s64, v48
  s_movk_i32 s66, 1152
  v_mul_lo_u32 v57, v50, s66
  v_lshl_add_u32 v51, v49, 4, v57
  v_lshlrev_b32 v52, 5, v49
  v_and_b32 v50, 31, v50
  v_lshlrev_b32 v56, 5, v48
  v_add_u32 v56, 135168, v56
  s_lshl_b32 s66, s3, 2
  v_add_u32 v55, s66, v56
  v_lshrrev_b32 v53, 2, v49
  v_lshlrev_b32 v53, 11, v53
  v_and_b32 v72, 1, v49
  v_lshl_add_u32 v53, v72, 10, v53
  v_bfe_u32 v72, v49, 1, 1
  v_lshl_add_u32 v53, v72, 9, v53
  v_lshl_add_u32 v53, v50, 4, v53
  s_mul_i32 s66, s65, 36864
  s_add_u32 s66, s66, 67108864
  v_add_u32 v53, s66, v53
  s_mul_i32 s67, s3, 4714496
  s_add_u32 s67, s67, 32768
  v_lshlrev_b32 v59, 2, v49
  s_movk_i32 s66, 11520
  buffer_load_dwordx4 v[104:107], v52, s[24:27], s66 offen
  buffer_load_dwordx4 v[108:111], v52, s[24:27], s66 offen offset:16
  buffer_load_dword v112, v59, s[24:27], s66 offen offset:2048
  s_add_u32 s70, s3, 1
  s_cmp_ge_u32 s3, 2
  s_cbranch_scc1 kf_main_kernel_gb3_late
  v_and_b32 v46, 15, v0
  v_lshlrev_b32 v46, 7, v46
  s_mov_b32 s71, 0x100000
kf_main_kernel_gb3e_poll:
  buffer_load_dword v47, v46, s[24:27], s68 offen sc1
  s_waitcnt vmcnt(0)
  v_cmp_gt_u32 vcc, s70, v47
  s_sub_u32 s71, s71, 1
  s_cbranch_scc1 kf_main_kernel_gb3e_out
  s_cbranch_vccnz kf_main_kernel_gb3e_poll
kf_main_kernel_gb3e_out:
  s_mov_b32 s66, 0
  buffer_load_dwordx4 v[144:147], v53, s[24:27], s66 offen sc1
  s_mov_b32 s66, 2359296
  buffer_load_dwordx4 v[148:151], v53, s[24:27], s66 offen sc1
  s_mov_b32 s66, 4718592
  buffer_load_dwordx4 v[152:155], v53, s[24:27], s66 offen sc1
  s_mov_b32 s66, 7077888
  buffer_load_dwordx4 v[156:159], v53, s[24:27], s66 offen sc1
  s_mov_b32 s66, 9437184
  buffer_load_dwordx4 v[208:211], v53, s[24:27], s66 offen sc1
  s_mov_b32 s66, 11796480
  buffer_load_dwordx4 v[212:215], v53, s[24:27], s66 offen sc1
  s_mov_b32 s66, 14155776
  buffer_load_dwordx4 v[216:219], v53, s[24:27], s66 offen sc1
  s_mov_b32 s66, 16515072
  buffer_load_dwordx4 v[220:223], v53, s[24:27], s66 offen sc1
  s_mov_b32 s66, 18874368
  buffer_load_dwordx4 v[168:171], v53, s[24:27], s66 offen sc1
  s_mov_b32 s66, 21233664
  buffer_load_dwordx4 v[172:175], v53, s[24:27], s66 offen sc1
  s_mov_b32 s66, 23592960
  buffer_load_dwordx4 v[200:203], v53, s[24:27], s66 offen sc1
  s_mov_b32 s66, 25952256
  buffer_load_dwordx4 v[204:207], v53, s[24:27], s66 offen sc1
  s_mov_b32 s66, 28311552
  buffer_load_dwordx4 v[232:235], v53, s[24:27], s66 offen sc1
  s_mov_b32 s66, 30670848
  buffer_load_dwordx4 v[236:239], v53, s[24:27], s66 offen sc1
  s_mov_b32 s66, 33030144
  buffer_load_dwordx4 v[32:35], v53, s[24:27], s66 offen sc1
  s_mov_b32 s66, 35389440
  buffer_load_dwordx4 v[36:39], v53, s[24:27], s66 offen sc1
kf_main_kernel_gb3_skip:
  s_barrier
  s_branch kf_main_kernel_gb3_join
kf_main_kernel_gb3_late:
  s_mov_b32 s70, 9
  s_cmp_lg_u32 s3, 7
  s_cbranch_scc1 kf_main_kernel_gb3_out
  v_and_b32 v46, 15, v0
  v_lshlrev_b32 v46, 7, v46
  s_mov_b32 s71, 0x100000
kf_main_kernel_gb3_poll:
  buffer_load_dword v47, v46, s[24:27], s68 offen sc1
  s_waitcnt vmcnt(0)
  v_cmp_gt_u32 vcc, s70, v47
  s_sub_u32 s71, s71, 1
  s_cbranch_scc1 kf_main_kernel_gb3_out
  s_cbranch_vccnz kf_main_kernel_gb3_poll
kf_main_kernel_gb3_out:
  s_barrier
  s_mov_b32 s66, 0
  buffer_load_dwordx4 v[144:147], v53, s[24:27], s66 offen sc1
  s_mov_b32 s66, 2359296
  buffer_load_dwordx4 v[148:151], v53, s[24:27], s66 offen sc1
  s_mov_b32 s66, 4718592
  buffer_load_dwordx4 v[152:155], v53, s[24:27], s66 offen sc1
  s_mov_b32 s66, 7077888
  buffer_load_dwordx4 v[156:159], v53, s[24:27], s66 offen sc1
  s_mov_b32 s66, 9437184
  buffer_load_dwordx4 v[208:211], v53, s[24:27], s66 offen sc1
  s_mov_b32 s66, 11796480
  buffer_load_dwordx4 v[212:215], v53, s[24:27], s66 offen sc1
  s_mov_b32 s66, 14155776
  buffer_load_dwordx4 v[216:219], v53, s[24:27], s66 offen sc1
  s_mov_b32 s66, 16515072
  buffer_load_dwordx4 v[220:223], v53, s[24:27], s66 offen sc1
  s_mov_b32 s66, 18874368
  buffer_load_dwordx4 v[168:171], v53, s[24:27], s66 offen sc1
  s_mov_b32 s66, 21233664
  buffer_load_dwordx4 v[172:175], v53, s[24:27], s66 offen sc1
  s_mov_b32 s66, 23592960
  buffer_load_dwordx4 v[200:203], v53, s[24:27], s66 offen sc1
  s_mov_b32 s66, 25952256
  buffer_load_dwordx4 v[204:207], v53, s[24:27], s66 offen sc1
  s_mov_b32 s66, 28311552
  buffer_load_dwordx4 v[232:235], v53, s[24:27], s66 offen sc1
  s_mov_b32 s66, 30670848
  buffer_load_dwordx4 v[236:239], v53, s[24:27], s66 offen sc1
  s_mov_b32 s66, 33030144
  buffer_load_dwordx4 v[32:35], v53, s[24:27], s66 offen sc1
  s_mov_b32 s66, 35389440
  buffer_load_dwordx4 v[36:39], v53, s[24:27], s66 offen sc1
kf_main_kernel_gb3_join:
  buffer_load_dwordx4 v[132:135], v53, s[24:27], s67 offen sc1
  s_add_u32 s67, s67, 2359296
  buffer_load_dwordx4 v[136:139], v53, s[24:27], s67 offen sc1
  v_lshlrev_b32 v60, 16, v26
  v_and_b32 v61, 0xffff0000, v26
  v_lshlrev_b32 v62, 16, v27
  v_and_b32 v63, 0xffff0000, v27
  v_lshlrev_b32 v64, 16, v28
  v_and_b32 v65, 0xffff0000, v28
  v_lshlrev_b32 v66, 16, v29
  v_and_b32 v67, 0xffff0000, v29
  v_mov_b32 v68, v30
  s_mov_b32 s68, 0x3f80
  s_mov_b32 s69, 0x3f800000
  s_waitcnt vmcnt(17)
  v_dot2_f32_bf16 v114, v144, s68, 0
  v_dot2_f32_bf16 v115, v144, s69, 0
  v_dot2_f32_bf16 v116, v145, s68, 0
  v_dot2_f32_bf16 v117, v145, s69, 0
  v_dot2_f32_bf16 v118, v146, s68, 0
  v_dot2_f32_bf16 v119, v146, s69, 0
  v_dot2_f32_bf16 v120, v147, s68, 0
  v_dot2_f32_bf16 v121, v147, s69, 0
  s_waitcnt vmcnt(16)
  v_dot2_f32_bf16 v114, v148, s68, v114
  v_dot2_f32_bf16 v115, v148, s69, v115
  v_dot2_f32_bf16 v116, v149, s68, v116
  v_dot2_f32_bf16 v117, v149, s69, v117
  v_dot2_f32_bf16 v118, v150, s68, v118
  v_dot2_f32_bf16 v119, v150, s69, v119
  v_dot2_f32_bf16 v120, v151, s68, v120
  v_dot2_f32_bf16 v121, v151, s69, v121
  s_waitcnt vmcnt(15)
  v_dot2_f32_bf16 v114, v152, s68, v114
  v_dot2_f32_bf16 v115, v152, s69, v115
  v_dot2_f32_bf16 v116, v153, s68, v116
  v_dot2_f32_bf16 v117, v153, s69, v117
  v_dot2_f32_bf16 v118, v154, s68, v118
  v_dot2_f32_bf16 v119, v154, s69, v119
  v_dot2_f32_bf16 v120, v155, s68, v120
  v_dot2_f32_bf16 v121, v155, s69, v121
  s_waitcnt vmcnt(14)
  v_dot2_f32_bf16 v114, v156, s68, v114
  v_dot2_f32_bf16 v115, v156, s69, v115
  v_dot2_f32_bf16 v116, v157, s68, v116
  v_dot2_f32_bf16 v117, v157, s69, v117
  v_dot2_f32_bf16 v118, v158, s68, v118
  v_dot2_f32_bf16 v119, v158, s69, v119
  v_dot2_f32_bf16 v120, v159, s68, v120
  v_dot2_f32_bf16 v121, v159, s69, v121
  s_waitcnt vmcnt(13)
  v_dot2_f32_bf16 v114, v208, s68, v114
  v_dot2_f32_bf16 v115, v208, s69, v115
  v_dot2_f32_bf16 v116, v209, s68, v116
  v_dot2_f32_bf16 v117, v209, s69, v117
  v_dot2_f32_bf16 v118, v210, s68, v118
  v_dot2_f32_bf16 v119, v210, s69, v119
  v_dot2_f32_bf16 v120, v211, s68, v120
  v_dot2_f32_bf16 v121, v211, s69, v121
  s_waitcnt vmcnt(12)
  v_dot2_f32_bf16 v114, v212, s68, v114
  v_dot2_f32_bf16 v115, v212, s69, v115
  v_dot2_f32_bf16 v116, v213, s68, v116
  v_dot2_f32_bf16 v117, v213, s69, v117
  v_dot2_f32_bf16 v118, v214, s68, v118
  v_dot2_f32_bf16 v119, v214, s69, v119
  v_dot2_f32_bf16 v120, v215, s68, v120
  v_dot2_f32_bf16 v121, v215, s69, v121
  s_waitcnt vmcnt(11)
  v_dot2_f32_bf16 v114, v216, s68, v114
  v_dot2_f32_bf16 v115, v216, s69, v115
  v_dot2_f32_bf16 v116, v217, s68, v116
  v_dot2_f32_bf16 v117, v217, s69, v117
  v_dot2_f32_bf16 v118, v218, s68, v118
  v_dot2_f32_bf16 v119, v218, s69, v119
  v_dot2_f32_bf16 v120, v219, s68, v120
  v_dot2_f32_bf16 v121, v219, s69, v121
  s_waitcnt vmcnt(10)
  v_dot2_f32_bf16 v114, v220, s68, v114
  v_dot2_f32_bf16 v115, v220, s69, v115
  v_dot2_f32_bf16 v116, v221, s68, v116
  v_dot2_f32_bf16 v117, v221, s69, v117
  v_dot2_f32_bf16 v118, v222, s68, v118
  v_dot2_f32_bf16 v119, v222, s69, v119
  v_dot2_f32_bf16 v120, v223, s68, v120
  v_dot2_f32_bf16 v121, v223, s69, v121
  s_waitcnt vmcnt(9)
  v_dot2_f32_bf16 v114, v168, s68, v114
  v_dot2_f32_bf16 v115, v168, s69, v115
  v_dot2_f32_bf16 v116, v169, s68, v116
  v_dot2_f32_bf16 v117, v169, s69, v117
  v_dot2_f32_bf16 v118, v170, s68, v118
  v_dot2_f32_bf16 v119, v170, s69, v119
  v_dot2_f32_bf16 v120, v171, s68, v120
  v_dot2_f32_bf16 v121, v171, s69, v121
  s_waitcnt vmcnt(8)
  v_dot2_f32_bf16 v114, v172, s68, v114
  v_dot2_f32_bf16 v115, v172, s69, v115
  v_dot2_f32_bf16 v116, v173, s68, v116
  v_dot2_f32_bf16 v117, v173, s69, v117
  v_dot2_f32_bf16 v118, v174, s68, v118
  v_dot2_f32_bf16 v119, v174, s69, v119
  v_dot2_f32_bf16 v120, v175, s68, v120
  v_dot2_f32_bf16 v121, v175, s69, v121
  s_waitcnt vmcnt(7)
  v_dot2_f32_bf16 v114, v200, s68, v114
  v_dot2_f32_bf16 v115, v200, s69, v115
  v_dot2_f32_bf16 v116, v201, s68, v116
  v_dot2_f32_bf16 v117, v201, s69, v117
  v_dot2_f32_bf16 v118, v202, s68, v118
  v_dot2_f32_bf16 v119, v202, s69, v119
  v_dot2_f32_bf16 v120, v203, s68, v120
  v_dot2_f32_bf16 v121, v203, s69, v121
  s_waitcnt vmcnt(6)
  v_dot2_f32_bf16 v114, v204, s68, v114
  v_dot2_f32_bf16 v115, v204, s69, v115
  v_dot2_f32_bf16 v116, v205, s68, v116
  v_dot2_f32_bf16 v117, v205, s69, v117
  v_dot2_f32_bf16 v118, v206, s68, v118
  v_dot2_f32_bf16 v119, v206, s69, v119
  v_dot2_f32_bf16 v120, v207, s68, v120
  v_dot2_f32_bf16 v121, v207, s69, v121
  s_waitcnt vmcnt(5)
  v_dot2_f32_bf16 v114, v232, s68, v114
  v_dot2_f32_bf16 v115, v232, s69, v115
  v_dot2_f32_bf16 v116, v233, s68, v116
  v_dot2_f32_bf16 v117, v233, s69, v117
  v_dot2_f32_bf16 v118, v234, s68, v118
  v_dot2_f32_bf16 v119, v234, s69, v119
  v_dot2_f32_bf16 v120, v235, s68, v120
  v_dot2_f32_bf16 v121, v235, s69, v121
  s_waitcnt vmcnt(4)
  v_dot2_f32_bf16 v114, v236, s68, v114
  v_dot2_f32_bf16 v115, v236, s69, v115
  v_dot2_f32_bf16 v116, v237, s68, v116
  v_dot2_f32_bf16 v117, v237, s69, v117
  v_dot2_f32_bf16 v118, v238, s68, v118
  v_dot2_f32_bf16 v119, v238, s69, v119
  v_dot2_f32_bf16 v120, v239, s68, v120
  v_dot2_f32_bf16 v121, v239, s69, v121
  s_waitcnt vmcnt(3)
  v_dot2_f32_bf16 v114, v32, s68, v114
  v_dot2_f32_bf16 v115, v32, s69, v115
  v_dot2_f32_bf16 v116, v33, s68, v116
  v_dot2_f32_bf16 v117, v33, s69, v117
  v_dot2_f32_bf16 v118, v34, s68, v118
  v_dot2_f32_bf16 v119, v34, s69, v119
  v_dot2_f32_bf16 v120, v35, s68, v120
  v_dot2_f32_bf16 v121, v35, s69, v121
  s_waitcnt vmcnt(2)
  v_dot2_f32_bf16 v114, v36, s68, v114
  v_dot2_f32_bf16 v115, v36, s69, v115
  v_dot2_f32_bf16 v116, v37, s68, v116
  v_dot2_f32_bf16 v117, v37, s69, v117
  v_dot2_f32_bf16 v118, v38, s68, v118
  v_dot2_f32_bf16 v119, v38, s69, v119
  v_dot2_f32_bf16 v120, v39, s68, v120
  v_dot2_f32_bf16 v121, v39, s69, v121
  s_nop 2
  s_waitcnt vmcnt(1)
  v_dot2_f32_bf16 v124, v132, s68, 0
  v_dot2_f32_bf16 v125, v132, s69, 0
  v_dot2_f32_bf16 v126, v133, s68, 0
  v_dot2_f32_bf16 v127, v133, s69, 0
  v_dot2_f32_bf16 v128, v134, s68, 0
  v_dot2_f32_bf16 v129, v134, s69, 0
  v_dot2_f32_bf16 v130, v135, s68, 0
  v_dot2_f32_bf16 v131, v135, s69, 0
  s_waitcnt vmcnt(0)
  v_dot2_f32_bf16 v124, v136, s68, v124
  v_dot2_f32_bf16 v125, v136, s69, v125
  v_dot2_f32_bf16 v126, v137, s68, v126
  v_dot2_f32_bf16 v127, v137, s69, v127
  v_dot2_f32_bf16 v128, v138, s68, v128
  v_dot2_f32_bf16 v129, v138, s69, v129
  v_dot2_f32_bf16 v130, v139, s68, v130
  v_dot2_f32_bf16 v131, v139, s69, v131
  s_nop 2
  v_lshlrev_b32 v58, 5, v0
  v_add_u32 v58, 137216, v58
  ds_write_b128 v58, v[124:127]
  ds_write_b128 v58, v[128:131] offset:16
  v_bfe_u32 v59, v0, 3, 3
  v_lshl_add_u32 v59, v59, 2, v56
  s_lshl_b32 s66, s3, 8
  v_add_u32 v59, s66, v59
  s_waitcnt lgkmcnt(0)
  s_barrier
  ds_read_b32 v124, v59 offset:2048
  ds_read_b32 v125, v59 offset:4096
  ds_read_b32 v126, v59 offset:6144
  ds_read_b32 v127, v59 offset:8192
  ds_read_b32 v128, v59 offset:10240
  ds_read_b32 v129, v59 offset:12288
  ds_read_b32 v130, v59 offset:14336
  ds_read_b32 v131, v59 offset:16384
  s_waitcnt lgkmcnt(6)
  v_add_f32 v124, v124, v125
  s_waitcnt lgkmcnt(4)
  v_add_f32 v126, v126, v127
  s_waitcnt lgkmcnt(2)
  v_add_f32 v128, v128, v129
  s_waitcnt lgkmcnt(0)
  v_add_f32 v130, v130, v131
  v_add_f32 v124, v124, v126
  v_add_f32 v128, v128, v130
  v_add_f32 v122, v124, v128
  v_cvt_pk_bf16_f32 v72, v114, v115
  v_cvt_pk_bf16_f32 v73, v116, v117
  v_cvt_pk_bf16_f32 v74, v118, v119
  v_cvt_pk_bf16_f32 v75, v120, v121
  v_cvt_pk_bf16_f32 v122, v122, v122
  v_lshlrev_b32 v114, 16, v72
  v_and_b32 v115, 0xffff0000, v72
  v_lshlrev_b32 v116, 16, v73
  v_and_b32 v117, 0xffff0000, v73
  v_lshlrev_b32 v118, 16, v74
  v_and_b32 v119, 0xffff0000, v74
  v_lshlrev_b32 v120, 16, v75
  v_and_b32 v121, 0xffff0000, v75
  v_lshlrev_b32 v122, 16, v122
  v_mul_f32 v114, v104, v114
  v_mul_f32 v115, v105, v115
  v_mul_f32 v116, v106, v116
  v_mul_f32 v117, v107, v117
  v_mul_f32 v118, v108, v118
  v_mul_f32 v119, v109, v119
  v_mul_f32 v120, v110, v120
  v_mul_f32 v121, v111, v121
  v_mul_f32 v122, v112, v122
  v_cvt_pk_bf16_f32 v72, v114, v115
  v_cvt_pk_bf16_f32 v73, v116, v117
  v_cvt_pk_bf16_f32 v74, v118, v119
  v_cvt_pk_bf16_f32 v75, v120, v121
  v_cvt_pk_bf16_f32 v122, v122, v122
  v_lshlrev_b32 v114, 16, v72
  v_and_b32 v115, 0xffff0000, v72
  v_lshlrev_b32 v116, 16, v73
  v_and_b32 v117, 0xffff0000, v73
  v_lshlrev_b32 v118, 16, v74
  v_and_b32 v119, 0xffff0000, v74
  v_lshlrev_b32 v120, 16, v75
  v_and_b32 v121, 0xffff0000, v75
  v_lshlrev_b32 v122, 16, v122
  v_add_f32 v60, v60, v114
  v_add_f32 v61, v61, v115
  v_add_f32 v62, v62, v116
  v_add_f32 v63, v63, v117
  v_add_f32 v64, v64, v118
  v_add_f32 v65, v65, v119
  v_add_f32 v66, v66, v120
  v_add_f32 v67, v67, v121
  v_add_f32 v68, v68, v122
  v_cvt_pk_bf16_f32 v72, v60, v61
  v_cvt_pk_bf16_f32 v73, v62, v63
  v_cvt_pk_bf16_f32 v74, v64, v65
  v_cvt_pk_bf16_f32 v75, v66, v67
  v_cvt_pk_bf16_f32 v76, v68, v68
  buffer_store_dwordx4 v[72:75], v51, s[60:63], 0 offen
  v_bfe_u32 v58, v0, 3, 3
  v_lshlrev_b32 v59, 4, v48
  s_lshl_b32 s66, s3, 7
  s_add_u32 s66, s66, 136192
  v_add_u32 v59, s66, v59
  v_lshl_add_u32 v58, v58, 1, v59
  ds_write_b16 v58, v76
  s_waitcnt lgkmcnt(0)
  ds_read_b128 v[124:127], v59
  s_mul_i32 s66, s3, 112
  s_sub_u32 s66, 1024, s66
  s_mov_b64 exec, 0xff
  s_waitcnt lgkmcnt(0)
  buffer_store_dwordx4 v[124:127], v51, s[60:63], s66 offen
  s_mov_b64 exec, -1
  s_waitcnt vmcnt(0)
kf_main_kernel_end:
  s_endpgm
k1_rare1:
  s_nop 7
  s_nop 7
  v_max3_f32 v42, v192, v193, v194
  v_max3_f32 v43, v195, v196, v197
  v_max3_f32 v42, v42, v198, v199
  v_max3_f32 v43, v43, v200, v201
  v_max3_f32 v42, v42, v202, v203
  v_max3_f32 v43, v43, v204, v205
  v_max3_f32 v42, v42, v206, v207
  v_max_f32 v42, v42, v43
  v_mov_b32 v43, v42
  s_nop 1
  v_permlane32_swap_b32 v43, v42
  v_max_f32 v42, v42, v43
  v_max_f32 v42, 0, v42
  v_ceil_f32 v42, v42
  v_sub_f32 v43, 0, v42
  v_exp_f32 v43, v43
  v_sub_f32 v192, v192, v42
  v_sub_f32 v193, v193, v42
  v_sub_f32 v194, v194, v42
  v_sub_f32 v195, v195, v42
  v_sub_f32 v196, v196, v42
  v_sub_f32 v197, v197, v42
  v_sub_f32 v198, v198, v42
  v_sub_f32 v199, v199, v42
  v_sub_f32 v200, v200, v42
  v_sub_f32 v201, v201, v42
  v_sub_f32 v202, v202, v42
  v_sub_f32 v203, v203, v42
  v_sub_f32 v204, v204, v42
  v_sub_f32 v205, v205, v42
  v_sub_f32 v206, v206, v42
  v_sub_f32 v207, v207, v42
  v_sub_f32 v224, v224, v42
  v_sub_f32 v225, v225, v42
  v_sub_f32 v226, v226, v42
  v_sub_f32 v227, v227, v42
  v_sub_f32 v228, v228, v42
  v_sub_f32 v229, v229, v42
  v_sub_f32 v230, v230, v42
  v_sub_f32 v231, v231, v42
  v_sub_f32 v232, v232, v42
  v_sub_f32 v233, v233, v42
  v_sub_f32 v234, v234, v42
  v_sub_f32 v235, v235, v42
  v_sub_f32 v236, v236, v42
  v_sub_f32 v237, v237, v42
  v_sub_f32 v238, v238, v42
  v_sub_f32 v239, v239, v42
  v_sub_f32 v176, v176, v42
  v_sub_f32 v177, v177, v42
  v_sub_f32 v178, v178, v42
  v_sub_f32 v179, v179, v42
  v_sub_f32 v180, v180, v42
  v_sub_f32 v181, v181, v42
  v_sub_f32 v182, v182, v42
  v_sub_f32 v183, v183, v42
  v_sub_f32 v184, v184, v42
  v_sub_f32 v185, v185, v42
  v_sub_f32 v186, v186, v42
  v_sub_f32 v187, v187, v42
  v_sub_f32 v188, v188, v42
  v_sub_f32 v189, v189, v42
  v_sub_f32 v190, v190, v42
  v_sub_f32 v191, v191, v42
  v_mul_f32 v80, v80, v43
  v_mul_f32 v81, v81, v43
  v_mul_f32 v82, v82, v43
  v_mul_f32 v83, v83, v43
  v_mul_f32 v84, v84, v43
  v_mul_f32 v85, v85, v43
  v_mul_f32 v86, v86, v43
  v_mul_f32 v87, v87, v43
  v_mul_f32 v88, v88, v43
  v_mul_f32 v89, v89, v43
  v_mul_f32 v90, v90, v43
  v_mul_f32 v91, v91, v43
  v_mul_f32 v92, v92, v43
  v_mul_f32 v93, v93, v43
  v_mul_f32 v94, v94, v43
  v_mul_f32 v95, v95, v43
  v_mul_f32 v96, v96, v43
  v_mul_f32 v97, v97, v43
  v_mul_f32 v98, v98, v43
  v_mul_f32 v99, v99, v43
  v_mul_f32 v100, v100, v43
  v_mul_f32 v101, v101, v43
  v_mul_f32 v102, v102, v43
  v_mul_f32 v103, v103, v43
  v_mul_f32 v104, v104, v43
  v_mul_f32 v105, v105, v43
  v_mul_f32 v106, v106, v43
  v_mul_f32 v107, v107, v43
  v_mul_f32 v108, v108, v43
  v_mul_f32 v109, v109, v43
  v_mul_f32 v110, v110, v43
  v_mul_f32 v111, v111, v43
  v_mul_f32 v112, v112, v43
  v_mul_f32 v113, v113, v43
  v_mul_f32 v114, v114, v43
  v_mul_f32 v115, v115, v43
  v_mul_f32 v116, v116, v43
  v_mul_f32 v117, v117, v43
  v_mul_f32 v118, v118, v43
  v_mul_f32 v119, v119, v43
  v_mul_f32 v120, v120, v43
  v_mul_f32 v121, v121, v43
  v_mul_f32 v122, v122, v43
  v_mul_f32 v123, v123, v43
  v_mul_f32 v124, v124, v43
  v_mul_f32 v125, v125, v43
  v_mul_f32 v126, v126, v43
  v_mul_f32 v127, v127, v43
  v_mul_f32 v128, v128, v43
  v_mul_f32 v129, v129, v43
  v_mul_f32 v130, v130, v43
  v_mul_f32 v131, v131, v43
  v_mul_f32 v132, v132, v43
  v_mul_f32 v133, v133, v43
  v_mul_f32 v134, v134, v43
  v_mul_f32 v135, v135, v43
  v_mul_f32 v136, v136, v43
  v_mul_f32 v137, v137, v43
  v_mul_f32 v138, v138, v43
  v_mul_f32 v139, v139, v43
  v_mul_f32 v140, v140, v43
  v_mul_f32 v141, v141, v43
  v_mul_f32 v142, v142, v43
  v_mul_f32 v143, v143, v43
  v_mul_f32 v34, v34, v43
  v_exp_f32 v38, v192
  v_exp_f32 v39, v193
  v_exp_f32 v40, v194
  v_exp_f32 v41, v195
  v_add_f32 v35, v38, v39
  v_cvt_pk_bf16_f32 v216, v38, v39
  v_exp_f32 v38, v196
  v_exp_f32 v39, v197
  v_add_f32 v36, v40, v41
  v_cvt_pk_bf16_f32 v217, v40, v41
  v_exp_f32 v40, v198
  v_exp_f32 v41, v199
  v_add_f32 v35, v35, v38
  v_add_f32 v36, v36, v39
  v_cvt_pk_bf16_f32 v218, v38, v39
  v_exp_f32 v38, v200
  v_exp_f32 v39, v201
  v_add_f32 v35, v35, v40
  v_add_f32 v36, v36, v41
  v_cvt_pk_bf16_f32 v219, v40, v41
  v_exp_f32 v40, v202
  v_exp_f32 v41, v203
  v_add_f32 v35, v35, v38
  v_add_f32 v36, v36, v39
  v_cvt_pk_bf16_f32 v220, v38, v39
  v_exp_f32 v38, v204
  v_exp_f32 v39, v205
  v_add_f32 v35, v35, v40
  v_add_f32 v36, v36, v41
  v_cvt_pk_bf16_f32 v221, v40, v41
  v_exp_f32 v40, v206
  v_exp_f32 v41, v207
  v_add_f32 v35, v35, v38
  v_add_f32 v36, v36, v39
  v_cvt_pk_bf16_f32 v222, v38, v39
  v_add_f32 v35, v35, v40
  v_add_f32 v36, v36, v41
  v_cvt_pk_bf16_f32 v223, v40, v41
  v_add_f32 v35, v35, v36
  s_nop 1
  s_branch k1_back1
k1_rare2:
  s_nop 7
  s_nop 7
  v_max3_f32 v42, v176, v177, v178
  v_max3_f32 v43, v179, v180, v181
  v_max3_f32 v42, v42, v182, v183
  v_max3_f32 v43, v43, v184, v185
  v_max3_f32 v42, v42, v186, v187
  v_max3_f32 v43, v43, v188, v189
  v_max3_f32 v42, v42, v190, v191
  v_max_f32 v42, v42, v43
  v_mov_b32 v43, v42
  s_nop 1
  v_permlane32_swap_b32 v43, v42
  v_max_f32 v42, v42, v43
  v_max_f32 v42, 0, v42
  v_ceil_f32 v42, v42
  v_sub_f32 v43, 0, v42
  v_exp_f32 v43, v43
  v_sub_f32 v176, v176, v42
  v_sub_f32 v177, v177, v42
  v_sub_f32 v178, v178, v42
  v_sub_f32 v179, v179, v42
  v_sub_f32 v180, v180, v42
  v_sub_f32 v181, v181, v42
  v_sub_f32 v182, v182, v42
  v_sub_f32 v183, v183, v42
  v_sub_f32 v184, v184, v42
  v_sub_f32 v185, v185, v42
  v_sub_f32 v186, v186, v42
  v_sub_f32 v187, v187, v42
  v_sub_f32 v188, v188, v42
  v_sub_f32 v189, v189, v42
  v_sub_f32 v190, v190, v42
  v_sub_f32 v191, v191, v42
  v_sub_f32 v224, v224, v42
  v_sub_f32 v225, v225, v42
  v_sub_f32 v226, v226, v42
  v_sub_f32 v227, v227, v42
  v_sub_f32 v228, v228, v42
  v_sub_f32 v229, v229, v42
  v_sub_f32 v230, v230, v42
  v_sub_f32 v231, v231, v42
  v_sub_f32 v232, v232, v42
  v_sub_f32 v233, v233, v42
  v_sub_f32 v234, v234, v42
  v_sub_f32 v235, v235, v42
  v_sub_f32 v236, v236, v42
  v_sub_f32 v237, v237, v42
  v_sub_f32 v238, v238, v42
  v_sub_f32 v239, v239, v42
  v_sub_f32 v192, v192, v42
  v_sub_f32 v193, v193, v42
  v_sub_f32 v194, v194, v42
  v_sub_f32 v195, v195, v42
  v_sub_f32 v196, v196, v42
  v_sub_f32 v197, v197, v42
  v_sub_f32 v198, v198, v42
  v_sub_f32 v199, v199, v42
  v_sub_f32 v200, v200, v42
  v_sub_f32 v201, v201, v42
  v_sub_f32 v202, v202, v42
  v_sub_f32 v203, v203, v42
  v_sub_f32 v204, v204, v42
  v_sub_f32 v205, v205, v42
  v_sub_f32 v206, v206, v42
  v_sub_f32 v207, v207, v42
  v_mul_f32 v80, v80, v43
  v_mul_f32 v81, v81, v43
  v_mul_f32 v82, v82, v43
  v_mul_f32 v83, v83, v43
  v_mul_f32 v84, v84, v43
  v_mul_f32 v85, v85, v43
  v_mul_f32 v86, v86, v43
  v_mul_f32 v87, v87, v43
  v_mul_f32 v88, v88, v43
  v_mul_f32 v89, v89, v43
  v_mul_f32 v90, v90, v43
  v_mul_f32 v91, v91, v43
  v_mul_f32 v92, v92, v43
  v_mul_f32 v93, v93, v43
  v_mul_f32 v94, v94, v43
  v_mul_f32 v95, v95, v43
  v_mul_f32 v96, v96, v43
  v_mul_f32 v97, v97, v43
  v_mul_f32 v98, v98, v43
  v_mul_f32 v99, v99, v43
  v_mul_f32 v100, v100, v43
  v_mul_f32 v101, v101, v43
  v_mul_f32 v102, v102, v43
  v_mul_f32 v103, v103, v43
  v_mul_f32 v104, v104, v43
  v_mul_f32 v105, v105, v43
  v_mul_f32 v106, v106, v43
  v_mul_f32 v107, v107, v43
  v_mul_f32 v108, v108, v43
  v_mul_f32 v109, v109, v43
  v_mul_f32 v110, v110, v43
  v_mul_f32 v111, v111, v43
  v_mul_f32 v112, v112, v43
  v_mul_f32 v113, v113, v43
  v_mul_f32 v114, v114, v43
  v_mul_f32 v115, v115, v43
  v_mul_f32 v116, v116, v43
  v_mul_f32 v117, v117, v43
  v_mul_f32 v118, v118, v43
  v_mul_f32 v119, v119, v43
  v_mul_f32 v120, v120, v43
  v_mul_f32 v121, v121, v43
  v_mul_f32 v122, v122, v43
  v_mul_f32 v123, v123, v43
  v_mul_f32 v124, v124, v43
  v_mul_f32 v125, v125, v43
  v_mul_f32 v126, v126, v43
  v_mul_f32 v127, v127, v43
  v_mul_f32 v128, v128, v43
  v_mul_f32 v129, v129, v43
  v_mul_f32 v130, v130, v43
  v_mul_f32 v131, v131, v43
  v_mul_f32 v132, v132, v43
  v_mul_f32 v133, v133, v43
  v_mul_f32 v134, v134, v43
  v_mul_f32 v135, v135, v43
  v_mul_f32 v136, v136, v43
  v_mul_f32 v137, v137, v43
  v_mul_f32 v138, v138, v43
  v_mul_f32 v139, v139, v43
  v_mul_f32 v140, v140, v43
  v_mul_f32 v141, v141, v43
  v_mul_f32 v142, v142, v43
  v_mul_f32 v143, v143, v43
  v_mul_f32 v34, v34, v43
  v_exp_f32 v38, v176
  v_exp_f32 v39, v177
  v_exp_f32 v40, v178
  v_exp_f32 v41, v179
  v_add_f32 v35, v38, v39
  v_cvt_pk_bf16_f32 v208, v38, v39
  v_exp_f32 v38, v180
  v_exp_f32 v39, v181
  v_add_f32 v36, v40, v41
  v_cvt_pk_bf16_f32 v209, v40, v41
  v_exp_f32 v40, v182
  v_exp_f32 v41, v183
  v_add_f32 v35, v35, v38
  v_add_f32 v36, v36, v39
  v_cvt_pk_bf16_f32 v210, v38, v39
  v_exp_f32 v38, v184
  v_exp_f32 v39, v185
  v_add_f32 v35, v35, v40
  v_add_f32 v36, v36, v41
  v_cvt_pk_bf16_f32 v211, v40, v41
  v_exp_f32 v40, v186
  v_exp_f32 v41, v187
  v_add_f32 v35, v35, v38
  v_add_f32 v36, v36, v39
  v_cvt_pk_bf16_f32 v212, v38, v39
  v_exp_f32 v38, v188
  v_exp_f32 v39, v189
  v_add_f32 v35, v35, v40
  v_add_f32 v36, v36, v41
  v_cvt_pk_bf16_f32 v213, v40, v41
  v_exp_f32 v40, v190
  v_exp_f32 v41, v191
  v_add_f32 v35, v35, v38
  v_add_f32 v36, v36, v39
  v_cvt_pk_bf16_f32 v214, v38, v39
  v_add_f32 v35, v35, v40
  v_add_f32 v36, v36, v41
  v_cvt_pk_bf16_f32 v215, v40, v41
  v_add_f32 v35, v35, v36
  s_nop 1
  s_branch k1_back2
k1_rare3:
  s_nop 7
  s_nop 7
  v_max3_f32 v42, v192, v193, v194
  v_max3_f32 v43, v195, v196, v197
  v_max3_f32 v42, v42, v198, v199
  v_max3_f32 v43, v43, v200, v201
  v_max3_f32 v42, v42, v202, v203
  v_max3_f32 v43, v43, v204, v205
  v_max3_f32 v42, v42, v206, v207
  v_max_f32 v42, v42, v43
  v_mov_b32 v43, v42
  s_nop 1
  v_permlane32_swap_b32 v43, v42
  v_max_f32 v42, v42, v43
  v_max_f32 v42, 0, v42
  v_ceil_f32 v42, v42
  v_sub_f32 v43, 0, v42
  v_exp_f32 v43, v43
  v_sub_f32 v192, v192, v42
  v_sub_f32 v193, v193, v42
  v_sub_f32 v194, v194, v42
  v_sub_f32 v195, v195, v42
  v_sub_f32 v196, v196, v42
  v_sub_f32 v197, v197, v42
  v_sub_f32 v198, v198, v42
  v_sub_f32 v199, v199, v42
  v_sub_f32 v200, v200, v42
  v_sub_f32 v201, v201, v42
  v_sub_f32 v202, v202, v42
  v_sub_f32 v203, v203, v42
  v_sub_f32 v204, v204, v42
  v_sub_f32 v205, v205, v42
  v_sub_f32 v206, v206, v42
  v_sub_f32 v207, v207, v42
  v_sub_f32 v224, v224, v42
  v_sub_f32 v225, v225, v42
  v_sub_f32 v226, v226, v42
  v_sub_f32 v227, v227, v42
  v_sub_f32 v228, v228, v42
  v_sub_f32 v229, v229, v42
  v_sub_f32 v230, v230, v42
  v_sub_f32 v231, v231, v42
  v_sub_f32 v232, v232, v42
  v_sub_f32 v233, v233, v42
  v_sub_f32 v234, v234, v42
  v_sub_f32 v235, v235, v42
  v_sub_f32 v236, v236, v42
  v_sub_f32 v237, v237, v42
  v_sub_f32 v238, v238, v42
  v_sub_f32 v239, v239, v42
  v_sub_f32 v176, v176, v42
  v_sub_f32 v177, v177, v42
  v_sub_f32 v178, v178, v42
  v_sub_f32 v179, v179, v42
  v_sub_f32 v180, v180, v42
  v_sub_f32 v181, v181, v42
  v_sub_f32 v182, v182, v42
  v_sub_f32 v183, v183, v42
  v_sub_f32 v184, v184, v42
  v_sub_f32 v185, v185, v42
  v_sub_f32 v186, v186, v42
  v_sub_f32 v187, v187, v42
  v_sub_f32 v188, v188, v42
  v_sub_f32 v189, v189, v42
  v_sub_f32 v190, v190, v42
  v_sub_f32 v191, v191, v42
  v_mul_f32 v80, v80, v43
  v_mul_f32 v81, v81, v43
  v_mul_f32 v82, v82, v43
  v_mul_f32 v83, v83, v43
  v_mul_f32 v84, v84, v43
  v_mul_f32 v85, v85, v43
  v_mul_f32 v86, v86, v43
  v_mul_f32 v87, v87, v43
  v_mul_f32 v88, v88, v43
  v_mul_f32 v89, v89, v43
  v_mul_f32 v90, v90, v43
  v_mul_f32 v91, v91, v43
  v_mul_f32 v92, v92, v43
  v_mul_f32 v93, v93, v43
  v_mul_f32 v94, v94, v43
  v_mul_f32 v95, v95, v43
  v_mul_f32 v96, v96, v43
  v_mul_f32 v97, v97, v43
  v_mul_f32 v98, v98, v43
  v_mul_f32 v99, v99, v43
  v_mul_f32 v100, v100, v43
  v_mul_f32 v101, v101, v43
  v_mul_f32 v102, v102, v43
  v_mul_f32 v103, v103, v43
  v_mul_f32 v104, v104, v43
  v_mul_f32 v105, v105, v43
  v_mul_f32 v106, v106, v43
  v_mul_f32 v107, v107, v43
  v_mul_f32 v108, v108, v43
  v_mul_f32 v109, v109, v43
  v_mul_f32 v110, v110, v43
  v_mul_f32 v111, v111, v43
  v_mul_f32 v112, v112, v43
  v_mul_f32 v113, v113, v43
  v_mul_f32 v114, v114, v43
  v_mul_f32 v115, v115, v43
  v_mul_f32 v116, v116, v43
  v_mul_f32 v117, v117, v43
  v_mul_f32 v118, v118, v43
  v_mul_f32 v119, v119, v43
  v_mul_f32 v120, v120, v43
  v_mul_f32 v121, v121, v43
  v_mul_f32 v122, v122, v43
  v_mul_f32 v123, v123, v43
  v_mul_f32 v124, v124, v43
  v_mul_f32 v125, v125, v43
  v_mul_f32 v126, v126, v43
  v_mul_f32 v127, v127, v43
  v_mul_f32 v128, v128, v43
  v_mul_f32 v129, v129, v43
  v_mul_f32 v130, v130, v43
  v_mul_f32 v131, v131, v43
  v_mul_f32 v132, v132, v43
  v_mul_f32 v133, v133, v43
  v_mul_f32 v134, v134, v43
  v_mul_f32 v135, v135, v43
  v_mul_f32 v136, v136, v43
  v_mul_f32 v137, v137, v43
  v_mul_f32 v138, v138, v43
  v_mul_f32 v139, v139, v43
  v_mul_f32 v140, v140, v43
  v_mul_f32 v141, v141, v43
  v_mul_f32 v142, v142, v43
  v_mul_f32 v143, v143, v43
  v_mul_f32 v34, v34, v43
  v_exp_f32 v38, v192
  v_exp_f32 v39, v193
  v_exp_f32 v40, v194
  v_exp_f32 v41, v195
  v_add_f32 v35, v38, v39
  v_cvt_pk_bf16_f32 v216, v38, v39
  v_exp_f32 v38, v196
  v_exp_f32 v39, v197
  v_add_f32 v36, v40, v41
  v_cvt_pk_bf16_f32 v217, v40, v41
  v_exp_f32 v40, v198
  v_exp_f32 v41, v199
  v_add_f32 v35, v35, v38
  v_add_f32 v36, v36, v39
  v_cvt_pk_bf16_f32 v218, v38, v39
  v_exp_f32 v38, v200
  v_exp_f32 v39, v201
  v_add_f32 v35, v35, v40
  v_add_f32 v36, v36, v41
  v_cvt_pk_bf16_f32 v219, v40, v41
  v_exp_f32 v40, v202
  v_exp_f32 v41, v203
  v_add_f32 v35, v35, v38
  v_add_f32 v36, v36, v39
  v_cvt_pk_bf16_f32 v220, v38, v39
  v_exp_f32 v38, v204
  v_exp_f32 v39, v205
  v_add_f32 v35, v35, v40
  v_add_f32 v36, v36, v41
  v_cvt_pk_bf16_f32 v221, v40, v41
  v_exp_f32 v40, v206
  v_exp_f32 v41, v207
  v_add_f32 v35, v35, v38
  v_add_f32 v36, v36, v39
  v_cvt_pk_bf16_f32 v222, v38, v39
  v_add_f32 v35, v35, v40
  v_add_f32 v36, v36, v41
  v_cvt_pk_bf16_f32 v223, v40, v41
  v_add_f32 v35, v35, v36
  s_nop 1
  s_branch k1_back3
k1_rare4:
  s_nop 7
  s_nop 7
  v_max3_f32 v42, v176, v177, v178
  v_max3_f32 v43, v179, v180, v181
  v_max3_f32 v42, v42, v182, v183
  v_max3_f32 v43, v43, v184, v185
  v_max3_f32 v42, v42, v186, v187
  v_max3_f32 v43, v43, v188, v189
  v_max3_f32 v42, v42, v190, v191
  v_max_f32 v42, v42, v43
  v_mov_b32 v43, v42
  s_nop 1
  v_permlane32_swap_b32 v43, v42
  v_max_f32 v42, v42, v43
  v_max_f32 v42, 0, v42
  v_ceil_f32 v42, v42
  v_sub_f32 v43, 0, v42
  v_exp_f32 v43, v43
  v_sub_f32 v176, v176, v42
  v_sub_f32 v177, v177, v42
  v_sub_f32 v178, v178, v42
  v_sub_f32 v179, v179, v42
  v_sub_f32 v180, v180, v42
  v_sub_f32 v181, v181, v42
  v_sub_f32 v182, v182, v42
  v_sub_f32 v183, v183, v42
  v_sub_f32 v184, v184, v42
  v_sub_f32 v185, v185, v42
  v_sub_f32 v186, v186, v42
  v_sub_f32 v187, v187, v42
  v_sub_f32 v188, v188, v42
  v_sub_f32 v189, v189, v42
  v_sub_f32 v190, v190, v42
  v_sub_f32 v191, v191, v42
  v_sub_f32 v224, v224, v42
  v_sub_f32 v225, v225, v42
  v_sub_f32 v226, v226, v42
  v_sub_f32 v227, v227, v42
  v_sub_f32 v228, v228, v42
  v_sub_f32 v229, v229, v42
  v_sub_f32 v230, v230, v42
  v_sub_f32 v231, v231, v42
  v_sub_f32 v232, v232, v42
  v_sub_f32 v233, v233, v42
  v_sub_f32 v234, v234, v42
  v_sub_f32 v235, v235, v42
  v_sub_f32 v236, v236, v42
  v_sub_f32 v237, v237, v42
  v_sub_f32 v238, v238, v42
  v_sub_f32 v239, v239, v42
  v_sub_f32 v192, v192, v42
  v_sub_f32 v193, v193, v42
  v_sub_f32 v194, v194, v42
  v_sub_f32 v195, v195, v42
  v_sub_f32 v196, v196, v42
  v_sub_f32 v197, v197, v42
  v_sub_f32 v198, v198, v42
  v_sub_f32 v199, v199, v42
  v_sub_f32 v200, v200, v42
  v_sub_f32 v201, v201, v42
  v_sub_f32 v202, v202, v42
  v_sub_f32 v203, v203, v42
  v_sub_f32 v204, v204, v42
  v_sub_f32 v205, v205, v42
  v_sub_f32 v206, v206, v42
  v_sub_f32 v207, v207, v42
  v_mul_f32 v80, v80, v43
  v_mul_f32 v81, v81, v43
  v_mul_f32 v82, v82, v43
  v_mul_f32 v83, v83, v43
  v_mul_f32 v84, v84, v43
  v_mul_f32 v85, v85, v43
  v_mul_f32 v86, v86, v43
  v_mul_f32 v87, v87, v43
  v_mul_f32 v88, v88, v43
  v_mul_f32 v89, v89, v43
  v_mul_f32 v90, v90, v43
  v_mul_f32 v91, v91, v43
  v_mul_f32 v92, v92, v43
  v_mul_f32 v93, v93, v43
  v_mul_f32 v94, v94, v43
  v_mul_f32 v95, v95, v43
  v_mul_f32 v96, v96, v43
  v_mul_f32 v97, v97, v43
  v_mul_f32 v98, v98, v43
  v_mul_f32 v99, v99, v43
  v_mul_f32 v100, v100, v43
  v_mul_f32 v101, v101, v43
  v_mul_f32 v102, v102, v43
  v_mul_f32 v103, v103, v43
  v_mul_f32 v104, v104, v43
  v_mul_f32 v105, v105, v43
  v_mul_f32 v106, v106, v43
  v_mul_f32 v107, v107, v43
  v_mul_f32 v108, v108, v43
  v_mul_f32 v109, v109, v43
  v_mul_f32 v110, v110, v43
  v_mul_f32 v111, v111, v43
  v_mul_f32 v112, v112, v43
  v_mul_f32 v113, v113, v43
  v_mul_f32 v114, v114, v43
  v_mul_f32 v115, v115, v43
  v_mul_f32 v116, v116, v43
  v_mul_f32 v117, v117, v43
  v_mul_f32 v118, v118, v43
  v_mul_f32 v119, v119, v43
  v_mul_f32 v120, v120, v43
  v_mul_f32 v121, v121, v43
  v_mul_f32 v122, v122, v43
  v_mul_f32 v123, v123, v43
  v_mul_f32 v124, v124, v43
  v_mul_f32 v125, v125, v43
  v_mul_f32 v126, v126, v43
  v_mul_f32 v127, v127, v43
  v_mul_f32 v128, v128, v43
  v_mul_f32 v129, v129, v43
  v_mul_f32 v130, v130, v43
  v_mul_f32 v131, v131, v43
  v_mul_f32 v132, v132, v43
  v_mul_f32 v133, v133, v43
  v_mul_f32 v134, v134, v43
  v_mul_f32 v135, v135, v43
  v_mul_f32 v136, v136, v43
  v_mul_f32 v137, v137, v43
  v_mul_f32 v138, v138, v43
  v_mul_f32 v139, v139, v43
  v_mul_f32 v140, v140, v43
  v_mul_f32 v141, v141, v43
  v_mul_f32 v142, v142, v43
  v_mul_f32 v143, v143, v43
  v_mul_f32 v34, v34, v43
  v_exp_f32 v38, v176
  v_exp_f32 v39, v177
  v_exp_f32 v40, v178
  v_exp_f32 v41, v179
  v_add_f32 v35, v38, v39
  v_cvt_pk_bf16_f32 v208, v38, v39
  v_exp_f32 v38, v180
  v_exp_f32 v39, v181
  v_add_f32 v36, v40, v41
  v_cvt_pk_bf16_f32 v209, v40, v41
  v_exp_f32 v40, v182
  v_exp_f32 v41, v183
  v_add_f32 v35, v35, v38
  v_add_f32 v36, v36, v39
  v_cvt_pk_bf16_f32 v210, v38, v39
  v_exp_f32 v38, v184
  v_exp_f32 v39, v185
  v_add_f32 v35, v35, v40
  v_add_f32 v36, v36, v41
  v_cvt_pk_bf16_f32 v211, v40, v41
  v_exp_f32 v40, v186
  v_exp_f32 v41, v187
  v_add_f32 v35, v35, v38
  v_add_f32 v36, v36, v39
  v_cvt_pk_bf16_f32 v212, v38, v39
  v_exp_f32 v38, v188
  v_exp_f32 v39, v189
  v_add_f32 v35, v35, v40
  v_add_f32 v36, v36, v41
  v_cvt_pk_bf16_f32 v213, v40, v41
  v_exp_f32 v40, v190
  v_exp_f32 v41, v191
  v_add_f32 v35, v35, v38
  v_add_f32 v36, v36, v39
  v_cvt_pk_bf16_f32 v214, v38, v39
  v_add_f32 v35, v35, v40
  v_add_f32 v36, v36, v41
  v_cvt_pk_bf16_f32 v215, v40, v41
  v_add_f32 v35, v35, v36
  s_nop 1
  s_branch k1_back4
k1_rare5:
  s_nop 7
  s_nop 7
  v_max3_f32 v42, v192, v193, v194
  v_max3_f32 v43, v195, v196, v197
  v_max3_f32 v42, v42, v198, v199
  v_max3_f32 v43, v43, v200, v201
  v_max3_f32 v42, v42, v202, v203
  v_max3_f32 v43, v43, v204, v205
  v_max3_f32 v42, v42, v206, v207
  v_max_f32 v42, v42, v43
  v_mov_b32 v43, v42
  s_nop 1
  v_permlane32_swap_b32 v43, v42
  v_max_f32 v42, v42, v43
  v_max_f32 v42, 0, v42
  v_ceil_f32 v42, v42
  v_sub_f32 v43, 0, v42
  v_exp_f32 v43, v43
  v_sub_f32 v192, v192, v42
  v_sub_f32 v193, v193, v42
  v_sub_f32 v194, v194, v42
  v_sub_f32 v195, v195, v42
  v_sub_f32 v196, v196, v42
  v_sub_f32 v197, v197, v42
  v_sub_f32 v198, v198, v42
  v_sub_f32 v199, v199, v42
  v_sub_f32 v200, v200, v42
  v_sub_f32 v201, v201, v42
  v_sub_f32 v202, v202, v42
  v_sub_f32 v203, v203, v42
  v_sub_f32 v204, v204, v42
  v_sub_f32 v205, v205, v42
  v_sub_f32 v206, v206, v42
  v_sub_f32 v207, v207, v42
  v_sub_f32 v224, v224, v42
  v_sub_f32 v225, v225, v42
  v_sub_f32 v226, v226, v42
  v_sub_f32 v227, v227, v42
  v_sub_f32 v228, v228, v42
  v_sub_f32 v229, v229, v42
  v_sub_f32 v230, v230, v42
  v_sub_f32 v231, v231, v42
  v_sub_f32 v232, v232, v42
  v_sub_f32 v233, v233, v42
  v_sub_f32 v234, v234, v42
  v_sub_f32 v235, v235, v42
  v_sub_f32 v236, v236, v42
  v_sub_f32 v237, v237, v42
  v_sub_f32 v238, v238, v42
  v_sub_f32 v239, v239, v42
  v_sub_f32 v176, v176, v42
  v_sub_f32 v177, v177, v42
  v_sub_f32 v178, v178, v42
  v_sub_f32 v179, v179, v42
  v_sub_f32 v180, v180, v42
  v_sub_f32 v181, v181, v42
  v_sub_f32 v182, v182, v42
  v_sub_f32 v183, v183, v42
  v_sub_f32 v184, v184, v42
  v_sub_f32 v185, v185, v42
  v_sub_f32 v186, v186, v42
  v_sub_f32 v187, v187, v42
  v_sub_f32 v188, v188, v42
  v_sub_f32 v189, v189, v42
  v_sub_f32 v190, v190, v42
  v_sub_f32 v191, v191, v42
  v_mul_f32 v80, v80, v43
  v_mul_f32 v81, v81, v43
  v_mul_f32 v82, v82, v43
  v_mul_f32 v83, v83, v43
  v_mul_f32 v84, v84, v43
  v_mul_f32 v85, v85, v43
  v_mul_f32 v86, v86, v43
  v_mul_f32 v87, v87, v43
  v_mul_f32 v88, v88, v43
  v_mul_f32 v89, v89, v43
  v_mul_f32 v90, v90, v43
  v_mul_f32 v91, v91, v43
  v_mul_f32 v92, v92, v43
  v_mul_f32 v93, v93, v43
  v_mul_f32 v94, v94, v43
  v_mul_f32 v95, v95, v43
  v_mul_f32 v96, v96, v43
  v_mul_f32 v97, v97, v43
  v_mul_f32 v98, v98, v43
  v_mul_f32 v99, v99, v43
  v_mul_f32 v100, v100, v43
  v_mul_f32 v101, v101, v43
  v_mul_f32 v102, v102, v43
  v_mul_f32 v103, v103, v43
  v_mul_f32 v104, v104, v43
  v_mul_f32 v105, v105, v43
  v_mul_f32 v106, v106, v43
  v_mul_f32 v107, v107, v43
  v_mul_f32 v108, v108, v43
  v_mul_f32 v109, v109, v43
  v_mul_f32 v110, v110, v43
  v_mul_f32 v111, v111, v43
  v_mul_f32 v112, v112, v43
  v_mul_f32 v113, v113, v43
  v_mul_f32 v114, v114, v43
  v_mul_f32 v115, v115, v43
  v_mul_f32 v116, v116, v43
  v_mul_f32 v117, v117, v43
  v_mul_f32 v118, v118, v43
  v_mul_f32 v119, v119, v43
  v_mul_f32 v120, v120, v43
  v_mul_f32 v121, v121, v43
  v_mul_f32 v122, v122, v43
  v_mul_f32 v123, v123, v43
  v_mul_f32 v124, v124, v43
  v_mul_f32 v125, v125, v43
  v_mul_f32 v126, v126, v43
  v_mul_f32 v127, v127, v43
  v_mul_f32 v128, v128, v43
  v_mul_f32 v129, v129, v43
  v_mul_f32 v130, v130, v43
  v_mul_f32 v131, v131, v43
  v_mul_f32 v132, v132, v43
  v_mul_f32 v133, v133, v43
  v_mul_f32 v134, v134, v43
  v_mul_f32 v135, v135, v43
  v_mul_f32 v136, v136, v43
  v_mul_f32 v137, v137, v43
  v_mul_f32 v138, v138, v43
  v_mul_f32 v139, v139, v43
  v_mul_f32 v140, v140, v43
  v_mul_f32 v141, v141, v43
  v_mul_f32 v142, v142, v43
  v_mul_f32 v143, v143, v43
  v_mul_f32 v34, v34, v43
  v_exp_f32 v38, v192
  v_exp_f32 v39, v193
  v_exp_f32 v40, v194
  v_exp_f32 v41, v195
  v_add_f32 v35, v38, v39
  v_cvt_pk_bf16_f32 v216, v38, v39
  v_exp_f32 v38, v196
  v_exp_f32 v39, v197
  v_add_f32 v36, v40, v41
  v_cvt_pk_bf16_f32 v217, v40, v41
  v_exp_f32 v40, v198
  v_exp_f32 v41, v199
  v_add_f32 v35, v35, v38
  v_add_f32 v36, v36, v39
  v_cvt_pk_bf16_f32 v218, v38, v39
  v_exp_f32 v38, v200
  v_exp_f32 v39, v201
  v_add_f32 v35, v35, v40
  v_add_f32 v36, v36, v41
  v_cvt_pk_bf16_f32 v219, v40, v41
  v_exp_f32 v40, v202
  v_exp_f32 v41, v203
  v_add_f32 v35, v35, v38
  v_add_f32 v36, v36, v39
  v_cvt_pk_bf16_f32 v220, v38, v39
  v_exp_f32 v38, v204
  v_exp_f32 v39, v205
  v_add_f32 v35, v35, v40
  v_add_f32 v36, v36, v41
  v_cvt_pk_bf16_f32 v221, v40, v41
  v_exp_f32 v40, v206
  v_exp_f32 v41, v207
  v_add_f32 v35, v35, v38
  v_add_f32 v36, v36, v39
  v_cvt_pk_bf16_f32 v222, v38, v39
  v_add_f32 v35, v35, v40
  v_add_f32 v36, v36, v41
  v_cvt_pk_bf16_f32 v223, v40, v41
  v_add_f32 v35, v35, v36
  s_nop 1
  s_branch k1_back5
k1_rare6:
  s_nop 7
  s_nop 7
  v_max3_f32 v42, v176, v177, v178
  v_max3_f32 v43, v179, v180, v181
  v_max3_f32 v42, v42, v182, v183
  v_max3_f32 v43, v43, v184, v185
  v_max3_f32 v42, v42, v186, v187
  v_max3_f32 v43, v43, v188, v189
  v_max3_f32 v42, v42, v190, v191
  v_max_f32 v42, v42, v43
  v_mov_b32 v43, v42
  s_nop 1
  v_permlane32_swap_b32 v43, v42
  v_max_f32 v42, v42, v43
  v_max_f32 v42, 0, v42
  v_ceil_f32 v42, v42
  v_sub_f32 v43, 0, v42
  v_exp_f32 v43, v43
  v_sub_f32 v176, v176, v42
  v_sub_f32 v177, v177, v42
  v_sub_f32 v178, v178, v42
  v_sub_f32 v179, v179, v42
  v_sub_f32 v180, v180, v42
  v_sub_f32 v181, v181, v42
  v_sub_f32 v182, v182, v42
  v_sub_f32 v183, v183, v42
  v_sub_f32 v184, v184, v42
  v_sub_f32 v185, v185, v42
  v_sub_f32 v186, v186, v42
  v_sub_f32 v187, v187, v42
  v_sub_f32 v188, v188, v42
  v_sub_f32 v189, v189, v42
  v_sub_f32 v190, v190, v42
  v_sub_f32 v191, v191, v42
  v_sub_f32 v224, v224, v42
  v_sub_f32 v225, v225, v42
  v_sub_f32 v226, v226, v42
  v_sub_f32 v227, v227, v42
  v_sub_f32 v228, v228, v42
  v_sub_f32 v229, v229, v42
  v_sub_f32 v230, v230, v42
  v_sub_f32 v231, v231, v42
  v_sub_f32 v232, v232, v42
  v_sub_f32 v233, v233, v42
  v_sub_f32 v234, v234, v42
  v_sub_f32 v235, v235, v42
  v_sub_f32 v236, v236, v42
  v_sub_f32 v237, v237, v42
  v_sub_f32 v238, v238, v42
  v_sub_f32 v239, v239, v42
  v_sub_f32 v192, v192, v42
  v_sub_f32 v193, v193, v42
  v_sub_f32 v194, v194, v42
  v_sub_f32 v195, v195, v42
  v_sub_f32 v196, v196, v42
  v_sub_f32 v197, v197, v42
  v_sub_f32 v198, v198, v42
  v_sub_f32 v199, v199, v42
  v_sub_f32 v200, v200, v42
  v_sub_f32 v201, v201, v42
  v_sub_f32 v202, v202, v42
  v_sub_f32 v203, v203, v42
  v_sub_f32 v204, v204, v42
  v_sub_f32 v205, v205, v42
  v_sub_f32 v206, v206, v42
  v_sub_f32 v207, v207, v42
  v_mul_f32 v80, v80, v43
  v_mul_f32 v81, v81, v43
  v_mul_f32 v82, v82, v43
  v_mul_f32 v83, v83, v43
  v_mul_f32 v84, v84, v43
  v_mul_f32 v85, v85, v43
  v_mul_f32 v86, v86, v43
  v_mul_f32 v87, v87, v43
  v_mul_f32 v88, v88, v43
  v_mul_f32 v89, v89, v43
  v_mul_f32 v90, v90, v43
  v_mul_f32 v91, v91, v43
  v_mul_f32 v92, v92, v43
  v_mul_f32 v93, v93, v43
  v_mul_f32 v94, v94, v43
  v_mul_f32 v95, v95, v43
  v_mul_f32 v96, v96, v43
  v_mul_f32 v97, v97, v43
  v_mul_f32 v98, v98, v43
  v_mul_f32 v99, v99, v43
  v_mul_f32 v100, v100, v43
  v_mul_f32 v101, v101, v43
  v_mul_f32 v102, v102, v43
  v_mul_f32 v103, v103, v43
  v_mul_f32 v104, v104, v43
  v_mul_f32 v105, v105, v43
  v_mul_f32 v106, v106, v43
  v_mul_f32 v107, v107, v43
  v_mul_f32 v108, v108, v43
  v_mul_f32 v109, v109, v43
  v_mul_f32 v110, v110, v43
  v_mul_f32 v111, v111, v43
  v_mul_f32 v112, v112, v43
  v_mul_f32 v113, v113, v43
  v_mul_f32 v114, v114, v43
  v_mul_f32 v115, v115, v43
  v_mul_f32 v116, v116, v43
  v_mul_f32 v117, v117, v43
  v_mul_f32 v118, v118, v43
  v_mul_f32 v119, v119, v43
  v_mul_f32 v120, v120, v43
  v_mul_f32 v121, v121, v43
  v_mul_f32 v122, v122, v43
  v_mul_f32 v123, v123, v43
  v_mul_f32 v124, v124, v43
  v_mul_f32 v125, v125, v43
  v_mul_f32 v126, v126, v43
  v_mul_f32 v127, v127, v43
  v_mul_f32 v128, v128, v43
  v_mul_f32 v129, v129, v43
  v_mul_f32 v130, v130, v43
  v_mul_f32 v131, v131, v43
  v_mul_f32 v132, v132, v43
  v_mul_f32 v133, v133, v43
  v_mul_f32 v134, v134, v43
  v_mul_f32 v135, v135, v43
  v_mul_f32 v136, v136, v43
  v_mul_f32 v137, v137, v43
  v_mul_f32 v138, v138, v43
  v_mul_f32 v139, v139, v43
  v_mul_f32 v140, v140, v43
  v_mul_f32 v141, v141, v43
  v_mul_f32 v142, v142, v43
  v_mul_f32 v143, v143, v43
  v_mul_f32 v34, v34, v43
  v_exp_f32 v38, v176
  v_exp_f32 v39, v177
  v_exp_f32 v40, v178
  v_exp_f32 v41, v179
  v_add_f32 v35, v38, v39
  v_cvt_pk_bf16_f32 v208, v38, v39
  v_exp_f32 v38, v180
  v_exp_f32 v39, v181
  v_add_f32 v36, v40, v41
  v_cvt_pk_bf16_f32 v209, v40, v41
  v_exp_f32 v40, v182
  v_exp_f32 v41, v183
  v_add_f32 v35, v35, v38
  v_add_f32 v36, v36, v39
  v_cvt_pk_bf16_f32 v210, v38, v39
  v_exp_f32 v38, v184
  v_exp_f32 v39, v185
  v_add_f32 v35, v35, v40
  v_add_f32 v36, v36, v41
  v_cvt_pk_bf16_f32 v211, v40, v41
  v_exp_f32 v40, v186
  v_exp_f32 v41, v187
  v_add_f32 v35, v35, v38
  v_add_f32 v36, v36, v39
  v_cvt_pk_bf16_f32 v212, v38, v39
  v_exp_f32 v38, v188
  v_exp_f32 v39, v189
  v_add_f32 v35, v35, v40
  v_add_f32 v36, v36, v41
  v_cvt_pk_bf16_f32 v213, v40, v41
  v_exp_f32 v40, v190
  v_exp_f32 v41, v191
  v_add_f32 v35, v35, v38
  v_add_f32 v36, v36, v39
  v_cvt_pk_bf16_f32 v214, v38, v39
  v_add_f32 v35, v35, v40
  v_add_f32 v36, v36, v41
  v_cvt_pk_bf16_f32 v215, v40, v41
  v_add_f32 v35, v35, v36
  s_nop 1
  s_branch k1_back6
k1_rare7:
  s_nop 7
  s_nop 7
  v_max3_f32 v42, v192, v193, v194
  v_max3_f32 v43, v195, v196, v197
  v_max3_f32 v42, v42, v198, v199
  v_max3_f32 v43, v43, v200, v201
  v_max3_f32 v42, v42, v202, v203
  v_max3_f32 v43, v43, v204, v205
  v_max3_f32 v42, v42, v206, v207
  v_max_f32 v42, v42, v43
  v_mov_b32 v43, v42
  s_nop 1
  v_permlane32_swap_b32 v43, v42
  v_max_f32 v42, v42, v43
  v_max_f32 v42, 0, v42
  v_ceil_f32 v42, v42
  v_sub_f32 v43, 0, v42
  v_exp_f32 v43, v43
  v_sub_f32 v192, v192, v42
  v_sub_f32 v193, v193, v42
  v_sub_f32 v194, v194, v42
  v_sub_f32 v195, v195, v42
  v_sub_f32 v196, v196, v42
  v_sub_f32 v197, v197, v42
  v_sub_f32 v198, v198, v42
  v_sub_f32 v199, v199, v42
  v_sub_f32 v200, v200, v42
  v_sub_f32 v201, v201, v42
  v_sub_f32 v202, v202, v42
  v_sub_f32 v203, v203, v42
  v_sub_f32 v204, v204, v42
  v_sub_f32 v205, v205, v42
  v_sub_f32 v206, v206, v42
  v_sub_f32 v207, v207, v42
  v_sub_f32 v224, v224, v42
  v_sub_f32 v225, v225, v42
  v_sub_f32 v226, v226, v42
  v_sub_f32 v227, v227, v42
  v_sub_f32 v228, v228, v42
  v_sub_f32 v229, v229, v42
  v_sub_f32 v230, v230, v42
  v_sub_f32 v231, v231, v42
  v_sub_f32 v232, v232, v42
  v_sub_f32 v233, v233, v42
  v_sub_f32 v234, v234, v42
  v_sub_f32 v235, v235, v42
  v_sub_f32 v236, v236, v42
  v_sub_f32 v237, v237, v42
  v_sub_f32 v238, v238, v42
  v_sub_f32 v239, v239, v42
  v_sub_f32 v176, v176, v42
  v_sub_f32 v177, v177, v42
  v_sub_f32 v178, v178, v42
  v_sub_f32 v179, v179, v42
  v_sub_f32 v180, v180, v42
  v_sub_f32 v181, v181, v42
  v_sub_f32 v182, v182, v42
  v_sub_f32 v183, v183, v42
  v_sub_f32 v184, v184, v42
  v_sub_f32 v185, v185, v42
  v_sub_f32 v186, v186, v42
  v_sub_f32 v187, v187, v42
  v_sub_f32 v188, v188, v42
  v_sub_f32 v189, v189, v42
  v_sub_f32 v190, v190, v42
  v_sub_f32 v191, v191, v42
  v_mul_f32 v80, v80, v43
  v_mul_f32 v81, v81, v43
  v_mul_f32 v82, v82, v43
  v_mul_f32 v83, v83, v43
  v_mul_f32 v84, v84, v43
  v_mul_f32 v85, v85, v43
  v_mul_f32 v86, v86, v43
  v_mul_f32 v87, v87, v43
  v_mul_f32 v88, v88, v43
  v_mul_f32 v89, v89, v43
  v_mul_f32 v90, v90, v43
  v_mul_f32 v91, v91, v43
  v_mul_f32 v92, v92, v43
  v_mul_f32 v93, v93, v43
  v_mul_f32 v94, v94, v43
  v_mul_f32 v95, v95, v43
  v_mul_f32 v96, v96, v43
  v_mul_f32 v97, v97, v43
  v_mul_f32 v98, v98, v43
  v_mul_f32 v99, v99, v43
  v_mul_f32 v100, v100, v43
  v_mul_f32 v101, v101, v43
  v_mul_f32 v102, v102, v43
  v_mul_f32 v103, v103, v43
  v_mul_f32 v104, v104, v43
  v_mul_f32 v105, v105, v43
  v_mul_f32 v106, v106, v43
  v_mul_f32 v107, v107, v43
  v_mul_f32 v108, v108, v43
  v_mul_f32 v109, v109, v43
  v_mul_f32 v110, v110, v43
  v_mul_f32 v111, v111, v43
  v_mul_f32 v112, v112, v43
  v_mul_f32 v113, v113, v43
  v_mul_f32 v114, v114, v43
  v_mul_f32 v115, v115, v43
  v_mul_f32 v116, v116, v43
  v_mul_f32 v117, v117, v43
  v_mul_f32 v118, v118, v43
  v_mul_f32 v119, v119, v43
  v_mul_f32 v120, v120, v43
  v_mul_f32 v121, v121, v43
  v_mul_f32 v122, v122, v43
  v_mul_f32 v123, v123, v43
  v_mul_f32 v124, v124, v43
  v_mul_f32 v125, v125, v43
  v_mul_f32 v126, v126, v43
  v_mul_f32 v127, v127, v43
  v_mul_f32 v128, v128, v43
  v_mul_f32 v129, v129, v43
  v_mul_f32 v130, v130, v43
  v_mul_f32 v131, v131, v43
  v_mul_f32 v132, v132, v43
  v_mul_f32 v133, v133, v43
  v_mul_f32 v134, v134, v43
  v_mul_f32 v135, v135, v43
  v_mul_f32 v136, v136, v43
  v_mul_f32 v137, v137, v43
  v_mul_f32 v138, v138, v43
  v_mul_f32 v139, v139, v43
  v_mul_f32 v140, v140, v43
  v_mul_f32 v141, v141, v43
  v_mul_f32 v142, v142, v43
  v_mul_f32 v143, v143, v43
  v_mul_f32 v34, v34, v43
  v_exp_f32 v38, v192
  v_exp_f32 v39, v193
  v_exp_f32 v40, v194
  v_exp_f32 v41, v195
  v_add_f32 v35, v38, v39
  v_cvt_pk_bf16_f32 v216, v38, v39
  v_exp_f32 v38, v196
  v_exp_f32 v39, v197
  v_add_f32 v36, v40, v41
  v_cvt_pk_bf16_f32 v217, v40, v41
  v_exp_f32 v40, v198
  v_exp_f32 v41, v199
  v_add_f32 v35, v35, v38
  v_add_f32 v36, v36, v39
  v_cvt_pk_bf16_f32 v218, v38, v39
  v_exp_f32 v38, v200
  v_exp_f32 v39, v201
  v_add_f32 v35, v35, v40
  v_add_f32 v36, v36, v41
  v_cvt_pk_bf16_f32 v219, v40, v41
  v_exp_f32 v40, v202
  v_exp_f32 v41, v203
  v_add_f32 v35, v35, v38
  v_add_f32 v36, v36, v39
  v_cvt_pk_bf16_f32 v220, v38, v39
  v_exp_f32 v38, v204
  v_exp_f32 v39, v205
  v_add_f32 v35, v35, v40
  v_add_f32 v36, v36, v41
  v_cvt_pk_bf16_f32 v221, v40, v41
  v_exp_f32 v40, v206
  v_exp_f32 v41, v207
  v_add_f32 v35, v35, v38
  v_add_f32 v36, v36, v39
  v_cvt_pk_bf16_f32 v222, v38, v39
  v_add_f32 v35, v35, v40
  v_add_f32 v36, v36, v41
  v_cvt_pk_bf16_f32 v223, v40, v41
  v_add_f32 v35, v35, v36
  s_nop 1
  s_branch k1_back7
k1_rare8:
  s_nop 7
  s_nop 7
  v_max3_f32 v42, v176, v177, v178
  v_max3_f32 v43, v179, v180, v181
  v_max3_f32 v42, v42, v182, v183
  v_max3_f32 v43, v43, v184, v185
  v_max3_f32 v42, v42, v186, v187
  v_max3_f32 v43, v43, v188, v189
  v_max3_f32 v42, v42, v190, v191
  v_max_f32 v42, v42, v43
  v_mov_b32 v43, v42
  s_nop 1
  v_permlane32_swap_b32 v43, v42
  v_max_f32 v42, v42, v43
  v_max_f32 v42, 0, v42
  v_ceil_f32 v42, v42
  v_sub_f32 v43, 0, v42
  v_exp_f32 v43, v43
  v_sub_f32 v176, v176, v42
  v_sub_f32 v177, v177, v42
  v_sub_f32 v178, v178, v42
  v_sub_f32 v179, v179, v42
  v_sub_f32 v180, v180, v42
  v_sub_f32 v181, v181, v42
  v_sub_f32 v182, v182, v42
  v_sub_f32 v183, v183, v42
  v_sub_f32 v184, v184, v42
  v_sub_f32 v185, v185, v42
  v_sub_f32 v186, v186, v42
  v_sub_f32 v187, v187, v42
  v_sub_f32 v188, v188, v42
  v_sub_f32 v189, v189, v42
  v_sub_f32 v190, v190, v42
  v_sub_f32 v191, v191, v42
  v_sub_f32 v224, v224, v42
  v_sub_f32 v225, v225, v42
  v_sub_f32 v226, v226, v42
  v_sub_f32 v227, v227, v42
  v_sub_f32 v228, v228, v42
  v_sub_f32 v229, v229, v42
  v_sub_f32 v230, v230, v42
  v_sub_f32 v231, v231, v42
  v_sub_f32 v232, v232, v42
  v_sub_f32 v233, v233, v42
  v_sub_f32 v234, v234, v42
  v_sub_f32 v235, v235, v42
  v_sub_f32 v236, v236, v42
  v_sub_f32 v237, v237, v42
  v_sub_f32 v238, v238, v42
  v_sub_f32 v239, v239, v42
  v_sub_f32 v192, v192, v42
  v_sub_f32 v193, v193, v42
  v_sub_f32 v194, v194, v42
  v_sub_f32 v195, v195, v42
  v_sub_f32 v196, v196, v42
  v_sub_f32 v197, v197, v42
  v_sub_f32 v198, v198, v42
  v_sub_f32 v199, v199, v42
  v_sub_f32 v200, v200, v42
  v_sub_f32 v201, v201, v42
  v_sub_f32 v202, v202, v42
  v_sub_f32 v203, v203, v42
  v_sub_f32 v204, v204, v42
  v_sub_f32 v205, v205, v42
  v_sub_f32 v206, v206, v42
  v_sub_f32 v207, v207, v42
  v_mul_f32 v80, v80, v43
  v_mul_f32 v81, v81, v43
  v_mul_f32 v82, v82, v43
  v_mul_f32 v83, v83, v43
  v_mul_f32 v84, v84, v43
  v_mul_f32 v85, v85, v43
  v_mul_f32 v86, v86, v43
  v_mul_f32 v87, v87, v43
  v_mul_f32 v88, v88, v43
  v_mul_f32 v89, v89, v43
  v_mul_f32 v90, v90, v43
  v_mul_f32 v91, v91, v43
  v_mul_f32 v92, v92, v43
  v_mul_f32 v93, v93, v43
  v_mul_f32 v94, v94, v43
  v_mul_f32 v95, v95, v43
  v_mul_f32 v96, v96, v43
  v_mul_f32 v97, v97, v43
  v_mul_f32 v98, v98, v43
  v_mul_f32 v99, v99, v43
  v_mul_f32 v100, v100, v43
  v_mul_f32 v101, v101, v43
  v_mul_f32 v102, v102, v43
  v_mul_f32 v103, v103, v43
  v_mul_f32 v104, v104, v43
  v_mul_f32 v105, v105, v43
  v_mul_f32 v106, v106, v43
  v_mul_f32 v107, v107, v43
  v_mul_f32 v108, v108, v43
  v_mul_f32 v109, v109, v43
  v_mul_f32 v110, v110, v43
  v_mul_f32 v111, v111, v43
  v_mul_f32 v112, v112, v43
  v_mul_f32 v113, v113, v43
  v_mul_f32 v114, v114, v43
  v_mul_f32 v115, v115, v43
  v_mul_f32 v116, v116, v43
  v_mul_f32 v117, v117, v43
  v_mul_f32 v118, v118, v43
  v_mul_f32 v119, v119, v43
  v_mul_f32 v120, v120, v43
  v_mul_f32 v121, v121, v43
  v_mul_f32 v122, v122, v43
  v_mul_f32 v123, v123, v43
  v_mul_f32 v124, v124, v43
  v_mul_f32 v125, v125, v43
  v_mul_f32 v126, v126, v43
  v_mul_f32 v127, v127, v43
  v_mul_f32 v128, v128, v43
  v_mul_f32 v129, v129, v43
  v_mul_f32 v130, v130, v43
  v_mul_f32 v131, v131, v43
  v_mul_f32 v132, v132, v43
  v_mul_f32 v133, v133, v43
  v_mul_f32 v134, v134, v43
  v_mul_f32 v135, v135, v43
  v_mul_f32 v136, v136, v43
  v_mul_f32 v137, v137, v43
  v_mul_f32 v138, v138, v43
  v_mul_f32 v139, v139, v43
  v_mul_f32 v140, v140, v43
  v_mul_f32 v141, v141, v43
  v_mul_f32 v142, v142, v43
  v_mul_f32 v143, v143, v43
  v_mul_f32 v34, v34, v43
  v_exp_f32 v38, v176
  v_exp_f32 v39, v177
  v_exp_f32 v40, v178
  v_exp_f32 v41, v179
  v_add_f32 v35, v38, v39
  v_cvt_pk_bf16_f32 v208, v38, v39
  v_exp_f32 v38, v180
  v_exp_f32 v39, v181
  v_add_f32 v36, v40, v41
  v_cvt_pk_bf16_f32 v209, v40, v41
  v_exp_f32 v40, v182
  v_exp_f32 v41, v183
  v_add_f32 v35, v35, v38
  v_add_f32 v36, v36, v39
  v_cvt_pk_bf16_f32 v210, v38, v39
  v_exp_f32 v38, v184
  v_exp_f32 v39, v185
  v_add_f32 v35, v35, v40
  v_add_f32 v36, v36, v41
  v_cvt_pk_bf16_f32 v211, v40, v41
  v_exp_f32 v40, v186
  v_exp_f32 v41, v187
  v_add_f32 v35, v35, v38
  v_add_f32 v36, v36, v39
  v_cvt_pk_bf16_f32 v212, v38, v39
  v_exp_f32 v38, v188
  v_exp_f32 v39, v189
  v_add_f32 v35, v35, v40
  v_add_f32 v36, v36, v41
  v_cvt_pk_bf16_f32 v213, v40, v41
  v_exp_f32 v40, v190
  v_exp_f32 v41, v191
  v_add_f32 v35, v35, v38
  v_add_f32 v36, v36, v39
  v_cvt_pk_bf16_f32 v214, v38, v39
  v_add_f32 v35, v35, v40
  v_add_f32 v36, v36, v41
  v_cvt_pk_bf16_f32 v215, v40, v41
  v_add_f32 v35, v35, v36
  s_nop 1
  s_branch k1_back8
k1_rare9:
  s_nop 7
  s_nop 7
  v_max3_f32 v42, v192, v193, v194
  v_max3_f32 v43, v195, v196, v197
  v_max3_f32 v42, v42, v198, v199
  v_max3_f32 v43, v43, v200, v201
  v_max3_f32 v42, v42, v202, v203
  v_max3_f32 v43, v43, v204, v205
  v_max3_f32 v42, v42, v206, v207
  v_max_f32 v42, v42, v43
  v_mov_b32 v43, v42
  s_nop 1
  v_permlane32_swap_b32 v43, v42
  v_max_f32 v42, v42, v43
  v_max_f32 v42, 0, v42
  v_ceil_f32 v42, v42
  v_sub_f32 v43, 0, v42
  v_exp_f32 v43, v43
  v_sub_f32 v192, v192, v42
  v_sub_f32 v193, v193, v42
  v_sub_f32 v194, v194, v42
  v_sub_f32 v195, v195, v42
  v_sub_f32 v196, v196, v42
  v_sub_f32 v197, v197, v42
  v_sub_f32 v198, v198, v42
  v_sub_f32 v199, v199, v42
  v_sub_f32 v200, v200, v42
  v_sub_f32 v201, v201, v42
  v_sub_f32 v202, v202, v42
  v_sub_f32 v203, v203, v42
  v_sub_f32 v204, v204, v42
  v_sub_f32 v205, v205, v42
  v_sub_f32 v206, v206, v42
  v_sub_f32 v207, v207, v42
  v_sub_f32 v224, v224, v42
  v_sub_f32 v225, v225, v42
  v_sub_f32 v226, v226, v42
  v_sub_f32 v227, v227, v42
  v_sub_f32 v228, v228, v42
  v_sub_f32 v229, v229, v42
  v_sub_f32 v230, v230, v42
  v_sub_f32 v231, v231, v42
  v_sub_f32 v232, v232, v42
  v_sub_f32 v233, v233, v42
  v_sub_f32 v234, v234, v42
  v_sub_f32 v235, v235, v42
  v_sub_f32 v236, v236, v42
  v_sub_f32 v237, v237, v42
  v_sub_f32 v238, v238, v42
  v_sub_f32 v239, v239, v42
  v_sub_f32 v176, v176, v42
  v_sub_f32 v177, v177, v42
  v_sub_f32 v178, v178, v42
  v_sub_f32 v179, v179, v42
  v_sub_f32 v180, v180, v42
  v_sub_f32 v181, v181, v42
  v_sub_f32 v182, v182, v42
  v_sub_f32 v183, v183, v42
  v_sub_f32 v184, v184, v42
  v_sub_f32 v185, v185, v42
  v_sub_f32 v186, v186, v42
  v_sub_f32 v187, v187, v42
  v_sub_f32 v188, v188, v42
  v_sub_f32 v189, v189, v42
  v_sub_f32 v190, v190, v42
  v_sub_f32 v191, v191, v42
  v_mul_f32 v80, v80, v43
  v_mul_f32 v81, v81, v43
  v_mul_f32 v82, v82, v43
  v_mul_f32 v83, v83, v43
  v_mul_f32 v84, v84, v43
  v_mul_f32 v85, v85, v43
  v_mul_f32 v86, v86, v43
  v_mul_f32 v87, v87, v43
  v_mul_f32 v88, v88, v43
  v_mul_f32 v89, v89, v43
  v_mul_f32 v90, v90, v43
  v_mul_f32 v91, v91, v43
  v_mul_f32 v92, v92, v43
  v_mul_f32 v93, v93, v43
  v_mul_f32 v94, v94, v43
  v_mul_f32 v95, v95, v43
  v_mul_f32 v96, v96, v43
  v_mul_f32 v97, v97, v43
  v_mul_f32 v98, v98, v43
  v_mul_f32 v99, v99, v43
  v_mul_f32 v100, v100, v43
  v_mul_f32 v101, v101, v43
  v_mul_f32 v102, v102, v43
  v_mul_f32 v103, v103, v43
  v_mul_f32 v104, v104, v43
  v_mul_f32 v105, v105, v43
  v_mul_f32 v106, v106, v43
  v_mul_f32 v107, v107, v43
  v_mul_f32 v108, v108, v43
  v_mul_f32 v109, v109, v43
  v_mul_f32 v110, v110, v43
  v_mul_f32 v111, v111, v43
  v_mul_f32 v112, v112, v43
  v_mul_f32 v113, v113, v43
  v_mul_f32 v114, v114, v43
  v_mul_f32 v115, v115, v43
  v_mul_f32 v116, v116, v43
  v_mul_f32 v117, v117, v43
  v_mul_f32 v118, v118, v43
  v_mul_f32 v119, v119, v43
  v_mul_f32 v120, v120, v43
  v_mul_f32 v121, v121, v43
  v_mul_f32 v122, v122, v43
  v_mul_f32 v123, v123, v43
  v_mul_f32 v124, v124, v43
  v_mul_f32 v125, v125, v43
  v_mul_f32 v126, v126, v43
  v_mul_f32 v127, v127, v43
  v_mul_f32 v128, v128, v43
  v_mul_f32 v129, v129, v43
  v_mul_f32 v130, v130, v43
  v_mul_f32 v131, v131, v43
  v_mul_f32 v132, v132, v43
  v_mul_f32 v133, v133, v43
  v_mul_f32 v134, v134, v43
  v_mul_f32 v135, v135, v43
  v_mul_f32 v136, v136, v43
  v_mul_f32 v137, v137, v43
  v_mul_f32 v138, v138, v43
  v_mul_f32 v139, v139, v43
  v_mul_f32 v140, v140, v43
  v_mul_f32 v141, v141, v43
  v_mul_f32 v142, v142, v43
  v_mul_f32 v143, v143, v43
  v_mul_f32 v34, v34, v43
  v_exp_f32 v38, v192
  v_exp_f32 v39, v193
  v_exp_f32 v40, v194
  v_exp_f32 v41, v195
  v_add_f32 v35, v38, v39
  v_cvt_pk_bf16_f32 v216, v38, v39
  v_exp_f32 v38, v196
  v_exp_f32 v39, v197
  v_add_f32 v36, v40, v41
  v_cvt_pk_bf16_f32 v217, v40, v41
  v_exp_f32 v40, v198
  v_exp_f32 v41, v199
  v_add_f32 v35, v35, v38
  v_add_f32 v36, v36, v39
  v_cvt_pk_bf16_f32 v218, v38, v39
  v_exp_f32 v38, v200
  v_exp_f32 v39, v201
  v_add_f32 v35, v35, v40
  v_add_f32 v36, v36, v41
  v_cvt_pk_bf16_f32 v219, v40, v41
  v_exp_f32 v40, v202
  v_exp_f32 v41, v203
  v_add_f32 v35, v35, v38
  v_add_f32 v36, v36, v39
  v_cvt_pk_bf16_f32 v220, v38, v39
  v_exp_f32 v38, v204
  v_exp_f32 v39, v205
  v_add_f32 v35, v35, v40
  v_add_f32 v36, v36, v41
  v_cvt_pk_bf16_f32 v221, v40, v41
  v_exp_f32 v40, v206
  v_exp_f32 v41, v207
  v_add_f32 v35, v35, v38
  v_add_f32 v36, v36, v39
  v_cvt_pk_bf16_f32 v222, v38, v39
  v_add_f32 v35, v35, v40
  v_add_f32 v36, v36, v41
  v_cvt_pk_bf16_f32 v223, v40, v41
  v_add_f32 v35, v35, v36
  s_nop 1
  s_branch k1_back9
k1_rare10:
  s_nop 7
  s_nop 7
  v_max3_f32 v42, v176, v177, v178
  v_max3_f32 v43, v179, v180, v181
  v_max3_f32 v42, v42, v182, v183
  v_max3_f32 v43, v43, v184, v185
  v_max3_f32 v42, v42, v186, v187
  v_max3_f32 v43, v43, v188, v189
  v_max3_f32 v42, v42, v190, v191
  v_max_f32 v42, v42, v43
  v_mov_b32 v43, v42
  s_nop 1
  v_permlane32_swap_b32 v43, v42
  v_max_f32 v42, v42, v43
  v_max_f32 v42, 0, v42
  v_ceil_f32 v42, v42
  v_sub_f32 v43, 0, v42
  v_exp_f32 v43, v43
  v_sub_f32 v176, v176, v42
  v_sub_f32 v177, v177, v42
  v_sub_f32 v178, v178, v42
  v_sub_f32 v179, v179, v42
  v_sub_f32 v180, v180, v42
  v_sub_f32 v181, v181, v42
  v_sub_f32 v182, v182, v42
  v_sub_f32 v183, v183, v42
  v_sub_f32 v184, v184, v42
  v_sub_f32 v185, v185, v42
  v_sub_f32 v186, v186, v42
  v_sub_f32 v187, v187, v42
  v_sub_f32 v188, v188, v42
  v_sub_f32 v189, v189, v42
  v_sub_f32 v190, v190, v42
  v_sub_f32 v191, v191, v42
  v_sub_f32 v224, v224, v42
  v_sub_f32 v225, v225, v42
  v_sub_f32 v226, v226, v42
  v_sub_f32 v227, v227, v42
  v_sub_f32 v228, v228, v42
  v_sub_f32 v229, v229, v42
  v_sub_f32 v230, v230, v42
  v_sub_f32 v231, v231, v42
  v_sub_f32 v232, v232, v42
  v_sub_f32 v233, v233, v42
  v_sub_f32 v234, v234, v42
  v_sub_f32 v235, v235, v42
  v_sub_f32 v236, v236, v42
  v_sub_f32 v237, v237, v42
  v_sub_f32 v238, v238, v42
  v_sub_f32 v239, v239, v42
  v_sub_f32 v192, v192, v42
  v_sub_f32 v193, v193, v42
  v_sub_f32 v194, v194, v42
  v_sub_f32 v195, v195, v42
  v_sub_f32 v196, v196, v42
  v_sub_f32 v197, v197, v42
  v_sub_f32 v198, v198, v42
  v_sub_f32 v199, v199, v42
  v_sub_f32 v200, v200, v42
  v_sub_f32 v201, v201, v42
  v_sub_f32 v202, v202, v42
  v_sub_f32 v203, v203, v42
  v_sub_f32 v204, v204, v42
  v_sub_f32 v205, v205, v42
  v_sub_f32 v206, v206, v42
  v_sub_f32 v207, v207, v42
  v_mul_f32 v80, v80, v43
  v_mul_f32 v81, v81, v43
  v_mul_f32 v82, v82, v43
  v_mul_f32 v83, v83, v43
  v_mul_f32 v84, v84, v43
  v_mul_f32 v85, v85, v43
  v_mul_f32 v86, v86, v43
  v_mul_f32 v87, v87, v43
  v_mul_f32 v88, v88, v43
  v_mul_f32 v89, v89, v43
  v_mul_f32 v90, v90, v43
  v_mul_f32 v91, v91, v43
  v_mul_f32 v92, v92, v43
  v_mul_f32 v93, v93, v43
  v_mul_f32 v94, v94, v43
  v_mul_f32 v95, v95, v43
  v_mul_f32 v96, v96, v43
  v_mul_f32 v97, v97, v43
  v_mul_f32 v98, v98, v43
  v_mul_f32 v99, v99, v43
  v_mul_f32 v100, v100, v43
  v_mul_f32 v101, v101, v43
  v_mul_f32 v102, v102, v43
  v_mul_f32 v103, v103, v43
  v_mul_f32 v104, v104, v43
  v_mul_f32 v105, v105, v43
  v_mul_f32 v106, v106, v43
  v_mul_f32 v107, v107, v43
  v_mul_f32 v108, v108, v43
  v_mul_f32 v109, v109, v43
  v_mul_f32 v110, v110, v43
  v_mul_f32 v111, v111, v43
  v_mul_f32 v112, v112, v43
  v_mul_f32 v113, v113, v43
  v_mul_f32 v114, v114, v43
  v_mul_f32 v115, v115, v43
  v_mul_f32 v116, v116, v43
  v_mul_f32 v117, v117, v43
  v_mul_f32 v118, v118, v43
  v_mul_f32 v119, v119, v43
  v_mul_f32 v120, v120, v43
  v_mul_f32 v121, v121, v43
  v_mul_f32 v122, v122, v43
  v_mul_f32 v123, v123, v43
  v_mul_f32 v124, v124, v43
  v_mul_f32 v125, v125, v43
  v_mul_f32 v126, v126, v43
  v_mul_f32 v127, v127, v43
  v_mul_f32 v128, v128, v43
  v_mul_f32 v129, v129, v43
  v_mul_f32 v130, v130, v43
  v_mul_f32 v131, v131, v43
  v_mul_f32 v132, v132, v43
  v_mul_f32 v133, v133, v43
  v_mul_f32 v134, v134, v43
  v_mul_f32 v135, v135, v43
  v_mul_f32 v136, v136, v43
  v_mul_f32 v137, v137, v43
  v_mul_f32 v138, v138, v43
  v_mul_f32 v139, v139, v43
  v_mul_f32 v140, v140, v43
  v_mul_f32 v141, v141, v43
  v_mul_f32 v142, v142, v43
  v_mul_f32 v143, v143, v43
  v_mul_f32 v34, v34, v43
  v_exp_f32 v38, v176
  v_exp_f32 v39, v177
  v_exp_f32 v40, v178
  v_exp_f32 v41, v179
  v_add_f32 v35, v38, v39
  v_cvt_pk_bf16_f32 v208, v38, v39
  v_exp_f32 v38, v180
  v_exp_f32 v39, v181
  v_add_f32 v36, v40, v41
  v_cvt_pk_bf16_f32 v209, v40, v41
  v_exp_f32 v40, v182
  v_exp_f32 v41, v183
  v_add_f32 v35, v35, v38
  v_add_f32 v36, v36, v39
  v_cvt_pk_bf16_f32 v210, v38, v39
  v_exp_f32 v38, v184
  v_exp_f32 v39, v185
  v_add_f32 v35, v35, v40
  v_add_f32 v36, v36, v41
  v_cvt_pk_bf16_f32 v211, v40, v41
  v_exp_f32 v40, v186
  v_exp_f32 v41, v187
  v_add_f32 v35, v35, v38
  v_add_f32 v36, v36, v39
  v_cvt_pk_bf16_f32 v212, v38, v39
  v_exp_f32 v38, v188
  v_exp_f32 v39, v189
  v_add_f32 v35, v35, v40
  v_add_f32 v36, v36, v41
  v_cvt_pk_bf16_f32 v213, v40, v41
  v_exp_f32 v40, v190
  v_exp_f32 v41, v191
  v_add_f32 v35, v35, v38
  v_add_f32 v36, v36, v39
  v_cvt_pk_bf16_f32 v214, v38, v39
  v_add_f32 v35, v35, v40
  v_add_f32 v36, v36, v41
  v_cvt_pk_bf16_f32 v215, v40, v41
  v_add_f32 v35, v35, v36
  s_nop 1
  s_branch k1_back10
k1_rare11:
  s_nop 7
  s_nop 7
  v_max3_f32 v42, v192, v193, v194
  v_max3_f32 v43, v195, v196, v197
  v_max3_f32 v42, v42, v198, v199
  v_max3_f32 v43, v43, v200, v201
  v_max3_f32 v42, v42, v202, v203
  v_max3_f32 v43, v43, v204, v205
  v_max3_f32 v42, v42, v206, v207
  v_max_f32 v42, v42, v43
  v_mov_b32 v43, v42
  s_nop 1
  v_permlane32_swap_b32 v43, v42
  v_max_f32 v42, v42, v43
  v_max_f32 v42, 0, v42
  v_ceil_f32 v42, v42
  v_sub_f32 v43, 0, v42
  v_exp_f32 v43, v43
  v_sub_f32 v192, v192, v42
  v_sub_f32 v193, v193, v42
  v_sub_f32 v194, v194, v42
  v_sub_f32 v195, v195, v42
  v_sub_f32 v196, v196, v42
  v_sub_f32 v197, v197, v42
  v_sub_f32 v198, v198, v42
  v_sub_f32 v199, v199, v42
  v_sub_f32 v200, v200, v42
  v_sub_f32 v201, v201, v42
  v_sub_f32 v202, v202, v42
  v_sub_f32 v203, v203, v42
  v_sub_f32 v204, v204, v42
  v_sub_f32 v205, v205, v42
  v_sub_f32 v206, v206, v42
  v_sub_f32 v207, v207, v42
  v_sub_f32 v224, v224, v42
  v_sub_f32 v225, v225, v42
  v_sub_f32 v226, v226, v42
  v_sub_f32 v227, v227, v42
  v_sub_f32 v228, v228, v42
  v_sub_f32 v229, v229, v42
  v_sub_f32 v230, v230, v42
  v_sub_f32 v231, v231, v42
  v_sub_f32 v232, v232, v42
  v_sub_f32 v233, v233, v42
  v_sub_f32 v234, v234, v42
  v_sub_f32 v235, v235, v42
  v_sub_f32 v236, v236, v42
  v_sub_f32 v237, v237, v42
  v_sub_f32 v238, v238, v42
  v_sub_f32 v239, v239, v42
  v_sub_f32 v176, v176, v42
  v_sub_f32 v177, v177, v42
  v_sub_f32 v178, v178, v42
  v_sub_f32 v179, v179, v42
  v_sub_f32 v180, v180, v42
  v_sub_f32 v181, v181, v42
  v_sub_f32 v182, v182, v42
  v_sub_f32 v183, v183, v42
  v_sub_f32 v184, v184, v42
  v_sub_f32 v185, v185, v42
  v_sub_f32 v186, v186, v42
  v_sub_f32 v187, v187, v42
  v_sub_f32 v188, v188, v42
  v_sub_f32 v189, v189, v42
  v_sub_f32 v190, v190, v42
  v_sub_f32 v191, v191, v42
  v_mul_f32 v80, v80, v43
  v_mul_f32 v81, v81, v43
  v_mul_f32 v82, v82, v43
  v_mul_f32 v83, v83, v43
  v_mul_f32 v84, v84, v43
  v_mul_f32 v85, v85, v43
  v_mul_f32 v86, v86, v43
  v_mul_f32 v87, v87, v43
  v_mul_f32 v88, v88, v43
  v_mul_f32 v89, v89, v43
  v_mul_f32 v90, v90, v43
  v_mul_f32 v91, v91, v43
  v_mul_f32 v92, v92, v43
  v_mul_f32 v93, v93, v43
  v_mul_f32 v94, v94, v43
  v_mul_f32 v95, v95, v43
  v_mul_f32 v96, v96, v43
  v_mul_f32 v97, v97, v43
  v_mul_f32 v98, v98, v43
  v_mul_f32 v99, v99, v43
  v_mul_f32 v100, v100, v43
  v_mul_f32 v101, v101, v43
  v_mul_f32 v102, v102, v43
  v_mul_f32 v103, v103, v43
  v_mul_f32 v104, v104, v43
  v_mul_f32 v105, v105, v43
  v_mul_f32 v106, v106, v43
  v_mul_f32 v107, v107, v43
  v_mul_f32 v108, v108, v43
  v_mul_f32 v109, v109, v43
  v_mul_f32 v110, v110, v43
  v_mul_f32 v111, v111, v43
  v_mul_f32 v112, v112, v43
  v_mul_f32 v113, v113, v43
  v_mul_f32 v114, v114, v43
  v_mul_f32 v115, v115, v43
  v_mul_f32 v116, v116, v43
  v_mul_f32 v117, v117, v43
  v_mul_f32 v118, v118, v43
  v_mul_f32 v119, v119, v43
  v_mul_f32 v120, v120, v43
  v_mul_f32 v121, v121, v43
  v_mul_f32 v122, v122, v43
  v_mul_f32 v123, v123, v43
  v_mul_f32 v124, v124, v43
  v_mul_f32 v125, v125, v43
  v_mul_f32 v126, v126, v43
  v_mul_f32 v127, v127, v43
  v_mul_f32 v128, v128, v43
  v_mul_f32 v129, v129, v43
  v_mul_f32 v130, v130, v43
  v_mul_f32 v131, v131, v43
  v_mul_f32 v132, v132, v43
  v_mul_f32 v133, v133, v43
  v_mul_f32 v134, v134, v43
  v_mul_f32 v135, v135, v43
  v_mul_f32 v136, v136, v43
  v_mul_f32 v137, v137, v43
  v_mul_f32 v138, v138, v43
  v_mul_f32 v139, v139, v43
  v_mul_f32 v140, v140, v43
  v_mul_f32 v141, v141, v43
  v_mul_f32 v142, v142, v43
  v_mul_f32 v143, v143, v43
  v_mul_f32 v34, v34, v43
  v_exp_f32 v38, v192
  v_exp_f32 v39, v193
  v_exp_f32 v40, v194
  v_exp_f32 v41, v195
  v_add_f32 v35, v38, v39
  v_cvt_pk_bf16_f32 v216, v38, v39
  v_exp_f32 v38, v196
  v_exp_f32 v39, v197
  v_add_f32 v36, v40, v41
  v_cvt_pk_bf16_f32 v217, v40, v41
  v_exp_f32 v40, v198
  v_exp_f32 v41, v199
  v_add_f32 v35, v35, v38
  v_add_f32 v36, v36, v39
  v_cvt_pk_bf16_f32 v218, v38, v39
  v_exp_f32 v38, v200
  v_exp_f32 v39, v201
  v_add_f32 v35, v35, v40
  v_add_f32 v36, v36, v41
  v_cvt_pk_bf16_f32 v219, v40, v41
  v_exp_f32 v40, v202
  v_exp_f32 v41, v203
  v_add_f32 v35, v35, v38
  v_add_f32 v36, v36, v39
  v_cvt_pk_bf16_f32 v220, v38, v39
  v_exp_f32 v38, v204
  v_exp_f32 v39, v205
  v_add_f32 v35, v35, v40
  v_add_f32 v36, v36, v41
  v_cvt_pk_bf16_f32 v221, v40, v41
  v_exp_f32 v40, v206
  v_exp_f32 v41, v207
  v_add_f32 v35, v35, v38
  v_add_f32 v36, v36, v39
  v_cvt_pk_bf16_f32 v222, v38, v39
  v_add_f32 v35, v35, v40
  v_add_f32 v36, v36, v41
  v_cvt_pk_bf16_f32 v223, v40, v41
  v_add_f32 v35, v35, v36
  s_nop 1
  s_branch k1_back11
k1_rare12:
  s_nop 7
  s_nop 7
  v_max3_f32 v42, v176, v177, v178
  v_max3_f32 v43, v179, v180, v181
  v_max3_f32 v42, v42, v182, v183
  v_max3_f32 v43, v43, v184, v185
  v_max3_f32 v42, v42, v186, v187
  v_max3_f32 v43, v43, v188, v189
  v_max3_f32 v42, v42, v190, v191
  v_max_f32 v42, v42, v43
  v_mov_b32 v43, v42
  s_nop 1
  v_permlane32_swap_b32 v43, v42
  v_max_f32 v42, v42, v43
  v_max_f32 v42, 0, v42
  v_ceil_f32 v42, v42
  v_sub_f32 v43, 0, v42
  v_exp_f32 v43, v43
  v_sub_f32 v176, v176, v42
  v_sub_f32 v177, v177, v42
  v_sub_f32 v178, v178, v42
  v_sub_f32 v179, v179, v42
  v_sub_f32 v180, v180, v42
  v_sub_f32 v181, v181, v42
  v_sub_f32 v182, v182, v42
  v_sub_f32 v183, v183, v42
  v_sub_f32 v184, v184, v42
  v_sub_f32 v185, v185, v42
  v_sub_f32 v186, v186, v42
  v_sub_f32 v187, v187, v42
  v_sub_f32 v188, v188, v42
  v_sub_f32 v189, v189, v42
  v_sub_f32 v190, v190, v42
  v_sub_f32 v191, v191, v42
  v_sub_f32 v224, v224, v42
  v_sub_f32 v225, v225, v42
  v_sub_f32 v226, v226, v42
  v_sub_f32 v227, v227, v42
  v_sub_f32 v228, v228, v42
  v_sub_f32 v229, v229, v42
  v_sub_f32 v230, v230, v42
  v_sub_f32 v231, v231, v42
  v_sub_f32 v232, v232, v42
  v_sub_f32 v233, v233, v42
  v_sub_f32 v234, v234, v42
  v_sub_f32 v235, v235, v42
  v_sub_f32 v236, v236, v42
  v_sub_f32 v237, v237, v42
  v_sub_f32 v238, v238, v42
  v_sub_f32 v239, v239, v42
  v_sub_f32 v192, v192, v42
  v_sub_f32 v193, v193, v42
  v_sub_f32 v194, v194, v42
  v_sub_f32 v195, v195, v42
  v_sub_f32 v196, v196, v42
  v_sub_f32 v197, v197, v42
  v_sub_f32 v198, v198, v42
  v_sub_f32 v199, v199, v42
  v_sub_f32 v200, v200, v42
  v_sub_f32 v201, v201, v42
  v_sub_f32 v202, v202, v42
  v_sub_f32 v203, v203, v42
  v_sub_f32 v204, v204, v42
  v_sub_f32 v205, v205, v42
  v_sub_f32 v206, v206, v42
  v_sub_f32 v207, v207, v42
  v_mul_f32 v80, v80, v43
  v_mul_f32 v81, v81, v43
  v_mul_f32 v82, v82, v43
  v_mul_f32 v83, v83, v43
  v_mul_f32 v84, v84, v43
  v_mul_f32 v85, v85, v43
  v_mul_f32 v86, v86, v43
  v_mul_f32 v87, v87, v43
  v_mul_f32 v88, v88, v43
  v_mul_f32 v89, v89, v43
  v_mul_f32 v90, v90, v43
  v_mul_f32 v91, v91, v43
  v_mul_f32 v92, v92, v43
  v_mul_f32 v93, v93, v43
  v_mul_f32 v94, v94, v43
  v_mul_f32 v95, v95, v43
  v_mul_f32 v96, v96, v43
  v_mul_f32 v97, v97, v43
  v_mul_f32 v98, v98, v43
  v_mul_f32 v99, v99, v43
  v_mul_f32 v100, v100, v43
  v_mul_f32 v101, v101, v43
  v_mul_f32 v102, v102, v43
  v_mul_f32 v103, v103, v43
  v_mul_f32 v104, v104, v43
  v_mul_f32 v105, v105, v43
  v_mul_f32 v106, v106, v43
  v_mul_f32 v107, v107, v43
  v_mul_f32 v108, v108, v43
  v_mul_f32 v109, v109, v43
  v_mul_f32 v110, v110, v43
  v_mul_f32 v111, v111, v43
  v_mul_f32 v112, v112, v43
  v_mul_f32 v113, v113, v43
  v_mul_f32 v114, v114, v43
  v_mul_f32 v115, v115, v43
  v_mul_f32 v116, v116, v43
  v_mul_f32 v117, v117, v43
  v_mul_f32 v118, v118, v43
  v_mul_f32 v119, v119, v43
  v_mul_f32 v120, v120, v43
  v_mul_f32 v121, v121, v43
  v_mul_f32 v122, v122, v43
  v_mul_f32 v123, v123, v43
  v_mul_f32 v124, v124, v43
  v_mul_f32 v125, v125, v43
  v_mul_f32 v126, v126, v43
  v_mul_f32 v127, v127, v43
  v_mul_f32 v128, v128, v43
  v_mul_f32 v129, v129, v43
  v_mul_f32 v130, v130, v43
  v_mul_f32 v131, v131, v43
  v_mul_f32 v132, v132, v43
  v_mul_f32 v133, v133, v43
  v_mul_f32 v134, v134, v43
  v_mul_f32 v135, v135, v43
  v_mul_f32 v136, v136, v43
  v_mul_f32 v137, v137, v43
  v_mul_f32 v138, v138, v43
  v_mul_f32 v139, v139, v43
  v_mul_f32 v140, v140, v43
  v_mul_f32 v141, v141, v43
  v_mul_f32 v142, v142, v43
  v_mul_f32 v143, v143, v43
  v_mul_f32 v34, v34, v43
  v_exp_f32 v38, v176
  v_exp_f32 v39, v177
  v_exp_f32 v40, v178
  v_exp_f32 v41, v179
  v_add_f32 v35, v38, v39
  v_cvt_pk_bf16_f32 v208, v38, v39
  v_exp_f32 v38, v180
  v_exp_f32 v39, v181
  v_add_f32 v36, v40, v41
  v_cvt_pk_bf16_f32 v209, v40, v41
  v_exp_f32 v40, v182
  v_exp_f32 v41, v183
  v_add_f32 v35, v35, v38
  v_add_f32 v36, v36, v39
  v_cvt_pk_bf16_f32 v210, v38, v39
  v_exp_f32 v38, v184
  v_exp_f32 v39, v185
  v_add_f32 v35, v35, v40
  v_add_f32 v36, v36, v41
  v_cvt_pk_bf16_f32 v211, v40, v41
  v_exp_f32 v40, v186
  v_exp_f32 v41, v187
  v_add_f32 v35, v35, v38
  v_add_f32 v36, v36, v39
  v_cvt_pk_bf16_f32 v212, v38, v39
  v_exp_f32 v38, v188
  v_exp_f32 v39, v189
  v_add_f32 v35, v35, v40
  v_add_f32 v36, v36, v41
  v_cvt_pk_bf16_f32 v213, v40, v41
  v_exp_f32 v40, v190
  v_exp_f32 v41, v191
  v_add_f32 v35, v35, v38
  v_add_f32 v36, v36, v39
  v_cvt_pk_bf16_f32 v214, v38, v39
  v_add_f32 v35, v35, v40
  v_add_f32 v36, v36, v41
  v_cvt_pk_bf16_f32 v215, v40, v41
  v_add_f32 v35, v35, v36
  s_nop 1
  s_branch k1_back12
k1_rare13:
  s_nop 7
  s_nop 7
  v_max3_f32 v42, v192, v193, v194
  v_max3_f32 v43, v195, v196, v197
  v_max3_f32 v42, v42, v198, v199
  v_max3_f32 v43, v43, v200, v201
  v_max3_f32 v42, v42, v202, v203
  v_max3_f32 v43, v43, v204, v205
  v_max3_f32 v42, v42, v206, v207
  v_max_f32 v42, v42, v43
  v_mov_b32 v43, v42
  s_nop 1
  v_permlane32_swap_b32 v43, v42
  v_max_f32 v42, v42, v43
  v_max_f32 v42, 0, v42
  v_ceil_f32 v42, v42
  v_sub_f32 v43, 0, v42
  v_exp_f32 v43, v43
  v_sub_f32 v192, v192, v42
  v_sub_f32 v193, v193, v42
  v_sub_f32 v194, v194, v42
  v_sub_f32 v195, v195, v42
  v_sub_f32 v196, v196, v42
  v_sub_f32 v197, v197, v42
  v_sub_f32 v198, v198, v42
  v_sub_f32 v199, v199, v42
  v_sub_f32 v200, v200, v42
  v_sub_f32 v201, v201, v42
  v_sub_f32 v202, v202, v42
  v_sub_f32 v203, v203, v42
  v_sub_f32 v204, v204, v42
  v_sub_f32 v205, v205, v42
  v_sub_f32 v206, v206, v42
  v_sub_f32 v207, v207, v42
  v_sub_f32 v224, v224, v42
  v_sub_f32 v225, v225, v42
  v_sub_f32 v226, v226, v42
  v_sub_f32 v227, v227, v42
  v_sub_f32 v228, v228, v42
  v_sub_f32 v229, v229, v42
  v_sub_f32 v230, v230, v42
  v_sub_f32 v231, v231, v42
  v_sub_f32 v232, v232, v42
  v_sub_f32 v233, v233, v42
  v_sub_f32 v234, v234, v42
  v_sub_f32 v235, v235, v42
  v_sub_f32 v236, v236, v42
  v_sub_f32 v237, v237, v42
  v_sub_f32 v238, v238, v42
  v_sub_f32 v239, v239, v42
  v_sub_f32 v176, v176, v42
  v_sub_f32 v177, v177, v42
  v_sub_f32 v178, v178, v42
  v_sub_f32 v179, v179, v42
  v_sub_f32 v180, v180, v42
  v_sub_f32 v181, v181, v42
  v_sub_f32 v182, v182, v42
  v_sub_f32 v183, v183, v42
  v_sub_f32 v184, v184, v42
  v_sub_f32 v185, v185, v42
  v_sub_f32 v186, v186, v42
  v_sub_f32 v187, v187, v42
  v_sub_f32 v188, v188, v42
  v_sub_f32 v189, v189, v42
  v_sub_f32 v190, v190, v42
  v_sub_f32 v191, v191, v42
  v_mul_f32 v80, v80, v43
  v_mul_f32 v81, v81, v43
  v_mul_f32 v82, v82, v43
  v_mul_f32 v83, v83, v43
  v_mul_f32 v84, v84, v43
  v_mul_f32 v85, v85, v43
  v_mul_f32 v86, v86, v43
  v_mul_f32 v87, v87, v43
  v_mul_f32 v88, v88, v43
  v_mul_f32 v89, v89, v43
  v_mul_f32 v90, v90, v43
  v_mul_f32 v91, v91, v43
  v_mul_f32 v92, v92, v43
  v_mul_f32 v93, v93, v43
  v_mul_f32 v94, v94, v43
  v_mul_f32 v95, v95, v43
  v_mul_f32 v96, v96, v43
  v_mul_f32 v97, v97, v43
  v_mul_f32 v98, v98, v43
  v_mul_f32 v99, v99, v43
  v_mul_f32 v100, v100, v43
  v_mul_f32 v101, v101, v43
  v_mul_f32 v102, v102, v43
  v_mul_f32 v103, v103, v43
  v_mul_f32 v104, v104, v43
  v_mul_f32 v105, v105, v43
  v_mul_f32 v106, v106, v43
  v_mul_f32 v107, v107, v43
  v_mul_f32 v108, v108, v43
  v_mul_f32 v109, v109, v43
  v_mul_f32 v110, v110, v43
  v_mul_f32 v111, v111, v43
  v_mul_f32 v112, v112, v43
  v_mul_f32 v113, v113, v43
  v_mul_f32 v114, v114, v43
  v_mul_f32 v115, v115, v43
  v_mul_f32 v116, v116, v43
  v_mul_f32 v117, v117, v43
  v_mul_f32 v118, v118, v43
  v_mul_f32 v119, v119, v43
  v_mul_f32 v120, v120, v43
  v_mul_f32 v121, v121, v43
  v_mul_f32 v122, v122, v43
  v_mul_f32 v123, v123, v43
  v_mul_f32 v124, v124, v43
  v_mul_f32 v125, v125, v43
  v_mul_f32 v126, v126, v43
  v_mul_f32 v127, v127, v43
  v_mul_f32 v128, v128, v43
  v_mul_f32 v129, v129, v43
  v_mul_f32 v130, v130, v43
  v_mul_f32 v131, v131, v43
  v_mul_f32 v132, v132, v43
  v_mul_f32 v133, v133, v43
  v_mul_f32 v134, v134, v43
  v_mul_f32 v135, v135, v43
  v_mul_f32 v136, v136, v43
  v_mul_f32 v137, v137, v43
  v_mul_f32 v138, v138, v43
  v_mul_f32 v139, v139, v43
  v_mul_f32 v140, v140, v43
  v_mul_f32 v141, v141, v43
  v_mul_f32 v142, v142, v43
  v_mul_f32 v143, v143, v43
  v_mul_f32 v34, v34, v43
  v_exp_f32 v38, v192
  v_exp_f32 v39, v193
  v_exp_f32 v40, v194
  v_exp_f32 v41, v195
  v_add_f32 v35, v38, v39
  v_cvt_pk_bf16_f32 v216, v38, v39
  v_exp_f32 v38, v196
  v_exp_f32 v39, v197
  v_add_f32 v36, v40, v41
  v_cvt_pk_bf16_f32 v217, v40, v41
  v_exp_f32 v40, v198
  v_exp_f32 v41, v199
  v_add_f32 v35, v35, v38
  v_add_f32 v36, v36, v39
  v_cvt_pk_bf16_f32 v218, v38, v39
  v_exp_f32 v38, v200
  v_exp_f32 v39, v201
  v_add_f32 v35, v35, v40
  v_add_f32 v36, v36, v41
  v_cvt_pk_bf16_f32 v219, v40, v41
  v_exp_f32 v40, v202
  v_exp_f32 v41, v203
  v_add_f32 v35, v35, v38
  v_add_f32 v36, v36, v39
  v_cvt_pk_bf16_f32 v220, v38, v39
  v_exp_f32 v38, v204
  v_exp_f32 v39, v205
  v_add_f32 v35, v35, v40
  v_add_f32 v36, v36, v41
  v_cvt_pk_bf16_f32 v221, v40, v41
  v_exp_f32 v40, v206
  v_exp_f32 v41, v207
  v_add_f32 v35, v35, v38
  v_add_f32 v36, v36, v39
  v_cvt_pk_bf16_f32 v222, v38, v39
  v_add_f32 v35, v35, v40
  v_add_f32 v36, v36, v41
  v_cvt_pk_bf16_f32 v223, v40, v41
  v_add_f32 v35, v35, v36
  s_nop 1
  s_branch k1_back13
k1_rare14:
  s_nop 7
  s_nop 7
  v_max3_f32 v42, v176, v177, v178
  v_max3_f32 v43, v179, v180, v181
  v_max3_f32 v42, v42, v182, v183
  v_max3_f32 v43, v43, v184, v185
  v_max3_f32 v42, v42, v186, v187
  v_max3_f32 v43, v43, v188, v189
  v_max3_f32 v42, v42, v190, v191
  v_max_f32 v42, v42, v43
  v_mov_b32 v43, v42
  s_nop 1
  v_permlane32_swap_b32 v43, v42
  v_max_f32 v42, v42, v43
  v_max_f32 v42, 0, v42
  v_ceil_f32 v42, v42
  v_sub_f32 v43, 0, v42
  v_exp_f32 v43, v43
  v_sub_f32 v176, v176, v42
  v_sub_f32 v177, v177, v42
  v_sub_f32 v178, v178, v42
  v_sub_f32 v179, v179, v42
  v_sub_f32 v180, v180, v42
  v_sub_f32 v181, v181, v42
  v_sub_f32 v182, v182, v42
  v_sub_f32 v183, v183, v42
  v_sub_f32 v184, v184, v42
  v_sub_f32 v185, v185, v42
  v_sub_f32 v186, v186, v42
  v_sub_f32 v187, v187, v42
  v_sub_f32 v188, v188, v42
  v_sub_f32 v189, v189, v42
  v_sub_f32 v190, v190, v42
  v_sub_f32 v191, v191, v42
  v_sub_f32 v224, v224, v42
  v_sub_f32 v225, v225, v42
  v_sub_f32 v226, v226, v42
  v_sub_f32 v227, v227, v42
  v_sub_f32 v228, v228, v42
  v_sub_f32 v229, v229, v42
  v_sub_f32 v230, v230, v42
  v_sub_f32 v231, v231, v42
  v_sub_f32 v232, v232, v42
  v_sub_f32 v233, v233, v42
  v_sub_f32 v234, v234, v42
  v_sub_f32 v235, v235, v42
  v_sub_f32 v236, v236, v42
  v_sub_f32 v237, v237, v42
  v_sub_f32 v238, v238, v42
  v_sub_f32 v239, v239, v42
  v_sub_f32 v192, v192, v42
  v_sub_f32 v193, v193, v42
  v_sub_f32 v194, v194, v42
  v_sub_f32 v195, v195, v42
  v_sub_f32 v196, v196, v42
  v_sub_f32 v197, v197, v42
  v_sub_f32 v198, v198, v42
  v_sub_f32 v199, v199, v42
  v_sub_f32 v200, v200, v42
  v_sub_f32 v201, v201, v42
  v_sub_f32 v202, v202, v42
  v_sub_f32 v203, v203, v42
  v_sub_f32 v204, v204, v42
  v_sub_f32 v205, v205, v42
  v_sub_f32 v206, v206, v42
  v_sub_f32 v207, v207, v42
  v_mul_f32 v80, v80, v43
  v_mul_f32 v81, v81, v43
  v_mul_f32 v82, v82, v43
  v_mul_f32 v83, v83, v43
  v_mul_f32 v84, v84, v43
  v_mul_f32 v85, v85, v43
  v_mul_f32 v86, v86, v43
  v_mul_f32 v87, v87, v43
  v_mul_f32 v88, v88, v43
  v_mul_f32 v89, v89, v43
  v_mul_f32 v90, v90, v43
  v_mul_f32 v91, v91, v43
  v_mul_f32 v92, v92, v43
  v_mul_f32 v93, v93, v43
  v_mul_f32 v94, v94, v43
  v_mul_f32 v95, v95, v43
  v_mul_f32 v96, v96, v43
  v_mul_f32 v97, v97, v43
  v_mul_f32 v98, v98, v43
  v_mul_f32 v99, v99, v43
  v_mul_f32 v100, v100, v43
  v_mul_f32 v101, v101, v43
  v_mul_f32 v102, v102, v43
  v_mul_f32 v103, v103, v43
  v_mul_f32 v104, v104, v43
  v_mul_f32 v105, v105, v43
  v_mul_f32 v106, v106, v43
  v_mul_f32 v107, v107, v43
  v_mul_f32 v108, v108, v43
  v_mul_f32 v109, v109, v43
  v_mul_f32 v110, v110, v43
  v_mul_f32 v111, v111, v43
  v_mul_f32 v112, v112, v43
  v_mul_f32 v113, v113, v43
  v_mul_f32 v114, v114, v43
  v_mul_f32 v115, v115, v43
  v_mul_f32 v116, v116, v43
  v_mul_f32 v117, v117, v43
  v_mul_f32 v118, v118, v43
  v_mul_f32 v119, v119, v43
  v_mul_f32 v120, v120, v43
  v_mul_f32 v121, v121, v43
  v_mul_f32 v122, v122, v43
  v_mul_f32 v123, v123, v43
  v_mul_f32 v124, v124, v43
  v_mul_f32 v125, v125, v43
  v_mul_f32 v126, v126, v43
  v_mul_f32 v127, v127, v43
  v_mul_f32 v128, v128, v43
  v_mul_f32 v129, v129, v43
  v_mul_f32 v130, v130, v43
  v_mul_f32 v131, v131, v43
  v_mul_f32 v132, v132, v43
  v_mul_f32 v133, v133, v43
  v_mul_f32 v134, v134, v43
  v_mul_f32 v135, v135, v43
  v_mul_f32 v136, v136, v43
  v_mul_f32 v137, v137, v43
  v_mul_f32 v138, v138, v43
  v_mul_f32 v139, v139, v43
  v_mul_f32 v140, v140, v43
  v_mul_f32 v141, v141, v43
  v_mul_f32 v142, v142, v43
  v_mul_f32 v143, v143, v43
  v_mul_f32 v34, v34, v43
  v_exp_f32 v38, v176
  v_exp_f32 v39, v177
  v_exp_f32 v40, v178
  v_exp_f32 v41, v179
  v_add_f32 v35, v38, v39
  v_cvt_pk_bf16_f32 v208, v38, v39
  v_exp_f32 v38, v180
  v_exp_f32 v39, v181
  v_add_f32 v36, v40, v41
  v_cvt_pk_bf16_f32 v209, v40, v41
  v_exp_f32 v40, v182
  v_exp_f32 v41, v183
  v_add_f32 v35, v35, v38
  v_add_f32 v36, v36, v39
  v_cvt_pk_bf16_f32 v210, v38, v39
  v_exp_f32 v38, v184
  v_exp_f32 v39, v185
  v_add_f32 v35, v35, v40
  v_add_f32 v36, v36, v41
  v_cvt_pk_bf16_f32 v211, v40, v41
  v_exp_f32 v40, v186
  v_exp_f32 v41, v187
  v_add_f32 v35, v35, v38
  v_add_f32 v36, v36, v39
  v_cvt_pk_bf16_f32 v212, v38, v39
  v_exp_f32 v38, v188
  v_exp_f32 v39, v189
  v_add_f32 v35, v35, v40
  v_add_f32 v36, v36, v41
  v_cvt_pk_bf16_f32 v213, v40, v41
  v_exp_f32 v40, v190
  v_exp_f32 v41, v191
  v_add_f32 v35, v35, v38
  v_add_f32 v36, v36, v39
  v_cvt_pk_bf16_f32 v214, v38, v39
  v_add_f32 v35, v35, v40
  v_add_f32 v36, v36, v41
  v_cvt_pk_bf16_f32 v215, v40, v41
  v_add_f32 v35, v35, v36
  s_nop 1
  s_branch k1_back14
k1_rare15:
  s_nop 7
  s_nop 7
  v_max3_f32 v42, v192, v193, v194
  v_max3_f32 v43, v195, v196, v197
  v_max3_f32 v42, v42, v198, v199
  v_max3_f32 v43, v43, v200, v201
  v_max3_f32 v42, v42, v202, v203
  v_max3_f32 v43, v43, v204, v205
  v_max3_f32 v42, v42, v206, v207
  v_max_f32 v42, v42, v43
  v_mov_b32 v43, v42
  s_nop 1
  v_permlane32_swap_b32 v43, v42
  v_max_f32 v42, v42, v43
  v_max_f32 v42, 0, v42
  v_ceil_f32 v42, v42
  v_sub_f32 v43, 0, v42
  v_exp_f32 v43, v43
  v_sub_f32 v192, v192, v42
  v_sub_f32 v193, v193, v42
  v_sub_f32 v194, v194, v42
  v_sub_f32 v195, v195, v42
  v_sub_f32 v196, v196, v42
  v_sub_f32 v197, v197, v42
  v_sub_f32 v198, v198, v42
  v_sub_f32 v199, v199, v42
  v_sub_f32 v200, v200, v42
  v_sub_f32 v201, v201, v42
  v_sub_f32 v202, v202, v42
  v_sub_f32 v203, v203, v42
  v_sub_f32 v204, v204, v42
  v_sub_f32 v205, v205, v42
  v_sub_f32 v206, v206, v42
  v_sub_f32 v207, v207, v42
  v_sub_f32 v224, v224, v42
  v_sub_f32 v225, v225, v42
  v_sub_f32 v226, v226, v42
  v_sub_f32 v227, v227, v42
  v_sub_f32 v228, v228, v42
  v_sub_f32 v229, v229, v42
  v_sub_f32 v230, v230, v42
  v_sub_f32 v231, v231, v42
  v_sub_f32 v232, v232, v42
  v_sub_f32 v233, v233, v42
  v_sub_f32 v234, v234, v42
  v_sub_f32 v235, v235, v42
  v_sub_f32 v236, v236, v42
  v_sub_f32 v237, v237, v42
  v_sub_f32 v238, v238, v42
  v_sub_f32 v239, v239, v42
  v_mul_f32 v80, v80, v43
  v_mul_f32 v81, v81, v43
  v_mul_f32 v82, v82, v43
  v_mul_f32 v83, v83, v43
  v_mul_f32 v84, v84, v43
  v_mul_f32 v85, v85, v43
  v_mul_f32 v86, v86, v43
  v_mul_f32 v87, v87, v43
  v_mul_f32 v88, v88, v43
  v_mul_f32 v89, v89, v43
  v_mul_f32 v90, v90, v43
  v_mul_f32 v91, v91, v43
  v_mul_f32 v92, v92, v43
  v_mul_f32 v93, v93, v43
  v_mul_f32 v94, v94, v43
  v_mul_f32 v95, v95, v43
  v_mul_f32 v96, v96, v43
  v_mul_f32 v97, v97, v43
  v_mul_f32 v98, v98, v43
  v_mul_f32 v99, v99, v43
  v_mul_f32 v100, v100, v43
  v_mul_f32 v101, v101, v43
  v_mul_f32 v102, v102, v43
  v_mul_f32 v103, v103, v43
  v_mul_f32 v104, v104, v43
  v_mul_f32 v105, v105, v43
  v_mul_f32 v106, v106, v43
  v_mul_f32 v107, v107, v43
  v_mul_f32 v108, v108, v43
  v_mul_f32 v109, v109, v43
  v_mul_f32 v110, v110, v43
  v_mul_f32 v111, v111, v43
  v_mul_f32 v112, v112, v43
  v_mul_f32 v113, v113, v43
  v_mul_f32 v114, v114, v43
  v_mul_f32 v115, v115, v43
  v_mul_f32 v116, v116, v43
  v_mul_f32 v117, v117, v43
  v_mul_f32 v118, v118, v43
  v_mul_f32 v119, v119, v43
  v_mul_f32 v120, v120, v43
  v_mul_f32 v121, v121, v43
  v_mul_f32 v122, v122, v43
  v_mul_f32 v123, v123, v43
  v_mul_f32 v124, v124, v43
  v_mul_f32 v125, v125, v43
  v_mul_f32 v126, v126, v43
  v_mul_f32 v127, v127, v43
  v_mul_f32 v128, v128, v43
  v_mul_f32 v129, v129, v43
  v_mul_f32 v130, v130, v43
  v_mul_f32 v131, v131, v43
  v_mul_f32 v132, v132, v43
  v_mul_f32 v133, v133, v43
  v_mul_f32 v134, v134, v43
  v_mul_f32 v135, v135, v43
  v_mul_f32 v136, v136, v43
  v_mul_f32 v137, v137, v43
  v_mul_f32 v138, v138, v43
  v_mul_f32 v139, v139, v43
  v_mul_f32 v140, v140, v43
  v_mul_f32 v141, v141, v43
  v_mul_f32 v142, v142, v43
  v_mul_f32 v143, v143, v43
  v_mul_f32 v34, v34, v43
  v_exp_f32 v38, v192
  v_exp_f32 v39, v193
  v_exp_f32 v40, v194
  v_exp_f32 v41, v195
  v_add_f32 v35, v38, v39
  v_cvt_pk_bf16_f32 v216, v38, v39
  v_exp_f32 v38, v196
  v_exp_f32 v39, v197
  v_add_f32 v36, v40, v41
  v_cvt_pk_bf16_f32 v217, v40, v41
  v_exp_f32 v40, v198
  v_exp_f32 v41, v199
  v_add_f32 v35, v35, v38
  v_add_f32 v36, v36, v39
  v_cvt_pk_bf16_f32 v218, v38, v39
  v_exp_f32 v38, v200
  v_exp_f32 v39, v201
  v_add_f32 v35, v35, v40
  v_add_f32 v36, v36, v41
  v_cvt_pk_bf16_f32 v219, v40, v41
  v_exp_f32 v40, v202
  v_exp_f32 v41, v203
  v_add_f32 v35, v35, v38
  v_add_f32 v36, v36, v39
  v_cvt_pk_bf16_f32 v220, v38, v39
  v_exp_f32 v38, v204
  v_exp_f32 v39, v205
  v_add_f32 v35, v35, v40
  v_add_f32 v36, v36, v41
  v_cvt_pk_bf16_f32 v221, v40, v41
  v_exp_f32 v40, v206
  v_exp_f32 v41, v207
  v_add_f32 v35, v35, v38
  v_add_f32 v36, v36, v39
  v_cvt_pk_bf16_f32 v222, v38, v39
  v_add_f32 v35, v35, v40
  v_add_f32 v36, v36, v41
  v_cvt_pk_bf16_f32 v223, v40, v41
  v_add_f32 v35, v35, v36
  s_nop 1
  s_branch k1_back15
.section .rodata,"a"
.p2align 6
.amdhsa_kernel k0_mod_kernel
  .amdhsa_next_free_vgpr 48
  .amdhsa_next_free_sgpr 102
  .amdhsa_accum_offset 48
  .amdhsa_group_segment_fixed_size 0
  .amdhsa_kernarg_size 112
  .amdhsa_user_sgpr_count 2
  .amdhsa_user_sgpr_kernarg_segment_ptr 1
  .amdhsa_system_sgpr_workgroup_id_x 1
.end_amdhsa_kernel
.p2align 6
.amdhsa_kernel kf_main_kernel
  .amdhsa_next_free_vgpr 256
  .amdhsa_next_free_sgpr 102
  .amdhsa_accum_offset 256
  .amdhsa_group_segment_fixed_size 0
  .amdhsa_kernarg_size 112
  .amdhsa_user_sgpr_count 2
  .amdhsa_user_sgpr_kernarg_segment_ptr 1
  .amdhsa_system_sgpr_workgroup_id_x 1
.end_amdhsa_kernel
```
